```python
import torch

def _softmax(x, axis=-1):
    return torch.softmax(x, dim=axis)
def _gelu(x):
    return torch.nn.functional.gelu(x, approximate="tanh")
def _silu(x):
    return torch.nn.functional.silu(x)
def _sigmoid(x):
    return torch.sigmoid(x)
def _layernorm(x, axis=-1, eps=1e-5):
    m = x.mean(dim=axis, keepdim=True)
    v = x.var(dim=axis, keepdim=True, unbiased=False)
    return (x - m) / torch.sqrt(v + eps)
def _scatter_add(tgt, idx, src, axis=0):
    return tgt.clone().index_add_(axis, idx, src)
def _segment_sum(src, seg, n):
    out = torch.zeros((n,) + src.shape[1:], dtype=src.dtype)
    return out.index_add_(0, seg, src)
def _pad(x, pw):
    flat = tuple(v for pair in reversed(pw) for v in pair)
    return torch.nn.functional.pad(x, flat)

kernel_name = 'parallel_sum__sliding_block__dense_activation_relu__prompt'

def setup_inputs():

    _w = (lambda a: (lambda t: t.to(torch.bfloat16) if t.is_floating_point() else t)(torch.as_tensor(a)))
    def _A_setup():
        B, S, D = 1, 2048, 576
        return {
            "x": _w((lambda *s: torch.randn(*s, dtype=torch.bfloat16) * 0.05)(B, S, D)),
            "wqkv": _w((lambda *s: torch.randn(*s, dtype=torch.bfloat16) * 0.1)(D, 3 * D)),
            "wo": _w((lambda *s: torch.randn(*s, dtype=torch.bfloat16) * 0.05)(D, D)),
        }
    _A_in = _A_setup()

    def _B_setup():
        B, S, D, Dff = 1, 2048, 576, 4608
        return {
            "x": _w((lambda *s: torch.randn(*s, dtype=torch.bfloat16) * 0.05)(B, S, D)),
            "w1": _w((lambda *s: torch.randn(*s, dtype=torch.bfloat16) * 0.05)(D, Dff)),
            "w2": _w((lambda *s: torch.randn(*s, dtype=torch.bfloat16) * 0.05)(Dff, D)),
        }
    _B_in = _B_setup()

    return {
        "A_x": _A_in["x"],
        "A_wqkv": _A_in["wqkv"],
        "A_wo": _A_in["wo"],
        "B_x": _B_in["x"],
        "B_w1": _B_in["w1"],
        "B_w2": _B_in["w2"],
    }

def reference(A_x, A_wqkv, A_wo, B_x, B_w1, B_w2):
    def _A_ref(x, wqkv, wo):
        B, S, D = x.shape
        H = 32; Dh = D // H; W = 256
        qkv = (lambda x, *d: x.permute(*d))((x @ wqkv).reshape(B, S, 3, H, Dh), 2, 0, 3, 1, 4)
        q, k, v = qkv[0], qkv[1], qkv[2]
        scores = torch.einsum("bhqd,bhkd->bhqk", q, k) * (Dh ** -0.5)
        idx = torch.arange(S)
        mask = (idx[:, None] - idx[None, :] >= 0) & (idx[:, None] - idx[None, :] < W)
        scores = torch.where(mask[None, None], scores, -1e9)
        p = _softmax(scores, axis=-1)
        o = torch.einsum("bhqk,bhkd->bhqd", p, v)
        return (lambda x, *d: x.permute(*d))(o, 0, 2, 1, 3).reshape(B, S, D) @ wo

    def _B_ref(x, w1, w2):
        h = torch.einsum("bsd,df->bsf", x, w1)
        zero = torch.zeros_like(h)
        h = torch.maximum(h, zero)
        return torch.einsum("bsf,fd->bsd", h, w2)

    x = A_x
    xn = _layernorm(x, axis=-1)
    return x + _A_ref(xn, A_wqkv, A_wo) + _B_ref(xn, B_w1, B_w2)
```

```asm
; @launch grid=(256,1,1) block=(512,1,1) lds=163840
.amdgcn_target "amdgcn-amd-amdhsa--gfx950"
.text
.globl parallel_sum__sliding_block__dense_activation_relu__prompt_kernel
.p2align 8
.type parallel_sum__sliding_block__dense_activation_relu__prompt_kernel,@function
parallel_sum__sliding_block__dense_activation_relu__prompt_kernel:
    s_cmp_ge_u32 s2, 256
    s_cbranch_scc1 L_exit
    s_load_dwordx2 s[4:5], s[0:1], 0
    s_load_dwordx2 s[8:9], s[0:1], 8
    s_load_dwordx2 s[12:13], s[0:1], 16
    s_load_dwordx2 s[16:17], s[0:1], 32
    s_load_dwordx2 s[20:21], s[0:1], 40
    s_load_dwordx4 s[32:35], s[0:1], 48
    s_load_dwordx2 s[36:37], s[0:1], 64
    v_lshrrev_b32 v2, 6, v0
    v_and_b32 v1, 63, v0
    s_nop 0
    v_readfirstlane_b32 s40, v2
    s_getpc_b64 s[82:83]
L_pc:
    s_lshr_b32 s42, s2, 3
    s_lshl_b32 s42, s42, 3
    s_add_u32 s42, s42, s40
    s_lshl_b32 s42, s42, 9
    s_min_u32 s42, s42, L_exit-L_pc-384
    v_and_b32_e64 v239, 3, v1
    v_lshl_add_u32 v239, v239, 7, s42
    global_load_dword v91, v239, s[82:83]
    s_and_b32 s38, s2, 3
    s_lshl_b32 s38, s38, 1
    s_bfe_u32 s42, s2, 0x10003
    s_add_u32 s38, s38, s42
    s_lshr_b32 s97, s2, 4
    s_bfe_u32 s42, s2, 0x10002
    s_lshl_b32 s42, s42, 4
    s_add_u32 s39, s97, s42
    v_lshrrev_b32 v236, 3, v1
    v_and_b32 v237, 7, v1
    s_lshl_b32 s42, s39, 3
    s_add_u32 s42, s42, s40
    s_mul_i32 s42, s42, 9216
    v_mul_u32_u24 v238, 1152, v236
    v_lshl_add_u32 v238, v237, 4, v238
    v_add_u32 v238, s42, v238
    s_waitcnt lgkmcnt(0)
    global_load_dwordx4 v[92:95], v238, s[4:5] offset:0
    global_load_dwordx4 v[96:99], v238, s[4:5] offset:128
    global_load_dwordx4 v[100:103], v238, s[4:5] offset:256
    global_load_dwordx4 v[104:107], v238, s[4:5] offset:384
    global_load_dwordx4 v[108:111], v238, s[4:5] offset:512
    global_load_dwordx4 v[112:115], v238, s[4:5] offset:640
    global_load_dwordx4 v[116:119], v238, s[4:5] offset:768
    global_load_dwordx4 v[120:123], v238, s[4:5] offset:896
    global_load_dwordx4 v[124:127], v238, s[4:5] offset:1024
    s_lshl_b32 s42, s38, 7
    v_add_u32 v238, s42, v238
    global_load_dwordx4 v[128:131], v238, s[4:5]
    s_mov_b32 s92, 0xc7ffffff
    s_mov_b32 s93, 0x1ffffff
    s_movk_i32 s94, 0x3f80
    s_mov_b32 s95, 0x3f800000
    s_mov_b32 s10, 1990656
    s_mov_b32 s11, 0x20000
    s_mov_b32 s14, 663552
    s_mov_b32 s15, 0x20000
    s_mov_b32 s18, 5308416
    s_mov_b32 s19, 0x20000
    s_mov_b32 s22, 5308416
    s_mov_b32 s23, 0x20000
    s_mov_b32 s26, 294912
    s_mov_b32 s27, 0x20000
    s_mov_b32 s30, 294912
    s_mov_b32 s31, 0x20000
    s_mov_b32 s70, 589824
    s_mov_b32 s71, 0x20000
    s_and_b32 s41, s40, 3
    s_lshl_b32 s46, s41, 10
    s_mul_i32 s96, s41, 960
    s_mul_i32 s72, s38, 144
    s_mul_i32 s73, s38, 1152
    s_mul_i32 s74, s38, 663552
    s_mul_i32 s75, s38, 82944
    s_mul_i32 s42, s41, 9216
    s_add_u32 s76, s75, 73728
    s_sub_u32 s76, s76, s42
    s_lshl_b32 s42, s41, 4
    s_mov_b64 s[78:79], 0xffff
    s_lshl_b64 s[78:79], s[78:79], s42
    s_mov_b32 s80, 0x3eae1a93
    s_mov_b32 s81, 0xf149f2ca
    s_mov_b32 s87, 0xffff0000
    s_mul_i32 s42, s39, 57
    s_lshr_b32 s42, s42, 9
    s_mul_i32 s42, s42, 9
    s_sub_u32 s48, s39, s42
    s_add_u32 s49, s48, 1
    s_cmp_eq_u32 s49, 9
    s_cselect_b32 s49, 0, s49
    s_add_u32 s50, s49, 1
    s_cmp_eq_u32 s50, 9
    s_cselect_b32 s50, 0, s50
    s_add_u32 s51, s50, 1
    s_cmp_eq_u32 s51, 9
    s_cselect_b32 s51, 0, s51
    s_add_u32 s52, s51, 1
    s_cmp_eq_u32 s52, 9
    s_cselect_b32 s52, 0, s52
    s_add_u32 s53, s52, 1
    s_cmp_eq_u32 s53, 9
    s_cselect_b32 s53, 0, s53
    s_add_u32 s54, s53, 1
    s_cmp_eq_u32 s54, 9
    s_cselect_b32 s54, 0, s54
    s_add_u32 s55, s54, 1
    s_cmp_eq_u32 s55, 9
    s_cselect_b32 s55, 0, s55
    s_add_u32 s56, s55, 1
    s_cmp_eq_u32 s56, 9
    s_cselect_b32 s56, 0, s56
    s_mul_i32 s42, s39, 37
    s_lshr_b32 s42, s42, 8
    s_mul_i32 s42, s42, 7
    s_sub_u32 s42, s39, s42
    s_movk_i32 s58, 1024
    s_lshl_b32 s66, s38, 7
    s_add_u32 s43, s42, s38
    s_add_u32 s43, s43, 1
    s_and_b32 s43, s43, 7
    s_lshl_b32 s59, s43, 7
    s_add_u32 s42, s42, 1
    s_cmp_eq_u32 s42, 7
    s_cselect_b32 s42, 0, s42
    s_add_u32 s43, s42, s38
    s_add_u32 s43, s43, 1
    s_and_b32 s43, s43, 7
    s_lshl_b32 s60, s43, 7
    s_add_u32 s42, s42, 1
    s_cmp_eq_u32 s42, 7
    s_cselect_b32 s42, 0, s42
    s_add_u32 s43, s42, s38
    s_add_u32 s43, s43, 1
    s_and_b32 s43, s43, 7
    s_lshl_b32 s61, s43, 7
    s_add_u32 s42, s42, 1
    s_cmp_eq_u32 s42, 7
    s_cselect_b32 s42, 0, s42
    s_add_u32 s43, s42, s38
    s_add_u32 s43, s43, 1
    s_and_b32 s43, s43, 7
    s_lshl_b32 s62, s43, 7
    s_add_u32 s42, s42, 1
    s_cmp_eq_u32 s42, 7
    s_cselect_b32 s42, 0, s42
    s_add_u32 s43, s42, s38
    s_add_u32 s43, s43, 1
    s_and_b32 s43, s43, 7
    s_lshl_b32 s63, s43, 7
    s_add_u32 s42, s42, 1
    s_cmp_eq_u32 s42, 7
    s_cselect_b32 s42, 0, s42
    s_add_u32 s43, s42, s38
    s_add_u32 s43, s43, 1
    s_and_b32 s43, s43, 7
    s_lshl_b32 s64, s43, 7
    s_add_u32 s42, s42, 1
    s_cmp_eq_u32 s42, 7
    s_cselect_b32 s42, 0, s42
    s_add_u32 s43, s42, s38
    s_add_u32 s43, s43, 1
    s_and_b32 s43, s43, 7
    s_lshl_b32 s65, s43, 7
    s_add_u32 s42, s42, 1
    s_cmp_eq_u32 s42, 7
    s_cselect_b32 s42, 0, s42
    s_mul_i32 s42, s38, 294912
    s_add_u32 s24, s36, s42
    s_addc_u32 s25, s37, 0
    s_add_u32 s28, s24, 2359296
    s_addc_u32 s29, s25, 0
    s_mul_i32 s42, s39, 589824
    s_add_u32 s42, s42, 4784128
    s_add_u32 s68, s36, s42
    s_addc_u32 s69, s37, 0
    v_lshrrev_b32 v238, 4, v1
    v_lshrrev_b32_e64 v240, 4, v1
    v_bfe_u32 v241, v1, 1, 2
    v_xor_b32 v241, v241, v240
    v_and_b32 v242, 1, v1
    v_lshlrev_b32 v242, 4, v242
    s_lshl_b32 s42, s41, 3
    v_add_u32_e64 v243, s42, v236
    v_lshl_add_u32 v244, v241, 5, v242
    s_movk_i32 s43, 9216
    v_mad_u32_u24 v10, v243, s43, v244
    s_movk_i32 s43, 1152
    v_mad_u32_u24 v11, v243, s43, v244
    v_cmp_le_u32 vcc, 30, v1
    v_subrev_u32 v241, 30, v1
    v_mov_b32 v242, 0
    v_cndmask_b32 v241, v1, v241, vcc
    v_cndmask_b32 v242, v242, 1, vcc
    s_add_u32 s42, s72, 1008
    v_lshlrev_b32 v243, 4, v241
    v_add_u32 v240, s42, v243
    v_cmp_lt_u32 vcc, 8, v241
    s_nop 1
    v_cndmask_b32 v243, v243, v240, vcc
    s_lshl_b32 s42, s41, 1
    v_add_u32 v242, s42, v242
    s_movk_i32 s43, 3456
    v_mad_u32_u24 v8, v242, s43, v243
    s_cmp_lg_u32 s2, 0
    s_cbranch_scc1 L_nn
    s_cmp_lg_u32 s40, 4
    s_cbranch_scc1 L_nn
    s_memrealtime s[98:99]
    s_waitcnt lgkmcnt(0)
    s_or_b32 s98, s98, 1
    v_mov_b32 v240, s98
    v_mov_b32 v241, s99
    v_mov_b32 v242, 0
    s_mov_b64 exec, 1
    global_store_dwordx2 v242, v[240:241], s[34:35] sc1
    s_mov_b64 exec, -1
L_nn:
    v_lshrrev_b32 v240, 2, v1
    v_bfe_u32 v241, v1, 3, 2
    v_and_b32 v242, 3, v1
    v_xor_b32 v2, s41, v241
    v_lshlrev_b32_e64 v2, 5, v2
    v_lshl_add_u32 v2, v240, 7, v2
    v_lshl_add_u32 v2, v242, 3, v2
    v_add_u32 v3, 49152, v2
    v_add_u32 v4, 98304, v2
    v_mul_u32_u24 v240, 480, v240
    s_add_u32 s42, s41, 1
    s_lshr_b32 s42, s42, 1
    s_lshl_b32 s42, s42, 3
    s_lshl_b32 s43, s41, 5
    s_add_u32 s42, s42, s43
    v_lshl_add_u32 v5, v242, 3, v240
    v_add_u32_e64 v5, s42, v5
    s_lshr_b32 s42, s41, 1
    s_mul_i32 s42, s42, 72
    s_add_u32 s42, s42, 32
    s_mul_i32 s43, s41, 72
    s_add_u32 s43, s43, 144
    v_lshl_add_u32 v52, v242, 3, v240
    v_add_u32 v52, s43, v52
    s_add_u32 s43, s43, 32
    s_sub_u32 s43, s43, s42
    v_min_u32_e64 v242, 1, v242
    v_mad_u32_u24 v242, v242, s43, v240
    v_add_u32_e64 v6, s42, v242
    v_add_u32 v48, 52224, v5
    v_add_u32 v49, 52224, v6
    v_add_u32 v53, 52224, v52
    v_add_u32 v50, 104448, v5
    v_add_u32 v51, 104448, v6
    v_add_u32 v54, 104448, v52
    v_lshlrev_b32 v7, 4, v1
    s_lshr_b32 s42, s40, 2
    s_mul_i32 s42, s42, 36864
    v_add_u32 v7, s42, v7
    s_lshr_b32 s42, s40, 1
    s_mul_i32 s42, s42, 18432
    s_and_b32 s43, s40, 1
    s_lshl_b32 s43, s43, 7
    s_add_u32 s42, s42, s43
    v_and_b32 v240, 1, v237
    v_lshlrev_b32 v12, 1, v240
    v_and_b32 v241, 4, v237
    v_or_b32 v12, v12, v241
    v_xor_b32 v12, v12, v236
    v_lshl_add_u32 v12, v12, 4, s42
    v_lshl_add_u32 v12, v240, 9, v12
    v_lshl_add_u32 v12, v241, 8, v12
    v_bfe_u32 v240, v237, 1, 1
    v_lshl_add_u32 v12, v240, 3, v12
    v_lshrrev_b32 v240, 5, v1
    v_lshlrev_b32 v240, 5, v240
    v_xor_b32 v14, v240, v7
    v_xor_b32 v15, 64, v14
    v_mov_b32 v244, 0x3f803f80
    v_mov_b32 v240, 0
    v_mov_b32 v242, 0
    v_mov_b32 v241, 0
    v_mov_b32 v243, 0
    s_waitcnt vmcnt(0)
    s_lshl_b32 s42, s40, 10
    s_add_u32 s42, s42, 155648
    v_lshl_add_u32 v245, v1, 4, s42
    ds_write_b128 v245, v[128:131]
    s_cmp_ge_u32 s40, 4
    s_cbranch_scc1 L_npq
    s_lshl_b32 s42, s41, 6
    v_add_u32_e64 v252, s42, v1
    s_mul_i32 s43, s97, 36
    v_min_u32 v253, 179, v252
    v_mul_u32_u24 v254, 205, v253
    v_lshrrev_b32 v254, 10, v254
    v_mul_u32_u24 v255, 5, v254
    v_sub_u32 v253, v253, v255
    v_add_u32 v254, s43, v254
    v_mul_u32_u24 v254, 3456, v254
    v_lshl_add_u32 v254, v253, 7, v254
    s_add_u32 s42, s72, 896
    v_add_u32 v255, s42, v254
    v_cmp_lt_u32 vcc, 1, v253
    s_nop 1
    v_cndmask_b32 v254, v254, v255, vcc
    buffer_load_dword v88, v254, s[8:11], s72 offen
L_npq:
    v_dot2_f32_bf16 v240, v92, v244, v240
    v_dot2_f32_bf16 v242, v92, v92, v242
    v_dot2_f32_bf16 v241, v93, v244, v241
    v_dot2_f32_bf16 v243, v93, v93, v243
    v_dot2_f32_bf16 v240, v94, v244, v240
    v_dot2_f32_bf16 v242, v94, v94, v242
    v_dot2_f32_bf16 v241, v95, v244, v241
    v_dot2_f32_bf16 v243, v95, v95, v243
    v_dot2_f32_bf16 v240, v96, v244, v240
    v_dot2_f32_bf16 v242, v96, v96, v242
    v_dot2_f32_bf16 v241, v97, v244, v241
    v_dot2_f32_bf16 v243, v97, v97, v243
    v_dot2_f32_bf16 v240, v98, v244, v240
    v_dot2_f32_bf16 v242, v98, v98, v242
    v_dot2_f32_bf16 v241, v99, v244, v241
    v_dot2_f32_bf16 v243, v99, v99, v243
    v_dot2_f32_bf16 v240, v100, v244, v240
    v_dot2_f32_bf16 v242, v100, v100, v242
    v_dot2_f32_bf16 v241, v101, v244, v241
    v_dot2_f32_bf16 v243, v101, v101, v243
    v_dot2_f32_bf16 v240, v102, v244, v240
    v_dot2_f32_bf16 v242, v102, v102, v242
    v_dot2_f32_bf16 v241, v103, v244, v241
    v_dot2_f32_bf16 v243, v103, v103, v243
    v_dot2_f32_bf16 v240, v104, v244, v240
    v_dot2_f32_bf16 v242, v104, v104, v242
    v_dot2_f32_bf16 v241, v105, v244, v241
    v_dot2_f32_bf16 v243, v105, v105, v243
    v_dot2_f32_bf16 v240, v106, v244, v240
    v_dot2_f32_bf16 v242, v106, v106, v242
    v_dot2_f32_bf16 v241, v107, v244, v241
    v_dot2_f32_bf16 v243, v107, v107, v243
    v_dot2_f32_bf16 v240, v108, v244, v240
    v_dot2_f32_bf16 v242, v108, v108, v242
    v_dot2_f32_bf16 v241, v109, v244, v241
    v_dot2_f32_bf16 v243, v109, v109, v243
    v_dot2_f32_bf16 v240, v110, v244, v240
    v_dot2_f32_bf16 v242, v110, v110, v242
    v_dot2_f32_bf16 v241, v111, v244, v241
    v_dot2_f32_bf16 v243, v111, v111, v243
    v_dot2_f32_bf16 v240, v112, v244, v240
    v_dot2_f32_bf16 v242, v112, v112, v242
    v_dot2_f32_bf16 v241, v113, v244, v241
    v_dot2_f32_bf16 v243, v113, v113, v243
    v_dot2_f32_bf16 v240, v114, v244, v240
    v_dot2_f32_bf16 v242, v114, v114, v242
    v_dot2_f32_bf16 v241, v115, v244, v241
    v_dot2_f32_bf16 v243, v115, v115, v243
    v_dot2_f32_bf16 v240, v116, v244, v240
    v_dot2_f32_bf16 v242, v116, v116, v242
    v_dot2_f32_bf16 v241, v117, v244, v241
    v_dot2_f32_bf16 v243, v117, v117, v243
    v_dot2_f32_bf16 v240, v118, v244, v240
    v_dot2_f32_bf16 v242, v118, v118, v242
    v_dot2_f32_bf16 v241, v119, v244, v241
    v_dot2_f32_bf16 v243, v119, v119, v243
    v_dot2_f32_bf16 v240, v120, v244, v240
    v_dot2_f32_bf16 v242, v120, v120, v242
    v_dot2_f32_bf16 v241, v121, v244, v241
    v_dot2_f32_bf16 v243, v121, v121, v243
    v_dot2_f32_bf16 v240, v122, v244, v240
    v_dot2_f32_bf16 v242, v122, v122, v242
    v_dot2_f32_bf16 v241, v123, v244, v241
    v_dot2_f32_bf16 v243, v123, v123, v243
    v_dot2_f32_bf16 v240, v124, v244, v240
    v_dot2_f32_bf16 v242, v124, v124, v242
    v_dot2_f32_bf16 v241, v125, v244, v241
    v_dot2_f32_bf16 v243, v125, v125, v243
    v_dot2_f32_bf16 v240, v126, v244, v240
    v_dot2_f32_bf16 v242, v126, v126, v242
    v_dot2_f32_bf16 v241, v127, v244, v241
    v_dot2_f32_bf16 v243, v127, v127, v243
    s_nop 2
    v_add_f32 v240, v240, v241
    v_add_f32 v242, v242, v243
    s_nop 1
    v_add_f32 v240, v240, v240 quad_perm:[1,0,3,2]
    v_add_f32 v242, v242, v242 quad_perm:[1,0,3,2]
    s_nop 0
    v_add_f32 v240, v240, v240 quad_perm:[2,3,0,1]
    v_add_f32 v242, v242, v242 quad_perm:[2,3,0,1]
    s_nop 0
    v_add_f32 v240, v240, v240 row_half_mirror
    v_add_f32 v242, v242, v242 row_half_mirror
    s_nop 0
    v_mul_f32 v240, 0x3ae38e39, v240
    v_mul_f32 v242, 0x3ae38e39, v242
    v_fma_f32 v242, -v240, v240, v242
    v_max_f32 v242, 0, v242
    v_cvt_pk_bf16_f32 v240, v240, v240
    v_and_b32_e64 v240, s87, v240
    v_cvt_pk_bf16_f32 v242, v242, v242
    v_and_b32_e64 v242, s87, v242
    v_add_f32 v242, 0x3727c5ac, v242
    v_cvt_pk_bf16_f32 v242, v242, v242
    v_and_b32_e64 v242, s87, v242
    v_sqrt_f32 v242, v242
    s_nop 0
    v_cvt_pk_bf16_f32 v242, v242, v242
    v_and_b32 v242, s87, v242
    v_rcp_f32 v242, v242
    v_sub_f32_e64 v240, 0, v240
    v_dot2_f32_bf16 v132, v92, s94, v240
    v_dot2_f32_bf16 v133, v92, s95, v240
    v_dot2_f32_bf16 v134, v93, s94, v240
    v_dot2_f32_bf16 v135, v93, s95, v240
    v_dot2_f32_bf16 v136, v94, s94, v240
    v_dot2_f32_bf16 v137, v94, s95, v240
    v_dot2_f32_bf16 v138, v95, s94, v240
    v_dot2_f32_bf16 v139, v95, s95, v240
    v_dot2_f32_bf16 v140, v96, s94, v240
    v_dot2_f32_bf16 v141, v96, s95, v240
    v_dot2_f32_bf16 v142, v97, s94, v240
    v_dot2_f32_bf16 v143, v97, s95, v240
    v_dot2_f32_bf16 v144, v98, s94, v240
    v_dot2_f32_bf16 v145, v98, s95, v240
    v_dot2_f32_bf16 v146, v99, s94, v240
    v_dot2_f32_bf16 v147, v99, s95, v240
    v_cvt_pk_bf16_f32 v92, v132, v133
    v_cvt_pk_bf16_f32 v93, v134, v135
    v_cvt_pk_bf16_f32 v94, v136, v137
    v_cvt_pk_bf16_f32 v95, v138, v139
    v_lshlrev_b32 v132, 16, v92
    v_and_b32 v133, s87, v92
    v_lshlrev_b32 v134, 16, v93
    v_and_b32 v135, s87, v93
    v_lshlrev_b32 v136, 16, v94
    v_and_b32 v137, s87, v94
    v_lshlrev_b32 v138, 16, v95
    v_and_b32 v139, s87, v95
    v_pk_mul_f32 v[132:133], v[132:133], v[242:243] op_sel_hi:[1,0]
    v_pk_mul_f32 v[134:135], v[134:135], v[242:243] op_sel_hi:[1,0]
    v_pk_mul_f32 v[136:137], v[136:137], v[242:243] op_sel_hi:[1,0]
    v_pk_mul_f32 v[138:139], v[138:139], v[242:243] op_sel_hi:[1,0]
    v_dot2_f32_bf16 v148, v100, s94, v240
    v_dot2_f32_bf16 v149, v100, s95, v240
    v_dot2_f32_bf16 v150, v101, s94, v240
    v_dot2_f32_bf16 v151, v101, s95, v240
    v_dot2_f32_bf16 v152, v102, s94, v240
    v_dot2_f32_bf16 v153, v102, s95, v240
    v_dot2_f32_bf16 v154, v103, s94, v240
    v_dot2_f32_bf16 v155, v103, s95, v240
    v_cvt_pk_bf16_f32 v92, v132, v133
    v_cvt_pk_bf16_f32 v93, v134, v135
    v_cvt_pk_bf16_f32 v94, v136, v137
    v_cvt_pk_bf16_f32 v95, v138, v139
    ds_write_b64 v12, v[92:93] offset:0
    ds_write_b64 v12, v[94:95] offset:256
    v_cvt_pk_bf16_f32 v96, v140, v141
    v_cvt_pk_bf16_f32 v97, v142, v143
    v_cvt_pk_bf16_f32 v98, v144, v145
    v_cvt_pk_bf16_f32 v99, v146, v147
    v_lshlrev_b32 v140, 16, v96
    v_and_b32 v141, s87, v96
    v_lshlrev_b32 v142, 16, v97
    v_and_b32 v143, s87, v97
    v_lshlrev_b32 v144, 16, v98
    v_and_b32 v145, s87, v98
    v_lshlrev_b32 v146, 16, v99
    v_and_b32 v147, s87, v99
    v_pk_mul_f32 v[140:141], v[140:141], v[242:243] op_sel_hi:[1,0]
    v_pk_mul_f32 v[142:143], v[142:143], v[242:243] op_sel_hi:[1,0]
    v_pk_mul_f32 v[144:145], v[144:145], v[242:243] op_sel_hi:[1,0]
    v_pk_mul_f32 v[146:147], v[146:147], v[242:243] op_sel_hi:[1,0]
    v_dot2_f32_bf16 v132, v104, s94, v240
    v_dot2_f32_bf16 v133, v104, s95, v240
    v_dot2_f32_bf16 v134, v105, s94, v240
    v_dot2_f32_bf16 v135, v105, s95, v240
    v_dot2_f32_bf16 v136, v106, s94, v240
    v_dot2_f32_bf16 v137, v106, s95, v240
    v_dot2_f32_bf16 v138, v107, s94, v240
    v_dot2_f32_bf16 v139, v107, s95, v240
    v_cvt_pk_bf16_f32 v96, v140, v141
    v_cvt_pk_bf16_f32 v97, v142, v143
    v_cvt_pk_bf16_f32 v98, v144, v145
    v_cvt_pk_bf16_f32 v99, v146, v147
    ds_write_b64 v12, v[96:97] offset:2048
    ds_write_b64 v12, v[98:99] offset:2304
    v_cvt_pk_bf16_f32 v100, v148, v149
    v_cvt_pk_bf16_f32 v101, v150, v151
    v_cvt_pk_bf16_f32 v102, v152, v153
    v_cvt_pk_bf16_f32 v103, v154, v155
    v_lshlrev_b32 v148, 16, v100
    v_and_b32 v149, s87, v100
    v_lshlrev_b32 v150, 16, v101
    v_and_b32 v151, s87, v101
    v_lshlrev_b32 v152, 16, v102
    v_and_b32 v153, s87, v102
    v_lshlrev_b32 v154, 16, v103
    v_and_b32 v155, s87, v103
    v_pk_mul_f32 v[148:149], v[148:149], v[242:243] op_sel_hi:[1,0]
    v_pk_mul_f32 v[150:151], v[150:151], v[242:243] op_sel_hi:[1,0]
    v_pk_mul_f32 v[152:153], v[152:153], v[242:243] op_sel_hi:[1,0]
    v_pk_mul_f32 v[154:155], v[154:155], v[242:243] op_sel_hi:[1,0]
    v_dot2_f32_bf16 v140, v108, s94, v240
    v_dot2_f32_bf16 v141, v108, s95, v240
    v_dot2_f32_bf16 v142, v109, s94, v240
    v_dot2_f32_bf16 v143, v109, s95, v240
    v_dot2_f32_bf16 v144, v110, s94, v240
    v_dot2_f32_bf16 v145, v110, s95, v240
    v_dot2_f32_bf16 v146, v111, s94, v240
    v_dot2_f32_bf16 v147, v111, s95, v240
    v_cvt_pk_bf16_f32 v100, v148, v149
    v_cvt_pk_bf16_f32 v101, v150, v151
    v_cvt_pk_bf16_f32 v102, v152, v153
    v_cvt_pk_bf16_f32 v103, v154, v155
    ds_write_b64 v12, v[100:101] offset:4096
    ds_write_b64 v12, v[102:103] offset:4352
    v_cvt_pk_bf16_f32 v104, v132, v133
    v_cvt_pk_bf16_f32 v105, v134, v135
    v_cvt_pk_bf16_f32 v106, v136, v137
    v_cvt_pk_bf16_f32 v107, v138, v139
    v_lshlrev_b32 v132, 16, v104
    v_and_b32 v133, s87, v104
    v_lshlrev_b32 v134, 16, v105
    v_and_b32 v135, s87, v105
    v_lshlrev_b32 v136, 16, v106
    v_and_b32 v137, s87, v106
    v_lshlrev_b32 v138, 16, v107
    v_and_b32 v139, s87, v107
    v_pk_mul_f32 v[132:133], v[132:133], v[242:243] op_sel_hi:[1,0]
    v_pk_mul_f32 v[134:135], v[134:135], v[242:243] op_sel_hi:[1,0]
    v_pk_mul_f32 v[136:137], v[136:137], v[242:243] op_sel_hi:[1,0]
    v_pk_mul_f32 v[138:139], v[138:139], v[242:243] op_sel_hi:[1,0]
    v_dot2_f32_bf16 v148, v112, s94, v240
    v_dot2_f32_bf16 v149, v112, s95, v240
    v_dot2_f32_bf16 v150, v113, s94, v240
    v_dot2_f32_bf16 v151, v113, s95, v240
    v_dot2_f32_bf16 v152, v114, s94, v240
    v_dot2_f32_bf16 v153, v114, s95, v240
    v_dot2_f32_bf16 v154, v115, s94, v240
    v_dot2_f32_bf16 v155, v115, s95, v240
    v_cvt_pk_bf16_f32 v104, v132, v133
    v_cvt_pk_bf16_f32 v105, v134, v135
    v_cvt_pk_bf16_f32 v106, v136, v137
    v_cvt_pk_bf16_f32 v107, v138, v139
    ds_write_b64 v12, v[104:105] offset:6144
    ds_write_b64 v12, v[106:107] offset:6400
    v_cvt_pk_bf16_f32 v108, v140, v141
    v_cvt_pk_bf16_f32 v109, v142, v143
    v_cvt_pk_bf16_f32 v110, v144, v145
    v_cvt_pk_bf16_f32 v111, v146, v147
    v_lshlrev_b32 v140, 16, v108
    v_and_b32 v141, s87, v108
    v_lshlrev_b32 v142, 16, v109
    v_and_b32 v143, s87, v109
    v_lshlrev_b32 v144, 16, v110
    v_and_b32 v145, s87, v110
    v_lshlrev_b32 v146, 16, v111
    v_and_b32 v147, s87, v111
    v_pk_mul_f32 v[140:141], v[140:141], v[242:243] op_sel_hi:[1,0]
    v_pk_mul_f32 v[142:143], v[142:143], v[242:243] op_sel_hi:[1,0]
    v_pk_mul_f32 v[144:145], v[144:145], v[242:243] op_sel_hi:[1,0]
    v_pk_mul_f32 v[146:147], v[146:147], v[242:243] op_sel_hi:[1,0]
    v_dot2_f32_bf16 v132, v116, s94, v240
    v_dot2_f32_bf16 v133, v116, s95, v240
    v_dot2_f32_bf16 v134, v117, s94, v240
    v_dot2_f32_bf16 v135, v117, s95, v240
    v_dot2_f32_bf16 v136, v118, s94, v240
    v_dot2_f32_bf16 v137, v118, s95, v240
    v_dot2_f32_bf16 v138, v119, s94, v240
    v_dot2_f32_bf16 v139, v119, s95, v240
    v_cvt_pk_bf16_f32 v108, v140, v141
    v_cvt_pk_bf16_f32 v109, v142, v143
    v_cvt_pk_bf16_f32 v110, v144, v145
    v_cvt_pk_bf16_f32 v111, v146, v147
    ds_write_b64 v12, v[108:109] offset:8192
    ds_write_b64 v12, v[110:111] offset:8448
    v_cvt_pk_bf16_f32 v112, v148, v149
    v_cvt_pk_bf16_f32 v113, v150, v151
    v_cvt_pk_bf16_f32 v114, v152, v153
    v_cvt_pk_bf16_f32 v115, v154, v155
    v_lshlrev_b32 v148, 16, v112
    v_and_b32 v149, s87, v112
    v_lshlrev_b32 v150, 16, v113
    v_and_b32 v151, s87, v113
    v_lshlrev_b32 v152, 16, v114
    v_and_b32 v153, s87, v114
    v_lshlrev_b32 v154, 16, v115
    v_and_b32 v155, s87, v115
    v_pk_mul_f32 v[148:149], v[148:149], v[242:243] op_sel_hi:[1,0]
    v_pk_mul_f32 v[150:151], v[150:151], v[242:243] op_sel_hi:[1,0]
    v_pk_mul_f32 v[152:153], v[152:153], v[242:243] op_sel_hi:[1,0]
    v_pk_mul_f32 v[154:155], v[154:155], v[242:243] op_sel_hi:[1,0]
    v_dot2_f32_bf16 v140, v120, s94, v240
    v_dot2_f32_bf16 v141, v120, s95, v240
    v_dot2_f32_bf16 v142, v121, s94, v240
    v_dot2_f32_bf16 v143, v121, s95, v240
    v_dot2_f32_bf16 v144, v122, s94, v240
    v_dot2_f32_bf16 v145, v122, s95, v240
    v_dot2_f32_bf16 v146, v123, s94, v240
    v_dot2_f32_bf16 v147, v123, s95, v240
    v_cvt_pk_bf16_f32 v112, v148, v149
    v_cvt_pk_bf16_f32 v113, v150, v151
    v_cvt_pk_bf16_f32 v114, v152, v153
    v_cvt_pk_bf16_f32 v115, v154, v155
    ds_write_b64 v12, v[112:113] offset:10240
    ds_write_b64 v12, v[114:115] offset:10496
    v_cvt_pk_bf16_f32 v116, v132, v133
    v_cvt_pk_bf16_f32 v117, v134, v135
    v_cvt_pk_bf16_f32 v118, v136, v137
    v_cvt_pk_bf16_f32 v119, v138, v139
    v_lshlrev_b32 v132, 16, v116
    v_and_b32 v133, s87, v116
    v_lshlrev_b32 v134, 16, v117
    v_and_b32 v135, s87, v117
    v_lshlrev_b32 v136, 16, v118
    v_and_b32 v137, s87, v118
    v_lshlrev_b32 v138, 16, v119
    v_and_b32 v139, s87, v119
    v_pk_mul_f32 v[132:133], v[132:133], v[242:243] op_sel_hi:[1,0]
    v_pk_mul_f32 v[134:135], v[134:135], v[242:243] op_sel_hi:[1,0]
    v_pk_mul_f32 v[136:137], v[136:137], v[242:243] op_sel_hi:[1,0]
    v_pk_mul_f32 v[138:139], v[138:139], v[242:243] op_sel_hi:[1,0]
    v_dot2_f32_bf16 v148, v124, s94, v240
    v_dot2_f32_bf16 v149, v124, s95, v240
    v_dot2_f32_bf16 v150, v125, s94, v240
    v_dot2_f32_bf16 v151, v125, s95, v240
    v_dot2_f32_bf16 v152, v126, s94, v240
    v_dot2_f32_bf16 v153, v126, s95, v240
    v_dot2_f32_bf16 v154, v127, s94, v240
    v_dot2_f32_bf16 v155, v127, s95, v240
    v_cvt_pk_bf16_f32 v116, v132, v133
    v_cvt_pk_bf16_f32 v117, v134, v135
    v_cvt_pk_bf16_f32 v118, v136, v137
    v_cvt_pk_bf16_f32 v119, v138, v139
    ds_write_b64 v12, v[116:117] offset:12288
    ds_write_b64 v12, v[118:119] offset:12544
    v_cvt_pk_bf16_f32 v120, v140, v141
    v_cvt_pk_bf16_f32 v121, v142, v143
    v_cvt_pk_bf16_f32 v122, v144, v145
    v_cvt_pk_bf16_f32 v123, v146, v147
    v_lshlrev_b32 v140, 16, v120
    v_and_b32 v141, s87, v120
    v_lshlrev_b32 v142, 16, v121
    v_and_b32 v143, s87, v121
    v_lshlrev_b32 v144, 16, v122
    v_and_b32 v145, s87, v122
    v_lshlrev_b32 v146, 16, v123
    v_and_b32 v147, s87, v123
    v_pk_mul_f32 v[140:141], v[140:141], v[242:243] op_sel_hi:[1,0]
    v_pk_mul_f32 v[142:143], v[142:143], v[242:243] op_sel_hi:[1,0]
    v_pk_mul_f32 v[144:145], v[144:145], v[242:243] op_sel_hi:[1,0]
    v_pk_mul_f32 v[146:147], v[146:147], v[242:243] op_sel_hi:[1,0]
    v_cvt_pk_bf16_f32 v120, v140, v141
    v_cvt_pk_bf16_f32 v121, v142, v143
    v_cvt_pk_bf16_f32 v122, v144, v145
    v_cvt_pk_bf16_f32 v123, v146, v147
    ds_write_b64 v12, v[120:121] offset:14336
    ds_write_b64 v12, v[122:123] offset:14592
    v_cvt_pk_bf16_f32 v124, v148, v149
    v_cvt_pk_bf16_f32 v125, v150, v151
    v_cvt_pk_bf16_f32 v126, v152, v153
    v_cvt_pk_bf16_f32 v127, v154, v155
    v_lshlrev_b32 v148, 16, v124
    v_and_b32 v149, s87, v124
    v_lshlrev_b32 v150, 16, v125
    v_and_b32 v151, s87, v125
    v_lshlrev_b32 v152, 16, v126
    v_and_b32 v153, s87, v126
    v_lshlrev_b32 v154, 16, v127
    v_and_b32 v155, s87, v127
    v_pk_mul_f32 v[148:149], v[148:149], v[242:243] op_sel_hi:[1,0]
    v_pk_mul_f32 v[150:151], v[150:151], v[242:243] op_sel_hi:[1,0]
    v_pk_mul_f32 v[152:153], v[152:153], v[242:243] op_sel_hi:[1,0]
    v_pk_mul_f32 v[154:155], v[154:155], v[242:243] op_sel_hi:[1,0]
    v_cvt_pk_bf16_f32 v124, v148, v149
    v_cvt_pk_bf16_f32 v125, v150, v151
    v_cvt_pk_bf16_f32 v126, v152, v153
    v_cvt_pk_bf16_f32 v127, v154, v155
    ds_write_b64 v12, v[124:125] offset:16384
    ds_write_b64 v12, v[126:127] offset:16640
    s_cmp_ge_u32 s40, 4
    s_cbranch_scc1 LS_start
    s_add_u32 m0, s96, 73728
    s_add_u32 s47, s72, 0
    s_mov_b64 exec, s[92:93]
    buffer_load_dwordx4 v8, s[8:11], s47 offen lds
    s_mov_b64 exec, -1
    s_add_u32 m0, s96, 77568
    s_add_u32 s47, s72, 27648
    s_mov_b64 exec, s[92:93]
    buffer_load_dwordx4 v8, s[8:11], s47 offen lds
    s_mov_b64 exec, -1
    s_add_u32 m0, s96, 81408
    s_add_u32 s47, s72, 55296
    s_mov_b64 exec, s[92:93]
    buffer_load_dwordx4 v8, s[8:11], s47 offen lds
    s_mov_b64 exec, -1
    s_add_u32 m0, s96, 85248
    s_add_u32 s47, s72, 82944
    s_mov_b64 exec, s[92:93]
    buffer_load_dwordx4 v8, s[8:11], s47 offen lds
    s_mov_b64 exec, -1
    s_add_u32 m0, s96, 89088
    s_add_u32 s47, s72, 110592
    s_mov_b64 exec, s[92:93]
    buffer_load_dwordx4 v8, s[8:11], s47 offen lds
    s_mov_b64 exec, -1
    s_add_u32 m0, s96, 92928
    s_add_u32 s47, s72, 138240
    s_mov_b64 exec, s[92:93]
    buffer_load_dwordx4 v8, s[8:11], s47 offen lds
    s_mov_b64 exec, -1
    s_add_u32 m0, s96, 96768
    s_add_u32 s47, s72, 165888
    s_mov_b64 exec, s[92:93]
    buffer_load_dwordx4 v8, s[8:11], s47 offen lds
    s_mov_b64 exec, -1
    s_add_u32 m0, s96, 100608
    s_add_u32 s47, s72, 193536
    s_mov_b64 exec, s[92:93]
    buffer_load_dwordx4 v8, s[8:11], s47 offen lds
    s_mov_b64 exec, -1
    s_add_u32 m0, s96, 104448
    s_add_u32 s47, s72, 221184
    s_mov_b64 exec, s[92:93]
    buffer_load_dwordx4 v8, s[8:11], s47 offen lds
    s_mov_b64 exec, -1
    s_add_u32 m0, s96, 108288
    s_add_u32 s47, s72, 248832
    s_mov_b64 exec, s[92:93]
    buffer_load_dwordx4 v8, s[8:11], s47 offen lds
    s_mov_b64 exec, -1
    s_add_u32 m0, s96, 112128
    s_add_u32 s47, s72, 276480
    s_mov_b64 exec, s[92:93]
    buffer_load_dwordx4 v8, s[8:11], s47 offen lds
    s_mov_b64 exec, -1
    s_add_u32 m0, s96, 115968
    s_add_u32 s47, s72, 304128
    s_mov_b64 exec, s[92:93]
    buffer_load_dwordx4 v8, s[8:11], s47 offen lds
    s_mov_b64 exec, -1
    s_add_u32 m0, s96, 122880
    s_add_u32 s47, s72, 331776
    s_mov_b64 exec, s[92:93]
    buffer_load_dwordx4 v8, s[8:11], s47 offen lds
    s_mov_b64 exec, -1
    s_add_u32 m0, s96, 126720
    s_add_u32 s47, s72, 359424
    s_mov_b64 exec, s[92:93]
    buffer_load_dwordx4 v8, s[8:11], s47 offen lds
    s_mov_b64 exec, -1
    s_add_u32 m0, s96, 130560
    s_add_u32 s47, s72, 387072
    s_mov_b64 exec, s[92:93]
    buffer_load_dwordx4 v8, s[8:11], s47 offen lds
    s_mov_b64 exec, -1
    s_add_u32 m0, s96, 134400
    s_add_u32 s47, s72, 414720
    s_mov_b64 exec, s[92:93]
    buffer_load_dwordx4 v8, s[8:11], s47 offen lds
    s_mov_b64 exec, -1
    s_add_u32 m0, s96, 138240
    s_add_u32 s47, s72, 442368
    s_mov_b64 exec, s[92:93]
    buffer_load_dwordx4 v8, s[8:11], s47 offen lds
    s_mov_b64 exec, -1
    s_add_u32 m0, s96, 142080
    s_add_u32 s47, s72, 470016
    s_mov_b64 exec, s[92:93]
    buffer_load_dwordx4 v8, s[8:11], s47 offen lds
    s_mov_b64 exec, -1
    s_add_u32 m0, s96, 145920
    s_add_u32 s47, s72, 497664
    s_mov_b64 exec, s[92:93]
    buffer_load_dwordx4 v8, s[8:11], s47 offen lds
    s_mov_b64 exec, -1
    s_add_u32 m0, s96, 149760
    s_add_u32 s47, s72, 525312
    s_mov_b64 exec, s[92:93]
    buffer_load_dwordx4 v8, s[8:11], s47 offen lds
    s_mov_b64 exec, -1
    s_lshl_b32 s42, s41, 6
    s_add_u32 s42, s42, 0
    v_add_u32 v252, s42, v1
    s_mul_i32 s43, s97, 24
    s_add_u32 s43, s43, 0
    v_min_u32 v253, 215, v252
    v_mul_u32_u24 v254, 456, v253
    v_lshrrev_b32 v254, 12, v254
    v_mul_u32_u24 v255, 9, v254
    v_sub_u32 v253, v253, v255
    v_add_u32 v254, s43, v254
    v_mul_u32_u24 v254, 9216, v254
    v_lshl_add_u32 v254, v253, 7, v254
    buffer_load_dword v89, v254, s[16:19], s73 offen
    s_lshl_b32 s42, s41, 10
    s_waitcnt lgkmcnt(0)
    s_lshr_b32 s42, s41, 1
    s_mul_i32 s42, s42, 9216
    s_and_b32 s43, s41, 1
    s_lshl_b32 s43, s43, 11
    s_add_u32 s42, s42, s43
    s_add_u32 s42, s42, 122880
    s_lshl_b32 s42, s38, 6
    s_add_u32 s42, s42, s39
    s_lshr_b32 s43, s41, 1
    s_lshl_b32 s43, s43, 5
    s_add_u32 s42, s42, s43
    s_mul_i32 s42, s42, 9216
    s_add_u32 s42, s42, 0
    s_add_u32 s82, s36, s42
    s_addc_u32 s83, s37, 0
    s_and_b32 s43, s41, 1
    s_lshl_b32 s43, s43, 11
    v_lshl_add_u32 v13, v1, 4, s43
    v_and_b32_e64 v12, 1, v1
    v_mul_u32_u24 v12, 504, v12
    v_lshl_add_u32 v12, v1, 3, v12
    v_add_u32_e64 v12, s43, v12
    s_waitcnt vmcnt(17)
    s_barrier
    ds_read_b128 v[92:95], v14 offset:0
    ds_read_b128 v[96:99], v14 offset:18432
    ds_read_b128 v[100:103], v15 offset:1024
    ds_read_b128 v[104:107], v15 offset:19456
    ds_read_b128 v[108:111], v14 offset:2048
    ds_read_b128 v[112:115], v14 offset:20480
    ds_read_b128 v[116:119], v15 offset:3072
    ds_read_b128 v[120:123], v15 offset:21504
    ds_read_b64_tr_b16 v[16:17], v48 offset:21504
    ds_read_b64_tr_b16 v[18:19], v48 offset:29184
    ds_read_b128 v[124:127], v14 offset:4096
    ds_read_b128 v[128:131], v14 offset:22528
    ds_read_b128 v[132:135], v15 offset:5120
    ds_read_b128 v[136:139], v15 offset:23552
    ds_read_b128 v[140:143], v14 offset:6144
    ds_read_b128 v[144:147], v14 offset:24576
    ds_read_b128 v[148:151], v15 offset:7168
    ds_read_b128 v[152:155], v15 offset:25600
    ds_read_b128 v[156:159], v14 offset:8192
    ds_read_b128 v[160:163], v14 offset:26624
    ds_read_b64_tr_b16 v[20:21], v53 offset:21504
    ds_read_b64_tr_b16 v[22:23], v53 offset:29184
    ds_read_b128 v[164:167], v15 offset:9216
    ds_read_b128 v[168:171], v15 offset:27648
    ds_read_b128 v[172:175], v14 offset:10240
    ds_read_b128 v[176:179], v14 offset:28672
    ds_read_b128 v[180:183], v15 offset:11264
    ds_read_b128 v[184:187], v15 offset:29696
    ds_read_b128 v[188:191], v14 offset:12288
    ds_read_b128 v[192:195], v14 offset:30720
    ds_read_b128 v[196:199], v15 offset:13312
    ds_read_b128 v[200:203], v15 offset:31744
    ds_read_b64_tr_b16 v[24:25], v53 offset:21544
    ds_read_b64_tr_b16 v[26:27], v53 offset:29224
    v_mfma_f32_16x16x32_bf16 v[56:59], v[16:19], v[92:95], 0
    ds_read_b128 v[204:207], v14 offset:14336
    ds_read_b128 v[208:211], v14 offset:32768
    ds_read_b128 v[212:215], v15 offset:15360
    ds_read_b128 v[216:219], v15 offset:33792
    ds_read_b128 v[220:223], v14 offset:16384
    ds_read_b128 v[224:227], v14 offset:34816
    ds_read_b128 v[228:231], v15 offset:17408
    ds_read_b128 v[232:235], v15 offset:35840
    ds_read_b64_tr_b16 v[28:29], v49 offset:21504
    v_mfma_f32_16x16x32_bf16 v[60:63], v[16:19], v[96:99], 0
    ds_read_b64_tr_b16 v[30:31], v49 offset:29184
    s_waitcnt lgkmcnt(2)
    s_waitcnt vmcnt(13)
    s_barrier
    s_bitcmp1_b32 s38, 2
    s_cbranch_scc1 LD_odd
    v_mfma_f32_16x16x32_bf16 v[64:67], v[20:23], v[92:95], 0
    ds_read_b64_tr_b16 v[16:17], v48 offset:36864
    s_add_u32 m0, s96, 52224
    s_add_u32 s47, s72, 552960
    s_mov_b64 exec, s[92:93]
    buffer_load_dwordx4 v8, s[8:11], s47 offen lds
    s_mov_b64 exec, -1
    v_mfma_f32_16x16x32_bf16 v[68:71], v[20:23], v[96:99], 0
    ds_read_b64_tr_b16 v[18:19], v48 offset:44544
    s_add_u32 m0, s96, 56064
    s_add_u32 s47, s72, 580608
    s_mov_b64 exec, s[92:93]
    buffer_load_dwordx4 v8, s[8:11], s47 offen lds
    s_mov_b64 exec, -1
    v_mfma_f32_16x16x32_bf16 v[72:75], v[24:27], v[92:95], 0
    ds_read_b64_tr_b16 v[20:21], v53 offset:36864
    s_add_u32 m0, s96, 59904
    s_add_u32 s47, s72, 608256
    s_mov_b64 exec, s[92:93]
    buffer_load_dwordx4 v8, s[8:11], s47 offen lds
    s_mov_b64 exec, -1
    v_mfma_f32_16x16x32_bf16 v[76:79], v[24:27], v[96:99], 0
    ds_read_b64_tr_b16 v[22:23], v53 offset:44544
    s_add_u32 m0, s96, 63744
    s_add_u32 s47, s72, 635904
    s_mov_b64 exec, s[92:93]
    buffer_load_dwordx4 v8, s[8:11], s47 offen lds
    s_mov_b64 exec, -1
    s_waitcnt lgkmcnt(4)
    v_mfma_f32_16x16x32_bf16 v[80:83], v[28:31], v[92:95], 0
    ds_read_b64_tr_b16 v[24:25], v53 offset:36904
    s_add_u32 m0, s96, 0
    s_add_u32 s47, s72, 663552
    s_mov_b64 exec, s[92:93]
    buffer_load_dwordx4 v8, s[8:11], s47 offen lds
    s_mov_b64 exec, -1
    v_mfma_f32_16x16x32_bf16 v[84:87], v[28:31], v[96:99], 0
    ds_read_b64_tr_b16 v[26:27], v53 offset:44584
    s_add_u32 m0, s96, 3840
    s_add_u32 s47, s72, 691200
    s_mov_b64 exec, s[92:93]
    buffer_load_dwordx4 v8, s[8:11], s47 offen lds
    s_mov_b64 exec, -1
    s_waitcnt lgkmcnt(4)
    v_mfma_f32_16x16x32_bf16 v[56:59], v[16:19], v[100:103], v[56:59]
    ds_read_b64_tr_b16 v[28:29], v49 offset:36864
    s_add_u32 m0, s96, 7680
    s_add_u32 s47, s72, 718848
    s_mov_b64 exec, s[92:93]
    buffer_load_dwordx4 v8, s[8:11], s47 offen lds
    s_mov_b64 exec, -1
    v_mfma_f32_16x16x32_bf16 v[60:63], v[16:19], v[104:107], v[60:63]
    ds_read_b64_tr_b16 v[30:31], v49 offset:44544
    s_add_u32 m0, s96, 11520
    s_add_u32 s47, s72, 746496
    s_mov_b64 exec, s[92:93]
    buffer_load_dwordx4 v8, s[8:11], s47 offen lds
    s_mov_b64 exec, -1
    s_waitcnt vmcnt(17)
    s_barrier
    s_waitcnt lgkmcnt(4)
    v_mfma_f32_16x16x32_bf16 v[64:67], v[20:23], v[100:103], v[64:67]
    ds_read_b64_tr_b16 v[16:17], v50 offset:0
    s_add_u32 m0, s96, 15360
    s_add_u32 s47, s72, 774144
    s_mov_b64 exec, s[92:93]
    buffer_load_dwordx4 v8, s[8:11], s47 offen lds
    s_mov_b64 exec, -1
    v_mfma_f32_16x16x32_bf16 v[68:71], v[20:23], v[104:107], v[68:71]
    ds_read_b64_tr_b16 v[18:19], v50 offset:7680
    s_add_u32 m0, s96, 19200
    s_add_u32 s47, s72, 801792
    s_mov_b64 exec, s[92:93]
    buffer_load_dwordx4 v8, s[8:11], s47 offen lds
    s_mov_b64 exec, -1
    s_waitcnt lgkmcnt(4)
    v_mfma_f32_16x16x32_bf16 v[72:75], v[24:27], v[100:103], v[72:75]
    ds_read_b64_tr_b16 v[20:21], v54 offset:0
    s_add_u32 m0, s96, 23040
    s_add_u32 s47, s72, 829440
    s_mov_b64 exec, s[92:93]
    buffer_load_dwordx4 v8, s[8:11], s47 offen lds
    s_mov_b64 exec, -1
    v_mfma_f32_16x16x32_bf16 v[76:79], v[24:27], v[104:107], v[76:79]
    ds_read_b64_tr_b16 v[22:23], v54 offset:7680
    s_add_u32 m0, s96, 26880
    s_add_u32 s47, s72, 857088
    s_mov_b64 exec, s[92:93]
    buffer_load_dwordx4 v8, s[8:11], s47 offen lds
    s_mov_b64 exec, -1
    s_waitcnt lgkmcnt(4)
    v_mfma_f32_16x16x32_bf16 v[80:83], v[28:31], v[100:103], v[80:83]
    ds_read_b64_tr_b16 v[24:25], v54 offset:40
    s_add_u32 m0, s96, 30720
    s_add_u32 s47, s72, 884736
    s_mov_b64 exec, s[92:93]
    buffer_load_dwordx4 v8, s[8:11], s47 offen lds
    s_mov_b64 exec, -1
    v_mfma_f32_16x16x32_bf16 v[84:87], v[28:31], v[104:107], v[84:87]
    ds_read_b64_tr_b16 v[26:27], v54 offset:7720
    s_add_u32 m0, s96, 34560
    s_add_u32 s47, s72, 912384
    s_mov_b64 exec, s[92:93]
    buffer_load_dwordx4 v8, s[8:11], s47 offen lds
    s_mov_b64 exec, -1
    s_waitcnt lgkmcnt(4)
    v_mfma_f32_16x16x32_bf16 v[56:59], v[16:19], v[108:111], v[56:59]
    ds_read_b64_tr_b16 v[28:29], v51 offset:0
    s_add_u32 m0, s96, 38400
    s_add_u32 s47, s72, 940032
    s_mov_b64 exec, s[92:93]
    buffer_load_dwordx4 v8, s[8:11], s47 offen lds
    s_mov_b64 exec, -1
    v_mfma_f32_16x16x32_bf16 v[60:63], v[16:19], v[112:115], v[60:63]
    ds_read_b64_tr_b16 v[30:31], v51 offset:7680
    s_add_u32 m0, s96, 42240
    s_add_u32 s47, s72, 967680
    s_mov_b64 exec, s[92:93]
    buffer_load_dwordx4 v8, s[8:11], s47 offen lds
    s_mov_b64 exec, -1
    s_waitcnt vmcnt(21)
    s_barrier
    s_waitcnt lgkmcnt(4)
    v_mfma_f32_16x16x32_bf16 v[64:67], v[20:23], v[108:111], v[64:67]
    ds_read_b64_tr_b16 v[16:17], v50 offset:18432
    s_lshl_b32 s45, s48, 7
    s_add_u32 s45, s45, s73
    s_add_u32 m0, s46, 73728
    s_add_u32 s47, s45, 0
    buffer_load_dwordx4 v10, s[16:19], s47 offen lds
    v_mfma_f32_16x16x32_bf16 v[68:71], v[20:23], v[112:115], v[68:71]
    ds_read_b64_tr_b16 v[18:19], v50 offset:26112
    s_add_u32 m0, s46, 77824
    s_add_u32 s47, s45, 294912
    buffer_load_dwordx4 v10, s[16:19], s47 offen lds
    s_waitcnt lgkmcnt(4)
    v_mfma_f32_16x16x32_bf16 v[72:75], v[24:27], v[108:111], v[72:75]
    ds_read_b64_tr_b16 v[20:21], v54 offset:18432
    s_add_u32 m0, s46, 81920
    s_add_u32 s47, s45, 589824
    buffer_load_dwordx4 v10, s[16:19], s47 offen lds
    v_mfma_f32_16x16x32_bf16 v[76:79], v[24:27], v[112:115], v[76:79]
    ds_read_b64_tr_b16 v[22:23], v54 offset:26112
    s_add_u32 m0, s46, 86016
    s_add_u32 s47, s45, 884736
    buffer_load_dwordx4 v10, s[16:19], s47 offen lds
    s_waitcnt lgkmcnt(4)
    v_mfma_f32_16x16x32_bf16 v[80:83], v[28:31], v[108:111], v[80:83]
    ds_read_b64_tr_b16 v[24:25], v54 offset:18472
    s_add_u32 m0, s46, 90112
    s_add_u32 s47, s45, 1179648
    buffer_load_dwordx4 v10, s[16:19], s47 offen lds
    v_mfma_f32_16x16x32_bf16 v[84:87], v[28:31], v[112:115], v[84:87]
    ds_read_b64_tr_b16 v[26:27], v54 offset:26152
    s_add_u32 m0, s46, 94208
    s_add_u32 s47, s45, 1474560
    buffer_load_dwordx4 v10, s[16:19], s47 offen lds
    s_waitcnt lgkmcnt(4)
    v_mfma_f32_16x16x32_bf16 v[56:59], v[16:19], v[116:119], v[56:59]
    ds_read_b64_tr_b16 v[28:29], v51 offset:18432
    v_mfma_f32_16x16x32_bf16 v[60:63], v[16:19], v[120:123], v[60:63]
    ds_read_b64_tr_b16 v[30:31], v51 offset:26112
    s_waitcnt vmcnt(23)
    s_barrier
    s_waitcnt lgkmcnt(4)
    v_mfma_f32_16x16x32_bf16 v[64:67], v[20:23], v[116:119], v[64:67]
    ds_read_b64_tr_b16 v[16:17], v50 offset:33792
    s_lshl_b32 s45, s48, 7
    s_add_u32 s45, s45, s73
    s_add_u32 m0, s46, 98304
    s_add_u32 s47, s45, 1769472
    buffer_load_dwordx4 v10, s[16:19], s47 offen lds
    v_mfma_f32_16x16x32_bf16 v[68:71], v[20:23], v[120:123], v[68:71]
    ds_read_b64_tr_b16 v[18:19], v50 offset:41472
    s_add_u32 m0, s46, 102400
    s_add_u32 s47, s45, 2064384
    buffer_load_dwordx4 v10, s[16:19], s47 offen lds
    s_waitcnt lgkmcnt(4)
    v_mfma_f32_16x16x32_bf16 v[72:75], v[24:27], v[116:119], v[72:75]
    ds_read_b64_tr_b16 v[20:21], v54 offset:33792
    s_add_u32 m0, s46, 106496
    s_add_u32 s47, s45, 2359296
    buffer_load_dwordx4 v10, s[16:19], s47 offen lds
    v_mfma_f32_16x16x32_bf16 v[76:79], v[24:27], v[120:123], v[76:79]
    ds_read_b64_tr_b16 v[22:23], v54 offset:41472
    s_add_u32 m0, s46, 110592
    s_add_u32 s47, s45, 2654208
    buffer_load_dwordx4 v10, s[16:19], s47 offen lds
    s_waitcnt lgkmcnt(4)
    v_mfma_f32_16x16x32_bf16 v[80:83], v[28:31], v[116:119], v[80:83]
    ds_read_b64_tr_b16 v[24:25], v54 offset:33832
    s_add_u32 m0, s46, 114688
    s_add_u32 s47, s45, 2949120
    buffer_load_dwordx4 v10, s[16:19], s47 offen lds
    v_mfma_f32_16x16x32_bf16 v[84:87], v[28:31], v[120:123], v[84:87]
    ds_read_b64_tr_b16 v[26:27], v54 offset:41512
    s_add_u32 m0, s46, 118784
    s_add_u32 s47, s45, 3244032
    buffer_load_dwordx4 v10, s[16:19], s47 offen lds
    s_waitcnt lgkmcnt(4)
    v_mfma_f32_16x16x32_bf16 v[56:59], v[16:19], v[124:127], v[56:59]
    ds_read_b64_tr_b16 v[28:29], v51 offset:33792
    v_mfma_f32_16x16x32_bf16 v[60:63], v[16:19], v[128:131], v[60:63]
    ds_read_b64_tr_b16 v[30:31], v51 offset:41472
    s_waitcnt vmcnt(24)
    s_barrier
    s_waitcnt lgkmcnt(4)
    v_mfma_f32_16x16x32_bf16 v[64:67], v[20:23], v[124:127], v[64:67]
    ds_read_b64_tr_b16 v[16:17], v48 offset:0
    s_add_u32 m0, s96, 122880
    s_add_u32 s47, s72, 995328
    s_mov_b64 exec, s[92:93]
    buffer_load_dwordx4 v8, s[8:11], s47 offen lds
    s_mov_b64 exec, -1
    v_mfma_f32_16x16x32_bf16 v[68:71], v[20:23], v[128:131], v[68:71]
    ds_read_b64_tr_b16 v[18:19], v48 offset:7680
    s_add_u32 m0, s96, 126720
    s_add_u32 s47, s72, 1022976
    s_mov_b64 exec, s[92:93]
    buffer_load_dwordx4 v8, s[8:11], s47 offen lds
    s_mov_b64 exec, -1
    s_waitcnt lgkmcnt(4)
    v_mfma_f32_16x16x32_bf16 v[72:75], v[24:27], v[124:127], v[72:75]
    ds_read_b64_tr_b16 v[20:21], v53 offset:0
    s_add_u32 m0, s96, 130560
    s_add_u32 s47, s72, 1050624
    s_mov_b64 exec, s[92:93]
    buffer_load_dwordx4 v8, s[8:11], s47 offen lds
    s_mov_b64 exec, -1
    v_mfma_f32_16x16x32_bf16 v[76:79], v[24:27], v[128:131], v[76:79]
    ds_read_b64_tr_b16 v[22:23], v53 offset:7680
    s_add_u32 m0, s96, 134400
    s_add_u32 s47, s72, 1078272
    s_mov_b64 exec, s[92:93]
    buffer_load_dwordx4 v8, s[8:11], s47 offen lds
    s_mov_b64 exec, -1
    s_waitcnt lgkmcnt(4)
    v_mfma_f32_16x16x32_bf16 v[80:83], v[28:31], v[124:127], v[80:83]
    ds_read_b64_tr_b16 v[24:25], v53 offset:40
    v_mfma_f32_16x16x32_bf16 v[84:87], v[28:31], v[128:131], v[84:87]
    ds_read_b64_tr_b16 v[26:27], v53 offset:7720
    s_waitcnt lgkmcnt(4)
    v_mfma_f32_16x16x32_bf16 v[56:59], v[16:19], v[132:135], v[56:59]
    ds_read_b64_tr_b16 v[28:29], v49 offset:0
    v_mfma_f32_16x16x32_bf16 v[60:63], v[16:19], v[136:139], v[60:63]
    ds_read_b64_tr_b16 v[30:31], v49 offset:7680
    s_waitcnt vmcnt(24)
    s_barrier
    s_waitcnt lgkmcnt(4)
    v_mfma_f32_16x16x32_bf16 v[64:67], v[20:23], v[132:135], v[64:67]
    ds_read_b64_tr_b16 v[16:17], v5 offset:0
    s_add_u32 m0, s96, 138240
    s_add_u32 s47, s72, 1105920
    s_mov_b64 exec, s[92:93]
    buffer_load_dwordx4 v8, s[8:11], s47 offen lds
    s_mov_b64 exec, -1
    v_mfma_f32_16x16x32_bf16 v[68:71], v[20:23], v[136:139], v[68:71]
    ds_read_b64_tr_b16 v[18:19], v5 offset:7680
    s_add_u32 m0, s96, 142080
    s_add_u32 s47, s72, 1133568
    s_mov_b64 exec, s[92:93]
    buffer_load_dwordx4 v8, s[8:11], s47 offen lds
    s_mov_b64 exec, -1
    s_waitcnt lgkmcnt(4)
    v_mfma_f32_16x16x32_bf16 v[72:75], v[24:27], v[132:135], v[72:75]
    ds_read_b64_tr_b16 v[20:21], v52 offset:0
    s_add_u32 m0, s96, 145920
    s_add_u32 s47, s72, 1161216
    s_mov_b64 exec, s[92:93]
    buffer_load_dwordx4 v8, s[8:11], s47 offen lds
    s_mov_b64 exec, -1
    v_mfma_f32_16x16x32_bf16 v[76:79], v[24:27], v[136:139], v[76:79]
    ds_read_b64_tr_b16 v[22:23], v52 offset:7680
    s_add_u32 m0, s96, 149760
    s_add_u32 s47, s72, 1188864
    s_mov_b64 exec, s[92:93]
    buffer_load_dwordx4 v8, s[8:11], s47 offen lds
    s_mov_b64 exec, -1
    s_waitcnt lgkmcnt(4)
    v_mfma_f32_16x16x32_bf16 v[80:83], v[28:31], v[132:135], v[80:83]
    ds_read_b64_tr_b16 v[24:25], v52 offset:40
    v_mfma_f32_16x16x32_bf16 v[84:87], v[28:31], v[136:139], v[84:87]
    ds_read_b64_tr_b16 v[26:27], v52 offset:7720
    s_waitcnt lgkmcnt(4)
    v_mfma_f32_16x16x32_bf16 v[56:59], v[16:19], v[140:143], v[56:59]
    ds_read_b64_tr_b16 v[28:29], v6 offset:0
    v_mfma_f32_16x16x32_bf16 v[60:63], v[16:19], v[144:147], v[60:63]
    ds_read_b64_tr_b16 v[30:31], v6 offset:7680
    s_waitcnt vmcnt(24)
    s_barrier
    s_waitcnt lgkmcnt(4)
    v_mfma_f32_16x16x32_bf16 v[64:67], v[20:23], v[140:143], v[64:67]
    ds_read_b64_tr_b16 v[16:17], v5 offset:15360
    s_add_u32 m0, s96, 52224
    s_add_u32 s47, s72, 1216512
    s_mov_b64 exec, s[92:93]
    buffer_load_dwordx4 v8, s[8:11], s47 offen lds
    s_mov_b64 exec, -1
    v_mfma_f32_16x16x32_bf16 v[68:71], v[20:23], v[144:147], v[68:71]
    ds_read_b64_tr_b16 v[18:19], v5 offset:23040
    s_add_u32 m0, s96, 56064
    s_add_u32 s47, s72, 1244160
    s_mov_b64 exec, s[92:93]
    buffer_load_dwordx4 v8, s[8:11], s47 offen lds
    s_mov_b64 exec, -1
    s_waitcnt lgkmcnt(4)
    v_mfma_f32_16x16x32_bf16 v[72:75], v[24:27], v[140:143], v[72:75]
    ds_read_b64_tr_b16 v[20:21], v52 offset:15360
    s_add_u32 m0, s96, 59904
    s_add_u32 s47, s72, 1271808
    s_mov_b64 exec, s[92:93]
    buffer_load_dwordx4 v8, s[8:11], s47 offen lds
    s_mov_b64 exec, -1
    v_mfma_f32_16x16x32_bf16 v[76:79], v[24:27], v[144:147], v[76:79]
    ds_read_b64_tr_b16 v[22:23], v52 offset:23040
    s_add_u32 m0, s96, 63744
    s_add_u32 s47, s72, 1299456
    s_mov_b64 exec, s[92:93]
    buffer_load_dwordx4 v8, s[8:11], s47 offen lds
    s_mov_b64 exec, -1
    s_waitcnt lgkmcnt(4)
    v_mfma_f32_16x16x32_bf16 v[80:83], v[28:31], v[140:143], v[80:83]
    ds_read_b64_tr_b16 v[24:25], v52 offset:15400
    v_mfma_f32_16x16x32_bf16 v[84:87], v[28:31], v[144:147], v[84:87]
    ds_read_b64_tr_b16 v[26:27], v52 offset:23080
    s_waitcnt lgkmcnt(4)
    v_mfma_f32_16x16x32_bf16 v[56:59], v[16:19], v[148:151], v[56:59]
    ds_read_b64_tr_b16 v[28:29], v6 offset:15360
    v_mfma_f32_16x16x32_bf16 v[60:63], v[16:19], v[152:155], v[60:63]
    ds_read_b64_tr_b16 v[30:31], v6 offset:23040
    s_waitcnt vmcnt(24)
    s_barrier
    s_waitcnt lgkmcnt(4)
    v_mfma_f32_16x16x32_bf16 v[64:67], v[20:23], v[148:151], v[64:67]
    ds_read_b64_tr_b16 v[16:17], v5 offset:30720
    s_add_u32 m0, s96, 0
    s_add_u32 s47, s72, 1327104
    s_mov_b64 exec, s[92:93]
    buffer_load_dwordx4 v8, s[8:11], s47 offen lds
    s_mov_b64 exec, -1
    v_mfma_f32_16x16x32_bf16 v[68:71], v[20:23], v[152:155], v[68:71]
    ds_read_b64_tr_b16 v[18:19], v5 offset:38400
    s_add_u32 m0, s96, 3840
    s_add_u32 s47, s72, 1354752
    s_mov_b64 exec, s[92:93]
    buffer_load_dwordx4 v8, s[8:11], s47 offen lds
    s_mov_b64 exec, -1
    s_waitcnt lgkmcnt(4)
    v_mfma_f32_16x16x32_bf16 v[72:75], v[24:27], v[148:151], v[72:75]
    ds_read_b64_tr_b16 v[20:21], v52 offset:30720
    s_add_u32 m0, s96, 7680
    s_add_u32 s47, s72, 1382400
    s_mov_b64 exec, s[92:93]
    buffer_load_dwordx4 v8, s[8:11], s47 offen lds
    s_mov_b64 exec, -1
    v_mfma_f32_16x16x32_bf16 v[76:79], v[24:27], v[152:155], v[76:79]
    ds_read_b64_tr_b16 v[22:23], v52 offset:38400
    s_add_u32 m0, s96, 11520
    s_add_u32 s47, s72, 1410048
    s_mov_b64 exec, s[92:93]
    buffer_load_dwordx4 v8, s[8:11], s47 offen lds
    s_mov_b64 exec, -1
    s_waitcnt lgkmcnt(4)
    v_mfma_f32_16x16x32_bf16 v[80:83], v[28:31], v[148:151], v[80:83]
    ds_read_b64_tr_b16 v[24:25], v52 offset:30760
    v_mfma_f32_16x16x32_bf16 v[84:87], v[28:31], v[152:155], v[84:87]
    ds_read_b64_tr_b16 v[26:27], v52 offset:38440
    s_waitcnt lgkmcnt(4)
    v_mfma_f32_16x16x32_bf16 v[56:59], v[16:19], v[156:159], v[56:59]
    ds_read_b64_tr_b16 v[28:29], v6 offset:30720
    v_mfma_f32_16x16x32_bf16 v[60:63], v[16:19], v[160:163], v[60:63]
    ds_read_b64_tr_b16 v[30:31], v6 offset:38400
    s_waitcnt vmcnt(12)
    s_barrier
    s_waitcnt lgkmcnt(4)
    v_mfma_f32_16x16x32_bf16 v[64:67], v[20:23], v[156:159], v[64:67]
    ds_read_b64_tr_b16 v[16:17], v50 offset:18432
    s_add_u32 m0, s96, 15360
    s_add_u32 s47, s72, 1437696
    s_mov_b64 exec, s[92:93]
    buffer_load_dwordx4 v8, s[8:11], s47 offen lds
    s_mov_b64 exec, -1
    v_mfma_f32_16x16x32_bf16 v[68:71], v[20:23], v[160:163], v[68:71]
    ds_read_b64_tr_b16 v[18:19], v50 offset:26112
    s_add_u32 m0, s96, 19200
    s_add_u32 s47, s72, 1465344
    s_mov_b64 exec, s[92:93]
    buffer_load_dwordx4 v8, s[8:11], s47 offen lds
    s_mov_b64 exec, -1
    s_waitcnt lgkmcnt(4)
    v_mfma_f32_16x16x32_bf16 v[72:75], v[24:27], v[156:159], v[72:75]
    ds_read_b64_tr_b16 v[20:21], v54 offset:18432
    s_add_u32 m0, s96, 23040
    s_add_u32 s47, s72, 1492992
    s_mov_b64 exec, s[92:93]
    buffer_load_dwordx4 v8, s[8:11], s47 offen lds
    s_mov_b64 exec, -1
    v_mfma_f32_16x16x32_bf16 v[76:79], v[24:27], v[160:163], v[76:79]
    ds_read_b64_tr_b16 v[22:23], v54 offset:26112
    s_add_u32 m0, s96, 26880
    s_add_u32 s47, s72, 1520640
    s_mov_b64 exec, s[92:93]
    buffer_load_dwordx4 v8, s[8:11], s47 offen lds
    s_mov_b64 exec, -1
    s_waitcnt lgkmcnt(4)
    v_mfma_f32_16x16x32_bf16 v[80:83], v[28:31], v[156:159], v[80:83]
    ds_read_b64_tr_b16 v[24:25], v54 offset:18472
    v_mfma_f32_16x16x32_bf16 v[84:87], v[28:31], v[160:163], v[84:87]
    ds_read_b64_tr_b16 v[26:27], v54 offset:26152
    s_waitcnt lgkmcnt(4)
    v_mfma_f32_16x16x32_bf16 v[56:59], v[16:19], v[164:167], v[56:59]
    ds_read_b64_tr_b16 v[28:29], v51 offset:18432
    v_mfma_f32_16x16x32_bf16 v[60:63], v[16:19], v[168:171], v[60:63]
    ds_read_b64_tr_b16 v[30:31], v51 offset:26112
    s_waitcnt vmcnt(12)
    s_barrier
    s_waitcnt lgkmcnt(4)
    v_mfma_f32_16x16x32_bf16 v[64:67], v[20:23], v[164:167], v[64:67]
    ds_read_b64_tr_b16 v[16:17], v50 offset:33792
    s_add_u32 m0, s96, 30720
    s_add_u32 s47, s72, 1548288
    s_mov_b64 exec, s[92:93]
    buffer_load_dwordx4 v8, s[8:11], s47 offen lds
    s_mov_b64 exec, -1
    v_mfma_f32_16x16x32_bf16 v[68:71], v[20:23], v[168:171], v[68:71]
    ds_read_b64_tr_b16 v[18:19], v50 offset:41472
    s_add_u32 m0, s96, 34560
    s_add_u32 s47, s72, 1575936
    s_mov_b64 exec, s[92:93]
    buffer_load_dwordx4 v8, s[8:11], s47 offen lds
    s_mov_b64 exec, -1
    s_waitcnt lgkmcnt(4)
    v_mfma_f32_16x16x32_bf16 v[72:75], v[24:27], v[164:167], v[72:75]
    ds_read_b64_tr_b16 v[20:21], v54 offset:33792
    s_add_u32 m0, s96, 38400
    s_add_u32 s47, s72, 1603584
    s_mov_b64 exec, s[92:93]
    buffer_load_dwordx4 v8, s[8:11], s47 offen lds
    s_mov_b64 exec, -1
    v_mfma_f32_16x16x32_bf16 v[76:79], v[24:27], v[168:171], v[76:79]
    ds_read_b64_tr_b16 v[22:23], v54 offset:41472
    s_add_u32 m0, s96, 42240
    s_add_u32 s47, s72, 1631232
    s_mov_b64 exec, s[92:93]
    buffer_load_dwordx4 v8, s[8:11], s47 offen lds
    s_mov_b64 exec, -1
    s_waitcnt lgkmcnt(4)
    v_mfma_f32_16x16x32_bf16 v[80:83], v[28:31], v[164:167], v[80:83]
    ds_read_b64_tr_b16 v[24:25], v54 offset:33832
    v_mfma_f32_16x16x32_bf16 v[84:87], v[28:31], v[168:171], v[84:87]
    ds_read_b64_tr_b16 v[26:27], v54 offset:41512
    s_waitcnt lgkmcnt(4)
    v_mfma_f32_16x16x32_bf16 v[56:59], v[16:19], v[172:175], v[56:59]
    ds_read_b64_tr_b16 v[28:29], v51 offset:33792
    v_mfma_f32_16x16x32_bf16 v[60:63], v[16:19], v[176:179], v[60:63]
    ds_read_b64_tr_b16 v[30:31], v51 offset:41472
    s_waitcnt vmcnt(12)
    s_barrier
    s_waitcnt lgkmcnt(4)
    v_mfma_f32_16x16x32_bf16 v[64:67], v[20:23], v[172:175], v[64:67]
    ds_read_b64_tr_b16 v[16:17], v48 offset:0
    s_add_u32 m0, s96, 122880
    s_add_u32 s47, s72, 1658880
    s_mov_b64 exec, s[92:93]
    buffer_load_dwordx4 v8, s[8:11], s47 offen lds
    s_mov_b64 exec, -1
    v_mfma_f32_16x16x32_bf16 v[68:71], v[20:23], v[176:179], v[68:71]
    ds_read_b64_tr_b16 v[18:19], v48 offset:7680
    s_add_u32 m0, s96, 126720
    s_add_u32 s47, s72, 1686528
    s_mov_b64 exec, s[92:93]
    buffer_load_dwordx4 v8, s[8:11], s47 offen lds
    s_mov_b64 exec, -1
    s_waitcnt lgkmcnt(4)
    v_mfma_f32_16x16x32_bf16 v[72:75], v[24:27], v[172:175], v[72:75]
    ds_read_b64_tr_b16 v[20:21], v53 offset:0
    s_add_u32 m0, s96, 130560
    s_add_u32 s47, s72, 1714176
    s_mov_b64 exec, s[92:93]
    buffer_load_dwordx4 v8, s[8:11], s47 offen lds
    s_mov_b64 exec, -1
    v_mfma_f32_16x16x32_bf16 v[76:79], v[24:27], v[176:179], v[76:79]
    ds_read_b64_tr_b16 v[22:23], v53 offset:7680
    s_add_u32 m0, s96, 134400
    s_add_u32 s47, s72, 1741824
    s_mov_b64 exec, s[92:93]
    buffer_load_dwordx4 v8, s[8:11], s47 offen lds
    s_mov_b64 exec, -1
    s_waitcnt lgkmcnt(4)
    v_mfma_f32_16x16x32_bf16 v[80:83], v[28:31], v[172:175], v[80:83]
    ds_read_b64_tr_b16 v[24:25], v53 offset:40
    v_mfma_f32_16x16x32_bf16 v[84:87], v[28:31], v[176:179], v[84:87]
    ds_read_b64_tr_b16 v[26:27], v53 offset:7720
    s_waitcnt lgkmcnt(4)
    v_mfma_f32_16x16x32_bf16 v[56:59], v[16:19], v[180:183], v[56:59]
    ds_read_b64_tr_b16 v[28:29], v49 offset:0
    v_mfma_f32_16x16x32_bf16 v[60:63], v[16:19], v[184:187], v[60:63]
    ds_read_b64_tr_b16 v[30:31], v49 offset:7680
    s_waitcnt vmcnt(12)
    s_barrier
    s_waitcnt lgkmcnt(4)
    v_mfma_f32_16x16x32_bf16 v[64:67], v[20:23], v[180:183], v[64:67]
    ds_read_b64_tr_b16 v[16:17], v5 offset:0
    s_add_u32 m0, s96, 138240
    s_add_u32 s47, s72, 1769472
    s_mov_b64 exec, s[92:93]
    buffer_load_dwordx4 v8, s[8:11], s47 offen lds
    s_mov_b64 exec, -1
    v_mfma_f32_16x16x32_bf16 v[68:71], v[20:23], v[184:187], v[68:71]
    ds_read_b64_tr_b16 v[18:19], v5 offset:7680
    s_add_u32 m0, s96, 142080
    s_add_u32 s47, s72, 1797120
    s_mov_b64 exec, s[92:93]
    buffer_load_dwordx4 v8, s[8:11], s47 offen lds
    s_mov_b64 exec, -1
    s_waitcnt lgkmcnt(4)
    v_mfma_f32_16x16x32_bf16 v[72:75], v[24:27], v[180:183], v[72:75]
    ds_read_b64_tr_b16 v[20:21], v52 offset:0
    s_add_u32 m0, s96, 145920
    s_add_u32 s47, s72, 1824768
    s_mov_b64 exec, s[92:93]
    buffer_load_dwordx4 v8, s[8:11], s47 offen lds
    s_mov_b64 exec, -1
    v_mfma_f32_16x16x32_bf16 v[76:79], v[24:27], v[184:187], v[76:79]
    ds_read_b64_tr_b16 v[22:23], v52 offset:7680
    s_add_u32 m0, s96, 149760
    s_add_u32 s47, s72, 1852416
    s_mov_b64 exec, s[92:93]
    buffer_load_dwordx4 v8, s[8:11], s47 offen lds
    s_mov_b64 exec, -1
    s_waitcnt lgkmcnt(4)
    v_mfma_f32_16x16x32_bf16 v[80:83], v[28:31], v[180:183], v[80:83]
    ds_read_b64_tr_b16 v[24:25], v52 offset:40
    v_mfma_f32_16x16x32_bf16 v[84:87], v[28:31], v[184:187], v[84:87]
    ds_read_b64_tr_b16 v[26:27], v52 offset:7720
    s_waitcnt lgkmcnt(4)
    v_mfma_f32_16x16x32_bf16 v[56:59], v[16:19], v[188:191], v[56:59]
    ds_read_b64_tr_b16 v[28:29], v6 offset:0
    v_mfma_f32_16x16x32_bf16 v[60:63], v[16:19], v[192:195], v[60:63]
    ds_read_b64_tr_b16 v[30:31], v6 offset:7680
    s_waitcnt vmcnt(12)
    s_barrier
    s_waitcnt lgkmcnt(4)
    v_mfma_f32_16x16x32_bf16 v[64:67], v[20:23], v[188:191], v[64:67]
    ds_read_b64_tr_b16 v[16:17], v5 offset:15360
    s_add_u32 m0, s96, 52224
    s_add_u32 s47, s72, 1880064
    s_mov_b64 exec, s[92:93]
    buffer_load_dwordx4 v8, s[8:11], s47 offen lds
    s_mov_b64 exec, -1
    v_mfma_f32_16x16x32_bf16 v[68:71], v[20:23], v[192:195], v[68:71]
    ds_read_b64_tr_b16 v[18:19], v5 offset:23040
    s_add_u32 m0, s96, 56064
    s_add_u32 s47, s72, 1907712
    s_mov_b64 exec, s[92:93]
    buffer_load_dwordx4 v8, s[8:11], s47 offen lds
    s_mov_b64 exec, -1
    s_waitcnt lgkmcnt(4)
    v_mfma_f32_16x16x32_bf16 v[72:75], v[24:27], v[188:191], v[72:75]
    ds_read_b64_tr_b16 v[20:21], v52 offset:15360
    s_add_u32 m0, s96, 59904
    s_add_u32 s47, s72, 1935360
    s_mov_b64 exec, s[92:93]
    buffer_load_dwordx4 v8, s[8:11], s47 offen lds
    s_mov_b64 exec, -1
    v_mfma_f32_16x16x32_bf16 v[76:79], v[24:27], v[192:195], v[76:79]
    ds_read_b64_tr_b16 v[22:23], v52 offset:23040
    s_add_u32 m0, s96, 63744
    s_add_u32 s47, s72, 1963008
    s_mov_b64 exec, s[92:93]
    buffer_load_dwordx4 v8, s[8:11], s47 offen lds
    s_mov_b64 exec, -1
    s_waitcnt lgkmcnt(4)
    v_mfma_f32_16x16x32_bf16 v[80:83], v[28:31], v[188:191], v[80:83]
    ds_read_b64_tr_b16 v[24:25], v52 offset:15400
    s_lshl_b32 s42, s41, 6
    s_add_u32 s42, s42, 0
    v_add_u32_e64 v252, s42, v1
    s_mul_i32 s43, s97, 12
    s_add_u32 s43, s43, 384
    v_min_u32 v253, 107, v252
    v_mul_u32_u24 v254, 456, v253
    v_lshrrev_b32 v254, 12, v254
    v_mul_u32_u24 v255, 9, v254
    v_sub_u32 v253, v253, v255
    v_add_u32 v254, s43, v254
    v_mul_u32_u24 v254, 9216, v254
    v_lshl_add_u32 v254, v253, 7, v254
    buffer_load_dword v89, v254, s[16:19], s73 offen
    v_mfma_f32_16x16x32_bf16 v[84:87], v[28:31], v[192:195], v[84:87]
    ds_read_b64_tr_b16 v[26:27], v52 offset:23080
    s_waitcnt lgkmcnt(4)
    v_mfma_f32_16x16x32_bf16 v[56:59], v[16:19], v[196:199], v[56:59]
    ds_read_b64_tr_b16 v[28:29], v6 offset:15360
    v_mfma_f32_16x16x32_bf16 v[60:63], v[16:19], v[200:203], v[60:63]
    ds_read_b64_tr_b16 v[30:31], v6 offset:23040
    s_waitcnt vmcnt(13)
    s_barrier
    s_waitcnt lgkmcnt(4)
    v_mfma_f32_16x16x32_bf16 v[64:67], v[20:23], v[196:199], v[64:67]
    ds_read_b64_tr_b16 v[16:17], v5 offset:30720
    v_mfma_f32_16x16x32_bf16 v[68:71], v[20:23], v[200:203], v[68:71]
    ds_read_b64_tr_b16 v[18:19], v5 offset:38400
    s_waitcnt lgkmcnt(4)
    v_mfma_f32_16x16x32_bf16 v[72:75], v[24:27], v[196:199], v[72:75]
    ds_read_b64_tr_b16 v[20:21], v52 offset:30720
    v_mfma_f32_16x16x32_bf16 v[76:79], v[24:27], v[200:203], v[76:79]
    ds_read_b64_tr_b16 v[22:23], v52 offset:38400
    s_waitcnt lgkmcnt(4)
    v_mfma_f32_16x16x32_bf16 v[80:83], v[28:31], v[196:199], v[80:83]
    ds_read_b64_tr_b16 v[24:25], v52 offset:30760
    v_mfma_f32_16x16x32_bf16 v[84:87], v[28:31], v[200:203], v[84:87]
    ds_read_b64_tr_b16 v[26:27], v52 offset:38440
    s_waitcnt lgkmcnt(4)
    v_mfma_f32_16x16x32_bf16 v[56:59], v[16:19], v[204:207], v[56:59]
    ds_read_b64_tr_b16 v[28:29], v6 offset:30720
    v_mfma_f32_16x16x32_bf16 v[60:63], v[16:19], v[208:211], v[60:63]
    ds_read_b64_tr_b16 v[30:31], v6 offset:38400
    s_waitcnt vmcnt(9)
    s_barrier
    s_waitcnt lgkmcnt(4)
    v_mfma_f32_16x16x32_bf16 v[64:67], v[20:23], v[204:207], v[64:67]
    ds_read_b64_tr_b16 v[16:17], v50 offset:18432
    s_lshl_b32 s45, s48, 7
    s_add_u32 s45, s45, s73
    s_add_u32 m0, s46, 0
    s_add_u32 s47, s45, 3538944
    buffer_load_dwordx4 v10, s[16:19], s47 offen lds
    v_mfma_f32_16x16x32_bf16 v[68:71], v[20:23], v[208:211], v[68:71]
    ds_read_b64_tr_b16 v[18:19], v50 offset:26112
    s_add_u32 m0, s46, 4096
    s_add_u32 s47, s45, 3833856
    buffer_load_dwordx4 v10, s[16:19], s47 offen lds
    s_waitcnt lgkmcnt(4)
    v_mfma_f32_16x16x32_bf16 v[72:75], v[24:27], v[204:207], v[72:75]
    ds_read_b64_tr_b16 v[20:21], v54 offset:18432
    s_add_u32 m0, s46, 8192
    s_add_u32 s47, s45, 4128768
    buffer_load_dwordx4 v10, s[16:19], s47 offen lds
    v_mfma_f32_16x16x32_bf16 v[76:79], v[24:27], v[208:211], v[76:79]
    ds_read_b64_tr_b16 v[22:23], v54 offset:26112
    s_add_u32 m0, s46, 12288
    s_add_u32 s47, s45, 4423680
    buffer_load_dwordx4 v10, s[16:19], s47 offen lds
    s_waitcnt lgkmcnt(4)
    v_mfma_f32_16x16x32_bf16 v[80:83], v[28:31], v[204:207], v[80:83]
    ds_read_b64_tr_b16 v[24:25], v54 offset:18472
    s_add_u32 m0, s46, 16384
    s_add_u32 s47, s45, 4718592
    buffer_load_dwordx4 v10, s[16:19], s47 offen lds
    v_mfma_f32_16x16x32_bf16 v[84:87], v[28:31], v[208:211], v[84:87]
    ds_read_b64_tr_b16 v[26:27], v54 offset:26152
    s_add_u32 m0, s46, 20480
    s_add_u32 s47, s45, 5013504
    buffer_load_dwordx4 v10, s[16:19], s47 offen lds
    s_waitcnt lgkmcnt(4)
    v_mfma_f32_16x16x32_bf16 v[56:59], v[16:19], v[212:215], v[56:59]
    ds_read_b64_tr_b16 v[28:29], v51 offset:18432
    v_mfma_f32_16x16x32_bf16 v[60:63], v[16:19], v[216:219], v[60:63]
    ds_read_b64_tr_b16 v[30:31], v51 offset:26112
    s_waitcnt vmcnt(11)
    s_barrier
    s_waitcnt lgkmcnt(4)
    v_mfma_f32_16x16x32_bf16 v[64:67], v[20:23], v[212:215], v[64:67]
    ds_read_b64_tr_b16 v[16:17], v50 offset:33792
    s_lshl_b32 s45, s49, 7
    s_add_u32 s45, s45, s73
    s_add_u32 m0, s46, 24576
    s_add_u32 s47, s45, 0
    buffer_load_dwordx4 v10, s[16:19], s47 offen lds
    v_mfma_f32_16x16x32_bf16 v[68:71], v[20:23], v[216:219], v[68:71]
    ds_read_b64_tr_b16 v[18:19], v50 offset:41472
    s_add_u32 m0, s46, 28672
    s_add_u32 s47, s45, 294912
    buffer_load_dwordx4 v10, s[16:19], s47 offen lds
    s_waitcnt lgkmcnt(4)
    v_mfma_f32_16x16x32_bf16 v[72:75], v[24:27], v[212:215], v[72:75]
    ds_read_b64_tr_b16 v[20:21], v54 offset:33792
    s_add_u32 m0, s46, 32768
    s_add_u32 s47, s45, 589824
    buffer_load_dwordx4 v10, s[16:19], s47 offen lds
    v_mfma_f32_16x16x32_bf16 v[76:79], v[24:27], v[216:219], v[76:79]
    ds_read_b64_tr_b16 v[22:23], v54 offset:41472
    s_add_u32 m0, s46, 36864
    s_add_u32 s47, s45, 884736
    buffer_load_dwordx4 v10, s[16:19], s47 offen lds
    s_waitcnt lgkmcnt(4)
    v_mfma_f32_16x16x32_bf16 v[80:83], v[28:31], v[212:215], v[80:83]
    ds_read_b64_tr_b16 v[24:25], v54 offset:33832
    s_add_u32 m0, s46, 40960
    s_add_u32 s47, s45, 1179648
    buffer_load_dwordx4 v10, s[16:19], s47 offen lds
    v_mfma_f32_16x16x32_bf16 v[84:87], v[28:31], v[216:219], v[84:87]
    ds_read_b64_tr_b16 v[26:27], v54 offset:41512
    s_add_u32 m0, s46, 45056
    s_add_u32 s47, s45, 1474560
    buffer_load_dwordx4 v10, s[16:19], s47 offen lds
    s_waitcnt lgkmcnt(4)
    v_mfma_f32_16x16x32_bf16 v[56:59], v[16:19], v[220:223], v[56:59]
    ds_read_b64_tr_b16 v[28:29], v51 offset:33792
    v_mfma_f32_16x16x32_bf16 v[60:63], v[16:19], v[224:227], v[60:63]
    ds_read_b64_tr_b16 v[30:31], v51 offset:41472
    s_waitcnt vmcnt(13)
    s_barrier
    s_waitcnt lgkmcnt(4)
    v_mfma_f32_16x16x32_bf16 v[64:67], v[20:23], v[220:223], v[64:67]
    ds_read_b64_tr_b16 v[16:17], v48 offset:0
    v_mfma_f32_16x16x32_bf16 v[68:71], v[20:23], v[224:227], v[68:71]
    ds_read_b64_tr_b16 v[18:19], v48 offset:7680
    s_waitcnt lgkmcnt(4)
    v_mfma_f32_16x16x32_bf16 v[72:75], v[24:27], v[220:223], v[72:75]
    ds_read_b64_tr_b16 v[20:21], v53 offset:0
    v_mfma_f32_16x16x32_bf16 v[76:79], v[24:27], v[224:227], v[76:79]
    ds_read_b64_tr_b16 v[22:23], v53 offset:7680
    s_waitcnt lgkmcnt(4)
    v_mfma_f32_16x16x32_bf16 v[80:83], v[28:31], v[220:223], v[80:83]
    ds_read_b64_tr_b16 v[24:25], v53 offset:40
    v_mfma_f32_16x16x32_bf16 v[84:87], v[28:31], v[224:227], v[84:87]
    ds_read_b64_tr_b16 v[26:27], v53 offset:7720
    s_waitcnt lgkmcnt(4)
    v_mfma_f32_16x16x32_bf16 v[56:59], v[16:19], v[228:231], v[56:59]
    ds_read_b64_tr_b16 v[28:29], v49 offset:0
    v_mfma_f32_16x16x32_bf16 v[60:63], v[16:19], v[232:235], v[60:63]
    ds_read_b64_tr_b16 v[30:31], v49 offset:7680
    s_barrier
    s_waitcnt lgkmcnt(4)
    v_mfma_f32_16x16x32_bf16 v[64:67], v[20:23], v[228:231], v[64:67]
    ds_read_b64_tr_b16 v[16:17], v3 offset:24576
    v_mfma_f32_16x16x32_bf16 v[68:71], v[20:23], v[232:235], v[68:71]
    ds_read_b64_tr_b16 v[18:19], v3 offset:26624
    s_waitcnt lgkmcnt(4)
    v_mfma_f32_16x16x32_bf16 v[72:75], v[24:27], v[228:231], v[72:75]
    ds_read_b64_tr_b16 v[20:21], v3 offset:28672
    v_mfma_f32_16x16x32_bf16 v[76:79], v[24:27], v[232:235], v[76:79]
    ds_read_b64_tr_b16 v[22:23], v3 offset:30720
    s_waitcnt lgkmcnt(4)
    v_mfma_f32_16x16x32_bf16 v[80:83], v[28:31], v[228:231], v[80:83]
    ds_read_b64_tr_b16 v[24:25], v3 offset:32768
    v_mfma_f32_16x16x32_bf16 v[84:87], v[28:31], v[232:235], v[84:87]
    ds_read_b64_tr_b16 v[26:27], v3 offset:34816
    s_waitcnt lgkmcnt(4)
    v_mfma_f32_16x16x32_bf16 v[32:35], v[16:19], v[92:95], 0
    ds_read_b64_tr_b16 v[28:29], v3 offset:36864
    v_mfma_f32_16x16x32_bf16 v[36:39], v[16:19], v[96:99], 0
    ds_read_b64_tr_b16 v[30:31], v3 offset:38912
    s_waitcnt lgkmcnt(4)
    v_mfma_f32_16x16x32_bf16 v[32:35], v[20:23], v[100:103], v[32:35]
    ds_read_b64_tr_b16 v[16:17], v3 offset:40960
    v_mfma_f32_16x16x32_bf16 v[36:39], v[20:23], v[104:107], v[36:39]
    ds_read_b64_tr_b16 v[18:19], v3 offset:43008
    s_waitcnt lgkmcnt(4)
    v_mfma_f32_16x16x32_bf16 v[32:35], v[24:27], v[108:111], v[32:35]
    ds_read_b64_tr_b16 v[20:21], v3 offset:45056
    v_cvt_pk_bf16_f32 v236, v64, v65
    v_mfma_f32_16x16x32_bf16 v[36:39], v[24:27], v[112:115], v[36:39]
    ds_read_b64_tr_b16 v[22:23], v3 offset:47104
    v_cvt_pk_bf16_f32 v237, v66, v67
    s_barrier
    s_waitcnt lgkmcnt(4)
    v_mfma_f32_16x16x32_bf16 v[32:35], v[28:31], v[116:119], v[32:35]
    ds_read_b64_tr_b16 v[24:25], v4 offset:0
    v_cvt_pk_bf16_f32 v238, v68, v69
    v_mfma_f32_16x16x32_bf16 v[36:39], v[28:31], v[120:123], v[36:39]
    ds_read_b64_tr_b16 v[26:27], v4 offset:2048
    v_cvt_pk_bf16_f32 v239, v70, v71
    s_waitcnt lgkmcnt(4)
    v_mfma_f32_16x16x32_bf16 v[32:35], v[16:19], v[124:127], v[32:35]
    ds_read_b64_tr_b16 v[28:29], v4 offset:4096
    v_mfma_f32_16x16x32_bf16 v[36:39], v[16:19], v[128:131], v[36:39]
    ds_read_b64_tr_b16 v[30:31], v4 offset:6144
    s_mov_b32 vcc_lo, 0x55555555
    s_mov_b32 vcc_hi, 0x55555555
    v_cndmask_b32_dpp v248, v238, v236, vcc quad_perm:[1,0,3,2] row_mask:0xf bank_mask:0xf
    v_cndmask_b32_dpp v249, v239, v237, vcc quad_perm:[1,0,3,2] row_mask:0xf bank_mask:0xf
    s_not_b64 vcc, vcc
    v_cndmask_b32_dpp v250, v236, v238, vcc quad_perm:[1,0,3,2] row_mask:0xf bank_mask:0xf
    v_cndmask_b32_dpp v251, v237, v239, vcc quad_perm:[1,0,3,2] row_mask:0xf bank_mask:0xf
    global_store_dwordx4 v12, v[248:251], s[82:83] offset:0 sc1
    s_waitcnt lgkmcnt(4)
    v_mfma_f32_16x16x32_bf16 v[32:35], v[20:23], v[132:135], v[32:35]
    ds_read_b64_tr_b16 v[16:17], v4 offset:8192
    v_cvt_pk_bf16_f32 v240, v72, v73
    v_mfma_f32_16x16x32_bf16 v[36:39], v[20:23], v[136:139], v[36:39]
    ds_read_b64_tr_b16 v[18:19], v4 offset:10240
    v_cvt_pk_bf16_f32 v241, v74, v75
    s_waitcnt lgkmcnt(4)
    v_mfma_f32_16x16x32_bf16 v[32:35], v[24:27], v[140:143], v[32:35]
    ds_read_b64_tr_b16 v[20:21], v4 offset:12288
    v_cvt_pk_bf16_f32 v242, v76, v77
    v_mfma_f32_16x16x32_bf16 v[36:39], v[24:27], v[144:147], v[36:39]
    ds_read_b64_tr_b16 v[22:23], v4 offset:14336
    v_cvt_pk_bf16_f32 v243, v78, v79
    s_waitcnt lgkmcnt(4)
    v_mfma_f32_16x16x32_bf16 v[32:35], v[28:31], v[148:151], v[32:35]
    ds_read_b64_tr_b16 v[24:25], v4 offset:16384
    v_mfma_f32_16x16x32_bf16 v[36:39], v[28:31], v[152:155], v[36:39]
    ds_read_b64_tr_b16 v[26:27], v4 offset:18432
    s_mov_b32 vcc_lo, 0x55555555
    s_mov_b32 vcc_hi, 0x55555555
    v_cndmask_b32_dpp v248, v242, v240, vcc quad_perm:[1,0,3,2] row_mask:0xf bank_mask:0xf
    v_cndmask_b32_dpp v249, v243, v241, vcc quad_perm:[1,0,3,2] row_mask:0xf bank_mask:0xf
    s_not_b64 vcc, vcc
    v_cndmask_b32_dpp v250, v240, v242, vcc quad_perm:[1,0,3,2] row_mask:0xf bank_mask:0xf
    v_cndmask_b32_dpp v251, v241, v243, vcc quad_perm:[1,0,3,2] row_mask:0xf bank_mask:0xf
    global_store_dwordx4 v12, v[248:251], s[82:83] offset:1024 sc1
    s_waitcnt lgkmcnt(4)
    s_nop 0
    v_mfma_f32_16x16x32_bf16 v[32:35], v[16:19], v[156:159], v[32:35]
    ds_read_b64_tr_b16 v[28:29], v4 offset:20480
    v_cvt_pk_bf16_f32 v252, v80, v81
    v_mfma_f32_16x16x32_bf16 v[36:39], v[16:19], v[160:163], v[36:39]
    ds_read_b64_tr_b16 v[30:31], v4 offset:22528
    v_cvt_pk_bf16_f32 v253, v82, v83
    v_cvt_pk_bf16_f32 v254, v84, v85
    v_cvt_pk_bf16_f32 v255, v86, v87
    s_and_b32 s42, s41, 1
    s_lshl_b32 s42, s42, 8
    s_add_u32 s42, s42, 3968
    s_lshl_b32 s43, s40, 8
    s_add_u32 s43, s43, 141312
    v_lshl_add_u32 v15, v1, 3, s43
    v_lshl_add_u32 v14, v1, 3, s42
    s_mov_b64 exec, 0xffff
    ds_write_b64 v15, v[252:253] offset:0
    ds_write_b64 v15, v[254:255] offset:128
    s_mov_b64 exec, 0xffff0000
    global_store_dwordx2 v14, v[252:253], s[82:83] offset:0 sc1
    global_store_dwordx2 v14, v[254:255], s[82:83] offset:128 sc1
    s_branch LD_join
LD_odd:
    v_mfma_f32_16x16x32_bf16 v[64:67], v[92:95], v[20:23], 0
    ds_read_b64_tr_b16 v[16:17], v48 offset:36864
    s_add_u32 m0, s96, 52224
    s_add_u32 s47, s72, 552960
    s_mov_b64 exec, s[92:93]
    buffer_load_dwordx4 v8, s[8:11], s47 offen lds
    s_mov_b64 exec, -1
    v_mfma_f32_16x16x32_bf16 v[68:71], v[96:99], v[20:23], 0
    ds_read_b64_tr_b16 v[18:19], v48 offset:44544
    s_add_u32 m0, s96, 56064
    s_add_u32 s47, s72, 580608
    s_mov_b64 exec, s[92:93]
    buffer_load_dwordx4 v8, s[8:11], s47 offen lds
    s_mov_b64 exec, -1
    v_mfma_f32_16x16x32_bf16 v[72:75], v[92:95], v[24:27], 0
    ds_read_b64_tr_b16 v[20:21], v53 offset:36864
    s_add_u32 m0, s96, 59904
    s_add_u32 s47, s72, 608256
    s_mov_b64 exec, s[92:93]
    buffer_load_dwordx4 v8, s[8:11], s47 offen lds
    s_mov_b64 exec, -1
    v_mfma_f32_16x16x32_bf16 v[76:79], v[96:99], v[24:27], 0
    ds_read_b64_tr_b16 v[22:23], v53 offset:44544
    s_add_u32 m0, s96, 63744
    s_add_u32 s47, s72, 635904
    s_mov_b64 exec, s[92:93]
    buffer_load_dwordx4 v8, s[8:11], s47 offen lds
    s_mov_b64 exec, -1
    s_waitcnt lgkmcnt(4)
    v_mfma_f32_16x16x32_bf16 v[80:83], v[92:95], v[28:31], 0
    ds_read_b64_tr_b16 v[24:25], v53 offset:36904
    s_add_u32 m0, s96, 0
    s_add_u32 s47, s72, 663552
    s_mov_b64 exec, s[92:93]
    buffer_load_dwordx4 v8, s[8:11], s47 offen lds
    s_mov_b64 exec, -1
    v_mfma_f32_16x16x32_bf16 v[84:87], v[96:99], v[28:31], 0
    ds_read_b64_tr_b16 v[26:27], v53 offset:44584
    s_add_u32 m0, s96, 3840
    s_add_u32 s47, s72, 691200
    s_mov_b64 exec, s[92:93]
    buffer_load_dwordx4 v8, s[8:11], s47 offen lds
    s_mov_b64 exec, -1
    s_waitcnt lgkmcnt(4)
    v_mfma_f32_16x16x32_bf16 v[56:59], v[16:19], v[100:103], v[56:59]
    ds_read_b64_tr_b16 v[28:29], v49 offset:36864
    s_add_u32 m0, s96, 7680
    s_add_u32 s47, s72, 718848
    s_mov_b64 exec, s[92:93]
    buffer_load_dwordx4 v8, s[8:11], s47 offen lds
    s_mov_b64 exec, -1
    v_mfma_f32_16x16x32_bf16 v[60:63], v[16:19], v[104:107], v[60:63]
    ds_read_b64_tr_b16 v[30:31], v49 offset:44544
    s_add_u32 m0, s96, 11520
    s_add_u32 s47, s72, 746496
    s_mov_b64 exec, s[92:93]
    buffer_load_dwordx4 v8, s[8:11], s47 offen lds
    s_mov_b64 exec, -1
    s_waitcnt vmcnt(17)
    s_barrier
    s_waitcnt lgkmcnt(4)
    v_mfma_f32_16x16x32_bf16 v[64:67], v[100:103], v[20:23], v[64:67]
    ds_read_b64_tr_b16 v[16:17], v50 offset:0
    s_add_u32 m0, s96, 15360
    s_add_u32 s47, s72, 774144
    s_mov_b64 exec, s[92:93]
    buffer_load_dwordx4 v8, s[8:11], s47 offen lds
    s_mov_b64 exec, -1
    v_mfma_f32_16x16x32_bf16 v[68:71], v[104:107], v[20:23], v[68:71]
    ds_read_b64_tr_b16 v[18:19], v50 offset:7680
    s_add_u32 m0, s96, 19200
    s_add_u32 s47, s72, 801792
    s_mov_b64 exec, s[92:93]
    buffer_load_dwordx4 v8, s[8:11], s47 offen lds
    s_mov_b64 exec, -1
    s_waitcnt lgkmcnt(4)
    v_mfma_f32_16x16x32_bf16 v[72:75], v[100:103], v[24:27], v[72:75]
    ds_read_b64_tr_b16 v[20:21], v54 offset:0
    s_add_u32 m0, s96, 23040
    s_add_u32 s47, s72, 829440
    s_mov_b64 exec, s[92:93]
    buffer_load_dwordx4 v8, s[8:11], s47 offen lds
    s_mov_b64 exec, -1
    v_mfma_f32_16x16x32_bf16 v[76:79], v[104:107], v[24:27], v[76:79]
    ds_read_b64_tr_b16 v[22:23], v54 offset:7680
    s_add_u32 m0, s96, 26880
    s_add_u32 s47, s72, 857088
    s_mov_b64 exec, s[92:93]
    buffer_load_dwordx4 v8, s[8:11], s47 offen lds
    s_mov_b64 exec, -1
    s_waitcnt lgkmcnt(4)
    v_mfma_f32_16x16x32_bf16 v[80:83], v[100:103], v[28:31], v[80:83]
    ds_read_b64_tr_b16 v[24:25], v54 offset:40
    s_add_u32 m0, s96, 30720
    s_add_u32 s47, s72, 884736
    s_mov_b64 exec, s[92:93]
    buffer_load_dwordx4 v8, s[8:11], s47 offen lds
    s_mov_b64 exec, -1
    v_mfma_f32_16x16x32_bf16 v[84:87], v[104:107], v[28:31], v[84:87]
    ds_read_b64_tr_b16 v[26:27], v54 offset:7720
    s_add_u32 m0, s96, 34560
    s_add_u32 s47, s72, 912384
    s_mov_b64 exec, s[92:93]
    buffer_load_dwordx4 v8, s[8:11], s47 offen lds
    s_mov_b64 exec, -1
    s_waitcnt lgkmcnt(4)
    v_mfma_f32_16x16x32_bf16 v[56:59], v[16:19], v[108:111], v[56:59]
    ds_read_b64_tr_b16 v[28:29], v51 offset:0
    s_add_u32 m0, s96, 38400
    s_add_u32 s47, s72, 940032
    s_mov_b64 exec, s[92:93]
    buffer_load_dwordx4 v8, s[8:11], s47 offen lds
    s_mov_b64 exec, -1
    v_mfma_f32_16x16x32_bf16 v[60:63], v[16:19], v[112:115], v[60:63]
    ds_read_b64_tr_b16 v[30:31], v51 offset:7680
    s_add_u32 m0, s96, 42240
    s_add_u32 s47, s72, 967680
    s_mov_b64 exec, s[92:93]
    buffer_load_dwordx4 v8, s[8:11], s47 offen lds
    s_mov_b64 exec, -1
    s_waitcnt vmcnt(21)
    s_barrier
    s_waitcnt lgkmcnt(4)
    v_mfma_f32_16x16x32_bf16 v[64:67], v[108:111], v[20:23], v[64:67]
    ds_read_b64_tr_b16 v[16:17], v50 offset:18432
    s_lshl_b32 s45, s48, 7
    s_add_u32 s45, s45, s73
    s_add_u32 m0, s46, 73728
    s_add_u32 s47, s45, 0
    buffer_load_dwordx4 v10, s[16:19], s47 offen lds
    v_mfma_f32_16x16x32_bf16 v[68:71], v[112:115], v[20:23], v[68:71]
    ds_read_b64_tr_b16 v[18:19], v50 offset:26112
    s_add_u32 m0, s46, 77824
    s_add_u32 s47, s45, 294912
    buffer_load_dwordx4 v10, s[16:19], s47 offen lds
    s_waitcnt lgkmcnt(4)
    v_mfma_f32_16x16x32_bf16 v[72:75], v[108:111], v[24:27], v[72:75]
    ds_read_b64_tr_b16 v[20:21], v54 offset:18432
    s_add_u32 m0, s46, 81920
    s_add_u32 s47, s45, 589824
    buffer_load_dwordx4 v10, s[16:19], s47 offen lds
    v_mfma_f32_16x16x32_bf16 v[76:79], v[112:115], v[24:27], v[76:79]
    ds_read_b64_tr_b16 v[22:23], v54 offset:26112
    s_add_u32 m0, s46, 86016
    s_add_u32 s47, s45, 884736
    buffer_load_dwordx4 v10, s[16:19], s47 offen lds
    s_waitcnt lgkmcnt(4)
    v_mfma_f32_16x16x32_bf16 v[80:83], v[108:111], v[28:31], v[80:83]
    ds_read_b64_tr_b16 v[24:25], v54 offset:18472
    s_add_u32 m0, s46, 90112
    s_add_u32 s47, s45, 1179648
    buffer_load_dwordx4 v10, s[16:19], s47 offen lds
    v_mfma_f32_16x16x32_bf16 v[84:87], v[112:115], v[28:31], v[84:87]
    ds_read_b64_tr_b16 v[26:27], v54 offset:26152
    s_add_u32 m0, s46, 94208
    s_add_u32 s47, s45, 1474560
    buffer_load_dwordx4 v10, s[16:19], s47 offen lds
    s_waitcnt lgkmcnt(4)
    v_mfma_f32_16x16x32_bf16 v[56:59], v[16:19], v[116:119], v[56:59]
    ds_read_b64_tr_b16 v[28:29], v51 offset:18432
    v_mfma_f32_16x16x32_bf16 v[60:63], v[16:19], v[120:123], v[60:63]
    ds_read_b64_tr_b16 v[30:31], v51 offset:26112
    s_waitcnt vmcnt(23)
    s_barrier
    s_waitcnt lgkmcnt(4)
    v_mfma_f32_16x16x32_bf16 v[64:67], v[116:119], v[20:23], v[64:67]
    ds_read_b64_tr_b16 v[16:17], v50 offset:33792
    s_lshl_b32 s45, s48, 7
    s_add_u32 s45, s45, s73
    s_add_u32 m0, s46, 98304
    s_add_u32 s47, s45, 1769472
    buffer_load_dwordx4 v10, s[16:19], s47 offen lds
    v_mfma_f32_16x16x32_bf16 v[68:71], v[120:123], v[20:23], v[68:71]
    ds_read_b64_tr_b16 v[18:19], v50 offset:41472
    s_add_u32 m0, s46, 102400
    s_add_u32 s47, s45, 2064384
    buffer_load_dwordx4 v10, s[16:19], s47 offen lds
    s_waitcnt lgkmcnt(4)
    v_mfma_f32_16x16x32_bf16 v[72:75], v[116:119], v[24:27], v[72:75]
    ds_read_b64_tr_b16 v[20:21], v54 offset:33792
    s_add_u32 m0, s46, 106496
    s_add_u32 s47, s45, 2359296
    buffer_load_dwordx4 v10, s[16:19], s47 offen lds
    v_mfma_f32_16x16x32_bf16 v[76:79], v[120:123], v[24:27], v[76:79]
    ds_read_b64_tr_b16 v[22:23], v54 offset:41472
    s_add_u32 m0, s46, 110592
    s_add_u32 s47, s45, 2654208
    buffer_load_dwordx4 v10, s[16:19], s47 offen lds
    s_waitcnt lgkmcnt(4)
    v_mfma_f32_16x16x32_bf16 v[80:83], v[116:119], v[28:31], v[80:83]
    ds_read_b64_tr_b16 v[24:25], v54 offset:33832
    s_add_u32 m0, s46, 114688
    s_add_u32 s47, s45, 2949120
    buffer_load_dwordx4 v10, s[16:19], s47 offen lds
    v_mfma_f32_16x16x32_bf16 v[84:87], v[120:123], v[28:31], v[84:87]
    ds_read_b64_tr_b16 v[26:27], v54 offset:41512
    s_add_u32 m0, s46, 118784
    s_add_u32 s47, s45, 3244032
    buffer_load_dwordx4 v10, s[16:19], s47 offen lds
    s_waitcnt lgkmcnt(4)
    v_mfma_f32_16x16x32_bf16 v[56:59], v[16:19], v[124:127], v[56:59]
    ds_read_b64_tr_b16 v[28:29], v51 offset:33792
    v_mfma_f32_16x16x32_bf16 v[60:63], v[16:19], v[128:131], v[60:63]
    ds_read_b64_tr_b16 v[30:31], v51 offset:41472
    s_waitcnt vmcnt(24)
    s_barrier
    s_waitcnt lgkmcnt(4)
    v_mfma_f32_16x16x32_bf16 v[64:67], v[124:127], v[20:23], v[64:67]
    ds_read_b64_tr_b16 v[16:17], v48 offset:0
    s_add_u32 m0, s96, 122880
    s_add_u32 s47, s72, 995328
    s_mov_b64 exec, s[92:93]
    buffer_load_dwordx4 v8, s[8:11], s47 offen lds
    s_mov_b64 exec, -1
    v_mfma_f32_16x16x32_bf16 v[68:71], v[128:131], v[20:23], v[68:71]
    ds_read_b64_tr_b16 v[18:19], v48 offset:7680
    s_add_u32 m0, s96, 126720
    s_add_u32 s47, s72, 1022976
    s_mov_b64 exec, s[92:93]
    buffer_load_dwordx4 v8, s[8:11], s47 offen lds
    s_mov_b64 exec, -1
    s_waitcnt lgkmcnt(4)
    v_mfma_f32_16x16x32_bf16 v[72:75], v[124:127], v[24:27], v[72:75]
    ds_read_b64_tr_b16 v[20:21], v53 offset:0
    s_add_u32 m0, s96, 130560
    s_add_u32 s47, s72, 1050624
    s_mov_b64 exec, s[92:93]
    buffer_load_dwordx4 v8, s[8:11], s47 offen lds
    s_mov_b64 exec, -1
    v_mfma_f32_16x16x32_bf16 v[76:79], v[128:131], v[24:27], v[76:79]
    ds_read_b64_tr_b16 v[22:23], v53 offset:7680
    s_add_u32 m0, s96, 134400
    s_add_u32 s47, s72, 1078272
    s_mov_b64 exec, s[92:93]
    buffer_load_dwordx4 v8, s[8:11], s47 offen lds
    s_mov_b64 exec, -1
    s_waitcnt lgkmcnt(4)
    v_mfma_f32_16x16x32_bf16 v[80:83], v[124:127], v[28:31], v[80:83]
    ds_read_b64_tr_b16 v[24:25], v53 offset:40
    v_mfma_f32_16x16x32_bf16 v[84:87], v[128:131], v[28:31], v[84:87]
    ds_read_b64_tr_b16 v[26:27], v53 offset:7720
    s_waitcnt lgkmcnt(4)
    v_mfma_f32_16x16x32_bf16 v[56:59], v[16:19], v[132:135], v[56:59]
    ds_read_b64_tr_b16 v[28:29], v49 offset:0
    v_mfma_f32_16x16x32_bf16 v[60:63], v[16:19], v[136:139], v[60:63]
    ds_read_b64_tr_b16 v[30:31], v49 offset:7680
    s_waitcnt vmcnt(24)
    s_barrier
    s_waitcnt lgkmcnt(4)
    v_mfma_f32_16x16x32_bf16 v[64:67], v[132:135], v[20:23], v[64:67]
    ds_read_b64_tr_b16 v[16:17], v5 offset:0
    s_add_u32 m0, s96, 138240
    s_add_u32 s47, s72, 1105920
    s_mov_b64 exec, s[92:93]
    buffer_load_dwordx4 v8, s[8:11], s47 offen lds
    s_mov_b64 exec, -1
    v_mfma_f32_16x16x32_bf16 v[68:71], v[136:139], v[20:23], v[68:71]
    ds_read_b64_tr_b16 v[18:19], v5 offset:7680
    s_add_u32 m0, s96, 142080
    s_add_u32 s47, s72, 1133568
    s_mov_b64 exec, s[92:93]
    buffer_load_dwordx4 v8, s[8:11], s47 offen lds
    s_mov_b64 exec, -1
    s_waitcnt lgkmcnt(4)
    v_mfma_f32_16x16x32_bf16 v[72:75], v[132:135], v[24:27], v[72:75]
    ds_read_b64_tr_b16 v[20:21], v52 offset:0
    s_add_u32 m0, s96, 145920
    s_add_u32 s47, s72, 1161216
    s_mov_b64 exec, s[92:93]
    buffer_load_dwordx4 v8, s[8:11], s47 offen lds
    s_mov_b64 exec, -1
    v_mfma_f32_16x16x32_bf16 v[76:79], v[136:139], v[24:27], v[76:79]
    ds_read_b64_tr_b16 v[22:23], v52 offset:7680
    s_add_u32 m0, s96, 149760
    s_add_u32 s47, s72, 1188864
    s_mov_b64 exec, s[92:93]
    buffer_load_dwordx4 v8, s[8:11], s47 offen lds
    s_mov_b64 exec, -1
    s_waitcnt lgkmcnt(4)
    v_mfma_f32_16x16x32_bf16 v[80:83], v[132:135], v[28:31], v[80:83]
    ds_read_b64_tr_b16 v[24:25], v52 offset:40
    v_mfma_f32_16x16x32_bf16 v[84:87], v[136:139], v[28:31], v[84:87]
    ds_read_b64_tr_b16 v[26:27], v52 offset:7720
    s_waitcnt lgkmcnt(4)
    v_mfma_f32_16x16x32_bf16 v[56:59], v[16:19], v[140:143], v[56:59]
    ds_read_b64_tr_b16 v[28:29], v6 offset:0
    v_mfma_f32_16x16x32_bf16 v[60:63], v[16:19], v[144:147], v[60:63]
    ds_read_b64_tr_b16 v[30:31], v6 offset:7680
    s_waitcnt vmcnt(24)
    s_barrier
    s_waitcnt lgkmcnt(4)
    v_mfma_f32_16x16x32_bf16 v[64:67], v[140:143], v[20:23], v[64:67]
    ds_read_b64_tr_b16 v[16:17], v5 offset:15360
    s_add_u32 m0, s96, 52224
    s_add_u32 s47, s72, 1216512
    s_mov_b64 exec, s[92:93]
    buffer_load_dwordx4 v8, s[8:11], s47 offen lds
    s_mov_b64 exec, -1
    v_mfma_f32_16x16x32_bf16 v[68:71], v[144:147], v[20:23], v[68:71]
    ds_read_b64_tr_b16 v[18:19], v5 offset:23040
    s_add_u32 m0, s96, 56064
    s_add_u32 s47, s72, 1244160
    s_mov_b64 exec, s[92:93]
    buffer_load_dwordx4 v8, s[8:11], s47 offen lds
    s_mov_b64 exec, -1
    s_waitcnt lgkmcnt(4)
    v_mfma_f32_16x16x32_bf16 v[72:75], v[140:143], v[24:27], v[72:75]
    ds_read_b64_tr_b16 v[20:21], v52 offset:15360
    s_add_u32 m0, s96, 59904
    s_add_u32 s47, s72, 1271808
    s_mov_b64 exec, s[92:93]
    buffer_load_dwordx4 v8, s[8:11], s47 offen lds
    s_mov_b64 exec, -1
    v_mfma_f32_16x16x32_bf16 v[76:79], v[144:147], v[24:27], v[76:79]
    ds_read_b64_tr_b16 v[22:23], v52 offset:23040
    s_add_u32 m0, s96, 63744
    s_add_u32 s47, s72, 1299456
    s_mov_b64 exec, s[92:93]
    buffer_load_dwordx4 v8, s[8:11], s47 offen lds
    s_mov_b64 exec, -1
    s_waitcnt lgkmcnt(4)
    v_mfma_f32_16x16x32_bf16 v[80:83], v[140:143], v[28:31], v[80:83]
    ds_read_b64_tr_b16 v[24:25], v52 offset:15400
    v_mfma_f32_16x16x32_bf16 v[84:87], v[144:147], v[28:31], v[84:87]
    ds_read_b64_tr_b16 v[26:27], v52 offset:23080
    s_waitcnt lgkmcnt(4)
    v_mfma_f32_16x16x32_bf16 v[56:59], v[16:19], v[148:151], v[56:59]
    ds_read_b64_tr_b16 v[28:29], v6 offset:15360
    v_mfma_f32_16x16x32_bf16 v[60:63], v[16:19], v[152:155], v[60:63]
    ds_read_b64_tr_b16 v[30:31], v6 offset:23040
    s_waitcnt vmcnt(24)
    s_barrier
    s_waitcnt lgkmcnt(4)
    v_mfma_f32_16x16x32_bf16 v[64:67], v[148:151], v[20:23], v[64:67]
    ds_read_b64_tr_b16 v[16:17], v5 offset:30720
    s_add_u32 m0, s96, 0
    s_add_u32 s47, s72, 1327104
    s_mov_b64 exec, s[92:93]
    buffer_load_dwordx4 v8, s[8:11], s47 offen lds
    s_mov_b64 exec, -1
    v_mfma_f32_16x16x32_bf16 v[68:71], v[152:155], v[20:23], v[68:71]
    ds_read_b64_tr_b16 v[18:19], v5 offset:38400
    s_add_u32 m0, s96, 3840
    s_add_u32 s47, s72, 1354752
    s_mov_b64 exec, s[92:93]
    buffer_load_dwordx4 v8, s[8:11], s47 offen lds
    s_mov_b64 exec, -1
    s_waitcnt lgkmcnt(4)
    v_mfma_f32_16x16x32_bf16 v[72:75], v[148:151], v[24:27], v[72:75]
    ds_read_b64_tr_b16 v[20:21], v52 offset:30720
    s_add_u32 m0, s96, 7680
    s_add_u32 s47, s72, 1382400
    s_mov_b64 exec, s[92:93]
    buffer_load_dwordx4 v8, s[8:11], s47 offen lds
    s_mov_b64 exec, -1
    v_mfma_f32_16x16x32_bf16 v[76:79], v[152:155], v[24:27], v[76:79]
    ds_read_b64_tr_b16 v[22:23], v52 offset:38400
    s_add_u32 m0, s96, 11520
    s_add_u32 s47, s72, 1410048
    s_mov_b64 exec, s[92:93]
    buffer_load_dwordx4 v8, s[8:11], s47 offen lds
    s_mov_b64 exec, -1
    s_waitcnt lgkmcnt(4)
    v_mfma_f32_16x16x32_bf16 v[80:83], v[148:151], v[28:31], v[80:83]
    ds_read_b64_tr_b16 v[24:25], v52 offset:30760
    v_mfma_f32_16x16x32_bf16 v[84:87], v[152:155], v[28:31], v[84:87]
    ds_read_b64_tr_b16 v[26:27], v52 offset:38440
    s_waitcnt lgkmcnt(4)
    v_mfma_f32_16x16x32_bf16 v[56:59], v[16:19], v[156:159], v[56:59]
    ds_read_b64_tr_b16 v[28:29], v6 offset:30720
    v_mfma_f32_16x16x32_bf16 v[60:63], v[16:19], v[160:163], v[60:63]
    ds_read_b64_tr_b16 v[30:31], v6 offset:38400
    s_waitcnt vmcnt(12)
    s_barrier
    s_waitcnt lgkmcnt(4)
    v_mfma_f32_16x16x32_bf16 v[64:67], v[156:159], v[20:23], v[64:67]
    ds_read_b64_tr_b16 v[16:17], v50 offset:18432
    s_add_u32 m0, s96, 15360
    s_add_u32 s47, s72, 1437696
    s_mov_b64 exec, s[92:93]
    buffer_load_dwordx4 v8, s[8:11], s47 offen lds
    s_mov_b64 exec, -1
    v_mfma_f32_16x16x32_bf16 v[68:71], v[160:163], v[20:23], v[68:71]
    ds_read_b64_tr_b16 v[18:19], v50 offset:26112
    s_add_u32 m0, s96, 19200
    s_add_u32 s47, s72, 1465344
    s_mov_b64 exec, s[92:93]
    buffer_load_dwordx4 v8, s[8:11], s47 offen lds
    s_mov_b64 exec, -1
    s_waitcnt lgkmcnt(4)
    v_mfma_f32_16x16x32_bf16 v[72:75], v[156:159], v[24:27], v[72:75]
    ds_read_b64_tr_b16 v[20:21], v54 offset:18432
    s_add_u32 m0, s96, 23040
    s_add_u32 s47, s72, 1492992
    s_mov_b64 exec, s[92:93]
    buffer_load_dwordx4 v8, s[8:11], s47 offen lds
    s_mov_b64 exec, -1
    v_mfma_f32_16x16x32_bf16 v[76:79], v[160:163], v[24:27], v[76:79]
    ds_read_b64_tr_b16 v[22:23], v54 offset:26112
    s_add_u32 m0, s96, 26880
    s_add_u32 s47, s72, 1520640
    s_mov_b64 exec, s[92:93]
    buffer_load_dwordx4 v8, s[8:11], s47 offen lds
    s_mov_b64 exec, -1
    s_waitcnt lgkmcnt(4)
    v_mfma_f32_16x16x32_bf16 v[80:83], v[156:159], v[28:31], v[80:83]
    ds_read_b64_tr_b16 v[24:25], v54 offset:18472
    v_mfma_f32_16x16x32_bf16 v[84:87], v[160:163], v[28:31], v[84:87]
    ds_read_b64_tr_b16 v[26:27], v54 offset:26152
    s_waitcnt lgkmcnt(4)
    v_mfma_f32_16x16x32_bf16 v[56:59], v[16:19], v[164:167], v[56:59]
    ds_read_b64_tr_b16 v[28:29], v51 offset:18432
    v_mfma_f32_16x16x32_bf16 v[60:63], v[16:19], v[168:171], v[60:63]
    ds_read_b64_tr_b16 v[30:31], v51 offset:26112
    s_waitcnt vmcnt(12)
    s_barrier
    s_waitcnt lgkmcnt(4)
    v_mfma_f32_16x16x32_bf16 v[64:67], v[164:167], v[20:23], v[64:67]
    ds_read_b64_tr_b16 v[16:17], v50 offset:33792
    s_add_u32 m0, s96, 30720
    s_add_u32 s47, s72, 1548288
    s_mov_b64 exec, s[92:93]
    buffer_load_dwordx4 v8, s[8:11], s47 offen lds
    s_mov_b64 exec, -1
    v_mfma_f32_16x16x32_bf16 v[68:71], v[168:171], v[20:23], v[68:71]
    ds_read_b64_tr_b16 v[18:19], v50 offset:41472
    s_add_u32 m0, s96, 34560
    s_add_u32 s47, s72, 1575936
    s_mov_b64 exec, s[92:93]
    buffer_load_dwordx4 v8, s[8:11], s47 offen lds
    s_mov_b64 exec, -1
    s_waitcnt lgkmcnt(4)
    v_mfma_f32_16x16x32_bf16 v[72:75], v[164:167], v[24:27], v[72:75]
    ds_read_b64_tr_b16 v[20:21], v54 offset:33792
    s_add_u32 m0, s96, 38400
    s_add_u32 s47, s72, 1603584
    s_mov_b64 exec, s[92:93]
    buffer_load_dwordx4 v8, s[8:11], s47 offen lds
    s_mov_b64 exec, -1
    v_mfma_f32_16x16x32_bf16 v[76:79], v[168:171], v[24:27], v[76:79]
    ds_read_b64_tr_b16 v[22:23], v54 offset:41472
    s_add_u32 m0, s96, 42240
    s_add_u32 s47, s72, 1631232
    s_mov_b64 exec, s[92:93]
    buffer_load_dwordx4 v8, s[8:11], s47 offen lds
    s_mov_b64 exec, -1
    s_waitcnt lgkmcnt(4)
    v_mfma_f32_16x16x32_bf16 v[80:83], v[164:167], v[28:31], v[80:83]
    ds_read_b64_tr_b16 v[24:25], v54 offset:33832
    v_mfma_f32_16x16x32_bf16 v[84:87], v[168:171], v[28:31], v[84:87]
    ds_read_b64_tr_b16 v[26:27], v54 offset:41512
    s_waitcnt lgkmcnt(4)
    v_mfma_f32_16x16x32_bf16 v[56:59], v[16:19], v[172:175], v[56:59]
    ds_read_b64_tr_b16 v[28:29], v51 offset:33792
    v_mfma_f32_16x16x32_bf16 v[60:63], v[16:19], v[176:179], v[60:63]
    ds_read_b64_tr_b16 v[30:31], v51 offset:41472
    s_waitcnt vmcnt(12)
    s_barrier
    s_waitcnt lgkmcnt(4)
    v_mfma_f32_16x16x32_bf16 v[64:67], v[172:175], v[20:23], v[64:67]
    ds_read_b64_tr_b16 v[16:17], v48 offset:0
    s_add_u32 m0, s96, 122880
    s_add_u32 s47, s72, 1658880
    s_mov_b64 exec, s[92:93]
    buffer_load_dwordx4 v8, s[8:11], s47 offen lds
    s_mov_b64 exec, -1
    v_mfma_f32_16x16x32_bf16 v[68:71], v[176:179], v[20:23], v[68:71]
    ds_read_b64_tr_b16 v[18:19], v48 offset:7680
    s_add_u32 m0, s96, 126720
    s_add_u32 s47, s72, 1686528
    s_mov_b64 exec, s[92:93]
    buffer_load_dwordx4 v8, s[8:11], s47 offen lds
    s_mov_b64 exec, -1
    s_waitcnt lgkmcnt(4)
    v_mfma_f32_16x16x32_bf16 v[72:75], v[172:175], v[24:27], v[72:75]
    ds_read_b64_tr_b16 v[20:21], v53 offset:0
    s_add_u32 m0, s96, 130560
    s_add_u32 s47, s72, 1714176
    s_mov_b64 exec, s[92:93]
    buffer_load_dwordx4 v8, s[8:11], s47 offen lds
    s_mov_b64 exec, -1
    v_mfma_f32_16x16x32_bf16 v[76:79], v[176:179], v[24:27], v[76:79]
    ds_read_b64_tr_b16 v[22:23], v53 offset:7680
    s_add_u32 m0, s96, 134400
    s_add_u32 s47, s72, 1741824
    s_mov_b64 exec, s[92:93]
    buffer_load_dwordx4 v8, s[8:11], s47 offen lds
    s_mov_b64 exec, -1
    s_waitcnt lgkmcnt(4)
    v_mfma_f32_16x16x32_bf16 v[80:83], v[172:175], v[28:31], v[80:83]
    ds_read_b64_tr_b16 v[24:25], v53 offset:40
    v_mfma_f32_16x16x32_bf16 v[84:87], v[176:179], v[28:31], v[84:87]
    ds_read_b64_tr_b16 v[26:27], v53 offset:7720
    s_waitcnt lgkmcnt(4)
    v_mfma_f32_16x16x32_bf16 v[56:59], v[16:19], v[180:183], v[56:59]
    ds_read_b64_tr_b16 v[28:29], v49 offset:0
    v_mfma_f32_16x16x32_bf16 v[60:63], v[16:19], v[184:187], v[60:63]
    ds_read_b64_tr_b16 v[30:31], v49 offset:7680
    s_waitcnt vmcnt(12)
    s_barrier
    s_waitcnt lgkmcnt(4)
    v_mfma_f32_16x16x32_bf16 v[64:67], v[180:183], v[20:23], v[64:67]
    ds_read_b64_tr_b16 v[16:17], v5 offset:0
    s_add_u32 m0, s96, 138240
    s_add_u32 s47, s72, 1769472
    s_mov_b64 exec, s[92:93]
    buffer_load_dwordx4 v8, s[8:11], s47 offen lds
    s_mov_b64 exec, -1
    v_mfma_f32_16x16x32_bf16 v[68:71], v[184:187], v[20:23], v[68:71]
    ds_read_b64_tr_b16 v[18:19], v5 offset:7680
    s_add_u32 m0, s96, 142080
    s_add_u32 s47, s72, 1797120
    s_mov_b64 exec, s[92:93]
    buffer_load_dwordx4 v8, s[8:11], s47 offen lds
    s_mov_b64 exec, -1
    s_waitcnt lgkmcnt(4)
    v_mfma_f32_16x16x32_bf16 v[72:75], v[180:183], v[24:27], v[72:75]
    ds_read_b64_tr_b16 v[20:21], v52 offset:0
    s_add_u32 m0, s96, 145920
    s_add_u32 s47, s72, 1824768
    s_mov_b64 exec, s[92:93]
    buffer_load_dwordx4 v8, s[8:11], s47 offen lds
    s_mov_b64 exec, -1
    v_mfma_f32_16x16x32_bf16 v[76:79], v[184:187], v[24:27], v[76:79]
    ds_read_b64_tr_b16 v[22:23], v52 offset:7680
    s_add_u32 m0, s96, 149760
    s_add_u32 s47, s72, 1852416
    s_mov_b64 exec, s[92:93]
    buffer_load_dwordx4 v8, s[8:11], s47 offen lds
    s_mov_b64 exec, -1
    s_waitcnt lgkmcnt(4)
    v_mfma_f32_16x16x32_bf16 v[80:83], v[180:183], v[28:31], v[80:83]
    ds_read_b64_tr_b16 v[24:25], v52 offset:40
    v_mfma_f32_16x16x32_bf16 v[84:87], v[184:187], v[28:31], v[84:87]
    ds_read_b64_tr_b16 v[26:27], v52 offset:7720
    s_waitcnt lgkmcnt(4)
    v_mfma_f32_16x16x32_bf16 v[56:59], v[16:19], v[188:191], v[56:59]
    ds_read_b64_tr_b16 v[28:29], v6 offset:0
    v_mfma_f32_16x16x32_bf16 v[60:63], v[16:19], v[192:195], v[60:63]
    ds_read_b64_tr_b16 v[30:31], v6 offset:7680
    s_waitcnt vmcnt(12)
    s_barrier
    s_waitcnt lgkmcnt(4)
    v_mfma_f32_16x16x32_bf16 v[64:67], v[188:191], v[20:23], v[64:67]
    ds_read_b64_tr_b16 v[16:17], v5 offset:15360
    s_add_u32 m0, s96, 52224
    s_add_u32 s47, s72, 1880064
    s_mov_b64 exec, s[92:93]
    buffer_load_dwordx4 v8, s[8:11], s47 offen lds
    s_mov_b64 exec, -1
    v_mfma_f32_16x16x32_bf16 v[68:71], v[192:195], v[20:23], v[68:71]
    ds_read_b64_tr_b16 v[18:19], v5 offset:23040
    s_add_u32 m0, s96, 56064
    s_add_u32 s47, s72, 1907712
    s_mov_b64 exec, s[92:93]
    buffer_load_dwordx4 v8, s[8:11], s47 offen lds
    s_mov_b64 exec, -1
    s_waitcnt lgkmcnt(4)
    v_mfma_f32_16x16x32_bf16 v[72:75], v[188:191], v[24:27], v[72:75]
    ds_read_b64_tr_b16 v[20:21], v52 offset:15360
    s_add_u32 m0, s96, 59904
    s_add_u32 s47, s72, 1935360
    s_mov_b64 exec, s[92:93]
    buffer_load_dwordx4 v8, s[8:11], s47 offen lds
    s_mov_b64 exec, -1
    v_mfma_f32_16x16x32_bf16 v[76:79], v[192:195], v[24:27], v[76:79]
    ds_read_b64_tr_b16 v[22:23], v52 offset:23040
    s_add_u32 m0, s96, 63744
    s_add_u32 s47, s72, 1963008
    s_mov_b64 exec, s[92:93]
    buffer_load_dwordx4 v8, s[8:11], s47 offen lds
    s_mov_b64 exec, -1
    s_waitcnt lgkmcnt(4)
    v_mfma_f32_16x16x32_bf16 v[80:83], v[188:191], v[28:31], v[80:83]
    ds_read_b64_tr_b16 v[24:25], v52 offset:15400
    s_lshl_b32 s42, s41, 6
    s_add_u32 s42, s42, 0
    v_add_u32 v252, s42, v1
    s_mul_i32 s43, s97, 12
    s_add_u32 s43, s43, 384
    v_min_u32 v253, 107, v252
    v_mul_u32_u24 v254, 456, v253
    v_lshrrev_b32 v254, 12, v254
    v_mul_u32_u24 v255, 9, v254
    v_sub_u32 v253, v253, v255
    v_add_u32 v254, s43, v254
    v_mul_u32_u24 v254, 9216, v254
    v_lshl_add_u32 v254, v253, 7, v254
    buffer_load_dword v89, v254, s[16:19], s73 offen
    v_mfma_f32_16x16x32_bf16 v[84:87], v[192:195], v[28:31], v[84:87]
    ds_read_b64_tr_b16 v[26:27], v52 offset:23080
    s_waitcnt lgkmcnt(4)
    v_mfma_f32_16x16x32_bf16 v[56:59], v[16:19], v[196:199], v[56:59]
    ds_read_b64_tr_b16 v[28:29], v6 offset:15360
    v_mfma_f32_16x16x32_bf16 v[60:63], v[16:19], v[200:203], v[60:63]
    ds_read_b64_tr_b16 v[30:31], v6 offset:23040
    s_waitcnt vmcnt(13)
    s_barrier
    s_waitcnt lgkmcnt(4)
    v_mfma_f32_16x16x32_bf16 v[64:67], v[196:199], v[20:23], v[64:67]
    ds_read_b64_tr_b16 v[16:17], v5 offset:30720
    v_mfma_f32_16x16x32_bf16 v[68:71], v[200:203], v[20:23], v[68:71]
    ds_read_b64_tr_b16 v[18:19], v5 offset:38400
    s_waitcnt lgkmcnt(4)
    v_mfma_f32_16x16x32_bf16 v[72:75], v[196:199], v[24:27], v[72:75]
    ds_read_b64_tr_b16 v[20:21], v52 offset:30720
    v_mfma_f32_16x16x32_bf16 v[76:79], v[200:203], v[24:27], v[76:79]
    ds_read_b64_tr_b16 v[22:23], v52 offset:38400
    s_waitcnt lgkmcnt(4)
    v_mfma_f32_16x16x32_bf16 v[80:83], v[196:199], v[28:31], v[80:83]
    ds_read_b64_tr_b16 v[24:25], v52 offset:30760
    v_mfma_f32_16x16x32_bf16 v[84:87], v[200:203], v[28:31], v[84:87]
    ds_read_b64_tr_b16 v[26:27], v52 offset:38440
    s_waitcnt lgkmcnt(4)
    v_mfma_f32_16x16x32_bf16 v[56:59], v[16:19], v[204:207], v[56:59]
    ds_read_b64_tr_b16 v[28:29], v6 offset:30720
    v_mfma_f32_16x16x32_bf16 v[60:63], v[16:19], v[208:211], v[60:63]
    ds_read_b64_tr_b16 v[30:31], v6 offset:38400
    s_waitcnt vmcnt(9)
    s_barrier
    s_waitcnt lgkmcnt(4)
    v_mfma_f32_16x16x32_bf16 v[64:67], v[204:207], v[20:23], v[64:67]
    ds_read_b64_tr_b16 v[16:17], v50 offset:18432
    s_lshl_b32 s45, s48, 7
    s_add_u32 s45, s45, s73
    s_add_u32 m0, s46, 0
    s_add_u32 s47, s45, 3538944
    buffer_load_dwordx4 v10, s[16:19], s47 offen lds
    v_mfma_f32_16x16x32_bf16 v[68:71], v[208:211], v[20:23], v[68:71]
    ds_read_b64_tr_b16 v[18:19], v50 offset:26112
    s_add_u32 m0, s46, 4096
    s_add_u32 s47, s45, 3833856
    buffer_load_dwordx4 v10, s[16:19], s47 offen lds
    s_waitcnt lgkmcnt(4)
    v_mfma_f32_16x16x32_bf16 v[72:75], v[204:207], v[24:27], v[72:75]
    ds_read_b64_tr_b16 v[20:21], v54 offset:18432
    s_add_u32 m0, s46, 8192
    s_add_u32 s47, s45, 4128768
    buffer_load_dwordx4 v10, s[16:19], s47 offen lds
    v_mfma_f32_16x16x32_bf16 v[76:79], v[208:211], v[24:27], v[76:79]
    ds_read_b64_tr_b16 v[22:23], v54 offset:26112
    s_add_u32 m0, s46, 12288
    s_add_u32 s47, s45, 4423680
    buffer_load_dwordx4 v10, s[16:19], s47 offen lds
    s_waitcnt lgkmcnt(4)
    v_mfma_f32_16x16x32_bf16 v[80:83], v[204:207], v[28:31], v[80:83]
    ds_read_b64_tr_b16 v[24:25], v54 offset:18472
    s_add_u32 m0, s46, 16384
    s_add_u32 s47, s45, 4718592
    buffer_load_dwordx4 v10, s[16:19], s47 offen lds
    v_mfma_f32_16x16x32_bf16 v[84:87], v[208:211], v[28:31], v[84:87]
    ds_read_b64_tr_b16 v[26:27], v54 offset:26152
    s_add_u32 m0, s46, 20480
    s_add_u32 s47, s45, 5013504
    buffer_load_dwordx4 v10, s[16:19], s47 offen lds
    s_waitcnt lgkmcnt(4)
    v_mfma_f32_16x16x32_bf16 v[56:59], v[16:19], v[212:215], v[56:59]
    ds_read_b64_tr_b16 v[28:29], v51 offset:18432
    v_mfma_f32_16x16x32_bf16 v[60:63], v[16:19], v[216:219], v[60:63]
    ds_read_b64_tr_b16 v[30:31], v51 offset:26112
    s_waitcnt vmcnt(11)
    s_barrier
    s_waitcnt lgkmcnt(4)
    v_mfma_f32_16x16x32_bf16 v[64:67], v[212:215], v[20:23], v[64:67]
    ds_read_b64_tr_b16 v[16:17], v50 offset:33792
    s_lshl_b32 s45, s49, 7
    s_add_u32 s45, s45, s73
    s_add_u32 m0, s46, 24576
    s_add_u32 s47, s45, 0
    buffer_load_dwordx4 v10, s[16:19], s47 offen lds
    v_mfma_f32_16x16x32_bf16 v[68:71], v[216:219], v[20:23], v[68:71]
    ds_read_b64_tr_b16 v[18:19], v50 offset:41472
    s_add_u32 m0, s46, 28672
    s_add_u32 s47, s45, 294912
    buffer_load_dwordx4 v10, s[16:19], s47 offen lds
    s_waitcnt lgkmcnt(4)
    v_mfma_f32_16x16x32_bf16 v[72:75], v[212:215], v[24:27], v[72:75]
    ds_read_b64_tr_b16 v[20:21], v54 offset:33792
    s_add_u32 m0, s46, 32768
    s_add_u32 s47, s45, 589824
    buffer_load_dwordx4 v10, s[16:19], s47 offen lds
    v_mfma_f32_16x16x32_bf16 v[76:79], v[216:219], v[24:27], v[76:79]
    ds_read_b64_tr_b16 v[22:23], v54 offset:41472
    s_add_u32 m0, s46, 36864
    s_add_u32 s47, s45, 884736
    buffer_load_dwordx4 v10, s[16:19], s47 offen lds
    s_waitcnt lgkmcnt(4)
    v_mfma_f32_16x16x32_bf16 v[80:83], v[212:215], v[28:31], v[80:83]
    ds_read_b64_tr_b16 v[24:25], v54 offset:33832
    s_add_u32 m0, s46, 40960
    s_add_u32 s47, s45, 1179648
    buffer_load_dwordx4 v10, s[16:19], s47 offen lds
    v_mfma_f32_16x16x32_bf16 v[84:87], v[216:219], v[28:31], v[84:87]
    ds_read_b64_tr_b16 v[26:27], v54 offset:41512
    s_add_u32 m0, s46, 45056
    s_add_u32 s47, s45, 1474560
    buffer_load_dwordx4 v10, s[16:19], s47 offen lds
    s_waitcnt lgkmcnt(4)
    v_mfma_f32_16x16x32_bf16 v[56:59], v[16:19], v[220:223], v[56:59]
    ds_read_b64_tr_b16 v[28:29], v51 offset:33792
    v_mfma_f32_16x16x32_bf16 v[60:63], v[16:19], v[224:227], v[60:63]
    ds_read_b64_tr_b16 v[30:31], v51 offset:41472
    s_waitcnt vmcnt(13)
    s_barrier
    s_waitcnt lgkmcnt(4)
    v_mfma_f32_16x16x32_bf16 v[64:67], v[220:223], v[20:23], v[64:67]
    ds_read_b64_tr_b16 v[16:17], v48 offset:0
    v_mfma_f32_16x16x32_bf16 v[68:71], v[224:227], v[20:23], v[68:71]
    ds_read_b64_tr_b16 v[18:19], v48 offset:7680
    s_waitcnt lgkmcnt(4)
    v_mfma_f32_16x16x32_bf16 v[72:75], v[220:223], v[24:27], v[72:75]
    ds_read_b64_tr_b16 v[20:21], v53 offset:0
    v_mfma_f32_16x16x32_bf16 v[76:79], v[224:227], v[24:27], v[76:79]
    ds_read_b64_tr_b16 v[22:23], v53 offset:7680
    s_waitcnt lgkmcnt(4)
    v_mfma_f32_16x16x32_bf16 v[80:83], v[220:223], v[28:31], v[80:83]
    ds_read_b64_tr_b16 v[24:25], v53 offset:40
    v_mfma_f32_16x16x32_bf16 v[84:87], v[224:227], v[28:31], v[84:87]
    ds_read_b64_tr_b16 v[26:27], v53 offset:7720
    s_waitcnt lgkmcnt(4)
    v_mfma_f32_16x16x32_bf16 v[56:59], v[16:19], v[228:231], v[56:59]
    ds_read_b64_tr_b16 v[28:29], v49 offset:0
    v_mfma_f32_16x16x32_bf16 v[60:63], v[16:19], v[232:235], v[60:63]
    ds_read_b64_tr_b16 v[30:31], v49 offset:7680
    s_barrier
    s_waitcnt lgkmcnt(4)
    v_mfma_f32_16x16x32_bf16 v[64:67], v[228:231], v[20:23], v[64:67]
    ds_read_b64_tr_b16 v[16:17], v3 offset:24576
    v_mfma_f32_16x16x32_bf16 v[68:71], v[232:235], v[20:23], v[68:71]
    ds_read_b64_tr_b16 v[18:19], v3 offset:26624
    s_waitcnt lgkmcnt(4)
    v_mfma_f32_16x16x32_bf16 v[72:75], v[228:231], v[24:27], v[72:75]
    ds_read_b64_tr_b16 v[20:21], v3 offset:28672
    v_mfma_f32_16x16x32_bf16 v[76:79], v[232:235], v[24:27], v[76:79]
    ds_read_b64_tr_b16 v[22:23], v3 offset:30720
    s_waitcnt lgkmcnt(4)
    v_mfma_f32_16x16x32_bf16 v[80:83], v[228:231], v[28:31], v[80:83]
    ds_read_b64_tr_b16 v[24:25], v3 offset:32768
    v_mfma_f32_16x16x32_bf16 v[84:87], v[232:235], v[28:31], v[84:87]
    ds_read_b64_tr_b16 v[26:27], v3 offset:34816
    s_waitcnt lgkmcnt(4)
    v_mfma_f32_16x16x32_bf16 v[32:35], v[16:19], v[92:95], 0
    ds_read_b64_tr_b16 v[28:29], v3 offset:36864
    v_mfma_f32_16x16x32_bf16 v[36:39], v[16:19], v[96:99], 0
    ds_read_b64_tr_b16 v[30:31], v3 offset:38912
    s_waitcnt lgkmcnt(4)
    v_mfma_f32_16x16x32_bf16 v[32:35], v[20:23], v[100:103], v[32:35]
    ds_read_b64_tr_b16 v[16:17], v3 offset:40960
    v_mfma_f32_16x16x32_bf16 v[36:39], v[20:23], v[104:107], v[36:39]
    ds_read_b64_tr_b16 v[18:19], v3 offset:43008
    s_waitcnt lgkmcnt(4)
    v_mfma_f32_16x16x32_bf16 v[32:35], v[24:27], v[108:111], v[32:35]
    ds_read_b64_tr_b16 v[20:21], v3 offset:45056
    v_cvt_pk_bf16_f32 v236, v64, v65
    v_mfma_f32_16x16x32_bf16 v[36:39], v[24:27], v[112:115], v[36:39]
    ds_read_b64_tr_b16 v[22:23], v3 offset:47104
    v_cvt_pk_bf16_f32 v237, v66, v67
    s_barrier
    s_waitcnt lgkmcnt(4)
    v_mfma_f32_16x16x32_bf16 v[32:35], v[28:31], v[116:119], v[32:35]
    ds_read_b64_tr_b16 v[24:25], v4 offset:0
    v_cvt_pk_bf16_f32 v238, v68, v69
    v_mfma_f32_16x16x32_bf16 v[36:39], v[28:31], v[120:123], v[36:39]
    ds_read_b64_tr_b16 v[26:27], v4 offset:2048
    v_cvt_pk_bf16_f32 v239, v70, v71
    s_waitcnt lgkmcnt(4)
    v_mfma_f32_16x16x32_bf16 v[32:35], v[16:19], v[124:127], v[32:35]
    ds_read_b64_tr_b16 v[28:29], v4 offset:4096
    v_mfma_f32_16x16x32_bf16 v[36:39], v[16:19], v[128:131], v[36:39]
    ds_read_b64_tr_b16 v[30:31], v4 offset:6144
    global_store_dwordx4 v13, v[236:239], s[82:83] offset:0 sc1
    s_waitcnt lgkmcnt(4)
    v_mfma_f32_16x16x32_bf16 v[32:35], v[20:23], v[132:135], v[32:35]
    ds_read_b64_tr_b16 v[16:17], v4 offset:8192
    v_cvt_pk_bf16_f32 v240, v72, v73
    v_mfma_f32_16x16x32_bf16 v[36:39], v[20:23], v[136:139], v[36:39]
    ds_read_b64_tr_b16 v[18:19], v4 offset:10240
    v_cvt_pk_bf16_f32 v241, v74, v75
    s_waitcnt lgkmcnt(4)
    v_mfma_f32_16x16x32_bf16 v[32:35], v[24:27], v[140:143], v[32:35]
    ds_read_b64_tr_b16 v[20:21], v4 offset:12288
    v_cvt_pk_bf16_f32 v242, v76, v77
    v_mfma_f32_16x16x32_bf16 v[36:39], v[24:27], v[144:147], v[36:39]
    ds_read_b64_tr_b16 v[22:23], v4 offset:14336
    v_cvt_pk_bf16_f32 v243, v78, v79
    s_waitcnt lgkmcnt(4)
    v_mfma_f32_16x16x32_bf16 v[32:35], v[28:31], v[148:151], v[32:35]
    ds_read_b64_tr_b16 v[24:25], v4 offset:16384
    v_mfma_f32_16x16x32_bf16 v[36:39], v[28:31], v[152:155], v[36:39]
    ds_read_b64_tr_b16 v[26:27], v4 offset:18432
    global_store_dwordx4 v13, v[240:243], s[82:83] offset:1024 sc1
    s_waitcnt lgkmcnt(4)
    s_nop 0
    v_mfma_f32_16x16x32_bf16 v[32:35], v[16:19], v[156:159], v[32:35]
    ds_read_b64_tr_b16 v[28:29], v4 offset:20480
    v_cvt_pk_bf16_f32 v252, v80, v81
    v_mfma_f32_16x16x32_bf16 v[36:39], v[16:19], v[160:163], v[36:39]
    ds_read_b64_tr_b16 v[30:31], v4 offset:22528
    v_cvt_pk_bf16_f32 v253, v82, v83
    v_cvt_pk_bf16_f32 v254, v84, v85
    v_cvt_pk_bf16_f32 v255, v86, v87
    s_and_b32 s42, s41, 1
    s_lshl_b32 s42, s42, 8
    s_add_u32 s42, s42, 3840
    s_lshl_b32 s43, s40, 8
    s_add_u32 s43, s43, 141312
    v_and_b32 v244, 15, v1
    v_and_b32_e64 v245, 48, v1
    v_add_lshl_u32 v15, v244, v245, 1
    v_add_u32_e64 v15, s43, v15
    v_lshl_add_u32 v14, v244, 6, s42
    v_add_u32_e64 v14, v14, v245
    s_mov_b32 exec_lo, 0x000f000f
    s_mov_b32 exec_hi, 0x000f000f
    ds_write_b16 v15, v252 offset:0
    ds_write_b16_d16_hi v15, v252 offset:8
    ds_write_b16 v15, v253 offset:16
    ds_write_b16_d16_hi v15, v253 offset:24
    ds_write_b16 v15, v254 offset:128
    ds_write_b16_d16_hi v15, v254 offset:136
    ds_write_b16 v15, v255 offset:144
    ds_write_b16_d16_hi v15, v255 offset:152
    s_mov_b32 exec_lo, 0x00f000f0
    s_mov_b32 exec_hi, 0x00f000f0
    global_store_dwordx2 v14, v[252:253], s[82:83] offset:0 sc1
    global_store_dwordx2 v14, v[254:255], s[82:83] offset:8 sc1
LD_join:
    s_mov_b64 exec, -1
    v_cvt_pk_bf16_f32 v48, v56, v57
    v_cvt_pk_bf16_f32 v49, v58, v59
    v_mov_b32 v50, 0
    v_mov_b32_e64 v51, 0
    v_cvt_pk_bf16_f32 v52, v60, v61
    v_cvt_pk_bf16_f32 v53, v62, v63
    v_mov_b32 v54, 0
    v_mov_b32_e64 v55, 0
    s_waitcnt lgkmcnt(0)
    s_waitcnt vmcnt(10)
    s_barrier
    v_mfma_f32_16x16x32_bf16 v[32:35], v[20:23], v[164:167], v[32:35]
    ds_read_b64_tr_b16 v[16:17], v2 offset:0
    s_lshl_b32 s45, s49, 7
    s_add_u32 s45, s45, s73
    s_add_u32 m0, s46, 49152
    s_add_u32 s47, s45, 1769472
    buffer_load_dwordx4 v10, s[16:19], s47 offen lds
    v_mfma_f32_16x16x32_bf16 v[36:39], v[20:23], v[168:171], v[36:39]
    ds_read_b64_tr_b16 v[18:19], v2 offset:2048
    s_add_u32 m0, s46, 53248
    s_add_u32 s47, s45, 2064384
    buffer_load_dwordx4 v10, s[16:19], s47 offen lds
    v_mfma_f32_16x16x32_bf16 v[32:35], v[24:27], v[172:175], v[32:35]
    ds_read_b64_tr_b16 v[20:21], v2 offset:4096
    s_add_u32 m0, s46, 57344
    s_add_u32 s47, s45, 2359296
    buffer_load_dwordx4 v10, s[16:19], s47 offen lds
    v_mfma_f32_16x16x32_bf16 v[36:39], v[24:27], v[176:179], v[36:39]
    ds_read_b64_tr_b16 v[22:23], v2 offset:6144
    s_add_u32 m0, s46, 61440
    s_add_u32 s47, s45, 2654208
    buffer_load_dwordx4 v10, s[16:19], s47 offen lds
    v_mfma_f32_16x16x32_bf16 v[32:35], v[28:31], v[180:183], v[32:35]
    ds_read_b64_tr_b16 v[24:25], v2 offset:8192
    s_add_u32 m0, s46, 65536
    s_add_u32 s47, s45, 2949120
    buffer_load_dwordx4 v10, s[16:19], s47 offen lds
    v_mfma_f32_16x16x32_bf16 v[36:39], v[28:31], v[184:187], v[36:39]
    ds_read_b64_tr_b16 v[26:27], v2 offset:10240
    s_add_u32 m0, s46, 69632
    s_add_u32 s47, s45, 3244032
    buffer_load_dwordx4 v10, s[16:19], s47 offen lds
    s_waitcnt lgkmcnt(4)
    v_mfma_f32_16x16x32_bf16 v[32:35], v[16:19], v[188:191], v[32:35]
    ds_read_b64_tr_b16 v[28:29], v2 offset:12288
    s_lshl_b32 s45, s49, 7
    s_add_u32 s45, s45, s73
    s_add_u32 m0, s46, 73728
    s_add_u32 s47, s45, 3538944
    buffer_load_dwordx4 v10, s[16:19], s47 offen lds
    v_mfma_f32_16x16x32_bf16 v[36:39], v[16:19], v[192:195], v[36:39]
    ds_read_b64_tr_b16 v[30:31], v2 offset:14336
    s_add_u32 m0, s46, 77824
    s_add_u32 s47, s45, 3833856
    buffer_load_dwordx4 v10, s[16:19], s47 offen lds
    s_waitcnt lgkmcnt(4)
    v_mfma_f32_16x16x32_bf16 v[32:35], v[20:23], v[196:199], v[32:35]
    ds_read_b64_tr_b16 v[16:17], v2 offset:16384
    s_add_u32 m0, s46, 81920
    s_add_u32 s47, s45, 4128768
    buffer_load_dwordx4 v10, s[16:19], s47 offen lds
    v_mfma_f32_16x16x32_bf16 v[36:39], v[20:23], v[200:203], v[36:39]
    ds_read_b64_tr_b16 v[18:19], v2 offset:18432
    s_add_u32 m0, s46, 86016
    s_add_u32 s47, s45, 4423680
    buffer_load_dwordx4 v10, s[16:19], s47 offen lds
    s_waitcnt lgkmcnt(4)
    v_mfma_f32_16x16x32_bf16 v[32:35], v[24:27], v[204:207], v[32:35]
    ds_read_b64_tr_b16 v[20:21], v2 offset:20480
    s_add_u32 m0, s46, 90112
    s_add_u32 s47, s45, 4718592
    buffer_load_dwordx4 v10, s[16:19], s47 offen lds
    v_mfma_f32_16x16x32_bf16 v[36:39], v[24:27], v[208:211], v[36:39]
    ds_read_b64_tr_b16 v[22:23], v2 offset:22528
    s_add_u32 m0, s46, 94208
    s_add_u32 s47, s45, 5013504
    buffer_load_dwordx4 v10, s[16:19], s47 offen lds
    s_lshl_b32 s42, s40, 8
    s_and_b32 s43, s41, 1
    s_lshl_b32 s43, s43, 2
    s_add_u32 s42, s42, s43
    s_add_u32 s42, s42, 141312
    v_lshl_add_u32 v14, v1, 3, s42
    s_mov_b64 exec, 0xffff
    ds_read_b32 v50, v14 offset:0
    ds_read_b32 v54, v14 offset:128
    s_mov_b64 exec, -1
    s_mul_i32 s42, s39, 9216
    s_sub_u32 s42, s42, 36864
    s_add_u32 s42, s42, s46
    v_lshl_add_u32 v8, v1, 4, s42
    s_waitcnt vmcnt(16)
    s_barrier
    s_waitcnt lgkmcnt(6)
    v_mfma_f32_16x16x32_bf16 v[32:35], v[28:31], v[212:215], v[32:35]
    ds_read_b64_tr_b16 v[24:25], v2 offset:24576
    s_lshl_b32 s45, s50, 7
    s_add_u32 s45, s45, s73
    s_add_u32 m0, s46, 98304
    s_add_u32 s47, s45, 0
    buffer_load_dwordx4 v10, s[16:19], s47 offen lds
    v_mfma_f32_16x16x32_bf16 v[36:39], v[28:31], v[216:219], v[36:39]
    ds_read_b64_tr_b16 v[26:27], v2 offset:26624
    s_add_u32 m0, s46, 102400
    s_add_u32 s47, s45, 294912
    buffer_load_dwordx4 v10, s[16:19], s47 offen lds
    s_waitcnt lgkmcnt(6)
    v_mfma_f32_16x16x32_bf16 v[32:35], v[16:19], v[220:223], v[32:35]
    ds_read_b64_tr_b16 v[28:29], v2 offset:28672
    s_add_u32 m0, s46, 106496
    s_add_u32 s47, s45, 589824
    buffer_load_dwordx4 v10, s[16:19], s47 offen lds
    v_mfma_f32_16x16x32_bf16 v[36:39], v[16:19], v[224:227], v[36:39]
    ds_read_b64_tr_b16 v[30:31], v2 offset:30720
    s_add_u32 m0, s46, 110592
    s_add_u32 s47, s45, 884736
    buffer_load_dwordx4 v10, s[16:19], s47 offen lds
    s_waitcnt lgkmcnt(6)
    v_mfma_f32_16x16x32_bf16 v[32:35], v[20:23], v[228:231], v[32:35]
    ds_read_b64_tr_b16 v[16:17], v2 offset:32768
    s_add_u32 m0, s46, 114688
    s_add_u32 s47, s45, 1179648
    buffer_load_dwordx4 v10, s[16:19], s47 offen lds
    v_mfma_f32_16x16x32_bf16 v[36:39], v[20:23], v[232:235], v[36:39]
    ds_read_b64_tr_b16 v[18:19], v2 offset:34816
    s_add_u32 m0, s46, 118784
    s_add_u32 s47, s45, 1474560
    buffer_load_dwordx4 v10, s[16:19], s47 offen lds
    s_waitcnt lgkmcnt(4)
    v_mfma_f32_16x16x32_bf16 v[40:43], v[24:27], v[92:95], 0
    ds_read_b64_tr_b16 v[20:21], v2 offset:36864
    v_mfma_f32_16x16x32_bf16 v[44:47], v[24:27], v[96:99], 0
    ds_read_b64_tr_b16 v[22:23], v2 offset:38912
    s_waitcnt lgkmcnt(4)
    v_mfma_f32_16x16x32_bf16 v[40:43], v[28:31], v[100:103], v[40:43]
    ds_read_b64_tr_b16 v[24:25], v2 offset:40960
    v_mfma_f32_16x16x32_bf16 v[44:47], v[28:31], v[104:107], v[44:47]
    ds_read_b64_tr_b16 v[26:27], v2 offset:43008
    s_waitcnt lgkmcnt(4)
    v_mfma_f32_16x16x32_bf16 v[40:43], v[16:19], v[108:111], v[40:43]
    ds_read_b64_tr_b16 v[28:29], v2 offset:45056
    v_cvt_pk_bf16_f32 v56, v32, v33
    v_mfma_f32_16x16x32_bf16 v[44:47], v[16:19], v[112:115], v[44:47]
    ds_read_b64_tr_b16 v[30:31], v2 offset:47104
    v_cvt_pk_bf16_f32 v57, v34, v35
    s_waitcnt vmcnt(12)
    s_barrier
    s_waitcnt lgkmcnt(4)
    v_mfma_f32_16x16x32_bf16 v[40:43], v[20:23], v[116:119], v[40:43]
    ds_read_b64_tr_b16 v[16:17], v3 offset:0
    v_cvt_pk_bf16_f32 v58, v36, v37
    v_mfma_f32_16x16x32_bf16 v[44:47], v[20:23], v[120:123], v[44:47]
    ds_read_b64_tr_b16 v[18:19], v3 offset:2048
    v_cvt_pk_bf16_f32 v59, v38, v39
    s_waitcnt lgkmcnt(4)
    v_mfma_f32_16x16x32_bf16 v[40:43], v[24:27], v[124:127], v[40:43]
    ds_read_b64_tr_b16 v[20:21], v3 offset:4096
    v_pk_max_i16 v56, v56, 0
    v_mfma_f32_16x16x32_bf16 v[44:47], v[24:27], v[128:131], v[44:47]
    ds_read_b64_tr_b16 v[22:23], v3 offset:6144
    v_pk_max_i16 v57, v57, 0
    s_waitcnt lgkmcnt(4)
    v_mfma_f32_16x16x32_bf16 v[40:43], v[28:31], v[132:135], v[40:43]
    ds_read_b64_tr_b16 v[24:25], v3 offset:8192
    v_pk_max_i16 v58, v58, 0
    v_mfma_f32_16x16x32_bf16 v[44:47], v[28:31], v[136:139], v[44:47]
    ds_read_b64_tr_b16 v[26:27], v3 offset:10240
    v_pk_max_i16 v59, v59, 0
    s_waitcnt lgkmcnt(4)
    v_mfma_f32_16x16x32_bf16 v[40:43], v[16:19], v[140:143], v[40:43]
    ds_read_b64_tr_b16 v[28:29], v3 offset:12288
    s_lshl_b32 s45, s50, 7
    s_add_u32 s45, s45, s73
    s_add_u32 m0, s46, 0
    s_add_u32 s47, s45, 1769472
    buffer_load_dwordx4 v10, s[16:19], s47 offen lds
    v_mfma_f32_16x16x32_bf16 v[44:47], v[16:19], v[144:147], v[44:47]
    ds_read_b64_tr_b16 v[30:31], v3 offset:14336
    s_add_u32 m0, s46, 4096
    s_add_u32 s47, s45, 2064384
    buffer_load_dwordx4 v10, s[16:19], s47 offen lds
    s_waitcnt lgkmcnt(4)
    v_mfma_f32_16x16x32_bf16 v[40:43], v[20:23], v[148:151], v[40:43]
    ds_read_b64_tr_b16 v[16:17], v3 offset:16384
    s_add_u32 m0, s46, 8192
    s_add_u32 s47, s45, 2359296
    buffer_load_dwordx4 v10, s[16:19], s47 offen lds
    v_mfma_f32_16x16x32_bf16 v[44:47], v[20:23], v[152:155], v[44:47]
    ds_read_b64_tr_b16 v[18:19], v3 offset:18432
    s_add_u32 m0, s46, 12288
    s_add_u32 s47, s45, 2654208
    buffer_load_dwordx4 v10, s[16:19], s47 offen lds
    s_waitcnt lgkmcnt(4)
    v_mfma_f32_16x16x32_bf16 v[40:43], v[24:27], v[156:159], v[40:43]
    ds_read_b64_tr_b16 v[20:21], v3 offset:20480
    s_add_u32 m0, s46, 16384
    s_add_u32 s47, s45, 2949120
    buffer_load_dwordx4 v10, s[16:19], s47 offen lds
    v_mfma_f32_16x16x32_bf16 v[44:47], v[24:27], v[160:163], v[44:47]
    ds_read_b64_tr_b16 v[22:23], v3 offset:22528
    s_add_u32 m0, s46, 20480
    s_add_u32 s47, s45, 3244032
    buffer_load_dwordx4 v10, s[16:19], s47 offen lds
    s_waitcnt vmcnt(12)
    s_barrier
    s_waitcnt lgkmcnt(4)
    v_mfma_f32_16x16x32_bf16 v[40:43], v[28:31], v[164:167], v[40:43]
    ds_read_b64_tr_b16 v[24:25], v3 offset:24576
    s_lshl_b32 s45, s50, 7
    s_add_u32 s45, s45, s73
    s_add_u32 m0, s46, 24576
    s_add_u32 s47, s45, 3538944
    buffer_load_dwordx4 v10, s[16:19], s47 offen lds
    v_mfma_f32_16x16x32_bf16 v[44:47], v[28:31], v[168:171], v[44:47]
    ds_read_b64_tr_b16 v[26:27], v3 offset:26624
    s_add_u32 m0, s46, 28672
    s_add_u32 s47, s45, 3833856
    buffer_load_dwordx4 v10, s[16:19], s47 offen lds
    s_waitcnt lgkmcnt(4)
    v_mfma_f32_16x16x32_bf16 v[40:43], v[16:19], v[172:175], v[40:43]
    ds_read_b64_tr_b16 v[28:29], v3 offset:28672
    s_add_u32 m0, s46, 32768
    s_add_u32 s47, s45, 4128768
    buffer_load_dwordx4 v10, s[16:19], s47 offen lds
    v_mfma_f32_16x16x32_bf16 v[44:47], v[16:19], v[176:179], v[44:47]
    ds_read_b64_tr_b16 v[30:31], v3 offset:30720
    s_add_u32 m0, s46, 36864
    s_add_u32 s47, s45, 4423680
    buffer_load_dwordx4 v10, s[16:19], s47 offen lds
    s_waitcnt lgkmcnt(4)
    v_mfma_f32_16x16x32_bf16 v[40:43], v[20:23], v[180:183], v[40:43]
    ds_read_b64_tr_b16 v[16:17], v3 offset:32768
    s_add_u32 m0, s46, 40960
    s_add_u32 s47, s45, 4718592
    buffer_load_dwordx4 v10, s[16:19], s47 offen lds
    v_mfma_f32_16x16x32_bf16 v[44:47], v[20:23], v[184:187], v[44:47]
    ds_read_b64_tr_b16 v[18:19], v3 offset:34816
    s_add_u32 m0, s46, 45056
    s_add_u32 s47, s45, 5013504
    buffer_load_dwordx4 v10, s[16:19], s47 offen lds
    s_waitcnt lgkmcnt(4)
    v_mfma_f32_16x16x32_bf16 v[40:43], v[24:27], v[188:191], v[40:43]
    ds_read_b64_tr_b16 v[20:21], v3 offset:36864
    v_mfma_f32_16x16x32_bf16 v[44:47], v[24:27], v[192:195], v[44:47]
    ds_read_b64_tr_b16 v[22:23], v3 offset:38912
    s_waitcnt lgkmcnt(4)
    v_mfma_f32_16x16x32_bf16 v[40:43], v[28:31], v[196:199], v[40:43]
    ds_read_b64_tr_b16 v[24:25], v3 offset:40960
    v_mfma_f32_16x16x32_bf16 v[44:47], v[28:31], v[200:203], v[44:47]
    ds_read_b64_tr_b16 v[26:27], v3 offset:43008
    s_waitcnt lgkmcnt(4)
    v_mfma_f32_16x16x32_bf16 v[40:43], v[16:19], v[204:207], v[40:43]
    ds_read_b64_tr_b16 v[28:29], v3 offset:45056
    v_mfma_f32_16x16x32_bf16 v[44:47], v[16:19], v[208:211], v[44:47]
    ds_read_b64_tr_b16 v[30:31], v3 offset:47104
    s_waitcnt vmcnt(12)
    s_barrier
    s_waitcnt lgkmcnt(4)
    v_mfma_f32_16x16x32_bf16 v[40:43], v[20:23], v[212:215], v[40:43]
    ds_read_b64_tr_b16 v[16:17], v4 offset:0
    s_lshl_b32 s45, s51, 7
    s_add_u32 s45, s45, s73
    s_add_u32 m0, s46, 49152
    s_add_u32 s47, s45, 0
    buffer_load_dwordx4 v10, s[16:19], s47 offen lds
    v_mfma_f32_16x16x32_bf16 v[44:47], v[20:23], v[216:219], v[44:47]
    ds_read_b64_tr_b16 v[18:19], v4 offset:2048
    s_add_u32 m0, s46, 53248
    s_add_u32 s47, s45, 294912
    buffer_load_dwordx4 v10, s[16:19], s47 offen lds
    s_waitcnt lgkmcnt(4)
    v_mfma_f32_16x16x32_bf16 v[40:43], v[24:27], v[220:223], v[40:43]
    ds_read_b64_tr_b16 v[20:21], v4 offset:4096
    s_add_u32 m0, s46, 57344
    s_add_u32 s47, s45, 589824
    buffer_load_dwordx4 v10, s[16:19], s47 offen lds
    v_mfma_f32_16x16x32_bf16 v[44:47], v[24:27], v[224:227], v[44:47]
    ds_read_b64_tr_b16 v[22:23], v4 offset:6144
    s_add_u32 m0, s46, 61440
    s_add_u32 s47, s45, 884736
    buffer_load_dwordx4 v10, s[16:19], s47 offen lds
    s_waitcnt lgkmcnt(4)
    v_mfma_f32_16x16x32_bf16 v[40:43], v[28:31], v[228:231], v[40:43]
    ds_read_b64_tr_b16 v[24:25], v4 offset:8192
    s_add_u32 m0, s46, 65536
    s_add_u32 s47, s45, 1179648
    buffer_load_dwordx4 v10, s[16:19], s47 offen lds
    v_mfma_f32_16x16x32_bf16 v[44:47], v[28:31], v[232:235], v[44:47]
    ds_read_b64_tr_b16 v[26:27], v4 offset:10240
    s_add_u32 m0, s46, 69632
    s_add_u32 s47, s45, 1474560
    buffer_load_dwordx4 v10, s[16:19], s47 offen lds
    s_waitcnt lgkmcnt(4)
    v_mfma_f32_16x16x32_bf16 v[32:35], v[16:19], v[92:95], 0
    ds_read_b64_tr_b16 v[28:29], v4 offset:12288
    v_mfma_f32_16x16x32_bf16 v[36:39], v[16:19], v[96:99], 0
    ds_read_b64_tr_b16 v[30:31], v4 offset:14336
    s_waitcnt lgkmcnt(4)
    v_mfma_f32_16x16x32_bf16 v[32:35], v[20:23], v[100:103], v[32:35]
    ds_read_b64_tr_b16 v[16:17], v4 offset:16384
    v_mfma_f32_16x16x32_bf16 v[36:39], v[20:23], v[104:107], v[36:39]
    ds_read_b64_tr_b16 v[18:19], v4 offset:18432
    s_waitcnt lgkmcnt(4)
    v_mfma_f32_16x16x32_bf16 v[32:35], v[24:27], v[108:111], v[32:35]
    ds_read_b64_tr_b16 v[20:21], v4 offset:20480
    v_cvt_pk_bf16_f32 v60, v40, v41
    v_mfma_f32_16x16x32_bf16 v[36:39], v[24:27], v[112:115], v[36:39]
    ds_read_b64_tr_b16 v[22:23], v4 offset:22528
    v_cvt_pk_bf16_f32 v61, v42, v43
    s_waitcnt vmcnt(12)
    s_barrier
    s_waitcnt lgkmcnt(4)
    v_mfma_f32_16x16x32_bf16 v[32:35], v[28:31], v[116:119], v[32:35]
    ds_read_b64_tr_b16 v[24:25], v2 offset:0
    v_cvt_pk_bf16_f32 v62, v44, v45
    v_mfma_f32_16x16x32_bf16 v[36:39], v[28:31], v[120:123], v[36:39]
    ds_read_b64_tr_b16 v[26:27], v2 offset:2048
    v_cvt_pk_bf16_f32 v63, v46, v47
    s_waitcnt lgkmcnt(4)
    v_mfma_f32_16x16x32_bf16 v[32:35], v[16:19], v[124:127], v[32:35]
    ds_read_b64_tr_b16 v[28:29], v2 offset:4096
    v_pk_max_i16 v60, v60, 0
    v_mfma_f32_16x16x32_bf16 v[36:39], v[16:19], v[128:131], v[36:39]
    ds_read_b64_tr_b16 v[30:31], v2 offset:6144
    v_pk_max_i16 v61, v61, 0
    s_waitcnt lgkmcnt(4)
    v_mfma_f32_16x16x32_bf16 v[32:35], v[20:23], v[132:135], v[32:35]
    ds_read_b64_tr_b16 v[16:17], v2 offset:8192
    v_pk_max_i16 v62, v62, 0
    v_mfma_f32_16x16x32_bf16 v[36:39], v[20:23], v[136:139], v[36:39]
    ds_read_b64_tr_b16 v[18:19], v2 offset:10240
    v_pk_max_i16 v63, v63, 0
    s_waitcnt lgkmcnt(4)
    v_mfma_f32_16x16x32_bf16 v[32:35], v[24:27], v[140:143], v[32:35]
    ds_read_b64_tr_b16 v[20:21], v2 offset:12288
    s_lshl_b32 s45, s51, 7
    s_add_u32 s45, s45, s73
    s_add_u32 m0, s46, 73728
    s_add_u32 s47, s45, 1769472
    buffer_load_dwordx4 v10, s[16:19], s47 offen lds
    v_mfma_f32_16x16x32_bf16 v[36:39], v[24:27], v[144:147], v[36:39]
    ds_read_b64_tr_b16 v[22:23], v2 offset:14336
    s_add_u32 m0, s46, 77824
    s_add_u32 s47, s45, 2064384
    buffer_load_dwordx4 v10, s[16:19], s47 offen lds
    s_waitcnt lgkmcnt(4)
    v_mfma_f32_16x16x32_bf16 v[32:35], v[28:31], v[148:151], v[32:35]
    ds_read_b64_tr_b16 v[24:25], v2 offset:16384
    s_add_u32 m0, s46, 81920
    s_add_u32 s47, s45, 2359296
    buffer_load_dwordx4 v10, s[16:19], s47 offen lds
    v_mfma_f32_16x16x32_bf16 v[36:39], v[28:31], v[152:155], v[36:39]
    ds_read_b64_tr_b16 v[26:27], v2 offset:18432
    s_add_u32 m0, s46, 86016
    s_add_u32 s47, s45, 2654208
    buffer_load_dwordx4 v10, s[16:19], s47 offen lds
    s_waitcnt lgkmcnt(4)
    v_mfma_f32_16x16x32_bf16 v[32:35], v[16:19], v[156:159], v[32:35]
    ds_read_b64_tr_b16 v[28:29], v2 offset:20480
    s_add_u32 m0, s46, 90112
    s_add_u32 s47, s45, 2949120
    buffer_load_dwordx4 v10, s[16:19], s47 offen lds
    v_mfma_f32_16x16x32_bf16 v[36:39], v[16:19], v[160:163], v[36:39]
    ds_read_b64_tr_b16 v[30:31], v2 offset:22528
    s_add_u32 m0, s46, 94208
    s_add_u32 s47, s45, 3244032
    buffer_load_dwordx4 v10, s[16:19], s47 offen lds
    s_waitcnt vmcnt(12)
    s_barrier
    s_waitcnt lgkmcnt(4)
    v_mfma_f32_16x16x32_bf16 v[32:35], v[20:23], v[164:167], v[32:35]
    ds_read_b64_tr_b16 v[16:17], v2 offset:24576
    s_lshl_b32 s45, s51, 7
    s_add_u32 s45, s45, s73
    s_add_u32 m0, s46, 98304
    s_add_u32 s47, s45, 3538944
    buffer_load_dwordx4 v10, s[16:19], s47 offen lds
    v_mfma_f32_16x16x32_bf16 v[36:39], v[20:23], v[168:171], v[36:39]
    ds_read_b64_tr_b16 v[18:19], v2 offset:26624
    s_add_u32 m0, s46, 102400
    s_add_u32 s47, s45, 3833856
    buffer_load_dwordx4 v10, s[16:19], s47 offen lds
    s_waitcnt lgkmcnt(4)
    v_mfma_f32_16x16x32_bf16 v[32:35], v[24:27], v[172:175], v[32:35]
    ds_read_b64_tr_b16 v[20:21], v2 offset:28672
    s_add_u32 m0, s46, 106496
    s_add_u32 s47, s45, 4128768
    buffer_load_dwordx4 v10, s[16:19], s47 offen lds
    v_mfma_f32_16x16x32_bf16 v[36:39], v[24:27], v[176:179], v[36:39]
    ds_read_b64_tr_b16 v[22:23], v2 offset:30720
    s_add_u32 m0, s46, 110592
    s_add_u32 s47, s45, 4423680
    buffer_load_dwordx4 v10, s[16:19], s47 offen lds
    s_waitcnt lgkmcnt(4)
    v_mfma_f32_16x16x32_bf16 v[32:35], v[28:31], v[180:183], v[32:35]
    ds_read_b64_tr_b16 v[24:25], v2 offset:32768
    s_add_u32 m0, s46, 114688
    s_add_u32 s47, s45, 4718592
    buffer_load_dwordx4 v10, s[16:19], s47 offen lds
    v_mfma_f32_16x16x32_bf16 v[36:39], v[28:31], v[184:187], v[36:39]
    ds_read_b64_tr_b16 v[26:27], v2 offset:34816
    s_add_u32 m0, s46, 118784
    s_add_u32 s47, s45, 5013504
    buffer_load_dwordx4 v10, s[16:19], s47 offen lds
    s_waitcnt lgkmcnt(4)
    v_mfma_f32_16x16x32_bf16 v[32:35], v[16:19], v[188:191], v[32:35]
    ds_read_b64_tr_b16 v[28:29], v2 offset:36864
    v_mfma_f32_16x16x32_bf16 v[36:39], v[16:19], v[192:195], v[36:39]
    ds_read_b64_tr_b16 v[30:31], v2 offset:38912
    s_waitcnt lgkmcnt(4)
    v_mfma_f32_16x16x32_bf16 v[32:35], v[20:23], v[196:199], v[32:35]
    ds_read_b64_tr_b16 v[16:17], v2 offset:40960
    v_mfma_f32_16x16x32_bf16 v[36:39], v[20:23], v[200:203], v[36:39]
    ds_read_b64_tr_b16 v[18:19], v2 offset:43008
    s_waitcnt lgkmcnt(4)
    v_mfma_f32_16x16x32_bf16 v[32:35], v[24:27], v[204:207], v[32:35]
    ds_read_b64_tr_b16 v[20:21], v2 offset:45056
    v_mfma_f32_16x16x32_bf16 v[36:39], v[24:27], v[208:211], v[36:39]
    ds_read_b64_tr_b16 v[22:23], v2 offset:47104
    s_waitcnt vmcnt(12)
    s_barrier
    s_waitcnt lgkmcnt(4)
    v_mfma_f32_16x16x32_bf16 v[32:35], v[28:31], v[212:215], v[32:35]
    ds_read_b64_tr_b16 v[24:25], v3 offset:0
    s_lshl_b32 s45, s52, 7
    s_add_u32 s45, s45, s73
    s_add_u32 m0, s46, 0
    s_add_u32 s47, s45, 0
    buffer_load_dwordx4 v10, s[16:19], s47 offen lds
    v_mfma_f32_16x16x32_bf16 v[36:39], v[28:31], v[216:219], v[36:39]
    ds_read_b64_tr_b16 v[26:27], v3 offset:2048
    s_add_u32 m0, s46, 4096
    s_add_u32 s47, s45, 294912
    buffer_load_dwordx4 v10, s[16:19], s47 offen lds
    s_waitcnt lgkmcnt(4)
    v_mfma_f32_16x16x32_bf16 v[32:35], v[16:19], v[220:223], v[32:35]
    ds_read_b64_tr_b16 v[28:29], v3 offset:4096
    s_add_u32 m0, s46, 8192
    s_add_u32 s47, s45, 589824
    buffer_load_dwordx4 v10, s[16:19], s47 offen lds
    v_mfma_f32_16x16x32_bf16 v[36:39], v[16:19], v[224:227], v[36:39]
    ds_read_b64_tr_b16 v[30:31], v3 offset:6144
    s_add_u32 m0, s46, 12288
    s_add_u32 s47, s45, 884736
    buffer_load_dwordx4 v10, s[16:19], s47 offen lds
    s_waitcnt lgkmcnt(4)
    v_mfma_f32_16x16x32_bf16 v[32:35], v[20:23], v[228:231], v[32:35]
    ds_read_b64_tr_b16 v[16:17], v3 offset:8192
    s_add_u32 m0, s46, 16384
    s_add_u32 s47, s45, 1179648
    buffer_load_dwordx4 v10, s[16:19], s47 offen lds
    v_mfma_f32_16x16x32_bf16 v[36:39], v[20:23], v[232:235], v[36:39]
    ds_read_b64_tr_b16 v[18:19], v3 offset:10240
    s_add_u32 m0, s46, 20480
    s_add_u32 s47, s45, 1474560
    buffer_load_dwordx4 v10, s[16:19], s47 offen lds
    s_waitcnt lgkmcnt(4)
    v_mfma_f32_16x16x32_bf16 v[40:43], v[24:27], v[92:95], 0
    ds_read_b64_tr_b16 v[20:21], v3 offset:12288
    v_mfma_f32_16x16x32_bf16 v[44:47], v[24:27], v[96:99], 0
    ds_read_b64_tr_b16 v[22:23], v3 offset:14336
    s_waitcnt lgkmcnt(4)
    v_mfma_f32_16x16x32_bf16 v[40:43], v[28:31], v[100:103], v[40:43]
    ds_read_b64_tr_b16 v[24:25], v3 offset:16384
    v_mfma_f32_16x16x32_bf16 v[44:47], v[28:31], v[104:107], v[44:47]
    ds_read_b64_tr_b16 v[26:27], v3 offset:18432
    s_waitcnt lgkmcnt(4)
    v_mfma_f32_16x16x32_bf16 v[40:43], v[16:19], v[108:111], v[40:43]
    ds_read_b64_tr_b16 v[28:29], v3 offset:20480
    v_cvt_pk_bf16_f32 v64, v32, v33
    v_mfma_f32_16x16x32_bf16 v[44:47], v[16:19], v[112:115], v[44:47]
    ds_read_b64_tr_b16 v[30:31], v3 offset:22528
    v_cvt_pk_bf16_f32 v65, v34, v35
    s_waitcnt vmcnt(12)
    s_barrier
    s_waitcnt lgkmcnt(4)
    v_mfma_f32_16x16x32_bf16 v[40:43], v[20:23], v[116:119], v[40:43]
    ds_read_b64_tr_b16 v[16:17], v3 offset:24576
    v_cvt_pk_bf16_f32 v66, v36, v37
    v_mfma_f32_16x16x32_bf16 v[44:47], v[20:23], v[120:123], v[44:47]
    ds_read_b64_tr_b16 v[18:19], v3 offset:26624
    v_cvt_pk_bf16_f32 v67, v38, v39
    s_waitcnt lgkmcnt(4)
    v_mfma_f32_16x16x32_bf16 v[40:43], v[24:27], v[124:127], v[40:43]
    ds_read_b64_tr_b16 v[20:21], v3 offset:28672
    v_pk_max_i16 v64, v64, 0
    v_mfma_f32_16x16x32_bf16 v[44:47], v[24:27], v[128:131], v[44:47]
    ds_read_b64_tr_b16 v[22:23], v3 offset:30720
    v_pk_max_i16 v65, v65, 0
    s_waitcnt lgkmcnt(4)
    v_mfma_f32_16x16x32_bf16 v[40:43], v[28:31], v[132:135], v[40:43]
    ds_read_b64_tr_b16 v[24:25], v3 offset:32768
    v_pk_max_i16 v66, v66, 0
    v_mfma_f32_16x16x32_bf16 v[44:47], v[28:31], v[136:139], v[44:47]
    ds_read_b64_tr_b16 v[26:27], v3 offset:34816
    v_pk_max_i16 v67, v67, 0
    s_waitcnt lgkmcnt(4)
    v_mfma_f32_16x16x32_bf16 v[40:43], v[16:19], v[140:143], v[40:43]
    ds_read_b64_tr_b16 v[28:29], v3 offset:36864
    s_lshl_b32 s45, s52, 7
    s_add_u32 s45, s45, s73
    s_add_u32 m0, s46, 24576
    s_add_u32 s47, s45, 1769472
    buffer_load_dwordx4 v10, s[16:19], s47 offen lds
    v_mfma_f32_16x16x32_bf16 v[44:47], v[16:19], v[144:147], v[44:47]
    ds_read_b64_tr_b16 v[30:31], v3 offset:38912
    s_add_u32 m0, s46, 28672
    s_add_u32 s47, s45, 2064384
    buffer_load_dwordx4 v10, s[16:19], s47 offen lds
    s_waitcnt lgkmcnt(4)
    v_mfma_f32_16x16x32_bf16 v[40:43], v[20:23], v[148:151], v[40:43]
    ds_read_b64_tr_b16 v[16:17], v3 offset:40960
    s_add_u32 m0, s46, 32768
    s_add_u32 s47, s45, 2359296
    buffer_load_dwordx4 v10, s[16:19], s47 offen lds
    v_mfma_f32_16x16x32_bf16 v[44:47], v[20:23], v[152:155], v[44:47]
    ds_read_b64_tr_b16 v[18:19], v3 offset:43008
    s_add_u32 m0, s46, 36864
    s_add_u32 s47, s45, 2654208
    buffer_load_dwordx4 v10, s[16:19], s47 offen lds
    s_waitcnt lgkmcnt(4)
    v_mfma_f32_16x16x32_bf16 v[40:43], v[24:27], v[156:159], v[40:43]
    ds_read_b64_tr_b16 v[20:21], v3 offset:45056
    s_add_u32 m0, s46, 40960
    s_add_u32 s47, s45, 2949120
    buffer_load_dwordx4 v10, s[16:19], s47 offen lds
    v_mfma_f32_16x16x32_bf16 v[44:47], v[24:27], v[160:163], v[44:47]
    ds_read_b64_tr_b16 v[22:23], v3 offset:47104
    s_add_u32 m0, s46, 45056
    s_add_u32 s47, s45, 3244032
    buffer_load_dwordx4 v10, s[16:19], s47 offen lds
    s_waitcnt vmcnt(12)
    s_barrier
    s_waitcnt lgkmcnt(4)
    v_mfma_f32_16x16x32_bf16 v[40:43], v[28:31], v[164:167], v[40:43]
    ds_read_b64_tr_b16 v[24:25], v4 offset:0
    s_lshl_b32 s45, s52, 7
    s_add_u32 s45, s45, s73
    s_add_u32 m0, s46, 49152
    s_add_u32 s47, s45, 3538944
    buffer_load_dwordx4 v10, s[16:19], s47 offen lds
    v_mfma_f32_16x16x32_bf16 v[44:47], v[28:31], v[168:171], v[44:47]
    ds_read_b64_tr_b16 v[26:27], v4 offset:2048
    s_add_u32 m0, s46, 53248
    s_add_u32 s47, s45, 3833856
    buffer_load_dwordx4 v10, s[16:19], s47 offen lds
    s_waitcnt lgkmcnt(4)
    v_mfma_f32_16x16x32_bf16 v[40:43], v[16:19], v[172:175], v[40:43]
    ds_read_b64_tr_b16 v[28:29], v4 offset:4096
    s_add_u32 m0, s46, 57344
    s_add_u32 s47, s45, 4128768
    buffer_load_dwordx4 v10, s[16:19], s47 offen lds
    v_mfma_f32_16x16x32_bf16 v[44:47], v[16:19], v[176:179], v[44:47]
    ds_read_b64_tr_b16 v[30:31], v4 offset:6144
    s_add_u32 m0, s46, 61440
    s_add_u32 s47, s45, 4423680
    buffer_load_dwordx4 v10, s[16:19], s47 offen lds
    s_waitcnt lgkmcnt(4)
    v_mfma_f32_16x16x32_bf16 v[40:43], v[20:23], v[180:183], v[40:43]
    ds_read_b64_tr_b16 v[16:17], v4 offset:8192
    s_add_u32 m0, s46, 65536
    s_add_u32 s47, s45, 4718592
    buffer_load_dwordx4 v10, s[16:19], s47 offen lds
    v_mfma_f32_16x16x32_bf16 v[44:47], v[20:23], v[184:187], v[44:47]
    ds_read_b64_tr_b16 v[18:19], v4 offset:10240
    s_add_u32 m0, s46, 69632
    s_add_u32 s47, s45, 5013504
    buffer_load_dwordx4 v10, s[16:19], s47 offen lds
    s_waitcnt lgkmcnt(4)
    v_mfma_f32_16x16x32_bf16 v[40:43], v[24:27], v[188:191], v[40:43]
    ds_read_b64_tr_b16 v[20:21], v4 offset:12288
    v_mfma_f32_16x16x32_bf16 v[44:47], v[24:27], v[192:195], v[44:47]
    ds_read_b64_tr_b16 v[22:23], v4 offset:14336
    s_waitcnt lgkmcnt(4)
    v_mfma_f32_16x16x32_bf16 v[40:43], v[28:31], v[196:199], v[40:43]
    ds_read_b64_tr_b16 v[24:25], v4 offset:16384
    v_mfma_f32_16x16x32_bf16 v[44:47], v[28:31], v[200:203], v[44:47]
    ds_read_b64_tr_b16 v[26:27], v4 offset:18432
    s_waitcnt lgkmcnt(4)
    v_mfma_f32_16x16x32_bf16 v[40:43], v[16:19], v[204:207], v[40:43]
    ds_read_b64_tr_b16 v[28:29], v4 offset:20480
    v_mfma_f32_16x16x32_bf16 v[44:47], v[16:19], v[208:211], v[44:47]
    ds_read_b64_tr_b16 v[30:31], v4 offset:22528
    s_waitcnt vmcnt(12)
    s_barrier
    s_waitcnt lgkmcnt(4)
    v_mfma_f32_16x16x32_bf16 v[40:43], v[20:23], v[212:215], v[40:43]
    ds_read_b64_tr_b16 v[16:17], v2 offset:0
    s_lshl_b32 s45, s53, 7
    s_add_u32 s45, s45, s73
    s_add_u32 m0, s46, 73728
    s_add_u32 s47, s45, 0
    buffer_load_dwordx4 v10, s[16:19], s47 offen lds
    v_mfma_f32_16x16x32_bf16 v[44:47], v[20:23], v[216:219], v[44:47]
    ds_read_b64_tr_b16 v[18:19], v2 offset:2048
    s_add_u32 m0, s46, 77824
    s_add_u32 s47, s45, 294912
    buffer_load_dwordx4 v10, s[16:19], s47 offen lds
    s_waitcnt lgkmcnt(4)
    v_mfma_f32_16x16x32_bf16 v[40:43], v[24:27], v[220:223], v[40:43]
    ds_read_b64_tr_b16 v[20:21], v2 offset:4096
    s_add_u32 m0, s46, 81920
    s_add_u32 s47, s45, 589824
    buffer_load_dwordx4 v10, s[16:19], s47 offen lds
    v_mfma_f32_16x16x32_bf16 v[44:47], v[24:27], v[224:227], v[44:47]
    ds_read_b64_tr_b16 v[22:23], v2 offset:6144
    s_add_u32 m0, s46, 86016
    s_add_u32 s47, s45, 884736
    buffer_load_dwordx4 v10, s[16:19], s47 offen lds
    s_waitcnt lgkmcnt(4)
    v_mfma_f32_16x16x32_bf16 v[40:43], v[28:31], v[228:231], v[40:43]
    ds_read_b64_tr_b16 v[24:25], v2 offset:8192
    s_add_u32 m0, s46, 90112
    s_add_u32 s47, s45, 1179648
    buffer_load_dwordx4 v10, s[16:19], s47 offen lds
    v_mfma_f32_16x16x32_bf16 v[44:47], v[28:31], v[232:235], v[44:47]
    ds_read_b64_tr_b16 v[26:27], v2 offset:10240
    s_add_u32 m0, s46, 94208
    s_add_u32 s47, s45, 1474560
    buffer_load_dwordx4 v10, s[16:19], s47 offen lds
    s_waitcnt lgkmcnt(4)
    v_mfma_f32_16x16x32_bf16 v[32:35], v[16:19], v[92:95], 0
    ds_read_b64_tr_b16 v[28:29], v2 offset:12288
    v_mfma_f32_16x16x32_bf16 v[36:39], v[16:19], v[96:99], 0
    ds_read_b64_tr_b16 v[30:31], v2 offset:14336
    s_waitcnt lgkmcnt(4)
    v_mfma_f32_16x16x32_bf16 v[32:35], v[20:23], v[100:103], v[32:35]
    ds_read_b64_tr_b16 v[16:17], v2 offset:16384
    v_mfma_f32_16x16x32_bf16 v[36:39], v[20:23], v[104:107], v[36:39]
    ds_read_b64_tr_b16 v[18:19], v2 offset:18432
    s_waitcnt lgkmcnt(4)
    v_mfma_f32_16x16x32_bf16 v[32:35], v[24:27], v[108:111], v[32:35]
    ds_read_b64_tr_b16 v[20:21], v2 offset:20480
    v_cvt_pk_bf16_f32 v68, v40, v41
    v_mfma_f32_16x16x32_bf16 v[36:39], v[24:27], v[112:115], v[36:39]
    ds_read_b64_tr_b16 v[22:23], v2 offset:22528
    v_cvt_pk_bf16_f32 v69, v42, v43
    s_waitcnt vmcnt(12)
    s_barrier
    s_waitcnt lgkmcnt(4)
    v_mfma_f32_16x16x32_bf16 v[32:35], v[28:31], v[116:119], v[32:35]
    ds_read_b64_tr_b16 v[24:25], v2 offset:24576
    v_cvt_pk_bf16_f32 v70, v44, v45
    v_mfma_f32_16x16x32_bf16 v[36:39], v[28:31], v[120:123], v[36:39]
    ds_read_b64_tr_b16 v[26:27], v2 offset:26624
    v_cvt_pk_bf16_f32 v71, v46, v47
    s_waitcnt lgkmcnt(4)
    v_mfma_f32_16x16x32_bf16 v[32:35], v[16:19], v[124:127], v[32:35]
    ds_read_b64_tr_b16 v[28:29], v2 offset:28672
    v_pk_max_i16 v68, v68, 0
    v_mfma_f32_16x16x32_bf16 v[36:39], v[16:19], v[128:131], v[36:39]
    ds_read_b64_tr_b16 v[30:31], v2 offset:30720
    v_pk_max_i16 v69, v69, 0
    s_waitcnt lgkmcnt(4)
    v_mfma_f32_16x16x32_bf16 v[32:35], v[20:23], v[132:135], v[32:35]
    ds_read_b64_tr_b16 v[16:17], v2 offset:32768
    v_pk_max_i16 v70, v70, 0
    v_mfma_f32_16x16x32_bf16 v[36:39], v[20:23], v[136:139], v[36:39]
    ds_read_b64_tr_b16 v[18:19], v2 offset:34816
    v_pk_max_i16 v71, v71, 0
    s_waitcnt lgkmcnt(4)
    v_mfma_f32_16x16x32_bf16 v[32:35], v[24:27], v[140:143], v[32:35]
    ds_read_b64_tr_b16 v[20:21], v2 offset:36864
    s_lshl_b32 s45, s53, 7
    s_add_u32 s45, s45, s73
    s_add_u32 m0, s46, 98304
    s_add_u32 s47, s45, 1769472
    buffer_load_dwordx4 v10, s[16:19], s47 offen lds
    v_mfma_f32_16x16x32_bf16 v[36:39], v[24:27], v[144:147], v[36:39]
    ds_read_b64_tr_b16 v[22:23], v2 offset:38912
    s_add_u32 m0, s46, 102400
    s_add_u32 s47, s45, 2064384
    buffer_load_dwordx4 v10, s[16:19], s47 offen lds
    s_waitcnt lgkmcnt(4)
    v_mfma_f32_16x16x32_bf16 v[32:35], v[28:31], v[148:151], v[32:35]
    ds_read_b64_tr_b16 v[24:25], v2 offset:40960
    s_add_u32 m0, s46, 106496
    s_add_u32 s47, s45, 2359296
    buffer_load_dwordx4 v10, s[16:19], s47 offen lds
    v_mfma_f32_16x16x32_bf16 v[36:39], v[28:31], v[152:155], v[36:39]
    ds_read_b64_tr_b16 v[26:27], v2 offset:43008
    s_add_u32 m0, s46, 110592
    s_add_u32 s47, s45, 2654208
    buffer_load_dwordx4 v10, s[16:19], s47 offen lds
    s_waitcnt lgkmcnt(4)
    v_mfma_f32_16x16x32_bf16 v[32:35], v[16:19], v[156:159], v[32:35]
    ds_read_b64_tr_b16 v[28:29], v2 offset:45056
    s_add_u32 m0, s46, 114688
    s_add_u32 s47, s45, 2949120
    buffer_load_dwordx4 v10, s[16:19], s47 offen lds
    v_mfma_f32_16x16x32_bf16 v[36:39], v[16:19], v[160:163], v[36:39]
    ds_read_b64_tr_b16 v[30:31], v2 offset:47104
    s_add_u32 m0, s46, 118784
    s_add_u32 s47, s45, 3244032
    buffer_load_dwordx4 v10, s[16:19], s47 offen lds
    s_waitcnt vmcnt(12)
    s_barrier
    s_waitcnt lgkmcnt(4)
    v_mfma_f32_16x16x32_bf16 v[32:35], v[20:23], v[164:167], v[32:35]
    ds_read_b64_tr_b16 v[16:17], v3 offset:0
    s_lshl_b32 s45, s53, 7
    s_add_u32 s45, s45, s73
    s_add_u32 m0, s46, 0
    s_add_u32 s47, s45, 3538944
    buffer_load_dwordx4 v10, s[16:19], s47 offen lds
    v_mfma_f32_16x16x32_bf16 v[36:39], v[20:23], v[168:171], v[36:39]
    ds_read_b64_tr_b16 v[18:19], v3 offset:2048
    s_add_u32 m0, s46, 4096
    s_add_u32 s47, s45, 3833856
    buffer_load_dwordx4 v10, s[16:19], s47 offen lds
    s_waitcnt lgkmcnt(4)
    v_mfma_f32_16x16x32_bf16 v[32:35], v[24:27], v[172:175], v[32:35]
    ds_read_b64_tr_b16 v[20:21], v3 offset:4096
    s_add_u32 m0, s46, 8192
    s_add_u32 s47, s45, 4128768
    buffer_load_dwordx4 v10, s[16:19], s47 offen lds
    v_mfma_f32_16x16x32_bf16 v[36:39], v[24:27], v[176:179], v[36:39]
    ds_read_b64_tr_b16 v[22:23], v3 offset:6144
    s_add_u32 m0, s46, 12288
    s_add_u32 s47, s45, 4423680
    buffer_load_dwordx4 v10, s[16:19], s47 offen lds
    s_waitcnt lgkmcnt(4)
    v_mfma_f32_16x16x32_bf16 v[32:35], v[28:31], v[180:183], v[32:35]
    ds_read_b64_tr_b16 v[24:25], v3 offset:8192
    s_add_u32 m0, s46, 16384
    s_add_u32 s47, s45, 4718592
    buffer_load_dwordx4 v10, s[16:19], s47 offen lds
    v_mfma_f32_16x16x32_bf16 v[36:39], v[28:31], v[184:187], v[36:39]
    ds_read_b64_tr_b16 v[26:27], v3 offset:10240
    s_add_u32 m0, s46, 20480
    s_add_u32 s47, s45, 5013504
    buffer_load_dwordx4 v10, s[16:19], s47 offen lds
    s_waitcnt lgkmcnt(4)
    v_mfma_f32_16x16x32_bf16 v[32:35], v[16:19], v[188:191], v[32:35]
    ds_read_b64_tr_b16 v[28:29], v3 offset:12288
    v_mfma_f32_16x16x32_bf16 v[36:39], v[16:19], v[192:195], v[36:39]
    ds_read_b64_tr_b16 v[30:31], v3 offset:14336
    s_waitcnt lgkmcnt(4)
    v_mfma_f32_16x16x32_bf16 v[32:35], v[20:23], v[196:199], v[32:35]
    ds_read_b64_tr_b16 v[16:17], v3 offset:16384
    v_mfma_f32_16x16x32_bf16 v[36:39], v[20:23], v[200:203], v[36:39]
    ds_read_b64_tr_b16 v[18:19], v3 offset:18432
    s_waitcnt lgkmcnt(4)
    v_mfma_f32_16x16x32_bf16 v[32:35], v[24:27], v[204:207], v[32:35]
    ds_read_b64_tr_b16 v[20:21], v3 offset:20480
    v_mfma_f32_16x16x32_bf16 v[36:39], v[24:27], v[208:211], v[36:39]
    ds_read_b64_tr_b16 v[22:23], v3 offset:22528
    s_waitcnt vmcnt(12)
    s_barrier
    s_waitcnt lgkmcnt(4)
    v_mfma_f32_16x16x32_bf16 v[32:35], v[28:31], v[212:215], v[32:35]
    ds_read_b64_tr_b16 v[24:25], v3 offset:24576
    s_lshl_b32 s45, s54, 7
    s_add_u32 s45, s45, s73
    s_add_u32 m0, s46, 24576
    s_add_u32 s47, s45, 0
    buffer_load_dwordx4 v10, s[16:19], s47 offen lds
    v_mfma_f32_16x16x32_bf16 v[36:39], v[28:31], v[216:219], v[36:39]
    ds_read_b64_tr_b16 v[26:27], v3 offset:26624
    s_add_u32 m0, s46, 28672
    s_add_u32 s47, s45, 294912
    buffer_load_dwordx4 v10, s[16:19], s47 offen lds
    s_waitcnt lgkmcnt(4)
    v_mfma_f32_16x16x32_bf16 v[32:35], v[16:19], v[220:223], v[32:35]
    ds_read_b64_tr_b16 v[28:29], v3 offset:28672
    s_add_u32 m0, s46, 32768
    s_add_u32 s47, s45, 589824
    buffer_load_dwordx4 v10, s[16:19], s47 offen lds
    v_mfma_f32_16x16x32_bf16 v[36:39], v[16:19], v[224:227], v[36:39]
    ds_read_b64_tr_b16 v[30:31], v3 offset:30720
    s_add_u32 m0, s46, 36864
    s_add_u32 s47, s45, 884736
    buffer_load_dwordx4 v10, s[16:19], s47 offen lds
    s_waitcnt lgkmcnt(4)
    v_mfma_f32_16x16x32_bf16 v[32:35], v[20:23], v[228:231], v[32:35]
    ds_read_b64_tr_b16 v[16:17], v3 offset:32768
    s_add_u32 m0, s46, 40960
    s_add_u32 s47, s45, 1179648
    buffer_load_dwordx4 v10, s[16:19], s47 offen lds
    v_mfma_f32_16x16x32_bf16 v[36:39], v[20:23], v[232:235], v[36:39]
    ds_read_b64_tr_b16 v[18:19], v3 offset:34816
    s_add_u32 m0, s46, 45056
    s_add_u32 s47, s45, 1474560
    buffer_load_dwordx4 v10, s[16:19], s47 offen lds
    s_waitcnt lgkmcnt(4)
    v_mfma_f32_16x16x32_bf16 v[40:43], v[24:27], v[92:95], 0
    ds_read_b64_tr_b16 v[20:21], v3 offset:36864
    v_mfma_f32_16x16x32_bf16 v[44:47], v[24:27], v[96:99], 0
    ds_read_b64_tr_b16 v[22:23], v3 offset:38912
    s_waitcnt lgkmcnt(4)
    v_mfma_f32_16x16x32_bf16 v[40:43], v[28:31], v[100:103], v[40:43]
    ds_read_b64_tr_b16 v[24:25], v3 offset:40960
    v_mfma_f32_16x16x32_bf16 v[44:47], v[28:31], v[104:107], v[44:47]
    ds_read_b64_tr_b16 v[26:27], v3 offset:43008
    s_waitcnt lgkmcnt(4)
    v_mfma_f32_16x16x32_bf16 v[40:43], v[16:19], v[108:111], v[40:43]
    ds_read_b64_tr_b16 v[28:29], v3 offset:45056
    v_cvt_pk_bf16_f32 v72, v32, v33
    v_mfma_f32_16x16x32_bf16 v[44:47], v[16:19], v[112:115], v[44:47]
    ds_read_b64_tr_b16 v[30:31], v3 offset:47104
    v_cvt_pk_bf16_f32 v73, v34, v35
    s_waitcnt vmcnt(12)
    s_barrier
    s_waitcnt lgkmcnt(4)
    v_mfma_f32_16x16x32_bf16 v[40:43], v[20:23], v[116:119], v[40:43]
    ds_read_b64_tr_b16 v[16:17], v4 offset:0
    v_cvt_pk_bf16_f32 v74, v36, v37
    v_mfma_f32_16x16x32_bf16 v[44:47], v[20:23], v[120:123], v[44:47]
    ds_read_b64_tr_b16 v[18:19], v4 offset:2048
    v_cvt_pk_bf16_f32 v75, v38, v39
    s_waitcnt lgkmcnt(4)
    v_mfma_f32_16x16x32_bf16 v[40:43], v[24:27], v[124:127], v[40:43]
    ds_read_b64_tr_b16 v[20:21], v4 offset:4096
    v_pk_max_i16 v72, v72, 0
    v_mfma_f32_16x16x32_bf16 v[44:47], v[24:27], v[128:131], v[44:47]
    ds_read_b64_tr_b16 v[22:23], v4 offset:6144
    v_pk_max_i16 v73, v73, 0
    s_waitcnt lgkmcnt(4)
    v_mfma_f32_16x16x32_bf16 v[40:43], v[28:31], v[132:135], v[40:43]
    ds_read_b64_tr_b16 v[24:25], v4 offset:8192
    v_pk_max_i16 v74, v74, 0
    v_mfma_f32_16x16x32_bf16 v[44:47], v[28:31], v[136:139], v[44:47]
    ds_read_b64_tr_b16 v[26:27], v4 offset:10240
    v_pk_max_i16 v75, v75, 0
    s_waitcnt lgkmcnt(4)
    v_mfma_f32_16x16x32_bf16 v[40:43], v[16:19], v[140:143], v[40:43]
    ds_read_b64_tr_b16 v[28:29], v4 offset:12288
    s_lshl_b32 s45, s54, 7
    s_add_u32 s45, s45, s73
    s_add_u32 m0, s46, 49152
    s_add_u32 s47, s45, 1769472
    buffer_load_dwordx4 v10, s[16:19], s47 offen lds
    v_mfma_f32_16x16x32_bf16 v[44:47], v[16:19], v[144:147], v[44:47]
    ds_read_b64_tr_b16 v[30:31], v4 offset:14336
    s_add_u32 m0, s46, 53248
    s_add_u32 s47, s45, 2064384
    buffer_load_dwordx4 v10, s[16:19], s47 offen lds
    s_waitcnt lgkmcnt(4)
    v_mfma_f32_16x16x32_bf16 v[40:43], v[20:23], v[148:151], v[40:43]
    ds_read_b64_tr_b16 v[16:17], v4 offset:16384
    s_add_u32 m0, s46, 57344
    s_add_u32 s47, s45, 2359296
    buffer_load_dwordx4 v10, s[16:19], s47 offen lds
    v_mfma_f32_16x16x32_bf16 v[44:47], v[20:23], v[152:155], v[44:47]
    ds_read_b64_tr_b16 v[18:19], v4 offset:18432
    s_add_u32 m0, s46, 61440
    s_add_u32 s47, s45, 2654208
    buffer_load_dwordx4 v10, s[16:19], s47 offen lds
    s_waitcnt lgkmcnt(4)
    v_mfma_f32_16x16x32_bf16 v[40:43], v[24:27], v[156:159], v[40:43]
    ds_read_b64_tr_b16 v[20:21], v4 offset:20480
    s_add_u32 m0, s46, 65536
    s_add_u32 s47, s45, 2949120
    buffer_load_dwordx4 v10, s[16:19], s47 offen lds
    v_mfma_f32_16x16x32_bf16 v[44:47], v[24:27], v[160:163], v[44:47]
    ds_read_b64_tr_b16 v[22:23], v4 offset:22528
    s_add_u32 m0, s46, 69632
    s_add_u32 s47, s45, 3244032
    buffer_load_dwordx4 v10, s[16:19], s47 offen lds
    s_waitcnt vmcnt(12)
    s_barrier
    s_waitcnt lgkmcnt(4)
    v_mfma_f32_16x16x32_bf16 v[40:43], v[28:31], v[164:167], v[40:43]
    ds_read_b64_tr_b16 v[24:25], v2 offset:0
    s_lshl_b32 s45, s54, 7
    s_add_u32 s45, s45, s73
    s_add_u32 m0, s46, 73728
    s_add_u32 s47, s45, 3538944
    buffer_load_dwordx4 v10, s[16:19], s47 offen lds
    v_mfma_f32_16x16x32_bf16 v[44:47], v[28:31], v[168:171], v[44:47]
    ds_read_b64_tr_b16 v[26:27], v2 offset:2048
    s_add_u32 m0, s46, 77824
    s_add_u32 s47, s45, 3833856
    buffer_load_dwordx4 v10, s[16:19], s47 offen lds
    s_waitcnt lgkmcnt(4)
    v_mfma_f32_16x16x32_bf16 v[40:43], v[16:19], v[172:175], v[40:43]
    ds_read_b64_tr_b16 v[28:29], v2 offset:4096
    s_add_u32 m0, s46, 81920
    s_add_u32 s47, s45, 4128768
    buffer_load_dwordx4 v10, s[16:19], s47 offen lds
    v_mfma_f32_16x16x32_bf16 v[44:47], v[16:19], v[176:179], v[44:47]
    ds_read_b64_tr_b16 v[30:31], v2 offset:6144
    s_add_u32 m0, s46, 86016
    s_add_u32 s47, s45, 4423680
    buffer_load_dwordx4 v10, s[16:19], s47 offen lds
    s_waitcnt lgkmcnt(4)
    v_mfma_f32_16x16x32_bf16 v[40:43], v[20:23], v[180:183], v[40:43]
    ds_read_b64_tr_b16 v[16:17], v2 offset:8192
    s_add_u32 m0, s46, 90112
    s_add_u32 s47, s45, 4718592
    buffer_load_dwordx4 v10, s[16:19], s47 offen lds
    v_mfma_f32_16x16x32_bf16 v[44:47], v[20:23], v[184:187], v[44:47]
    ds_read_b64_tr_b16 v[18:19], v2 offset:10240
    s_add_u32 m0, s46, 94208
    s_add_u32 s47, s45, 5013504
    buffer_load_dwordx4 v10, s[16:19], s47 offen lds
    s_waitcnt lgkmcnt(4)
    v_mfma_f32_16x16x32_bf16 v[40:43], v[24:27], v[188:191], v[40:43]
    ds_read_b64_tr_b16 v[20:21], v2 offset:12288
    v_mfma_f32_16x16x32_bf16 v[44:47], v[24:27], v[192:195], v[44:47]
    ds_read_b64_tr_b16 v[22:23], v2 offset:14336
    s_waitcnt lgkmcnt(4)
    v_mfma_f32_16x16x32_bf16 v[40:43], v[28:31], v[196:199], v[40:43]
    ds_read_b64_tr_b16 v[24:25], v2 offset:16384
    v_mfma_f32_16x16x32_bf16 v[44:47], v[28:31], v[200:203], v[44:47]
    ds_read_b64_tr_b16 v[26:27], v2 offset:18432
    s_waitcnt lgkmcnt(4)
    v_mfma_f32_16x16x32_bf16 v[40:43], v[16:19], v[204:207], v[40:43]
    ds_read_b64_tr_b16 v[28:29], v2 offset:20480
    v_mfma_f32_16x16x32_bf16 v[44:47], v[16:19], v[208:211], v[44:47]
    ds_read_b64_tr_b16 v[30:31], v2 offset:22528
    s_waitcnt vmcnt(12)
    s_barrier
    s_waitcnt lgkmcnt(4)
    v_mfma_f32_16x16x32_bf16 v[40:43], v[20:23], v[212:215], v[40:43]
    ds_read_b64_tr_b16 v[16:17], v2 offset:24576
    s_lshl_b32 s45, s55, 7
    s_add_u32 s45, s45, s73
    s_add_u32 m0, s46, 98304
    s_add_u32 s47, s45, 0
    buffer_load_dwordx4 v10, s[16:19], s47 offen lds
    v_mfma_f32_16x16x32_bf16 v[44:47], v[20:23], v[216:219], v[44:47]
    ds_read_b64_tr_b16 v[18:19], v2 offset:26624
    s_add_u32 m0, s46, 102400
    s_add_u32 s47, s45, 294912
    buffer_load_dwordx4 v10, s[16:19], s47 offen lds
    s_waitcnt lgkmcnt(4)
    v_mfma_f32_16x16x32_bf16 v[40:43], v[24:27], v[220:223], v[40:43]
    ds_read_b64_tr_b16 v[20:21], v2 offset:28672
    s_add_u32 m0, s46, 106496
    s_add_u32 s47, s45, 589824
    buffer_load_dwordx4 v10, s[16:19], s47 offen lds
    v_mfma_f32_16x16x32_bf16 v[44:47], v[24:27], v[224:227], v[44:47]
    ds_read_b64_tr_b16 v[22:23], v2 offset:30720
    s_add_u32 m0, s46, 110592
    s_add_u32 s47, s45, 884736
    buffer_load_dwordx4 v10, s[16:19], s47 offen lds
    s_waitcnt lgkmcnt(4)
    v_mfma_f32_16x16x32_bf16 v[40:43], v[28:31], v[228:231], v[40:43]
    ds_read_b64_tr_b16 v[24:25], v2 offset:32768
    s_add_u32 m0, s46, 114688
    s_add_u32 s47, s45, 1179648
    buffer_load_dwordx4 v10, s[16:19], s47 offen lds
    v_mfma_f32_16x16x32_bf16 v[44:47], v[28:31], v[232:235], v[44:47]
    ds_read_b64_tr_b16 v[26:27], v2 offset:34816
    s_add_u32 m0, s46, 118784
    s_add_u32 s47, s45, 1474560
    buffer_load_dwordx4 v10, s[16:19], s47 offen lds
    s_waitcnt lgkmcnt(4)
    v_mfma_f32_16x16x32_bf16 v[32:35], v[16:19], v[92:95], 0
    ds_read_b64_tr_b16 v[28:29], v2 offset:36864
    v_mfma_f32_16x16x32_bf16 v[36:39], v[16:19], v[96:99], 0
    ds_read_b64_tr_b16 v[30:31], v2 offset:38912
    s_waitcnt lgkmcnt(4)
    v_mfma_f32_16x16x32_bf16 v[32:35], v[20:23], v[100:103], v[32:35]
    ds_read_b64_tr_b16 v[16:17], v2 offset:40960
    v_mfma_f32_16x16x32_bf16 v[36:39], v[20:23], v[104:107], v[36:39]
    ds_read_b64_tr_b16 v[18:19], v2 offset:43008
    s_waitcnt lgkmcnt(4)
    v_mfma_f32_16x16x32_bf16 v[32:35], v[24:27], v[108:111], v[32:35]
    ds_read_b64_tr_b16 v[20:21], v2 offset:45056
    v_cvt_pk_bf16_f32 v76, v40, v41
    v_mfma_f32_16x16x32_bf16 v[36:39], v[24:27], v[112:115], v[36:39]
    ds_read_b64_tr_b16 v[22:23], v2 offset:47104
    v_cvt_pk_bf16_f32 v77, v42, v43
    s_waitcnt vmcnt(12)
    s_barrier
    s_waitcnt lgkmcnt(4)
    v_mfma_f32_16x16x32_bf16 v[32:35], v[28:31], v[116:119], v[32:35]
    ds_read_b64_tr_b16 v[24:25], v3 offset:0
    v_cvt_pk_bf16_f32 v78, v44, v45
    v_mfma_f32_16x16x32_bf16 v[36:39], v[28:31], v[120:123], v[36:39]
    ds_read_b64_tr_b16 v[26:27], v3 offset:2048
    v_cvt_pk_bf16_f32 v79, v46, v47
    s_waitcnt lgkmcnt(4)
    v_mfma_f32_16x16x32_bf16 v[32:35], v[16:19], v[124:127], v[32:35]
    ds_read_b64_tr_b16 v[28:29], v3 offset:4096
    v_pk_max_i16 v76, v76, 0
    v_mfma_f32_16x16x32_bf16 v[36:39], v[16:19], v[128:131], v[36:39]
    ds_read_b64_tr_b16 v[30:31], v3 offset:6144
    v_pk_max_i16 v77, v77, 0
    s_waitcnt lgkmcnt(4)
    v_mfma_f32_16x16x32_bf16 v[32:35], v[20:23], v[132:135], v[32:35]
    ds_read_b64_tr_b16 v[16:17], v3 offset:8192
    v_pk_max_i16 v78, v78, 0
    v_mfma_f32_16x16x32_bf16 v[36:39], v[20:23], v[136:139], v[36:39]
    ds_read_b64_tr_b16 v[18:19], v3 offset:10240
    v_pk_max_i16 v79, v79, 0
    s_waitcnt lgkmcnt(4)
    v_mfma_f32_16x16x32_bf16 v[32:35], v[24:27], v[140:143], v[32:35]
    ds_read_b64_tr_b16 v[20:21], v3 offset:12288
    s_lshl_b32 s45, s55, 7
    s_add_u32 s45, s45, s73
    s_add_u32 m0, s46, 0
    s_add_u32 s47, s45, 1769472
    buffer_load_dwordx4 v10, s[16:19], s47 offen lds
    v_mfma_f32_16x16x32_bf16 v[36:39], v[24:27], v[144:147], v[36:39]
    ds_read_b64_tr_b16 v[22:23], v3 offset:14336
    s_add_u32 m0, s46, 4096
    s_add_u32 s47, s45, 2064384
    buffer_load_dwordx4 v10, s[16:19], s47 offen lds
    s_waitcnt lgkmcnt(4)
    v_mfma_f32_16x16x32_bf16 v[32:35], v[28:31], v[148:151], v[32:35]
    ds_read_b64_tr_b16 v[24:25], v3 offset:16384
    s_add_u32 m0, s46, 8192
    s_add_u32 s47, s45, 2359296
    buffer_load_dwordx4 v10, s[16:19], s47 offen lds
    v_mfma_f32_16x16x32_bf16 v[36:39], v[28:31], v[152:155], v[36:39]
    ds_read_b64_tr_b16 v[26:27], v3 offset:18432
    s_add_u32 m0, s46, 12288
    s_add_u32 s47, s45, 2654208
    buffer_load_dwordx4 v10, s[16:19], s47 offen lds
    s_waitcnt lgkmcnt(4)
    v_mfma_f32_16x16x32_bf16 v[32:35], v[16:19], v[156:159], v[32:35]
    ds_read_b64_tr_b16 v[28:29], v3 offset:20480
    s_add_u32 m0, s46, 16384
    s_add_u32 s47, s45, 2949120
    buffer_load_dwordx4 v10, s[16:19], s47 offen lds
    v_mfma_f32_16x16x32_bf16 v[36:39], v[16:19], v[160:163], v[36:39]
    ds_read_b64_tr_b16 v[30:31], v3 offset:22528
    s_add_u32 m0, s46, 20480
    s_add_u32 s47, s45, 3244032
    buffer_load_dwordx4 v10, s[16:19], s47 offen lds
    s_waitcnt vmcnt(12)
    s_barrier
    s_waitcnt lgkmcnt(4)
    v_mfma_f32_16x16x32_bf16 v[32:35], v[20:23], v[164:167], v[32:35]
    ds_read_b64_tr_b16 v[16:17], v3 offset:24576
    s_lshl_b32 s45, s55, 7
    s_add_u32 s45, s45, s73
    s_add_u32 m0, s46, 24576
    s_add_u32 s47, s45, 3538944
    buffer_load_dwordx4 v10, s[16:19], s47 offen lds
    v_mfma_f32_16x16x32_bf16 v[36:39], v[20:23], v[168:171], v[36:39]
    ds_read_b64_tr_b16 v[18:19], v3 offset:26624
    s_add_u32 m0, s46, 28672
    s_add_u32 s47, s45, 3833856
    buffer_load_dwordx4 v10, s[16:19], s47 offen lds
    s_waitcnt lgkmcnt(4)
    v_mfma_f32_16x16x32_bf16 v[32:35], v[24:27], v[172:175], v[32:35]
    ds_read_b64_tr_b16 v[20:21], v3 offset:28672
    s_add_u32 m0, s46, 32768
    s_add_u32 s47, s45, 4128768
    buffer_load_dwordx4 v10, s[16:19], s47 offen lds
    v_mfma_f32_16x16x32_bf16 v[36:39], v[24:27], v[176:179], v[36:39]
    ds_read_b64_tr_b16 v[22:23], v3 offset:30720
    s_add_u32 m0, s46, 36864
    s_add_u32 s47, s45, 4423680
    buffer_load_dwordx4 v10, s[16:19], s47 offen lds
    s_waitcnt lgkmcnt(4)
    v_mfma_f32_16x16x32_bf16 v[32:35], v[28:31], v[180:183], v[32:35]
    ds_read_b64_tr_b16 v[24:25], v3 offset:32768
    s_add_u32 m0, s46, 40960
    s_add_u32 s47, s45, 4718592
    buffer_load_dwordx4 v10, s[16:19], s47 offen lds
    v_mfma_f32_16x16x32_bf16 v[36:39], v[28:31], v[184:187], v[36:39]
    ds_read_b64_tr_b16 v[26:27], v3 offset:34816
    s_add_u32 m0, s46, 45056
    s_add_u32 s47, s45, 5013504
    buffer_load_dwordx4 v10, s[16:19], s47 offen lds
    s_waitcnt lgkmcnt(4)
    v_mfma_f32_16x16x32_bf16 v[32:35], v[16:19], v[188:191], v[32:35]
    ds_read_b64_tr_b16 v[28:29], v3 offset:36864
    v_mfma_f32_16x16x32_bf16 v[36:39], v[16:19], v[192:195], v[36:39]
    ds_read_b64_tr_b16 v[30:31], v3 offset:38912
    s_waitcnt lgkmcnt(4)
    v_mfma_f32_16x16x32_bf16 v[32:35], v[20:23], v[196:199], v[32:35]
    ds_read_b64_tr_b16 v[16:17], v3 offset:40960
    v_mfma_f32_16x16x32_bf16 v[36:39], v[20:23], v[200:203], v[36:39]
    ds_read_b64_tr_b16 v[18:19], v3 offset:43008
    s_waitcnt lgkmcnt(4)
    v_mfma_f32_16x16x32_bf16 v[32:35], v[24:27], v[204:207], v[32:35]
    ds_read_b64_tr_b16 v[20:21], v3 offset:45056
    v_mfma_f32_16x16x32_bf16 v[36:39], v[24:27], v[208:211], v[36:39]
    ds_read_b64_tr_b16 v[22:23], v3 offset:47104
    s_waitcnt vmcnt(12)
    s_barrier
    s_waitcnt lgkmcnt(4)
    v_mfma_f32_16x16x32_bf16 v[32:35], v[28:31], v[212:215], v[32:35]
    ds_read_b64_tr_b16 v[24:25], v4 offset:0
    s_lshl_b32 s45, s56, 7
    s_add_u32 s45, s45, s73
    s_add_u32 m0, s46, 49152
    s_add_u32 s47, s45, 0
    buffer_load_dwordx4 v10, s[16:19], s47 offen lds
    v_mfma_f32_16x16x32_bf16 v[36:39], v[28:31], v[216:219], v[36:39]
    ds_read_b64_tr_b16 v[26:27], v4 offset:2048
    s_add_u32 m0, s46, 53248
    s_add_u32 s47, s45, 294912
    buffer_load_dwordx4 v10, s[16:19], s47 offen lds
    s_waitcnt lgkmcnt(4)
    v_mfma_f32_16x16x32_bf16 v[32:35], v[16:19], v[220:223], v[32:35]
    ds_read_b64_tr_b16 v[28:29], v4 offset:4096
    s_add_u32 m0, s46, 57344
    s_add_u32 s47, s45, 589824
    buffer_load_dwordx4 v10, s[16:19], s47 offen lds
    v_mfma_f32_16x16x32_bf16 v[36:39], v[16:19], v[224:227], v[36:39]
    ds_read_b64_tr_b16 v[30:31], v4 offset:6144
    s_add_u32 m0, s46, 61440
    s_add_u32 s47, s45, 884736
    buffer_load_dwordx4 v10, s[16:19], s47 offen lds
    s_waitcnt lgkmcnt(4)
    v_mfma_f32_16x16x32_bf16 v[32:35], v[20:23], v[228:231], v[32:35]
    ds_read_b64_tr_b16 v[16:17], v4 offset:8192
    s_add_u32 m0, s46, 65536
    s_add_u32 s47, s45, 1179648
    buffer_load_dwordx4 v10, s[16:19], s47 offen lds
    v_mfma_f32_16x16x32_bf16 v[36:39], v[20:23], v[232:235], v[36:39]
    ds_read_b64_tr_b16 v[18:19], v4 offset:10240
    s_add_u32 m0, s46, 69632
    s_add_u32 s47, s45, 1474560
    buffer_load_dwordx4 v10, s[16:19], s47 offen lds
    s_waitcnt lgkmcnt(4)
    v_mfma_f32_16x16x32_bf16 v[40:43], v[24:27], v[92:95], 0
    ds_read_b64_tr_b16 v[20:21], v4 offset:12288
    v_mfma_f32_16x16x32_bf16 v[44:47], v[24:27], v[96:99], 0
    ds_read_b64_tr_b16 v[22:23], v4 offset:14336
    s_waitcnt lgkmcnt(4)
    v_mfma_f32_16x16x32_bf16 v[40:43], v[28:31], v[100:103], v[40:43]
    ds_read_b64_tr_b16 v[24:25], v4 offset:16384
    v_mfma_f32_16x16x32_bf16 v[44:47], v[28:31], v[104:107], v[44:47]
    ds_read_b64_tr_b16 v[26:27], v4 offset:18432
    s_waitcnt lgkmcnt(4)
    v_mfma_f32_16x16x32_bf16 v[40:43], v[16:19], v[108:111], v[40:43]
    ds_read_b64_tr_b16 v[28:29], v4 offset:20480
    v_cvt_pk_bf16_f32 v80, v32, v33
    v_mfma_f32_16x16x32_bf16 v[44:47], v[16:19], v[112:115], v[44:47]
    ds_read_b64_tr_b16 v[30:31], v4 offset:22528
    v_cvt_pk_bf16_f32 v81, v34, v35
    s_waitcnt vmcnt(12)
    s_barrier
    s_waitcnt lgkmcnt(4)
    v_mfma_f32_16x16x32_bf16 v[40:43], v[20:23], v[116:119], v[40:43]
    ds_read_b64_tr_b16 v[16:17], v2 offset:0
    v_cvt_pk_bf16_f32 v82, v36, v37
    v_mfma_f32_16x16x32_bf16 v[44:47], v[20:23], v[120:123], v[44:47]
    ds_read_b64_tr_b16 v[18:19], v2 offset:2048
    v_cvt_pk_bf16_f32 v83, v38, v39
    s_waitcnt lgkmcnt(4)
    v_mfma_f32_16x16x32_bf16 v[40:43], v[24:27], v[124:127], v[40:43]
    ds_read_b64_tr_b16 v[20:21], v2 offset:4096
    v_pk_max_i16 v80, v80, 0
    v_mfma_f32_16x16x32_bf16 v[44:47], v[24:27], v[128:131], v[44:47]
    ds_read_b64_tr_b16 v[22:23], v2 offset:6144
    v_pk_max_i16 v81, v81, 0
    s_waitcnt lgkmcnt(4)
    v_mfma_f32_16x16x32_bf16 v[40:43], v[28:31], v[132:135], v[40:43]
    ds_read_b64_tr_b16 v[24:25], v2 offset:8192
    v_pk_max_i16 v82, v82, 0
    v_mfma_f32_16x16x32_bf16 v[44:47], v[28:31], v[136:139], v[44:47]
    ds_read_b64_tr_b16 v[26:27], v2 offset:10240
    v_pk_max_i16 v83, v83, 0
    s_waitcnt lgkmcnt(4)
    v_mfma_f32_16x16x32_bf16 v[40:43], v[16:19], v[140:143], v[40:43]
    ds_read_b64_tr_b16 v[28:29], v2 offset:12288
    s_lshl_b32 s45, s56, 7
    s_add_u32 s45, s45, s73
    s_add_u32 m0, s46, 73728
    s_add_u32 s47, s45, 1769472
    buffer_load_dwordx4 v10, s[16:19], s47 offen lds
    v_mfma_f32_16x16x32_bf16 v[44:47], v[16:19], v[144:147], v[44:47]
    ds_read_b64_tr_b16 v[30:31], v2 offset:14336
    s_add_u32 m0, s46, 77824
    s_add_u32 s47, s45, 2064384
    buffer_load_dwordx4 v10, s[16:19], s47 offen lds
    s_waitcnt lgkmcnt(4)
    v_mfma_f32_16x16x32_bf16 v[40:43], v[20:23], v[148:151], v[40:43]
    ds_read_b64_tr_b16 v[16:17], v2 offset:16384
    s_add_u32 m0, s46, 81920
    s_add_u32 s47, s45, 2359296
    buffer_load_dwordx4 v10, s[16:19], s47 offen lds
    v_mfma_f32_16x16x32_bf16 v[44:47], v[20:23], v[152:155], v[44:47]
    ds_read_b64_tr_b16 v[18:19], v2 offset:18432
    s_add_u32 m0, s46, 86016
    s_add_u32 s47, s45, 2654208
    buffer_load_dwordx4 v10, s[16:19], s47 offen lds
    s_waitcnt lgkmcnt(4)
    v_mfma_f32_16x16x32_bf16 v[40:43], v[24:27], v[156:159], v[40:43]
    ds_read_b64_tr_b16 v[20:21], v2 offset:20480
    s_add_u32 m0, s46, 90112
    s_add_u32 s47, s45, 2949120
    buffer_load_dwordx4 v10, s[16:19], s47 offen lds
    v_mfma_f32_16x16x32_bf16 v[44:47], v[24:27], v[160:163], v[44:47]
    ds_read_b64_tr_b16 v[22:23], v2 offset:22528
    s_add_u32 m0, s46, 94208
    s_add_u32 s47, s45, 3244032
    buffer_load_dwordx4 v10, s[16:19], s47 offen lds
    s_lshl_b32 s42, s41, 10
    v_lshl_add_u32 v12, v1, 3, s42
    v_lshl_add_u32 v14, v1, 4, s42
    v_and_b32 v236, 15, v1
    s_lshr_b32 s42, s41, 1
    s_lshl_b32 s42, s42, 8
    s_add_u32 s42, s42, 4096
    s_and_b32 s43, s41, 1
    s_lshl_b32 s44, s43, 2
    s_add_u32 s44, s44, s42
    v_lshl_add_u32 v13, v236, 3, s44
    s_lshl_b32 s43, s43, 7
    s_add_u32 s43, s43, s42
    v_lshl_add_u32 v15, v236, 6, s43
    v_and_b32 v237, 48, v1
    v_add_u32_e64 v15, v15, v237
    v_add_u32 v14, 73728, v14
    v_add_u32 v15, 73728, v15
    v_xor_b32 v5, 64, v4
    v_lshrrev_b32 v240, 4, v1
    v_lshrrev_b32 v241, 1, v240
    s_waitcnt vmcnt(12)
    s_barrier
    s_waitcnt lgkmcnt(4)
    v_mfma_f32_16x16x32_bf16 v[40:43], v[28:31], v[164:167], v[40:43]
    ds_read_b64_tr_b16 v[24:25], v2 offset:24576
    s_lshl_b32 s45, s56, 7
    s_add_u32 s45, s45, s73
    s_add_u32 m0, s46, 98304
    s_add_u32 s47, s45, 3538944
    buffer_load_dwordx4 v10, s[16:19], s47 offen lds
    v_mfma_f32_16x16x32_bf16 v[44:47], v[28:31], v[168:171], v[44:47]
    ds_read_b64_tr_b16 v[26:27], v2 offset:26624
    s_add_u32 m0, s46, 102400
    s_add_u32 s47, s45, 3833856
    buffer_load_dwordx4 v10, s[16:19], s47 offen lds
    s_waitcnt lgkmcnt(4)
    v_mfma_f32_16x16x32_bf16 v[40:43], v[16:19], v[172:175], v[40:43]
    ds_read_b64_tr_b16 v[28:29], v2 offset:28672
    s_add_u32 m0, s46, 106496
    s_add_u32 s47, s45, 4128768
    buffer_load_dwordx4 v10, s[16:19], s47 offen lds
    v_mfma_f32_16x16x32_bf16 v[44:47], v[16:19], v[176:179], v[44:47]
    ds_read_b64_tr_b16 v[30:31], v2 offset:30720
    s_add_u32 m0, s46, 110592
    s_add_u32 s47, s45, 4423680
    buffer_load_dwordx4 v10, s[16:19], s47 offen lds
    s_waitcnt lgkmcnt(4)
    v_mfma_f32_16x16x32_bf16 v[40:43], v[20:23], v[180:183], v[40:43]
    ds_read_b64_tr_b16 v[16:17], v2 offset:32768
    s_add_u32 m0, s46, 114688
    s_add_u32 s47, s45, 4718592
    buffer_load_dwordx4 v10, s[16:19], s47 offen lds
    v_mfma_f32_16x16x32_bf16 v[44:47], v[20:23], v[184:187], v[44:47]
    ds_read_b64_tr_b16 v[18:19], v2 offset:34816
    s_add_u32 m0, s46, 118784
    s_add_u32 s47, s45, 5013504
    buffer_load_dwordx4 v10, s[16:19], s47 offen lds
    s_waitcnt lgkmcnt(4)
    v_mfma_f32_16x16x32_bf16 v[40:43], v[24:27], v[188:191], v[40:43]
    ds_read_b64_tr_b16 v[20:21], v2 offset:36864
    v_mul_u32_u24 v241, 36, v241
    v_and_b32_e64 v240, 1, v240
    v_lshl_add_u32 v241, v240, 1, v241
    v_mfma_f32_16x16x32_bf16 v[44:47], v[24:27], v[192:195], v[44:47]
    ds_read_b64_tr_b16 v[22:23], v2 offset:38912
    v_bfe_u32 v240, v1, 2, 2
    v_add3_u32 v241, v241, v240, 16
    v_bfe_u32 v240, v241, 1, 2
    s_waitcnt lgkmcnt(4)
    v_mfma_f32_16x16x32_bf16 v[40:43], v[28:31], v[196:199], v[40:43]
    ds_read_b64_tr_b16 v[24:25], v2 offset:40960
    v_xor_b32 v240, s41, v240
    v_lshlrev_b32_e64 v240, 5, v240
    v_lshl_add_u32 v240, v241, 7, v240
    v_mfma_f32_16x16x32_bf16 v[44:47], v[28:31], v[200:203], v[44:47]
    ds_read_b64_tr_b16 v[26:27], v2 offset:43008
    v_and_b32_e64 v242, 3, v1
    v_lshl_add_u32 v240, v242, 3, v240
    v_add_u32 v6, 98304, v240
    s_waitcnt lgkmcnt(4)
    v_mfma_f32_16x16x32_bf16 v[40:43], v[16:19], v[204:207], v[40:43]
    ds_read_b64_tr_b16 v[28:29], v2 offset:45056
    v_lshrrev_b32 v237, 2, v237
    s_lshl_b32 s57, s39, 1
    s_add_u32 s57, s57, 0
    v_mfma_f32_16x16x32_bf16 v[44:47], v[16:19], v[208:211], v[44:47]
    ds_read_b64_tr_b16 v[30:31], v2 offset:47104
    v_mov_b32 v238, s81
    v_mov_b32_e64 v252, s80
    s_waitcnt vmcnt(12)
    s_barrier
    s_waitcnt lgkmcnt(4)
    v_mfma_f32_16x16x32_bf16 v[40:43], v[20:23], v[212:215], v[40:43]
    ds_read_b64_tr_b16 v[16:17], v3 offset:0
    s_add_u32 m0, s46, 0
    s_nop 0
    buffer_load_dwordx4 v8, s[24:27], 0 offen sc1 lds
    v_mfma_f32_16x16x32_bf16 v[44:47], v[20:23], v[216:219], v[44:47]
    ds_read_b64_tr_b16 v[18:19], v3 offset:2048
    v_add_u32 v8, 4096, v8
    s_add_u32 m0, s46, 4096
    s_nop 0
    buffer_load_dwordx4 v8, s[24:27], 0 offen sc1 lds
    s_waitcnt lgkmcnt(4)
    v_mfma_f32_16x16x32_bf16 v[40:43], v[24:27], v[220:223], v[40:43]
    ds_read_b64_tr_b16 v[20:21], v3 offset:4096
    v_add_u32 v8, 4096, v8
    s_add_u32 m0, s46, 8192
    s_nop 0
    buffer_load_dwordx4 v8, s[24:27], 0 offen sc1 lds
    v_mfma_f32_16x16x32_bf16 v[44:47], v[24:27], v[224:227], v[44:47]
    ds_read_b64_tr_b16 v[22:23], v3 offset:6144
    v_add_u32 v8, 4096, v8
    s_add_u32 m0, s46, 12288
    s_nop 0
    buffer_load_dwordx4 v8, s[24:27], 0 offen sc1 lds
    s_waitcnt lgkmcnt(4)
    v_mfma_f32_16x16x32_bf16 v[40:43], v[28:31], v[228:231], v[40:43]
    ds_read_b64_tr_b16 v[24:25], v3 offset:8192
    v_add_u32 v8, 4096, v8
    s_add_u32 m0, s46, 16384
    s_nop 0
    buffer_load_dwordx4 v8, s[24:27], 0 offen sc1 lds
    v_mfma_f32_16x16x32_bf16 v[44:47], v[28:31], v[232:235], v[44:47]
    ds_read_b64_tr_b16 v[26:27], v3 offset:10240
    v_add_u32 v8, 4096, v8
    s_add_u32 m0, s46, 20480
    s_nop 0
    buffer_load_dwordx4 v8, s[24:27], 0 offen sc1 lds
    s_waitcnt lgkmcnt(4)
    v_mfma_f32_16x16x32_bf16 v[32:35], v[16:19], v[92:95], 0
    ds_read_b64_tr_b16 v[28:29], v3 offset:12288
    v_mfma_f32_16x16x32_bf16 v[36:39], v[16:19], v[96:99], 0
    ds_read_b64_tr_b16 v[30:31], v3 offset:14336
    s_waitcnt lgkmcnt(4)
    v_mfma_f32_16x16x32_bf16 v[32:35], v[20:23], v[100:103], v[32:35]
    ds_read_b64_tr_b16 v[16:17], v3 offset:16384
    v_mfma_f32_16x16x32_bf16 v[36:39], v[20:23], v[104:107], v[36:39]
    ds_read_b64_tr_b16 v[18:19], v3 offset:18432
    s_waitcnt lgkmcnt(4)
    v_mfma_f32_16x16x32_bf16 v[32:35], v[24:27], v[108:111], v[32:35]
    ds_read_b64_tr_b16 v[20:21], v3 offset:20480
    v_cvt_pk_bf16_f32 v84, v40, v41
    v_mfma_f32_16x16x32_bf16 v[36:39], v[24:27], v[112:115], v[36:39]
    ds_read_b64_tr_b16 v[22:23], v3 offset:22528
    v_cvt_pk_bf16_f32 v85, v42, v43
    s_waitcnt vmcnt(12)
    s_barrier
    s_waitcnt lgkmcnt(4)
    v_mfma_f32_16x16x32_bf16 v[32:35], v[28:31], v[116:119], v[32:35]
    ds_read_b64_tr_b16 v[24:25], v3 offset:24576
    v_cvt_pk_bf16_f32 v86, v44, v45
    v_mfma_f32_16x16x32_bf16 v[36:39], v[28:31], v[120:123], v[36:39]
    ds_read_b64_tr_b16 v[26:27], v3 offset:26624
    v_cvt_pk_bf16_f32 v87, v46, v47
    s_waitcnt lgkmcnt(4)
    v_mfma_f32_16x16x32_bf16 v[32:35], v[16:19], v[124:127], v[32:35]
    ds_read_b64_tr_b16 v[28:29], v3 offset:28672
    v_pk_max_i16 v84, v84, 0
    v_mfma_f32_16x16x32_bf16 v[36:39], v[16:19], v[128:131], v[36:39]
    ds_read_b64_tr_b16 v[30:31], v3 offset:30720
    v_pk_max_i16 v85, v85, 0
    s_waitcnt lgkmcnt(4)
    v_mfma_f32_16x16x32_bf16 v[32:35], v[20:23], v[132:135], v[32:35]
    ds_read_b64_tr_b16 v[16:17], v3 offset:32768
    v_pk_max_i16 v86, v86, 0
    v_mfma_f32_16x16x32_bf16 v[36:39], v[20:23], v[136:139], v[36:39]
    ds_read_b64_tr_b16 v[18:19], v3 offset:34816
    v_pk_max_i16 v87, v87, 0
    s_waitcnt lgkmcnt(4)
    v_mfma_f32_16x16x32_bf16 v[32:35], v[24:27], v[140:143], v[32:35]
    ds_read_b64_tr_b16 v[20:21], v3 offset:36864
    v_add_u32 v8, 4096, v8
    s_add_u32 m0, s46, 24576
    s_nop 0
    buffer_load_dwordx4 v8, s[24:27], 0 offen sc1 lds
    v_mfma_f32_16x16x32_bf16 v[36:39], v[24:27], v[144:147], v[36:39]
    ds_read_b64_tr_b16 v[22:23], v3 offset:38912
    v_add_u32 v8, 4096, v8
    s_add_u32 m0, s46, 28672
    s_nop 0
    buffer_load_dwordx4 v8, s[24:27], 0 offen sc1 lds
    s_waitcnt lgkmcnt(4)
    v_mfma_f32_16x16x32_bf16 v[32:35], v[28:31], v[148:151], v[32:35]
    ds_read_b64_tr_b16 v[24:25], v3 offset:40960
    v_add_u32 v8, 4096, v8
    s_add_u32 m0, s46, 32768
    s_nop 0
    buffer_load_dwordx4 v8, s[24:27], 0 offen sc1 lds
    v_mfma_f32_16x16x32_bf16 v[36:39], v[28:31], v[152:155], v[36:39]
    ds_read_b64_tr_b16 v[26:27], v3 offset:43008
    v_add_u32 v8, 4096, v8
    s_add_u32 m0, s46, 36864
    s_nop 0
    buffer_load_dwordx4 v8, s[24:27], 0 offen sc1 lds
    s_waitcnt lgkmcnt(4)
    v_mfma_f32_16x16x32_bf16 v[32:35], v[16:19], v[156:159], v[32:35]
    ds_read_b64_tr_b16 v[28:29], v3 offset:45056
    v_add_u32 v8, 4096, v8
    s_add_u32 m0, s46, 40960
    s_nop 0
    buffer_load_dwordx4 v8, s[24:27], 0 offen sc1 lds
    v_mfma_f32_16x16x32_bf16 v[36:39], v[16:19], v[160:163], v[36:39]
    ds_read_b64_tr_b16 v[30:31], v3 offset:47104
    v_subrev_u32 v8, s46, v8
    v_add_u32 v8, 4096, v8
    s_mov_b32 m0, 45056
    s_mov_b64 exec, s[78:79]
    buffer_load_dwordx4 v8, s[24:27], 0 offen sc1 lds
    s_mov_b64 exec, -1
    s_cmp_ge_u32 s57, 8
    s_cselect_b32 s42, 0, s81
    v_mov_b32 v239, s42
    v_add_u32 v248, 0, v237
    v_cmp_le_u32 vcc, v248, v236
    s_nop 1
    v_cndmask_b32 v40, v238, 0, vcc
    v_cndmask_b32 v44, v239, v238, vcc
    v_add_u32 v248, 1, v237
    v_cmp_le_u32 vcc, v248, v236
    s_nop 1
    v_cndmask_b32 v41, v238, 0, vcc
    v_cndmask_b32 v45, v239, v238, vcc
    v_add_u32 v248, 2, v237
    v_cmp_le_u32 vcc, v248, v236
    s_nop 1
    v_cndmask_b32 v42, v238, 0, vcc
    v_cndmask_b32 v46, v239, v238, vcc
    v_add_u32 v248, 3, v237
    v_cmp_le_u32 vcc, v248, v236
    s_nop 1
    v_cndmask_b32 v43, v238, 0, vcc
    v_cndmask_b32 v47, v239, v238, vcc
    s_waitcnt vmcnt(12)
    s_barrier
    s_waitcnt lgkmcnt(4)
    v_mfma_f32_16x16x32_bf16 v[32:35], v[20:23], v[164:167], v[32:35]
    ds_read_b64_tr_b16 v[16:17], v4 offset:0
    v_mfma_f32_16x16x32_bf16 v[36:39], v[20:23], v[168:171], v[36:39]
    ds_read_b64_tr_b16 v[18:19], v4 offset:2048
    s_waitcnt lgkmcnt(4)
    v_mfma_f32_16x16x32_bf16 v[32:35], v[24:27], v[172:175], v[32:35]
    ds_read_b64_tr_b16 v[20:21], v4 offset:4096
    v_mfma_f32_16x16x32_bf16 v[36:39], v[24:27], v[176:179], v[36:39]
    ds_read_b64_tr_b16 v[22:23], v4 offset:6144
    s_waitcnt lgkmcnt(4)
    v_mfma_f32_16x16x32_bf16 v[32:35], v[28:31], v[180:183], v[32:35]
    ds_read_b64_tr_b16 v[24:25], v4 offset:8192
    v_mfma_f32_16x16x32_bf16 v[36:39], v[28:31], v[184:187], v[36:39]
    ds_read_b64_tr_b16 v[26:27], v4 offset:10240
    s_waitcnt lgkmcnt(4)
    v_mfma_f32_16x16x32_bf16 v[32:35], v[16:19], v[188:191], v[32:35]
    ds_read_b64_tr_b16 v[28:29], v4 offset:12288
    v_mfma_f32_16x16x32_bf16 v[36:39], v[16:19], v[192:195], v[36:39]
    ds_read_b64_tr_b16 v[30:31], v4 offset:14336
    s_waitcnt lgkmcnt(4)
    v_mfma_f32_16x16x32_bf16 v[32:35], v[20:23], v[196:199], v[32:35]
    ds_read_b64_tr_b16 v[16:17], v4 offset:16384
    v_mfma_f32_16x16x32_bf16 v[36:39], v[20:23], v[200:203], v[36:39]
    ds_read_b64_tr_b16 v[18:19], v4 offset:18432
    s_waitcnt lgkmcnt(4)
    v_mfma_f32_16x16x32_bf16 v[32:35], v[24:27], v[204:207], v[32:35]
    ds_read_b64_tr_b16 v[20:21], v4 offset:20480
    v_mfma_f32_16x16x32_bf16 v[36:39], v[24:27], v[208:211], v[36:39]
    ds_read_b64_tr_b16 v[22:23], v4 offset:22528
    s_waitcnt lgkmcnt(4)
    v_mfma_f32_16x16x32_bf16 v[32:35], v[28:31], v[212:215], v[32:35]
    v_mfma_f32_16x16x32_bf16 v[36:39], v[28:31], v[216:219], v[36:39]
    s_waitcnt lgkmcnt(2)
    v_mfma_f32_16x16x32_bf16 v[32:35], v[16:19], v[220:223], v[32:35]
    v_mfma_f32_16x16x32_bf16 v[36:39], v[16:19], v[224:227], v[36:39]
    s_waitcnt lgkmcnt(0)
    v_mfma_f32_16x16x32_bf16 v[32:35], v[20:23], v[228:231], v[32:35]
    v_mfma_f32_16x16x32_bf16 v[36:39], v[20:23], v[232:235], v[36:39]
    s_waitcnt vmcnt(0)
    s_barrier
    s_cmp_lt_u32 s57, 8
    s_cbranch_scc1 LD_sm
    ds_read_b64 v[16:17], v12 offset:36864
    ds_read_b32 v18, v13 offset:36864
    ds_read_b64 v[20:21], v12 offset:37376
    ds_read_b32 v22, v13 offset:36992
    ds_read_b64 v[24:25], v12 offset:32256
    ds_read_b32 v26, v13 offset:32256
    ds_read_b64 v[28:29], v12 offset:32768
    ds_read_b32 v30, v13 offset:32384
    ds_read_b64 v[92:93], v12 offset:27648
    ds_read_b32 v94, v13 offset:27648
    ds_read_b64 v[96:97], v12 offset:28160
    ds_read_b32 v98, v13 offset:27776
    v_add_u32_e64 v8, s46, v8
    v_subrev_u32 v8, 45056, v8
    s_add_u32 m0, s46, 73728
    s_nop 0
    buffer_load_dwordx4 v8, s[28:31], 0 offen sc1 lds
    v_add_u32 v8, 4096, v8
    s_add_u32 m0, s46, 77824
    s_nop 0
    buffer_load_dwordx4 v8, s[28:31], 0 offen sc1 lds
    v_add_u32 v8, 4096, v8
    s_add_u32 m0, s46, 81920
    s_nop 0
    s_nop 0
    buffer_load_dwordx4 v8, s[28:31], 0 offen sc1 lds
    v_cvt_pk_bf16_f32 v88, v32, v33
    v_cvt_pk_bf16_f32 v89, v34, v35
    v_cvt_pk_bf16_f32 v90, v36, v37
    v_cvt_pk_bf16_f32 v91, v38, v39
    v_pk_max_i16 v88, v88, 0
    v_pk_max_i16 v89, v89, 0
    v_pk_max_i16 v90, v90, 0
    v_pk_max_i16 v91, v91, 0
    ds_read_b64 v[100:101], v12 offset:23040
    ds_read_b32 v102, v13 offset:23040
    s_waitcnt lgkmcnt(12)
    v_mfma_f32_16x16x32_bf16 v[220:223], v[16:19], v[48:51], v[40:43]
    v_add_u32 v8, 4096, v8
    s_add_u32 m0, s46, 86016
    s_nop 0
    buffer_load_dwordx4 v8, s[28:31], 0 offen sc1 lds
    v_mfma_f32_16x16x32_bf16 v[228:231], v[16:19], v[52:55], 0
    v_add_u32 v8, 4096, v8
    s_add_u32 m0, s46, 90112
    s_nop 0
    buffer_load_dwordx4 v8, s[28:31], 0 offen sc1 lds
    ds_read_b64 v[104:105], v12 offset:23552
    ds_read_b32 v106, v13 offset:23168
    s_waitcnt lgkmcnt(12)
    v_mfma_f32_16x16x32_bf16 v[232:235], v[20:23], v[52:55], v[40:43]
    v_add_u32 v8, 4096, v8
    s_add_u32 m0, s46, 94208
    s_nop 0
    buffer_load_dwordx4 v8, s[28:31], 0 offen sc1 lds
    ds_read_b64 v[108:109], v12 offset:18432
    ds_read_b32 v110, v13 offset:18432
    s_waitcnt lgkmcnt(12)
    v_mfma_f32_16x16x32_bf16 v[204:207], v[24:27], v[48:51], 0
    v_add_u32 v8, 4096, v8
    s_add_u32 m0, s46, 98304
    s_nop 0
    buffer_load_dwordx4 v8, s[28:31], 0 offen sc1 lds
    v_mfma_f32_16x16x32_bf16 v[212:215], v[24:27], v[52:55], 0
    v_add_u32 v8, 4096, v8
    s_add_u32 m0, s46, 102400
    s_nop 0
    buffer_load_dwordx4 v8, s[28:31], 0 offen sc1 lds
    ds_read_b64 v[112:113], v12 offset:18944
    ds_read_b32 v114, v13 offset:18560
    s_waitcnt lgkmcnt(12)
    v_mfma_f32_16x16x32_bf16 v[208:211], v[28:31], v[48:51], 0
    v_add_u32 v8, 4096, v8
    s_add_u32 m0, s46, 106496
    s_nop 0
    buffer_load_dwordx4 v8, s[28:31], 0 offen sc1 lds
    v_mfma_f32_16x16x32_bf16 v[216:219], v[28:31], v[52:55], 0
    v_add_u32 v8, 4096, v8
    s_add_u32 m0, s46, 110592
    s_nop 0
    buffer_load_dwordx4 v8, s[28:31], 0 offen sc1 lds
    ds_read_b64 v[116:117], v12 offset:13824
    ds_read_b32 v118, v13 offset:13824
    s_waitcnt lgkmcnt(12)
    v_mfma_f32_16x16x32_bf16 v[188:191], v[92:95], v[48:51], 0
    v_max_f32 v248, v220, v221
    v_max_f32 v249, v222, v223
    v_add_u32 v8, 4096, v8
    s_add_u32 m0, s46, 114688
    s_nop 0
    buffer_load_dwordx4 v8, s[28:31], 0 offen sc1 lds
    v_mfma_f32_16x16x32_bf16 v[196:199], v[92:95], v[52:55], 0
    v_max_f32 v250, v228, v229
    v_max_f32 v251, v230, v231
    v_subrev_u32 v8, s46, v8
    v_add_u32 v8, 4096, v8
    s_mov_b32 m0, 118784
    s_mov_b64 exec, s[78:79]
    buffer_load_dwordx4 v8, s[28:31], 0 offen sc1 lds
    s_mov_b64 exec, -1
    ds_read_b64 v[120:121], v12 offset:14336
    ds_read_b32 v122, v13 offset:13952
    s_waitcnt lgkmcnt(12)
    v_mfma_f32_16x16x32_bf16 v[192:195], v[96:99], v[48:51], 0
    v_max3_f32 v250, v232, v233, v250
    v_max3_f32 v251, v234, v235, v251
    v_mfma_f32_16x16x32_bf16 v[200:203], v[96:99], v[52:55], 0
    ds_read_b64 v[16:17], v12 offset:9216
    ds_read_b32 v18, v13 offset:9216
    s_waitcnt lgkmcnt(12)
    v_mfma_f32_16x16x32_bf16 v[172:175], v[100:103], v[48:51], 0
    v_max3_f32 v248, v204, v205, v248
    v_max3_f32 v249, v206, v207, v249
    v_mfma_f32_16x16x32_bf16 v[180:183], v[100:103], v[52:55], 0
    v_max3_f32 v250, v212, v213, v250
    v_max3_f32 v251, v214, v215, v251
    ds_read_b64 v[20:21], v12 offset:9728
    ds_read_b32 v22, v13 offset:9344
    s_waitcnt lgkmcnt(12)
    s_nop 0
    v_mfma_f32_16x16x32_bf16 v[176:179], v[104:107], v[48:51], 0
    v_max3_f32 v248, v208, v209, v248
    v_max3_f32 v249, v210, v211, v249
    v_mfma_f32_16x16x32_bf16 v[184:187], v[104:107], v[52:55], 0
    v_max3_f32 v250, v216, v217, v250
    v_max3_f32 v251, v218, v219, v251
    ds_read_b64 v[24:25], v12 offset:4608
    ds_read_b32 v26, v13 offset:4608
    s_waitcnt lgkmcnt(12)
    s_nop 0
    v_mfma_f32_16x16x32_bf16 v[156:159], v[108:111], v[48:51], 0
    v_max3_f32 v248, v188, v189, v248
    v_max3_f32 v249, v190, v191, v249
    v_mfma_f32_16x16x32_bf16 v[164:167], v[108:111], v[52:55], 0
    v_max3_f32 v250, v196, v197, v250
    v_max3_f32 v251, v198, v199, v251
    ds_read_b64 v[28:29], v12 offset:5120
    ds_read_b32 v30, v13 offset:4736
    s_waitcnt lgkmcnt(12)
    s_nop 0
    v_mfma_f32_16x16x32_bf16 v[160:163], v[112:115], v[48:51], 0
    v_max3_f32 v248, v192, v193, v248
    v_max3_f32 v249, v194, v195, v249
    v_mfma_f32_16x16x32_bf16 v[168:171], v[112:115], v[52:55], 0
    v_max3_f32 v250, v200, v201, v250
    v_max3_f32 v251, v202, v203, v251
    s_waitcnt lgkmcnt(10)
    s_nop 0
    v_mfma_f32_16x16x32_bf16 v[140:143], v[116:119], v[48:51], 0
    v_max3_f32 v248, v172, v173, v248
    v_max3_f32 v249, v174, v175, v249
    v_mfma_f32_16x16x32_bf16 v[148:151], v[116:119], v[52:55], 0
    v_max3_f32 v250, v180, v181, v250
    v_max3_f32 v251, v182, v183, v251
    s_waitcnt lgkmcnt(8)
    s_nop 0
    v_mfma_f32_16x16x32_bf16 v[144:147], v[120:123], v[48:51], 0
    v_max3_f32 v248, v176, v177, v248
    v_max3_f32 v249, v178, v179, v249
    v_mfma_f32_16x16x32_bf16 v[152:155], v[120:123], v[52:55], 0
    v_max3_f32 v250, v184, v185, v250
    v_max3_f32 v251, v186, v187, v251
    s_waitcnt lgkmcnt(6)
    s_nop 0
    v_mfma_f32_16x16x32_bf16 v[124:127], v[16:19], v[48:51], 0
    v_max3_f32 v248, v156, v157, v248
    v_max3_f32 v249, v158, v159, v249
    v_mfma_f32_16x16x32_bf16 v[132:135], v[16:19], v[52:55], 0
    v_max3_f32 v250, v164, v165, v250
    v_max3_f32 v251, v166, v167, v251
    ds_read_b64 v[16:17], v12 offset:0
    ds_read_b32 v18, v13 offset:0
    s_waitcnt lgkmcnt(6)
    s_nop 0
    v_mfma_f32_16x16x32_bf16 v[128:131], v[20:23], v[48:51], 0
    v_max3_f32 v248, v160, v161, v248
    v_max3_f32 v249, v162, v163, v249
    v_mfma_f32_16x16x32_bf16 v[136:139], v[20:23], v[52:55], 0
    v_max3_f32 v250, v168, v169, v250
    v_max3_f32 v251, v170, v171, v251
    ds_read_b64 v[20:21], v12 offset:512
    ds_read_b32 v22, v13 offset:128
    s_waitcnt lgkmcnt(6)
    s_nop 0
    v_mfma_f32_16x16x32_bf16 v[108:111], v[24:27], v[48:51], 0
    v_max3_f32 v248, v140, v141, v248
    v_max3_f32 v249, v142, v143, v249
    v_mfma_f32_16x16x32_bf16 v[116:119], v[24:27], v[52:55], 0
    v_max3_f32 v250, v148, v149, v250
    v_max3_f32 v251, v150, v151, v251
    s_waitcnt lgkmcnt(4)
    s_nop 0
    v_mfma_f32_16x16x32_bf16 v[112:115], v[28:31], v[48:51], 0
    v_max3_f32 v248, v144, v145, v248
    v_max3_f32 v249, v146, v147, v249
    v_mfma_f32_16x16x32_bf16 v[120:123], v[28:31], v[52:55], 0
    v_max3_f32 v250, v152, v153, v250
    v_max3_f32 v251, v154, v155, v251
    s_waitcnt lgkmcnt(2)
    v_mfma_f32_16x16x32_bf16 v[92:95], v[16:19], v[48:51], v[44:47]
    v_max3_f32 v248, v124, v125, v248
    v_max3_f32 v249, v126, v127, v249
    s_waitcnt lgkmcnt(0)
    v_mfma_f32_16x16x32_bf16 v[96:99], v[20:23], v[48:51], 0
    v_max3_f32 v250, v132, v133, v250
    v_max3_f32 v251, v134, v135, v251
    v_mfma_f32_16x16x32_bf16 v[104:107], v[20:23], v[52:55], v[44:47]
    v_max3_f32 v248, v128, v129, v248
    v_max3_f32 v249, v130, v131, v249
    v_max3_f32 v250, v136, v137, v250
    v_max3_f32 v251, v138, v139, v251
    v_max3_f32 v248, v108, v109, v248
    v_max3_f32 v249, v110, v111, v249
    v_max3_f32 v250, v116, v117, v250
    v_max3_f32 v251, v118, v119, v251
    v_max3_f32 v248, v112, v113, v248
    v_max3_f32 v249, v114, v115, v249
    v_max3_f32 v250, v120, v121, v250
    v_max3_f32 v251, v122, v123, v251
    v_mov_b32 v20, 0x3f803f80
    v_mov_b32 v28, 0x3f803f80
    v_mov_b32 v21, 0x3f803f80
    v_mov_b32 v29, 0x3f803f80
    v_mov_b32 v22, 0x3f803f80
    v_mov_b32 v30, 0x3f803f80
    v_mov_b32 v23, 0x3f803f80
    v_mov_b32 v31, 0x3f803f80
    v_max3_f32 v248, v92, v93, v248
    v_max3_f32 v249, v94, v95, v249
    v_max3_f32 v248, v96, v97, v248
    v_max3_f32 v249, v98, v99, v249
    v_max3_f32 v250, v104, v105, v250
    v_max3_f32 v251, v106, v107, v251
LD_sj:
    v_max_f32 v248, v248, v249
    v_max_f32 v250, v250, v251
    v_mov_b32 v249, v248
    v_mov_b32 v251, v250
    s_nop 1
    v_permlane16_swap_b32 v248, v249
    v_permlane16_swap_b32 v250, v251
    v_max_f32 v248, v248, v249
    v_max_f32 v250, v250, v251
    v_mov_b32 v249, v248
    v_mov_b32 v251, v250
    s_nop 1
    v_permlane32_swap_b32 v248, v249
    v_permlane32_swap_b32 v250, v251
    v_max_f32 v248, v248, v249
    v_max_f32 v250, v250, v251
    v_mul_f32 v248, s80, v248
    v_mul_f32 v250, s80, v250
    s_lshr_b32 s42, s41, 1
    s_lshl_b32 s43, s42, 10
    s_and_b32 s44, s41, 1
    s_lshl_b32 s44, s44, 3
    s_add_u32 s43, s43, s44
    s_add_u32 s43, s43, 0
    v_lshl_add_u32 v12, v1, 4, s43
    s_lshl_b32 s43, s42, 11
    s_add_u32 s43, s43, s44
    s_add_u32 s43, s43, 142336
    v_lshl_add_u32 v13, v1, 4, s43
    s_lshl_b32 s43, s41, 2
    s_add_u32 s43, s43, 150528
    v_lshl_add_u32 v9, v1, 4, s43
    s_lshl_b32 s42, s41, 10
    s_add_u32 s42, s42, 151552
    v_lshl_add_u32 v52, v1, 4, s42
    s_lshl_b32 s42, s40, 10
    v_lshl_add_u32 v53, v1, 4, s42
    v_add_u32 v54, 4096, v53
    v_mov_b32 v48, -1
    v_mov_b32 v49, -1
    v_mov_b32 v50, -1
    v_mov_b32 v51, -1
    v_and_b32 v55, 15, v1
    v_lshlrev_b32 v55, 4, v55
    v_lshrrev_b32 v236, 4, v1
    v_lshl_add_u32 v55, v236, 2, v55
    v_add_u32 v55, 150528, v55
    v_mov_b32 v244, 0x3f803f80
    v_mov_b32 v245, 0x3f803f80
    v_mov_b32 v246, 0x3f803f80
    v_mov_b32 v247, 0x3f803f80
    v_pk_fma_f32 v[220:221], v[220:221], v[252:253], v[248:249] op_sel_hi:[1,0,0] neg_lo:[0,0,1] neg_hi:[0,0,1]
    v_pk_fma_f32 v[222:223], v[222:223], v[252:253], v[248:249] op_sel_hi:[1,0,0] neg_lo:[0,0,1] neg_hi:[0,0,1]
    v_exp_f32 v220, v220
    v_exp_f32 v221, v221
    v_exp_f32 v222, v222
    v_exp_f32 v223, v223
    v_cvt_pk_bf16_f32 v220, v220, v221
    v_cvt_pk_bf16_f32 v221, v222, v223
    v_mov_b32 v222, 0
    v_mov_b32 v223, 0
    v_pk_fma_f32 v[228:229], v[228:229], v[252:253], v[250:251] op_sel_hi:[1,0,0] neg_lo:[0,0,1] neg_hi:[0,0,1]
    v_pk_fma_f32 v[230:231], v[230:231], v[252:253], v[250:251] op_sel_hi:[1,0,0] neg_lo:[0,0,1] neg_hi:[0,0,1]
    v_pk_fma_f32 v[232:233], v[232:233], v[252:253], v[250:251] op_sel_hi:[1,0,0] neg_lo:[0,0,1] neg_hi:[0,0,1]
    v_pk_fma_f32 v[234:235], v[234:235], v[252:253], v[250:251] op_sel_hi:[1,0,0] neg_lo:[0,0,1] neg_hi:[0,0,1]
    v_exp_f32 v228, v228
    v_exp_f32 v229, v229
    v_exp_f32 v230, v230
    v_exp_f32 v231, v231
    v_exp_f32 v232, v232
    v_exp_f32 v233, v233
    v_exp_f32 v234, v234
    v_exp_f32 v235, v235
    v_cvt_pk_bf16_f32 v228, v228, v229
    v_cvt_pk_bf16_f32 v229, v230, v231
    v_cvt_pk_bf16_f32 v230, v232, v233
    v_cvt_pk_bf16_f32 v231, v234, v235
    v_pk_fma_f32 v[204:205], v[204:205], v[252:253], v[248:249] op_sel_hi:[1,0,0] neg_lo:[0,0,1] neg_hi:[0,0,1]
    v_pk_fma_f32 v[206:207], v[206:207], v[252:253], v[248:249] op_sel_hi:[1,0,0] neg_lo:[0,0,1] neg_hi:[0,0,1]
    v_pk_fma_f32 v[208:209], v[208:209], v[252:253], v[248:249] op_sel_hi:[1,0,0] neg_lo:[0,0,1] neg_hi:[0,0,1]
    v_pk_fma_f32 v[210:211], v[210:211], v[252:253], v[248:249] op_sel_hi:[1,0,0] neg_lo:[0,0,1] neg_hi:[0,0,1]
    v_exp_f32 v204, v204
    v_exp_f32 v205, v205
    v_exp_f32 v206, v206
    v_exp_f32 v207, v207
    v_exp_f32 v208, v208
    v_exp_f32 v209, v209
    v_exp_f32 v210, v210
    v_exp_f32 v211, v211
    v_cvt_pk_bf16_f32 v204, v204, v205
    v_cvt_pk_bf16_f32 v205, v206, v207
    v_cvt_pk_bf16_f32 v206, v208, v209
    v_cvt_pk_bf16_f32 v207, v210, v211
    v_pk_fma_f32 v[212:213], v[212:213], v[252:253], v[250:251] op_sel_hi:[1,0,0] neg_lo:[0,0,1] neg_hi:[0,0,1]
    v_pk_fma_f32 v[214:215], v[214:215], v[252:253], v[250:251] op_sel_hi:[1,0,0] neg_lo:[0,0,1] neg_hi:[0,0,1]
    v_pk_fma_f32 v[216:217], v[216:217], v[252:253], v[250:251] op_sel_hi:[1,0,0] neg_lo:[0,0,1] neg_hi:[0,0,1]
    v_pk_fma_f32 v[218:219], v[218:219], v[252:253], v[250:251] op_sel_hi:[1,0,0] neg_lo:[0,0,1] neg_hi:[0,0,1]
    v_exp_f32 v212, v212
    v_exp_f32 v213, v213
    v_exp_f32 v214, v214
    v_exp_f32 v215, v215
    v_exp_f32 v216, v216
    v_exp_f32 v217, v217
    v_exp_f32 v218, v218
    v_exp_f32 v219, v219
    v_cvt_pk_bf16_f32 v212, v212, v213
    v_cvt_pk_bf16_f32 v213, v214, v215
    v_cvt_pk_bf16_f32 v214, v216, v217
    v_cvt_pk_bf16_f32 v215, v218, v219
    v_pk_fma_f32 v[188:189], v[188:189], v[252:253], v[248:249] op_sel_hi:[1,0,0] neg_lo:[0,0,1] neg_hi:[0,0,1]
    v_pk_fma_f32 v[190:191], v[190:191], v[252:253], v[248:249] op_sel_hi:[1,0,0] neg_lo:[0,0,1] neg_hi:[0,0,1]
    v_pk_fma_f32 v[192:193], v[192:193], v[252:253], v[248:249] op_sel_hi:[1,0,0] neg_lo:[0,0,1] neg_hi:[0,0,1]
    v_pk_fma_f32 v[194:195], v[194:195], v[252:253], v[248:249] op_sel_hi:[1,0,0] neg_lo:[0,0,1] neg_hi:[0,0,1]
    v_exp_f32 v188, v188
    v_exp_f32 v189, v189
    v_exp_f32 v190, v190
    v_exp_f32 v191, v191
    v_exp_f32 v192, v192
    v_exp_f32 v193, v193
    v_exp_f32 v194, v194
    v_exp_f32 v195, v195
    v_cvt_pk_bf16_f32 v188, v188, v189
    v_cvt_pk_bf16_f32 v189, v190, v191
    v_cvt_pk_bf16_f32 v190, v192, v193
    v_cvt_pk_bf16_f32 v191, v194, v195
    v_pk_fma_f32 v[196:197], v[196:197], v[252:253], v[250:251] op_sel_hi:[1,0,0] neg_lo:[0,0,1] neg_hi:[0,0,1]
    v_pk_fma_f32 v[198:199], v[198:199], v[252:253], v[250:251] op_sel_hi:[1,0,0] neg_lo:[0,0,1] neg_hi:[0,0,1]
    v_pk_fma_f32 v[200:201], v[200:201], v[252:253], v[250:251] op_sel_hi:[1,0,0] neg_lo:[0,0,1] neg_hi:[0,0,1]
    v_pk_fma_f32 v[202:203], v[202:203], v[252:253], v[250:251] op_sel_hi:[1,0,0] neg_lo:[0,0,1] neg_hi:[0,0,1]
    v_exp_f32 v196, v196
    v_exp_f32 v197, v197
    v_exp_f32 v198, v198
    v_exp_f32 v199, v199
    v_exp_f32 v200, v200
    v_exp_f32 v201, v201
    v_exp_f32 v202, v202
    v_exp_f32 v203, v203
    v_cvt_pk_bf16_f32 v196, v196, v197
    v_cvt_pk_bf16_f32 v197, v198, v199
    v_cvt_pk_bf16_f32 v198, v200, v201
    v_cvt_pk_bf16_f32 v199, v202, v203
    v_pk_fma_f32 v[172:173], v[172:173], v[252:253], v[248:249] op_sel_hi:[1,0,0] neg_lo:[0,0,1] neg_hi:[0,0,1]
    v_pk_fma_f32 v[174:175], v[174:175], v[252:253], v[248:249] op_sel_hi:[1,0,0] neg_lo:[0,0,1] neg_hi:[0,0,1]
    v_pk_fma_f32 v[176:177], v[176:177], v[252:253], v[248:249] op_sel_hi:[1,0,0] neg_lo:[0,0,1] neg_hi:[0,0,1]
    v_pk_fma_f32 v[178:179], v[178:179], v[252:253], v[248:249] op_sel_hi:[1,0,0] neg_lo:[0,0,1] neg_hi:[0,0,1]
    v_exp_f32 v172, v172
    v_exp_f32 v173, v173
    v_exp_f32 v174, v174
    v_exp_f32 v175, v175
    v_exp_f32 v176, v176
    v_exp_f32 v177, v177
    v_exp_f32 v178, v178
    v_exp_f32 v179, v179
    v_cvt_pk_bf16_f32 v172, v172, v173
    v_cvt_pk_bf16_f32 v173, v174, v175
    v_cvt_pk_bf16_f32 v174, v176, v177
    v_cvt_pk_bf16_f32 v175, v178, v179
    v_pk_fma_f32 v[180:181], v[180:181], v[252:253], v[250:251] op_sel_hi:[1,0,0] neg_lo:[0,0,1] neg_hi:[0,0,1]
    v_pk_fma_f32 v[182:183], v[182:183], v[252:253], v[250:251] op_sel_hi:[1,0,0] neg_lo:[0,0,1] neg_hi:[0,0,1]
    v_pk_fma_f32 v[184:185], v[184:185], v[252:253], v[250:251] op_sel_hi:[1,0,0] neg_lo:[0,0,1] neg_hi:[0,0,1]
    v_pk_fma_f32 v[186:187], v[186:187], v[252:253], v[250:251] op_sel_hi:[1,0,0] neg_lo:[0,0,1] neg_hi:[0,0,1]
    v_exp_f32 v180, v180
    v_exp_f32 v181, v181
    v_exp_f32 v182, v182
    v_exp_f32 v183, v183
    v_exp_f32 v184, v184
    v_exp_f32 v185, v185
    v_exp_f32 v186, v186
    v_exp_f32 v187, v187
    v_cvt_pk_bf16_f32 v180, v180, v181
    v_cvt_pk_bf16_f32 v181, v182, v183
    v_cvt_pk_bf16_f32 v182, v184, v185
    v_cvt_pk_bf16_f32 v183, v186, v187
    s_lshl_b32 s43, s62, 6
    s_mul_i32 s44, s38, 73728
    s_add_u32 s44, s43, s44
    buffer_store_dwordx4 v[48:51], v53, s[68:71], s44 offen sc1
    s_lshl_b32 s43, s62, 6
    s_mul_i32 s44, s38, 73728
    s_add_u32 s44, s43, s44
    buffer_store_dwordx4 v[48:51], v54, s[68:71], s44 offen sc1
    s_waitcnt vmcnt(2)
    s_barrier
    ds_read_b128 v[16:19], v14 offset:36864
    s_mov_b32 exec_lo, 0x00030003
    s_mov_b32 exec_hi, 0x00030003
    ds_read_b128 v[20:23], v15 offset:36864
    s_mov_b64 exec, -1
    ds_read_b128 v[24:27], v14 offset:32256
    s_mov_b32 exec_lo, 0x00030003
    s_mov_b32 exec_hi, 0x00030003
    ds_read_b128 v[28:31], v15 offset:32256
    s_mov_b64 exec, -1
    s_waitcnt lgkmcnt(2)
    v_mfma_f32_16x16x32_bf16 v[32:35], v[16:19], v[220:223], 0
    ds_read_b128 v[240:243], v14 offset:27648
    s_mov_b32 exec_lo, 0x00030003
    s_mov_b32 exec_hi, 0x00030003
    ds_read_b128 v[244:247], v15 offset:27648
    s_mov_b64 exec, -1
    s_lshl_b32 s42, s48, 11
    v_add_u32 v236, s42, v12
    ds_write_b64 v236, v[56:57] offset:0
    ds_write_b64 v236, v[58:59] offset:18432
    v_pk_fma_f32 v[156:157], v[156:157], v[252:253], v[248:249] op_sel_hi:[1,0,0] neg_lo:[0,0,1] neg_hi:[0,0,1]
    v_pk_fma_f32 v[158:159], v[158:159], v[252:253], v[248:249] op_sel_hi:[1,0,0] neg_lo:[0,0,1] neg_hi:[0,0,1]
    v_pk_fma_f32 v[160:161], v[160:161], v[252:253], v[248:249] op_sel_hi:[1,0,0] neg_lo:[0,0,1] neg_hi:[0,0,1]
    v_pk_fma_f32 v[162:163], v[162:163], v[252:253], v[248:249] op_sel_hi:[1,0,0] neg_lo:[0,0,1] neg_hi:[0,0,1]
    v_exp_f32 v156, v156
    v_exp_f32 v157, v157
    v_exp_f32 v158, v158
    v_exp_f32 v159, v159
    v_mfma_f32_16x16x32_bf16 v[40:43], v[20:23], v[220:223], 0
    s_lshl_b32 s42, s49, 11
    v_add_u32 v237, s42, v12
    ds_write_b64 v237, v[60:61] offset:0
    ds_write_b64 v237, v[62:63] offset:18432
    s_add_u32 s45, s58, s75
    s_add_u32 m0, s46, 122880
    s_add_u32 s47, s45, 0
    buffer_load_dwordx4 v11, s[12:15], s47 offen lds
    v_exp_f32 v160, v160
    v_exp_f32 v161, v161
    v_exp_f32 v162, v162
    v_exp_f32 v163, v163
    v_cvt_pk_bf16_f32 v156, v156, v157
    v_cvt_pk_bf16_f32 v157, v158, v159
    v_cvt_pk_bf16_f32 v158, v160, v161
    v_cvt_pk_bf16_f32 v159, v162, v163
    v_mfma_f32_16x16x32_bf16 v[36:39], v[16:19], v[228:231], 0
    s_lshl_b32 s42, s50, 11
    v_add_u32 v236, s42, v12
    ds_write_b64 v236, v[64:65] offset:0
    ds_write_b64 v236, v[66:67] offset:18432
    v_pk_fma_f32 v[164:165], v[164:165], v[252:253], v[250:251] op_sel_hi:[1,0,0] neg_lo:[0,0,1] neg_hi:[0,0,1]
    v_pk_fma_f32 v[166:167], v[166:167], v[252:253], v[250:251] op_sel_hi:[1,0,0] neg_lo:[0,0,1] neg_hi:[0,0,1]
    v_pk_fma_f32 v[168:169], v[168:169], v[252:253], v[250:251] op_sel_hi:[1,0,0] neg_lo:[0,0,1] neg_hi:[0,0,1]
    v_pk_fma_f32 v[170:171], v[170:171], v[252:253], v[250:251] op_sel_hi:[1,0,0] neg_lo:[0,0,1] neg_hi:[0,0,1]
    v_exp_f32 v164, v164
    v_exp_f32 v165, v165
    v_exp_f32 v166, v166
    v_exp_f32 v167, v167
    v_mfma_f32_16x16x32_bf16 v[44:47], v[20:23], v[228:231], 0
    s_lshl_b32 s42, s51, 11
    v_add_u32 v237, s42, v12
    ds_write_b64 v237, v[68:69] offset:0
    ds_write_b64 v237, v[70:71] offset:18432
    v_exp_f32 v168, v168
    v_exp_f32 v169, v169
    v_exp_f32 v170, v170
    v_exp_f32 v171, v171
    v_cvt_pk_bf16_f32 v164, v164, v165
    v_cvt_pk_bf16_f32 v165, v166, v167
    v_cvt_pk_bf16_f32 v166, v168, v169
    v_cvt_pk_bf16_f32 v167, v170, v171
    s_waitcnt lgkmcnt(10)
    v_mfma_f32_16x16x32_bf16 v[32:35], v[24:27], v[204:207], v[32:35]
    ds_read_b128 v[16:19], v14 offset:23040
    s_mov_b32 exec_lo, 0x00030003
    s_mov_b32 exec_hi, 0x00030003
    ds_read_b128 v[20:23], v15 offset:23040
    s_mov_b64 exec, -1
    s_lshl_b32 s42, s52, 11
    v_add_u32 v236, s42, v12
    ds_write_b64 v236, v[72:73] offset:0
    ds_write_b64 v236, v[74:75] offset:18432
    v_pk_fma_f32 v[140:141], v[140:141], v[252:253], v[248:249] op_sel_hi:[1,0,0] neg_lo:[0,0,1] neg_hi:[0,0,1]
    v_pk_fma_f32 v[142:143], v[142:143], v[252:253], v[248:249] op_sel_hi:[1,0,0] neg_lo:[0,0,1] neg_hi:[0,0,1]
    v_pk_fma_f32 v[144:145], v[144:145], v[252:253], v[248:249] op_sel_hi:[1,0,0] neg_lo:[0,0,1] neg_hi:[0,0,1]
    v_pk_fma_f32 v[146:147], v[146:147], v[252:253], v[248:249] op_sel_hi:[1,0,0] neg_lo:[0,0,1] neg_hi:[0,0,1]
    v_exp_f32 v140, v140
    v_exp_f32 v141, v141
    v_exp_f32 v142, v142
    v_exp_f32 v143, v143
    v_mfma_f32_16x16x32_bf16 v[40:43], v[28:31], v[204:207], v[40:43]
    s_lshl_b32 s42, s53, 11
    v_add_u32 v237, s42, v12
    ds_write_b64 v237, v[76:77] offset:0
    ds_write_b64 v237, v[78:79] offset:18432
    s_add_u32 s45, s58, s75
    s_add_u32 m0, s46, 126976
    s_add_u32 s47, s45, 36864
    buffer_load_dwordx4 v11, s[12:15], s47 offen lds
    v_exp_f32 v144, v144
    v_exp_f32 v145, v145
    v_exp_f32 v146, v146
    v_exp_f32_e64 v147, v147
    v_cvt_pk_bf16_f32 v140, v140, v141
    v_cvt_pk_bf16_f32 v141, v142, v143
    v_cvt_pk_bf16_f32 v142, v144, v145
    v_cvt_pk_bf16_f32 v143, v146, v147
    v_mfma_f32_16x16x32_bf16 v[36:39], v[24:27], v[212:215], v[36:39]
    s_lshl_b32 s42, s54, 11
    v_add_u32 v236, s42, v12
    ds_write_b64 v236, v[80:81] offset:0
    ds_write_b64 v236, v[82:83] offset:18432
    v_pk_fma_f32 v[148:149], v[148:149], v[252:253], v[250:251] op_sel_hi:[1,0,0] neg_lo:[0,0,1] neg_hi:[0,0,1]
    v_pk_fma_f32 v[150:151], v[150:151], v[252:253], v[250:251] op_sel_hi:[1,0,0] neg_lo:[0,0,1] neg_hi:[0,0,1]
    v_pk_fma_f32 v[152:153], v[152:153], v[252:253], v[250:251] op_sel_hi:[1,0,0] neg_lo:[0,0,1] neg_hi:[0,0,1]
    v_pk_fma_f32 v[154:155], v[154:155], v[252:253], v[250:251] op_sel_hi:[1,0,0] neg_lo:[0,0,1] neg_hi:[0,0,1]
    v_exp_f32 v148, v148
    v_exp_f32 v149, v149
    v_exp_f32 v150, v150
    v_exp_f32 v151, v151
    v_mfma_f32_16x16x32_bf16 v[44:47], v[28:31], v[212:215], v[44:47]
    s_lshl_b32 s42, s55, 11
    v_add_u32 v237, s42, v12
    ds_write_b64 v237, v[84:85] offset:0
    ds_write_b64 v237, v[86:87] offset:18432
    v_exp_f32 v152, v152
    v_exp_f32 v153, v153
    v_exp_f32 v154, v154
    v_exp_f32 v155, v155
    v_cvt_pk_bf16_f32 v148, v148, v149
    v_cvt_pk_bf16_f32 v149, v150, v151
    v_cvt_pk_bf16_f32 v150, v152, v153
    v_cvt_pk_bf16_f32 v151, v154, v155
    v_mfma_f32_16x16x32_bf16 v[32:35], v[240:243], v[188:191], v[32:35]
    ds_read_b128 v[24:27], v14 offset:18432
    s_mov_b32 exec_lo, 0x00030003
    s_mov_b32 exec_hi, 0x00030003
    ds_read_b128 v[28:31], v15 offset:18432
    s_mov_b64 exec, -1
    s_lshl_b32 s42, s56, 11
    v_add_u32_e64 v236, s42, v12
    ds_write_b64 v236, v[88:89] offset:0
    ds_write_b64 v236, v[90:91] offset:18432
    v_pk_fma_f32 v[124:125], v[124:125], v[252:253], v[248:249] op_sel_hi:[1,0,0] neg_lo:[0,0,1] neg_hi:[0,0,1]
    v_pk_fma_f32 v[126:127], v[126:127], v[252:253], v[248:249] op_sel_hi:[1,0,0] neg_lo:[0,0,1] neg_hi:[0,0,1]
    v_pk_fma_f32 v[128:129], v[128:129], v[252:253], v[248:249] op_sel_hi:[1,0,0] neg_lo:[0,0,1] neg_hi:[0,0,1]
    v_pk_fma_f32 v[130:131], v[130:131], v[252:253], v[248:249] op_sel_hi:[1,0,0] neg_lo:[0,0,1] neg_hi:[0,0,1]
    v_exp_f32 v124, v124
    v_exp_f32 v125, v125
    v_exp_f32 v126, v126
    v_exp_f32 v127, v127
    v_mfma_f32_16x16x32_bf16 v[40:43], v[244:247], v[188:191], v[40:43]
    s_add_u32 s45, s58, s76
    s_mov_b32 m0, 131072
    s_add_u32 s47, s45, 0
    s_mov_b64 exec, s[78:79]
    buffer_load_dwordx4 v11, s[12:15], s47 offen lds
    s_mov_b64 exec, -1
    v_exp_f32 v128, v128
    v_exp_f32 v129, v129
    v_exp_f32 v130, v130
    v_exp_f32 v131, v131
    v_cvt_pk_bf16_f32 v124, v124, v125
    v_cvt_pk_bf16_f32 v125, v126, v127
    v_cvt_pk_bf16_f32 v126, v128, v129
    v_cvt_pk_bf16_f32 v127, v130, v131
    v_mfma_f32_16x16x32_bf16 v[36:39], v[240:243], v[196:199], v[36:39]
    v_pk_fma_f32 v[132:133], v[132:133], v[252:253], v[250:251] op_sel_hi:[1,0,0] neg_lo:[0,0,1] neg_hi:[0,0,1]
    v_pk_fma_f32 v[134:135], v[134:135], v[252:253], v[250:251] op_sel_hi:[1,0,0] neg_lo:[0,0,1] neg_hi:[0,0,1]
    v_pk_fma_f32 v[136:137], v[136:137], v[252:253], v[250:251] op_sel_hi:[1,0,0] neg_lo:[0,0,1] neg_hi:[0,0,1]
    v_pk_fma_f32 v[138:139], v[138:139], v[252:253], v[250:251] op_sel_hi:[1,0,0] neg_lo:[0,0,1] neg_hi:[0,0,1]
    v_exp_f32 v132, v132
    v_exp_f32 v133, v133
    v_exp_f32 v134, v134
    v_exp_f32 v135, v135
    v_mfma_f32_16x16x32_bf16 v[44:47], v[244:247], v[196:199], v[44:47]
    v_exp_f32 v136, v136
    v_exp_f32 v137, v137
    v_exp_f32 v138, v138
    v_exp_f32 v139, v139
    v_cvt_pk_bf16_f32 v132, v132, v133
    v_cvt_pk_bf16_f32 v133, v134, v135
    v_cvt_pk_bf16_f32 v134, v136, v137
    v_cvt_pk_bf16_f32 v135, v138, v139
    s_waitcnt lgkmcnt(12)
    v_mfma_f32_16x16x32_bf16 v[32:35], v[16:19], v[172:175], v[32:35]
    ds_read_b128 v[240:243], v14 offset:13824
    s_mov_b32 exec_lo, 0x00030003
    s_mov_b32 exec_hi, 0x00030003
    ds_read_b128 v[244:247], v15 offset:13824
    s_mov_b64 exec, -1
    v_pk_fma_f32 v[108:109], v[108:109], v[252:253], v[248:249] op_sel_hi:[1,0,0] neg_lo:[0,0,1] neg_hi:[0,0,1]
    v_pk_fma_f32 v[110:111], v[110:111], v[252:253], v[248:249] op_sel_hi:[1,0,0] neg_lo:[0,0,1] neg_hi:[0,0,1]
    v_pk_fma_f32 v[112:113], v[112:113], v[252:253], v[248:249] op_sel_hi:[1,0,0] neg_lo:[0,0,1] neg_hi:[0,0,1]
    v_pk_fma_f32 v[114:115], v[114:115], v[252:253], v[248:249] op_sel_hi:[1,0,0] neg_lo:[0,0,1] neg_hi:[0,0,1]
    v_exp_f32 v108, v108
    v_exp_f32 v109, v109
    v_exp_f32 v110, v110
    v_exp_f32 v111, v111
    v_mfma_f32_16x16x32_bf16 v[40:43], v[20:23], v[172:175], v[40:43]
    s_add_u32 s45, s59, s75
    s_add_u32 m0, s46, 132096
    s_add_u32 s47, s45, 0
    buffer_load_dwordx4 v11, s[12:15], s47 offen lds
    v_exp_f32 v112, v112
    v_exp_f32 v113, v113
    v_exp_f32 v114, v114
    v_exp_f32 v115, v115
    v_cvt_pk_bf16_f32 v108, v108, v109
    v_cvt_pk_bf16_f32 v109, v110, v111
    v_cvt_pk_bf16_f32 v110, v112, v113
    v_cvt_pk_bf16_f32 v111, v114, v115
    v_mfma_f32_16x16x32_bf16 v[36:39], v[16:19], v[180:183], v[36:39]
    v_pk_fma_f32 v[116:117], v[116:117], v[252:253], v[250:251] op_sel_hi:[1,0,0] neg_lo:[0,0,1] neg_hi:[0,0,1]
    v_pk_fma_f32 v[118:119], v[118:119], v[252:253], v[250:251] op_sel_hi:[1,0,0] neg_lo:[0,0,1] neg_hi:[0,0,1]
    v_pk_fma_f32 v[120:121], v[120:121], v[252:253], v[250:251] op_sel_hi:[1,0,0] neg_lo:[0,0,1] neg_hi:[0,0,1]
    v_pk_fma_f32 v[122:123], v[122:123], v[252:253], v[250:251] op_sel_hi:[1,0,0] neg_lo:[0,0,1] neg_hi:[0,0,1]
    v_exp_f32 v116, v116
    v_exp_f32 v117, v117
    v_exp_f32 v118, v118
    v_exp_f32 v119, v119
    v_mfma_f32_16x16x32_bf16 v[44:47], v[20:23], v[180:183], v[44:47]
    v_exp_f32 v120, v120
    v_exp_f32 v121, v121
    v_exp_f32 v122, v122
    v_exp_f32 v123, v123
    v_cvt_pk_bf16_f32 v116, v116, v117
    v_cvt_pk_bf16_f32 v117, v118, v119
    v_cvt_pk_bf16_f32 v118, v120, v121
    v_cvt_pk_bf16_f32 v119, v122, v123
    s_lshl_b32 s43, s63, 6
    s_mul_i32 s44, s38, 73728
    s_add_u32 s44, s43, s44
    buffer_store_dwordx4 v[48:51], v53, s[68:71], s44 offen sc1
    s_lshl_b32 s43, s63, 6
    s_mul_i32 s44, s38, 73728
    s_add_u32 s44, s43, s44
    buffer_store_dwordx4 v[48:51], v54, s[68:71], s44 offen sc1
    s_lshl_b32 s43, s64, 6
    s_mul_i32 s44, s38, 73728
    s_add_u32 s44, s43, s44
    buffer_store_dwordx4 v[48:51], v53, s[68:71], s44 offen sc1
    s_lshl_b32 s43, s64, 6
    s_mul_i32 s44, s38, 73728
    s_add_u32 s44, s43, s44
    buffer_store_dwordx4 v[48:51], v54, s[68:71], s44 offen sc1
    s_waitcnt lgkmcnt(2)
    s_barrier
    v_mfma_f32_16x16x32_bf16 v[32:35], v[24:27], v[156:159], v[32:35]
    ds_read_b128 v[16:19], v14 offset:9216
    s_mov_b32 exec_lo, 0x00030003
    s_mov_b32 exec_hi, 0x00030003
    ds_read_b128 v[20:23], v15 offset:9216
    s_mov_b64 exec, -1
    s_nop 0
    ds_read_b128 v[220:223], v7 offset:16384
    ds_read_b128 v[224:227], v7 offset:34816
    v_pk_fma_f32 v[92:93], v[92:93], v[252:253], v[248:249] op_sel_hi:[1,0,0] neg_lo:[0,0,1] neg_hi:[0,0,1]
    v_pk_fma_f32 v[94:95], v[94:95], v[252:253], v[248:249] op_sel_hi:[1,0,0] neg_lo:[0,0,1] neg_hi:[0,0,1]
    v_pk_fma_f32 v[96:97], v[96:97], v[252:253], v[248:249] op_sel_hi:[1,0,0] neg_lo:[0,0,1] neg_hi:[0,0,1]
    v_pk_fma_f32 v[98:99], v[98:99], v[252:253], v[248:249] op_sel_hi:[1,0,0] neg_lo:[0,0,1] neg_hi:[0,0,1]
    v_exp_f32 v92, v92
    v_exp_f32 v93, v93
    v_exp_f32_e64 v94, v94
    v_mfma_f32_16x16x32_bf16 v[40:43], v[28:31], v[156:159], v[40:43]
    ds_read_b128 v[228:231], v7 offset:17408
    ds_read_b128 v[232:235], v7 offset:35840
    s_add_u32 s45, s59, s75
    s_add_u32 m0, s46, 136192
    s_add_u32 s47, s45, 36864
    buffer_load_dwordx4 v11, s[12:15], s47 offen lds
    v_exp_f32 v95, v95
    v_exp_f32 v96, v96
    v_exp_f32 v97, v97
    v_exp_f32 v98, v98
    v_exp_f32 v99, v99
    v_cvt_pk_bf16_f32 v92, v92, v93
    v_cvt_pk_bf16_f32 v93, v94, v95
    v_mfma_f32_16x16x32_bf16 v[36:39], v[24:27], v[164:167], v[36:39]
    s_add_u32 s45, s58, s74
    s_add_u32 m0, s46, 98304
    s_add_u32 s47, s45, 0
    buffer_load_dwordx4 v11, s[20:23], s47 offen lds
    s_add_u32 s45, s58, s74
    s_nop 0
    s_add_u32 m0, s46, 102400
    s_add_u32 s47, s45, 36864
    buffer_load_dwordx4 v11, s[20:23], s47 offen lds
    v_cvt_pk_bf16_f32 v94, v96, v97
    v_cvt_pk_bf16_f32 v95, v98, v99
    v_pk_fma_f32 v[104:105], v[104:105], v[252:253], v[250:251] op_sel_hi:[1,0,0] neg_lo:[0,0,1] neg_hi:[0,0,1]
    v_pk_fma_f32 v[106:107], v[106:107], v[252:253], v[250:251] op_sel_hi:[1,0,0] neg_lo:[0,0,1] neg_hi:[0,0,1]
    v_exp_f32 v104, v104
    v_exp_f32 v105, v105
    v_exp_f32_e64 v106, v106
    v_mfma_f32_16x16x32_bf16 v[44:47], v[28:31], v[164:167], v[44:47]
    s_add_u32 s45, s58, s74
    s_add_u32 m0, s46, 106496
    s_add_u32 s47, s45, 73728
    buffer_load_dwordx4 v11, s[20:23], s47 offen lds
    s_add_u32 s45, s58, s74
    s_add_u32 m0, s46, 110592
    s_add_u32 s47, s45, 110592
    buffer_load_dwordx4 v11, s[20:23], s47 offen lds
    v_exp_f32 v107, v107
    v_mov_b32 v100, 0
    v_mov_b32_e64 v101, 0
    v_cvt_pk_bf16_f32 v102, v104, v105
    v_cvt_pk_bf16_f32 v103, v106, v107
    s_waitcnt lgkmcnt(6)
    v_mfma_f32_16x16x32_bf16 v[32:35], v[240:243], v[140:143], v[32:35]
    ds_read_b128 v[24:27], v14 offset:4608
    s_mov_b32 exec_lo, 0x00030003
    s_mov_b32 exec_hi, 0x00030003
    ds_read_b128 v[28:31], v15 offset:4608
    s_mov_b64 exec, -1
    s_add_u32 s45, s58, s74
    s_add_u32 m0, s46, 114688
    s_add_u32 s47, s45, 147456
    buffer_load_dwordx4 v11, s[20:23], s47 offen lds
    s_add_u32 s45, s58, s74
    s_add_u32 m0, s46, 118784
    s_add_u32 s47, s45, 184320
    buffer_load_dwordx4 v11, s[20:23], s47 offen lds
    v_mfma_f32_16x16x32_bf16 v[40:43], v[244:247], v[140:143], v[40:43]
    ds_read_b128 v[204:207], v7 offset:14336
    ds_read_b128 v[208:211], v7 offset:32768
    s_add_u32 s45, s59, s76
    s_mov_b32 m0, 140288
    s_add_u32 s47, s45, 0
    s_mov_b64 exec, s[78:79]
    buffer_load_dwordx4 v11, s[12:15], s47 offen lds
    s_mov_b64 exec, -1
    v_mfma_f32_16x16x32_bf16 v[36:39], v[240:243], v[148:151], v[36:39]
    ds_read_b128 v[212:215], v7 offset:15360
    ds_read_b128 v[216:219], v7 offset:33792
    v_mfma_f32_16x16x32_bf16 v[44:47], v[244:247], v[148:151], v[44:47]
    ds_read_b128 v[188:191], v7 offset:12288
    ds_read_b128 v[192:195], v7 offset:30720
    s_waitcnt lgkmcnt(12)
    v_mfma_f32_16x16x32_bf16 v[32:35], v[16:19], v[124:127], v[32:35]
    ds_read_b128 v[240:243], v14 offset:0
    s_mov_b32 exec_lo, 0x00030003
    s_mov_b32 exec_hi, 0x00030003
    ds_read_b128 v[244:247], v15 offset:0
    s_mov_b64 exec, -1
    ds_read_b128 v[196:199], v7 offset:13312
    ds_read_b128 v[200:203], v7 offset:31744
    v_mfma_f32_16x16x32_bf16 v[40:43], v[20:23], v[124:127], v[40:43]
    ds_read_b128 v[172:175], v7 offset:10240
    ds_read_b128 v[176:179], v7 offset:28672
    v_mfma_f32_16x16x32_bf16 v[36:39], v[16:19], v[132:135], v[36:39]
    ds_read_b128 v[180:183], v7 offset:11264
    ds_read_b128 v[184:187], v7 offset:29696
    v_mfma_f32_16x16x32_bf16 v[44:47], v[20:23], v[132:135], v[44:47]
    v_mov_b32 v73, 0
    v_mov_b32 v74, 0
    v_mov_b32 v75, 0
    v_mov_b32 v77, 0
    v_mov_b32 v78, 0
    v_mov_b32 v79, 0
    ds_read_b128 v[156:159], v7 offset:8192
    v_mfma_f32_16x16x32_bf16 v[32:35], v[24:27], v[108:111], v[32:35]
    ds_read_b128 v[160:163], v7 offset:26624
    ds_read_b128 v[164:167], v7 offset:9216
    v_mfma_f32_16x16x32_bf16 v[40:43], v[28:31], v[108:111], v[40:43]
    ds_read_b128 v[168:171], v7 offset:27648
    ds_read_b128 v[140:143], v7 offset:6144
    v_mfma_f32_16x16x32_bf16 v[36:39], v[24:27], v[116:119], v[36:39]
    ds_read_b128 v[144:147], v7 offset:24576
    ds_read_b128 v[148:151], v7 offset:7168
    v_mfma_f32_16x16x32_bf16 v[44:47], v[28:31], v[116:119], v[44:47]
    ds_read_b128 v[152:155], v7 offset:25600
    ds_read_b128 v[124:127], v7 offset:4096
    v_mfma_f32_16x16x32_bf16 v[32:35], v[240:243], v[92:95], v[32:35]
    ds_read_b128 v[128:131], v7 offset:22528
    ds_read_b128 v[132:135], v7 offset:5120
    v_mfma_f32_16x16x32_bf16 v[40:43], v[244:247], v[92:95], v[40:43]
    ds_read_b128 v[136:139], v7 offset:23552
    ds_read_b128 v[108:111], v7 offset:2048
    v_mfma_f32_16x16x32_bf16 v[36:39], v[240:243], v[100:103], v[36:39]
    ds_read_b128 v[112:115], v7 offset:20480
    ds_read_b128 v[116:119], v7 offset:3072
    v_mfma_f32_16x16x32_bf16 v[44:47], v[244:247], v[100:103], v[44:47]
    ds_read_b128 v[120:123], v7 offset:21504
    s_nop 7
    v_rcp_f32 v238, v42
    v_rcp_f32 v240, v46
    s_nop 0
    v_pk_mul_f32 v[32:33], v[32:33], v[238:239] op_sel_hi:[1,0]
    v_pk_mul_f32 v[34:35], v[34:35], v[238:239] op_sel_hi:[1,0]
    v_pk_mul_f32 v[40:41], v[40:41], v[238:239] op_sel_hi:[1,0]
    v_cvt_pk_bf16_f32 v32, v32, v33
    v_cvt_pk_bf16_f32 v33, v34, v35
    v_cvt_pk_bf16_f32 v40, v40, v41
    ds_write_b64 v13, v[32:33] offset:0
    v_pk_mul_f32 v[36:37], v[36:37], v[240:241] op_sel_hi:[1,0]
    v_pk_mul_f32 v[38:39], v[38:39], v[240:241] op_sel_hi:[1,0]
    v_pk_mul_f32 v[44:45], v[44:45], v[240:241] op_sel_hi:[1,0]
    v_cvt_pk_bf16_f32 v36, v36, v37
    v_cvt_pk_bf16_f32 v37, v38, v39
    v_cvt_pk_bf16_f32 v44, v44, v45
    ds_write_b64 v13, v[36:37] offset:1024
    ds_read_b128 v[92:95], v7 offset:0
    ds_read_b128 v[96:99], v7 offset:18432
    ds_read_b128 v[100:103], v7 offset:1024
    ds_read_b128 v[104:107], v7 offset:19456
    s_mov_b64 exec, 0xffff
    ds_write_b32 v9, v40 offset:0
    ds_write_b32 v9, v44 offset:256
    s_mov_b64 exec, -1
    s_lshl_b32 s43, s65, 6
    s_mul_i32 s44, s38, 73728
    s_add_u32 s44, s43, s44
    buffer_store_dwordx4 v[48:51], v53, s[68:71], s44 offen sc1
    s_lshl_b32 s43, s65, 6
    s_mul_i32 s44, s38, 73728
    s_add_u32 s44, s43, s44
    buffer_store_dwordx4 v[48:51], v54, s[68:71], s44 offen sc1
    s_waitcnt lgkmcnt(0)
    s_waitcnt vmcnt(3)
    s_barrier
    s_lshl_b32 s57, s66, 6
    s_add_u32 s45, s58, s74
    s_add_u32 m0, s46, 73728
    s_add_u32 s47, s45, 221184
    buffer_load_dwordx4 v11, s[20:23], s47 offen lds
    s_add_u32 s45, s58, s74
    s_add_u32 m0, s46, 77824
    s_add_u32 s47, s45, 258048
    buffer_load_dwordx4 v11, s[20:23], s47 offen lds
    s_add_u32 s45, s58, s74
    s_add_u32 m0, s46, 81920
    s_add_u32 s47, s45, 294912
    buffer_load_dwordx4 v11, s[20:23], s47 offen lds
    s_add_u32 s45, s58, s74
    s_add_u32 m0, s46, 86016
    s_add_u32 s47, s45, 331776
    buffer_load_dwordx4 v11, s[20:23], s47 offen lds
    s_add_u32 s45, s58, s74
    s_add_u32 m0, s46, 90112
    s_add_u32 s47, s45, 368640
    buffer_load_dwordx4 v11, s[20:23], s47 offen lds
    s_add_u32 s45, s58, s74
    s_add_u32 m0, s46, 94208
    s_add_u32 s47, s45, 405504
    buffer_load_dwordx4 v11, s[20:23], s47 offen lds
    ds_read_b64_tr_b16 v[16:17], v4 offset:0
    ds_read_b64_tr_b16 v[18:19], v4 offset:2048
    ds_read_b64_tr_b16 v[20:21], v4 offset:4096
    ds_read_b64_tr_b16 v[22:23], v4 offset:6144
    ds_read_b64_tr_b16 v[24:25], v4 offset:8192
    ds_read_b64_tr_b16 v[26:27], v4 offset:10240
    s_waitcnt lgkmcnt(4)
    v_mfma_f32_16x16x32_bf16 v[80:83], v[16:19], v[92:95], 0
    ds_read_b64_tr_b16 v[28:29], v4 offset:12288
    s_add_u32 s45, s58, s74
    s_add_u32 m0, s46, 0
    s_add_u32 s47, s45, 442368
    buffer_load_dwordx4 v11, s[20:23], s47 offen lds
    v_mfma_f32_16x16x32_bf16 v[84:87], v[16:19], v[96:99], 0
    ds_read_b64_tr_b16 v[30:31], v4 offset:14336
    s_add_u32 s45, s58, s74
    s_add_u32 m0, s46, 4096
    s_add_u32 s47, s45, 479232
    buffer_load_dwordx4 v11, s[20:23], s47 offen lds
    s_waitcnt lgkmcnt(4)
    v_mfma_f32_16x16x32_bf16 v[80:83], v[20:23], v[100:103], v[80:83]
    ds_read_b64_tr_b16 v[16:17], v4 offset:16384
    s_add_u32 s45, s58, s74
    s_add_u32 m0, s46, 8192
    s_add_u32 s47, s45, 516096
    buffer_load_dwordx4 v11, s[20:23], s47 offen lds
    v_mfma_f32_16x16x32_bf16 v[84:87], v[20:23], v[104:107], v[84:87]
    ds_read_b64_tr_b16 v[18:19], v4 offset:18432
    s_add_u32 s45, s58, s74
    s_add_u32 m0, s46, 12288
    s_add_u32 s47, s45, 552960
    buffer_load_dwordx4 v11, s[20:23], s47 offen lds
    s_waitcnt lgkmcnt(4)
    v_mfma_f32_16x16x32_bf16 v[80:83], v[24:27], v[108:111], v[80:83]
    ds_read_b64_tr_b16 v[20:21], v4 offset:20480
    s_add_u32 s45, s58, s74
    s_add_u32 m0, s46, 16384
    s_add_u32 s47, s45, 589824
    buffer_load_dwordx4 v11, s[20:23], s47 offen lds
    v_mfma_f32_16x16x32_bf16 v[84:87], v[24:27], v[112:115], v[84:87]
    ds_read_b64_tr_b16 v[22:23], v4 offset:22528
    s_add_u32 s45, s58, s74
    s_add_u32 m0, s46, 20480
    s_add_u32 s47, s45, 626688
    buffer_load_dwordx4 v11, s[20:23], s47 offen lds
    s_waitcnt vmcnt(6)
    s_barrier
    s_waitcnt lgkmcnt(4)
    v_mfma_f32_16x16x32_bf16 v[80:83], v[28:31], v[116:119], v[80:83]
    ds_read_b64_tr_b16 v[24:25], v3 offset:24576
    s_add_u32 s45, s59, s74
    s_add_u32 m0, s46, 24576
    s_add_u32 s47, s45, 0
    buffer_load_dwordx4 v11, s[20:23], s47 offen lds
    v_mfma_f32_16x16x32_bf16 v[84:87], v[28:31], v[120:123], v[84:87]
    ds_read_b64_tr_b16 v[26:27], v3 offset:26624
    s_add_u32 m0, s46, 28672
    s_add_u32 s47, s45, 36864
    buffer_load_dwordx4 v11, s[20:23], s47 offen lds
    s_waitcnt lgkmcnt(4)
    v_mfma_f32_16x16x32_bf16 v[80:83], v[16:19], v[124:127], v[80:83]
    ds_read_b64_tr_b16 v[28:29], v3 offset:28672
    s_add_u32 m0, s46, 32768
    s_add_u32 s47, s45, 73728
    buffer_load_dwordx4 v11, s[20:23], s47 offen lds
    v_mfma_f32_16x16x32_bf16 v[84:87], v[16:19], v[128:131], v[84:87]
    ds_read_b64_tr_b16 v[30:31], v3 offset:30720
    s_add_u32 m0, s46, 36864
    s_add_u32 s47, s45, 110592
    buffer_load_dwordx4 v11, s[20:23], s47 offen lds
    s_waitcnt lgkmcnt(4)
    v_mfma_f32_16x16x32_bf16 v[80:83], v[20:23], v[132:135], v[80:83]
    ds_read_b64_tr_b16 v[16:17], v3 offset:32768
    s_add_u32 m0, s46, 40960
    s_add_u32 s47, s45, 147456
    buffer_load_dwordx4 v11, s[20:23], s47 offen lds
    v_mfma_f32_16x16x32_bf16 v[84:87], v[20:23], v[136:139], v[84:87]
    ds_read_b64_tr_b16 v[18:19], v3 offset:34816
    s_add_u32 m0, s46, 45056
    s_add_u32 s47, s45, 184320
    buffer_load_dwordx4 v11, s[20:23], s47 offen lds
    s_waitcnt lgkmcnt(4)
    v_mfma_f32_16x16x32_bf16 v[80:83], v[24:27], v[140:143], v[80:83]
    ds_read_b64_tr_b16 v[20:21], v3 offset:36864
    s_add_u32 s45, s59, s74
    s_add_u32 m0, s46, 49152
    s_add_u32 s47, s45, 221184
    buffer_load_dwordx4 v11, s[20:23], s47 offen lds
    v_mfma_f32_16x16x32_bf16 v[84:87], v[24:27], v[144:147], v[84:87]
    ds_read_b64_tr_b16 v[22:23], v3 offset:38912
    s_add_u32 m0, s46, 53248
    s_add_u32 s47, s45, 258048
    buffer_load_dwordx4 v11, s[20:23], s47 offen lds
    s_waitcnt lgkmcnt(4)
    v_mfma_f32_16x16x32_bf16 v[80:83], v[28:31], v[148:151], v[80:83]
    ds_read_b64_tr_b16 v[24:25], v3 offset:40960
    s_add_u32 m0, s46, 57344
    s_add_u32 s47, s45, 294912
    buffer_load_dwordx4 v11, s[20:23], s47 offen lds
    v_mfma_f32_16x16x32_bf16 v[84:87], v[28:31], v[152:155], v[84:87]
    ds_read_b64_tr_b16 v[26:27], v3 offset:43008
    s_add_u32 m0, s46, 61440
    s_add_u32 s47, s45, 331776
    buffer_load_dwordx4 v11, s[20:23], s47 offen lds
    s_waitcnt lgkmcnt(4)
    v_mfma_f32_16x16x32_bf16 v[80:83], v[16:19], v[156:159], v[80:83]
    ds_read_b64_tr_b16 v[28:29], v3 offset:45056
    v_lshlrev_b32_e64 v236, 4, v1
    v_add_u32 v236, 142336, v236
    ds_read_b128 v[56:59], v236 offset:0
    ds_read_b128 v[60:63], v236 offset:1024
    ds_read_b128 v[64:67], v236 offset:2048
    ds_read_b128 v[68:71], v236 offset:3072
    ds_read_b32 v72, v55 offset:0
    ds_read_b32 v76, v55 offset:256
    v_mfma_f32_16x16x32_bf16 v[84:87], v[16:19], v[160:163], v[84:87]
    ds_read_b64_tr_b16 v[30:31], v3 offset:47104
    s_add_u32 m0, s46, 65536
    s_add_u32 s47, s45, 368640
    buffer_load_dwordx4 v11, s[20:23], s47 offen lds
    s_waitcnt vmcnt(11)
    s_barrier
    s_waitcnt lgkmcnt(10)
    v_mfma_f32_16x16x32_bf16 v[80:83], v[20:23], v[164:167], v[80:83]
    ds_read_b64_tr_b16 v[16:17], v2 offset:0
    s_add_u32 m0, s46, 69632
    s_add_u32 s47, s45, 405504
    buffer_load_dwordx4 v11, s[20:23], s47 offen lds
    v_mfma_f32_16x16x32_bf16 v[84:87], v[20:23], v[168:171], v[84:87]
    ds_read_b64_tr_b16 v[18:19], v2 offset:2048
    s_add_u32 s45, s59, s74
    s_add_u32 m0, s46, 98304
    s_add_u32 s47, s45, 442368
    buffer_load_dwordx4 v11, s[20:23], s47 offen lds
    s_waitcnt lgkmcnt(10)
    v_mfma_f32_16x16x32_bf16 v[80:83], v[24:27], v[172:175], v[80:83]
    ds_read_b64_tr_b16 v[20:21], v2 offset:4096
    s_add_u32 m0, s46, 102400
    s_add_u32 s47, s45, 479232
    buffer_load_dwordx4 v11, s[20:23], s47 offen lds
    v_mfma_f32_16x16x32_bf16 v[84:87], v[24:27], v[176:179], v[84:87]
    ds_read_b64_tr_b16 v[22:23], v2 offset:6144
    s_add_u32 m0, s46, 106496
    s_add_u32 s47, s45, 516096
    buffer_load_dwordx4 v11, s[20:23], s47 offen lds
    s_waitcnt lgkmcnt(4)
    v_mfma_f32_16x16x32_bf16 v[80:83], v[28:31], v[180:183], v[80:83]
    ds_read_b64_tr_b16 v[24:25], v2 offset:8192
    s_add_u32 m0, s46, 110592
    s_add_u32 s47, s45, 552960
    buffer_load_dwordx4 v11, s[20:23], s47 offen lds
    v_mfma_f32_16x16x32_bf16 v[84:87], v[28:31], v[184:187], v[84:87]
    ds_read_b64_tr_b16 v[26:27], v2 offset:10240
    s_add_u32 m0, s46, 114688
    s_add_u32 s47, s45, 589824
    buffer_load_dwordx4 v11, s[20:23], s47 offen lds
    s_waitcnt lgkmcnt(4)
    v_mfma_f32_16x16x32_bf16 v[80:83], v[16:19], v[188:191], v[80:83]
    ds_read_b64_tr_b16 v[28:29], v2 offset:12288
    s_add_u32 m0, s46, 118784
    s_add_u32 s47, s45, 626688
    buffer_load_dwordx4 v11, s[20:23], s47 offen lds
    v_mfma_f32_16x16x32_bf16 v[84:87], v[16:19], v[192:195], v[84:87]
    ds_read_b64_tr_b16 v[30:31], v2 offset:14336
    s_waitcnt lgkmcnt(4)
    v_mfma_f32_16x16x32_bf16 v[80:83], v[20:23], v[196:199], v[80:83]
    ds_read_b64_tr_b16 v[16:17], v2 offset:16384
    v_mfma_f32_16x16x32_bf16 v[84:87], v[20:23], v[200:203], v[84:87]
    ds_read_b64_tr_b16 v[18:19], v2 offset:18432
    s_waitcnt lgkmcnt(4)
    v_mfma_f32_16x16x32_bf16 v[80:83], v[24:27], v[204:207], v[80:83]
    ds_read_b64_tr_b16 v[20:21], v2 offset:20480
    v_mfma_f32_16x16x32_bf16 v[84:87], v[24:27], v[208:211], v[84:87]
    ds_read_b64_tr_b16 v[22:23], v2 offset:22528
    s_waitcnt lgkmcnt(4)
    v_mfma_f32_16x16x32_bf16 v[80:83], v[28:31], v[212:215], v[80:83]
    ds_read_b64_tr_b16 v[24:25], v4 offset:24576
    v_mfma_f32_16x16x32_bf16 v[84:87], v[28:31], v[216:219], v[84:87]
    ds_read_b64_tr_b16 v[26:27], v5 offset:27136
    s_waitcnt lgkmcnt(4)
    v_mfma_f32_16x16x32_bf16 v[80:83], v[16:19], v[220:223], v[80:83]
    ds_read_b64_tr_b16 v[28:29], v5 offset:29184
    v_mfma_f32_16x16x32_bf16 v[84:87], v[16:19], v[224:227], v[84:87]
    ds_read_b64_tr_b16 v[30:31], v4 offset:31744
    s_waitcnt lgkmcnt(4)
    v_mfma_f32_16x16x32_bf16 v[80:83], v[20:23], v[228:231], v[80:83]
    ds_read_b64_tr_b16 v[16:17], v6 offset:24576
    v_mfma_f32_16x16x32_bf16 v[84:87], v[20:23], v[232:235], v[84:87]
    s_waitcnt vmcnt(12)
    s_barrier
    s_waitcnt lgkmcnt(3)
    v_mfma_f32_16x16x32_bf16 v[80:83], v[24:27], v[56:59], v[80:83]
    ds_read_b64_tr_b16 v[20:21], v2 offset:24576
    s_add_u32 s45, s60, s74
    s_add_u32 m0, s46, 73728
    s_add_u32 s47, s45, 0
    buffer_load_dwordx4 v11, s[20:23], s47 offen lds
    v_mfma_f32_16x16x32_bf16 v[84:87], v[24:27], v[60:63], v[84:87]
    ds_read_b64_tr_b16 v[22:23], v2 offset:26624
    s_add_u32 m0, s46, 77824
    s_add_u32 s47, s45, 36864
    buffer_load_dwordx4 v11, s[20:23], s47 offen lds
    s_waitcnt lgkmcnt(3)
    v_mfma_f32_16x16x32_bf16 v[80:83], v[28:31], v[64:67], v[80:83]
    ds_read_b64_tr_b16 v[24:25], v2 offset:28672
    s_add_u32 m0, s46, 81920
    s_add_u32 s47, s45, 73728
    buffer_load_dwordx4 v11, s[20:23], s47 offen lds
    v_mfma_f32_16x16x32_bf16 v[84:87], v[28:31], v[68:71], v[84:87]
    ds_read_b64_tr_b16 v[26:27], v2 offset:30720
    s_add_u32 m0, s46, 86016
    s_add_u32 s47, s45, 110592
    buffer_load_dwordx4 v11, s[20:23], s47 offen lds
    s_waitcnt lgkmcnt(4)
    v_mfma_f32_16x16x32_bf16 v[80:83], v[16:19], v[72:75], v[80:83]
    ds_read_b64_tr_b16 v[28:29], v2 offset:32768
    s_add_u32 m0, s46, 90112
    s_add_u32 s47, s45, 147456
    buffer_load_dwordx4 v11, s[20:23], s47 offen lds
    v_mfma_f32_16x16x32_bf16 v[84:87], v[16:19], v[76:79], v[84:87]
    ds_read_b64_tr_b16 v[30:31], v2 offset:34816
    s_add_u32 m0, s46, 94208
    s_add_u32 s47, s45, 184320
    buffer_load_dwordx4 v11, s[20:23], s47 offen lds
    s_waitcnt lgkmcnt(4)
    v_mfma_f32_16x16x32_bf16 v[40:43], v[20:23], v[92:95], 0
    ds_read_b64_tr_b16 v[16:17], v2 offset:36864
    v_mfma_f32_16x16x32_bf16 v[44:47], v[20:23], v[96:99], 0
    ds_read_b64_tr_b16 v[18:19], v2 offset:38912
    s_waitcnt lgkmcnt(4)
    v_mfma_f32_16x16x32_bf16 v[40:43], v[24:27], v[100:103], v[40:43]
    ds_read_b64_tr_b16 v[20:21], v2 offset:40960
    v_mfma_f32_16x16x32_bf16 v[44:47], v[24:27], v[104:107], v[44:47]
    ds_read_b64_tr_b16 v[22:23], v2 offset:43008
    s_waitcnt lgkmcnt(4)
    v_mfma_f32_16x16x32_bf16 v[40:43], v[28:31], v[108:111], v[40:43]
    ds_read_b64_tr_b16 v[24:25], v2 offset:45056
    v_cvt_pk_bf16_f32 v88, v80, v81
    v_mfma_f32_16x16x32_bf16 v[44:47], v[28:31], v[112:115], v[44:47]
    ds_read_b64_tr_b16 v[26:27], v2 offset:47104
    v_cvt_pk_bf16_f32 v89, v82, v83
    v_cvt_pk_bf16_f32 v90, v84, v85
    v_cvt_pk_bf16_f32 v91, v86, v87
    s_lshl_b32 s42, s58, 6
    s_mul_i32 s43, s38, 73728
    s_add_u32 s44, s42, s43
    buffer_store_dwordx4 v[88:91], v53, s[68:71], s44 offen sc1
    s_waitcnt vmcnt(13)
    s_barrier
    s_waitcnt lgkmcnt(4)
    v_mfma_f32_16x16x32_bf16 v[40:43], v[16:19], v[116:119], v[40:43]
    ds_read_b64_tr_b16 v[28:29], v3 offset:0
    s_add_u32 s45, s60, s74
    s_add_u32 m0, s46, 0
    s_add_u32 s47, s45, 221184
    buffer_load_dwordx4 v11, s[20:23], s47 offen lds
    v_mfma_f32_16x16x32_bf16 v[44:47], v[16:19], v[120:123], v[44:47]
    ds_read_b64_tr_b16 v[30:31], v3 offset:2048
    s_add_u32 m0, s46, 4096
    s_add_u32 s47, s45, 258048
    buffer_load_dwordx4 v11, s[20:23], s47 offen lds
    s_waitcnt lgkmcnt(4)
    v_mfma_f32_16x16x32_bf16 v[40:43], v[20:23], v[124:127], v[40:43]
    ds_read_b64_tr_b16 v[16:17], v3 offset:4096
    s_add_u32 m0, s46, 8192
    s_add_u32 s47, s45, 294912
    buffer_load_dwordx4 v11, s[20:23], s47 offen lds
    v_mfma_f32_16x16x32_bf16 v[44:47], v[20:23], v[128:131], v[44:47]
    ds_read_b64_tr_b16 v[18:19], v3 offset:6144
    s_add_u32 m0, s46, 12288
    s_add_u32 s47, s45, 331776
    buffer_load_dwordx4 v11, s[20:23], s47 offen lds
    s_waitcnt lgkmcnt(4)
    v_mfma_f32_16x16x32_bf16 v[40:43], v[24:27], v[132:135], v[40:43]
    ds_read_b64_tr_b16 v[20:21], v3 offset:8192
    s_add_u32 m0, s46, 16384
    s_add_u32 s47, s45, 368640
    buffer_load_dwordx4 v11, s[20:23], s47 offen lds
    v_mfma_f32_16x16x32_bf16 v[44:47], v[24:27], v[136:139], v[44:47]
    ds_read_b64_tr_b16 v[22:23], v3 offset:10240
    s_add_u32 m0, s46, 20480
    s_add_u32 s47, s45, 405504
    buffer_load_dwordx4 v11, s[20:23], s47 offen lds
    s_waitcnt lgkmcnt(4)
    v_mfma_f32_16x16x32_bf16 v[40:43], v[28:31], v[140:143], v[40:43]
    ds_read_b64_tr_b16 v[24:25], v3 offset:12288
    v_mfma_f32_16x16x32_bf16 v[44:47], v[28:31], v[144:147], v[44:47]
    ds_read_b64_tr_b16 v[26:27], v3 offset:14336
    s_waitcnt lgkmcnt(4)
    v_mfma_f32_16x16x32_bf16 v[40:43], v[16:19], v[148:151], v[40:43]
    ds_read_b64_tr_b16 v[28:29], v3 offset:16384
    v_mfma_f32_16x16x32_bf16 v[44:47], v[16:19], v[152:155], v[44:47]
    ds_read_b64_tr_b16 v[30:31], v3 offset:18432
    s_waitcnt lgkmcnt(4)
    v_mfma_f32_16x16x32_bf16 v[40:43], v[20:23], v[156:159], v[40:43]
    ds_read_b64_tr_b16 v[16:17], v3 offset:20480
    v_mfma_f32_16x16x32_bf16 v[44:47], v[20:23], v[160:163], v[44:47]
    ds_read_b64_tr_b16 v[18:19], v3 offset:22528
    s_waitcnt vmcnt(13)
    s_barrier
    s_waitcnt lgkmcnt(4)
    v_mfma_f32_16x16x32_bf16 v[40:43], v[24:27], v[164:167], v[40:43]
    ds_read_b64_tr_b16 v[20:21], v4 offset:0
    s_add_u32 s45, s60, s74
    s_add_u32 m0, s46, 24576
    s_add_u32 s47, s45, 442368
    buffer_load_dwordx4 v11, s[20:23], s47 offen lds
    v_mfma_f32_16x16x32_bf16 v[44:47], v[24:27], v[168:171], v[44:47]
    ds_read_b64_tr_b16 v[22:23], v4 offset:2048
    s_add_u32 m0, s46, 28672
    s_add_u32 s47, s45, 479232
    buffer_load_dwordx4 v11, s[20:23], s47 offen lds
    s_waitcnt lgkmcnt(4)
    v_mfma_f32_16x16x32_bf16 v[40:43], v[28:31], v[172:175], v[40:43]
    ds_read_b64_tr_b16 v[24:25], v4 offset:4096
    s_add_u32 m0, s46, 32768
    s_add_u32 s47, s45, 516096
    buffer_load_dwordx4 v11, s[20:23], s47 offen lds
    v_mfma_f32_16x16x32_bf16 v[44:47], v[28:31], v[176:179], v[44:47]
    ds_read_b64_tr_b16 v[26:27], v4 offset:6144
    s_add_u32 m0, s46, 36864
    s_add_u32 s47, s45, 552960
    buffer_load_dwordx4 v11, s[20:23], s47 offen lds
    s_waitcnt lgkmcnt(4)
    v_mfma_f32_16x16x32_bf16 v[40:43], v[16:19], v[180:183], v[40:43]
    ds_read_b64_tr_b16 v[28:29], v4 offset:8192
    s_add_u32 m0, s46, 40960
    s_add_u32 s47, s45, 589824
    buffer_load_dwordx4 v11, s[20:23], s47 offen lds
    v_mfma_f32_16x16x32_bf16 v[44:47], v[16:19], v[184:187], v[44:47]
    ds_read_b64_tr_b16 v[30:31], v4 offset:10240
    s_add_u32 m0, s46, 45056
    s_add_u32 s47, s45, 626688
    buffer_load_dwordx4 v11, s[20:23], s47 offen lds
    s_waitcnt lgkmcnt(4)
    v_mfma_f32_16x16x32_bf16 v[40:43], v[20:23], v[188:191], v[40:43]
    ds_read_b64_tr_b16 v[16:17], v4 offset:12288
    s_add_u32 s45, s60, s75
    s_add_u32 m0, s46, 122880
    s_add_u32 s47, s45, 0
    buffer_load_dwordx4 v11, s[12:15], s47 offen lds
    v_mfma_f32_16x16x32_bf16 v[44:47], v[20:23], v[192:195], v[44:47]
    ds_read_b64_tr_b16 v[18:19], v4 offset:14336
    s_add_u32 m0, s46, 126976
    s_add_u32 s47, s45, 36864
    buffer_load_dwordx4 v11, s[12:15], s47 offen lds
    s_waitcnt lgkmcnt(4)
    v_mfma_f32_16x16x32_bf16 v[40:43], v[24:27], v[196:199], v[40:43]
    ds_read_b64_tr_b16 v[20:21], v4 offset:16384
    s_add_u32 s45, s60, s76
    s_mov_b32 m0, 131072
    s_add_u32 s47, s45, 0
    s_mov_b64 exec, s[78:79]
    buffer_load_dwordx4 v11, s[12:15], s47 offen lds
    s_mov_b64 exec, -1
    v_mfma_f32_16x16x32_bf16 v[44:47], v[24:27], v[200:203], v[44:47]
    ds_read_b64_tr_b16 v[22:23], v4 offset:18432
    s_waitcnt lgkmcnt(4)
    v_mfma_f32_16x16x32_bf16 v[40:43], v[28:31], v[204:207], v[40:43]
    ds_read_b64_tr_b16 v[24:25], v4 offset:20480
    v_mfma_f32_16x16x32_bf16 v[44:47], v[28:31], v[208:211], v[44:47]
    ds_read_b64_tr_b16 v[26:27], v4 offset:22528
    s_waitcnt lgkmcnt(4)
    v_mfma_f32_16x16x32_bf16 v[40:43], v[16:19], v[212:215], v[40:43]
    ds_read_b64_tr_b16 v[28:29], v4 offset:33792
    v_mfma_f32_16x16x32_bf16 v[44:47], v[16:19], v[216:219], v[44:47]
    ds_read_b64_tr_b16 v[30:31], v5 offset:36352
    s_waitcnt lgkmcnt(4)
    v_mfma_f32_16x16x32_bf16 v[40:43], v[20:23], v[220:223], v[40:43]
    ds_read_b64_tr_b16 v[16:17], v5 offset:38400
    v_mfma_f32_16x16x32_bf16 v[44:47], v[20:23], v[224:227], v[44:47]
    ds_read_b64_tr_b16 v[18:19], v4 offset:40960
    s_waitcnt lgkmcnt(4)
    v_mfma_f32_16x16x32_bf16 v[40:43], v[24:27], v[228:231], v[40:43]
    ds_read_b64_tr_b16 v[20:21], v6 offset:33792
    v_mfma_f32_16x16x32_bf16 v[44:47], v[24:27], v[232:235], v[44:47]
    s_waitcnt vmcnt(16)
    s_barrier
    s_waitcnt lgkmcnt(3)
    v_mfma_f32_16x16x32_bf16 v[40:43], v[28:31], v[56:59], v[40:43]
    ds_read_b64_tr_b16 v[24:25], v3 offset:24576
    s_add_u32 s45, s61, s74
    s_add_u32 m0, s46, 49152
    s_add_u32 s47, s45, 0
    buffer_load_dwordx4 v11, s[20:23], s47 offen lds
    v_mfma_f32_16x16x32_bf16 v[44:47], v[28:31], v[60:63], v[44:47]
    ds_read_b64_tr_b16 v[26:27], v3 offset:26624
    s_add_u32 m0, s46, 53248
    s_add_u32 s47, s45, 36864
    buffer_load_dwordx4 v11, s[20:23], s47 offen lds
    s_waitcnt lgkmcnt(3)
    v_mfma_f32_16x16x32_bf16 v[40:43], v[16:19], v[64:67], v[40:43]
    ds_read_b64_tr_b16 v[28:29], v3 offset:28672
    s_add_u32 m0, s46, 57344
    s_add_u32 s47, s45, 73728
    buffer_load_dwordx4 v11, s[20:23], s47 offen lds
    v_mfma_f32_16x16x32_bf16 v[44:47], v[16:19], v[68:71], v[44:47]
    ds_read_b64_tr_b16 v[30:31], v3 offset:30720
    s_add_u32 m0, s46, 61440
    s_add_u32 s47, s45, 110592
    buffer_load_dwordx4 v11, s[20:23], s47 offen lds
    s_waitcnt lgkmcnt(4)
    v_mfma_f32_16x16x32_bf16 v[40:43], v[20:23], v[72:75], v[40:43]
    ds_read_b64_tr_b16 v[16:17], v3 offset:32768
    s_add_u32 m0, s46, 65536
    s_add_u32 s47, s45, 147456
    buffer_load_dwordx4 v11, s[20:23], s47 offen lds
    v_mfma_f32_16x16x32_bf16 v[44:47], v[20:23], v[76:79], v[44:47]
    ds_read_b64_tr_b16 v[18:19], v3 offset:34816
    s_add_u32 m0, s46, 69632
    s_add_u32 s47, s45, 184320
    buffer_load_dwordx4 v11, s[20:23], s47 offen lds
    s_waitcnt lgkmcnt(4)
    v_mfma_f32_16x16x32_bf16 v[32:35], v[24:27], v[92:95], 0
    ds_read_b64_tr_b16 v[20:21], v3 offset:36864
    v_mfma_f32_16x16x32_bf16 v[36:39], v[24:27], v[96:99], 0
    ds_read_b64_tr_b16 v[22:23], v3 offset:38912
    s_waitcnt lgkmcnt(4)
    v_mfma_f32_16x16x32_bf16 v[32:35], v[28:31], v[100:103], v[32:35]
    ds_read_b64_tr_b16 v[24:25], v3 offset:40960
    v_mfma_f32_16x16x32_bf16 v[36:39], v[28:31], v[104:107], v[36:39]
    ds_read_b64_tr_b16 v[26:27], v3 offset:43008
    s_waitcnt lgkmcnt(4)
    v_mfma_f32_16x16x32_bf16 v[32:35], v[16:19], v[108:111], v[32:35]
    ds_read_b64_tr_b16 v[28:29], v3 offset:45056
    v_cvt_pk_bf16_f32 v88, v40, v41
    v_mfma_f32_16x16x32_bf16 v[36:39], v[16:19], v[112:115], v[36:39]
    ds_read_b64_tr_b16 v[30:31], v3 offset:47104
    v_cvt_pk_bf16_f32 v89, v42, v43
    v_cvt_pk_bf16_f32 v90, v44, v45
    v_cvt_pk_bf16_f32 v91, v46, v47
    s_lshl_b32 s42, s59, 6
    s_mul_i32 s43, s38, 73728
    s_add_u32 s44, s42, s43
    buffer_store_dwordx4 v[88:91], v53, s[68:71], s44 offen sc1
    s_waitcnt vmcnt(16)
    s_barrier
    s_waitcnt lgkmcnt(4)
    v_mfma_f32_16x16x32_bf16 v[32:35], v[20:23], v[116:119], v[32:35]
    ds_read_b64_tr_b16 v[16:17], v2 offset:0
    s_add_u32 s45, s61, s74
    s_add_u32 m0, s46, 98304
    s_add_u32 s47, s45, 221184
    buffer_load_dwordx4 v11, s[20:23], s47 offen lds
    v_mfma_f32_16x16x32_bf16 v[36:39], v[20:23], v[120:123], v[36:39]
    ds_read_b64_tr_b16 v[18:19], v2 offset:2048
    s_add_u32 m0, s46, 102400
    s_add_u32 s47, s45, 258048
    buffer_load_dwordx4 v11, s[20:23], s47 offen lds
    s_waitcnt lgkmcnt(4)
    v_mfma_f32_16x16x32_bf16 v[32:35], v[24:27], v[124:127], v[32:35]
    ds_read_b64_tr_b16 v[20:21], v2 offset:4096
    s_add_u32 m0, s46, 106496
    s_add_u32 s47, s45, 294912
    buffer_load_dwordx4 v11, s[20:23], s47 offen lds
    v_mfma_f32_16x16x32_bf16 v[36:39], v[24:27], v[128:131], v[36:39]
    ds_read_b64_tr_b16 v[22:23], v2 offset:6144
    s_add_u32 m0, s46, 110592
    s_add_u32 s47, s45, 331776
    buffer_load_dwordx4 v11, s[20:23], s47 offen lds
    s_waitcnt lgkmcnt(4)
    v_mfma_f32_16x16x32_bf16 v[32:35], v[28:31], v[132:135], v[32:35]
    ds_read_b64_tr_b16 v[24:25], v2 offset:8192
    s_add_u32 m0, s46, 114688
    s_add_u32 s47, s45, 368640
    buffer_load_dwordx4 v11, s[20:23], s47 offen lds
    v_mfma_f32_16x16x32_bf16 v[36:39], v[28:31], v[136:139], v[36:39]
    ds_read_b64_tr_b16 v[26:27], v2 offset:10240
    s_add_u32 m0, s46, 118784
    s_add_u32 s47, s45, 405504
    buffer_load_dwordx4 v11, s[20:23], s47 offen lds
    s_waitcnt lgkmcnt(4)
    v_mfma_f32_16x16x32_bf16 v[32:35], v[16:19], v[140:143], v[32:35]
    ds_read_b64_tr_b16 v[28:29], v2 offset:12288
    v_mfma_f32_16x16x32_bf16 v[36:39], v[16:19], v[144:147], v[36:39]
    ds_read_b64_tr_b16 v[30:31], v2 offset:14336
    s_waitcnt lgkmcnt(4)
    v_mfma_f32_16x16x32_bf16 v[32:35], v[20:23], v[148:151], v[32:35]
    ds_read_b64_tr_b16 v[16:17], v2 offset:16384
    v_mfma_f32_16x16x32_bf16 v[36:39], v[20:23], v[152:155], v[36:39]
    ds_read_b64_tr_b16 v[18:19], v2 offset:18432
    s_waitcnt lgkmcnt(4)
    v_mfma_f32_16x16x32_bf16 v[32:35], v[24:27], v[156:159], v[32:35]
    ds_read_b64_tr_b16 v[20:21], v2 offset:20480
    v_mfma_f32_16x16x32_bf16 v[36:39], v[24:27], v[160:163], v[36:39]
    ds_read_b64_tr_b16 v[22:23], v2 offset:22528
    s_waitcnt vmcnt(13)
    s_barrier
    s_waitcnt lgkmcnt(4)
    v_mfma_f32_16x16x32_bf16 v[32:35], v[28:31], v[164:167], v[32:35]
    ds_read_b64_tr_b16 v[24:25], v2 offset:24576
    s_add_u32 s45, s61, s74
    s_add_u32 m0, s46, 73728
    s_add_u32 s47, s45, 442368
    buffer_load_dwordx4 v11, s[20:23], s47 offen lds
    v_mfma_f32_16x16x32_bf16 v[36:39], v[28:31], v[168:171], v[36:39]
    ds_read_b64_tr_b16 v[26:27], v2 offset:26624
    s_add_u32 m0, s46, 77824
    s_add_u32 s47, s45, 479232
    buffer_load_dwordx4 v11, s[20:23], s47 offen lds
    s_waitcnt lgkmcnt(4)
    v_mfma_f32_16x16x32_bf16 v[32:35], v[16:19], v[172:175], v[32:35]
    ds_read_b64_tr_b16 v[28:29], v2 offset:28672
    s_add_u32 m0, s46, 81920
    s_add_u32 s47, s45, 516096
    buffer_load_dwordx4 v11, s[20:23], s47 offen lds
    v_mfma_f32_16x16x32_bf16 v[36:39], v[16:19], v[176:179], v[36:39]
    ds_read_b64_tr_b16 v[30:31], v2 offset:30720
    s_add_u32 m0, s46, 86016
    s_add_u32 s47, s45, 552960
    buffer_load_dwordx4 v11, s[20:23], s47 offen lds
    s_waitcnt lgkmcnt(4)
    v_mfma_f32_16x16x32_bf16 v[32:35], v[20:23], v[180:183], v[32:35]
    ds_read_b64_tr_b16 v[16:17], v2 offset:32768
    s_add_u32 m0, s46, 90112
    s_add_u32 s47, s45, 589824
    buffer_load_dwordx4 v11, s[20:23], s47 offen lds
    v_mfma_f32_16x16x32_bf16 v[36:39], v[20:23], v[184:187], v[36:39]
    ds_read_b64_tr_b16 v[18:19], v2 offset:34816
    s_add_u32 m0, s46, 94208
    s_add_u32 s47, s45, 626688
    buffer_load_dwordx4 v11, s[20:23], s47 offen lds
    s_waitcnt lgkmcnt(4)
    v_mfma_f32_16x16x32_bf16 v[32:35], v[24:27], v[188:191], v[32:35]
    ds_read_b64_tr_b16 v[20:21], v2 offset:36864
    s_add_u32 s45, s61, s75
    s_add_u32 m0, s46, 132096
    s_add_u32 s47, s45, 0
    buffer_load_dwordx4 v11, s[12:15], s47 offen lds
    v_mfma_f32_16x16x32_bf16 v[36:39], v[24:27], v[192:195], v[36:39]
    ds_read_b64_tr_b16 v[22:23], v2 offset:38912
    s_add_u32 m0, s46, 136192
    s_add_u32 s47, s45, 36864
    buffer_load_dwordx4 v11, s[12:15], s47 offen lds
    s_waitcnt lgkmcnt(4)
    v_mfma_f32_16x16x32_bf16 v[32:35], v[28:31], v[196:199], v[32:35]
    ds_read_b64_tr_b16 v[24:25], v2 offset:40960
    s_add_u32 s45, s61, s76
    s_mov_b32 m0, 140288
    s_add_u32 s47, s45, 0
    s_mov_b64 exec, s[78:79]
    buffer_load_dwordx4 v11, s[12:15], s47 offen lds
    s_mov_b64 exec, -1
    v_mfma_f32_16x16x32_bf16 v[36:39], v[28:31], v[200:203], v[36:39]
    ds_read_b64_tr_b16 v[26:27], v2 offset:43008
    s_waitcnt lgkmcnt(4)
    v_mfma_f32_16x16x32_bf16 v[32:35], v[16:19], v[204:207], v[32:35]
    ds_read_b64_tr_b16 v[28:29], v2 offset:45056
    v_mfma_f32_16x16x32_bf16 v[36:39], v[16:19], v[208:211], v[36:39]
    ds_read_b64_tr_b16 v[30:31], v2 offset:47104
    s_waitcnt lgkmcnt(4)
    v_mfma_f32_16x16x32_bf16 v[32:35], v[20:23], v[212:215], v[32:35]
    ds_read_b64_tr_b16 v[16:17], v4 offset:24576
    v_mfma_f32_16x16x32_bf16 v[36:39], v[20:23], v[216:219], v[36:39]
    ds_read_b64_tr_b16 v[18:19], v5 offset:27136
    s_waitcnt lgkmcnt(4)
    v_mfma_f32_16x16x32_bf16 v[32:35], v[24:27], v[220:223], v[32:35]
    ds_read_b64_tr_b16 v[20:21], v5 offset:29184
    v_mfma_f32_16x16x32_bf16 v[36:39], v[24:27], v[224:227], v[36:39]
    ds_read_b64_tr_b16 v[22:23], v4 offset:31744
    s_waitcnt lgkmcnt(4)
    v_mfma_f32_16x16x32_bf16 v[32:35], v[28:31], v[228:231], v[32:35]
    ds_read_b64_tr_b16 v[24:25], v6 offset:24576
    v_mfma_f32_16x16x32_bf16 v[36:39], v[28:31], v[232:235], v[36:39]
    s_waitcnt vmcnt(16)
    s_barrier
    s_waitcnt lgkmcnt(3)
    v_mfma_f32_16x16x32_bf16 v[32:35], v[16:19], v[56:59], v[32:35]
    ds_read_b64_tr_b16 v[28:29], v3 offset:0
    s_add_u32 s45, s62, s74
    s_add_u32 m0, s46, 0
    s_add_u32 s47, s45, 0
    buffer_load_dwordx4 v11, s[20:23], s47 offen lds
    v_mfma_f32_16x16x32_bf16 v[36:39], v[16:19], v[60:63], v[36:39]
    ds_read_b64_tr_b16 v[30:31], v3 offset:2048
    s_add_u32 m0, s46, 4096
    s_add_u32 s47, s45, 36864
    buffer_load_dwordx4 v11, s[20:23], s47 offen lds
    s_waitcnt lgkmcnt(3)
    v_mfma_f32_16x16x32_bf16 v[32:35], v[20:23], v[64:67], v[32:35]
    ds_read_b64_tr_b16 v[16:17], v3 offset:4096
    s_add_u32 m0, s46, 8192
    s_add_u32 s47, s45, 73728
    buffer_load_dwordx4 v11, s[20:23], s47 offen lds
    v_mfma_f32_16x16x32_bf16 v[36:39], v[20:23], v[68:71], v[36:39]
    ds_read_b64_tr_b16 v[18:19], v3 offset:6144
    s_add_u32 m0, s46, 12288
    s_add_u32 s47, s45, 110592
    buffer_load_dwordx4 v11, s[20:23], s47 offen lds
    s_waitcnt lgkmcnt(4)
    v_mfma_f32_16x16x32_bf16 v[32:35], v[24:27], v[72:75], v[32:35]
    ds_read_b64_tr_b16 v[20:21], v3 offset:8192
    s_add_u32 m0, s46, 16384
    s_add_u32 s47, s45, 147456
    buffer_load_dwordx4 v11, s[20:23], s47 offen lds
    v_mfma_f32_16x16x32_bf16 v[36:39], v[24:27], v[76:79], v[36:39]
    ds_read_b64_tr_b16 v[22:23], v3 offset:10240
    s_add_u32 m0, s46, 20480
    s_add_u32 s47, s45, 184320
    buffer_load_dwordx4 v11, s[20:23], s47 offen lds
    s_waitcnt lgkmcnt(4)
    v_mfma_f32_16x16x32_bf16 v[40:43], v[28:31], v[92:95], 0
    ds_read_b64_tr_b16 v[24:25], v3 offset:12288
    v_mfma_f32_16x16x32_bf16 v[44:47], v[28:31], v[96:99], 0
    ds_read_b64_tr_b16 v[26:27], v3 offset:14336
    s_waitcnt lgkmcnt(4)
    v_mfma_f32_16x16x32_bf16 v[40:43], v[16:19], v[100:103], v[40:43]
    ds_read_b64_tr_b16 v[28:29], v3 offset:16384
    v_mfma_f32_16x16x32_bf16 v[44:47], v[16:19], v[104:107], v[44:47]
    ds_read_b64_tr_b16 v[30:31], v3 offset:18432
    s_waitcnt lgkmcnt(4)
    v_mfma_f32_16x16x32_bf16 v[40:43], v[20:23], v[108:111], v[40:43]
    ds_read_b64_tr_b16 v[16:17], v3 offset:20480
    v_cvt_pk_bf16_f32 v88, v32, v33
    v_mfma_f32_16x16x32_bf16 v[44:47], v[20:23], v[112:115], v[44:47]
    ds_read_b64_tr_b16 v[18:19], v3 offset:22528
    v_cvt_pk_bf16_f32 v89, v34, v35
    v_cvt_pk_bf16_f32 v90, v36, v37
    v_cvt_pk_bf16_f32 v91, v38, v39
    s_lshl_b32 s42, s60, 6
    s_mul_i32 s43, s38, 73728
    s_add_u32 s44, s42, s43
    buffer_store_dwordx4 v[88:91], v53, s[68:71], s44 offen sc1
    s_waitcnt vmcnt(16)
    s_barrier
    s_waitcnt lgkmcnt(4)
    v_mfma_f32_16x16x32_bf16 v[40:43], v[24:27], v[116:119], v[40:43]
    ds_read_b64_tr_b16 v[20:21], v4 offset:0
    s_add_u32 s45, s62, s74
    s_add_u32 m0, s46, 24576
    s_add_u32 s47, s45, 221184
    buffer_load_dwordx4 v11, s[20:23], s47 offen lds
    v_mfma_f32_16x16x32_bf16 v[44:47], v[24:27], v[120:123], v[44:47]
    ds_read_b64_tr_b16 v[22:23], v4 offset:2048
    s_add_u32 m0, s46, 28672
    s_add_u32 s47, s45, 258048
    buffer_load_dwordx4 v11, s[20:23], s47 offen lds
    s_waitcnt lgkmcnt(4)
    v_mfma_f32_16x16x32_bf16 v[40:43], v[28:31], v[124:127], v[40:43]
    ds_read_b64_tr_b16 v[24:25], v4 offset:4096
    s_add_u32 m0, s46, 32768
    s_add_u32 s47, s45, 294912
    buffer_load_dwordx4 v11, s[20:23], s47 offen lds
    v_mfma_f32_16x16x32_bf16 v[44:47], v[28:31], v[128:131], v[44:47]
    ds_read_b64_tr_b16 v[26:27], v4 offset:6144
    s_add_u32 m0, s46, 36864
    s_add_u32 s47, s45, 331776
    buffer_load_dwordx4 v11, s[20:23], s47 offen lds
    s_waitcnt lgkmcnt(4)
    v_mfma_f32_16x16x32_bf16 v[40:43], v[16:19], v[132:135], v[40:43]
    ds_read_b64_tr_b16 v[28:29], v4 offset:8192
    s_add_u32 m0, s46, 40960
    s_add_u32 s47, s45, 368640
    buffer_load_dwordx4 v11, s[20:23], s47 offen lds
    v_mfma_f32_16x16x32_bf16 v[44:47], v[16:19], v[136:139], v[44:47]
    ds_read_b64_tr_b16 v[30:31], v4 offset:10240
    s_add_u32 m0, s46, 45056
    s_add_u32 s47, s45, 405504
    buffer_load_dwordx4 v11, s[20:23], s47 offen lds
    s_waitcnt lgkmcnt(4)
    v_mfma_f32_16x16x32_bf16 v[40:43], v[20:23], v[140:143], v[40:43]
    ds_read_b64_tr_b16 v[16:17], v4 offset:12288
    v_mfma_f32_16x16x32_bf16 v[44:47], v[20:23], v[144:147], v[44:47]
    ds_read_b64_tr_b16 v[18:19], v4 offset:14336
    s_waitcnt lgkmcnt(4)
    v_mfma_f32_16x16x32_bf16 v[40:43], v[24:27], v[148:151], v[40:43]
    ds_read_b64_tr_b16 v[20:21], v4 offset:16384
    v_mfma_f32_16x16x32_bf16 v[44:47], v[24:27], v[152:155], v[44:47]
    ds_read_b64_tr_b16 v[22:23], v4 offset:18432
    s_waitcnt lgkmcnt(4)
    v_mfma_f32_16x16x32_bf16 v[40:43], v[28:31], v[156:159], v[40:43]
    ds_read_b64_tr_b16 v[24:25], v4 offset:20480
    v_mfma_f32_16x16x32_bf16 v[44:47], v[28:31], v[160:163], v[44:47]
    ds_read_b64_tr_b16 v[26:27], v4 offset:22528
    s_waitcnt vmcnt(13)
    s_barrier
    s_waitcnt lgkmcnt(4)
    v_mfma_f32_16x16x32_bf16 v[40:43], v[16:19], v[164:167], v[40:43]
    ds_read_b64_tr_b16 v[28:29], v3 offset:24576
    s_add_u32 s45, s62, s74
    s_add_u32 m0, s46, 49152
    s_add_u32 s47, s45, 442368
    buffer_load_dwordx4 v11, s[20:23], s47 offen lds
    v_mfma_f32_16x16x32_bf16 v[44:47], v[16:19], v[168:171], v[44:47]
    ds_read_b64_tr_b16 v[30:31], v3 offset:26624
    s_add_u32 m0, s46, 53248
    s_add_u32 s47, s45, 479232
    buffer_load_dwordx4 v11, s[20:23], s47 offen lds
    s_waitcnt lgkmcnt(4)
    v_mfma_f32_16x16x32_bf16 v[40:43], v[20:23], v[172:175], v[40:43]
    ds_read_b64_tr_b16 v[16:17], v3 offset:28672
    s_add_u32 m0, s46, 57344
    s_add_u32 s47, s45, 516096
    buffer_load_dwordx4 v11, s[20:23], s47 offen lds
    v_mfma_f32_16x16x32_bf16 v[44:47], v[20:23], v[176:179], v[44:47]
    ds_read_b64_tr_b16 v[18:19], v3 offset:30720
    s_add_u32 m0, s46, 61440
    s_add_u32 s47, s45, 552960
    buffer_load_dwordx4 v11, s[20:23], s47 offen lds
    s_waitcnt lgkmcnt(4)
    v_mfma_f32_16x16x32_bf16 v[40:43], v[24:27], v[180:183], v[40:43]
    ds_read_b64_tr_b16 v[20:21], v3 offset:32768
    s_add_u32 m0, s46, 65536
    s_add_u32 s47, s45, 589824
    buffer_load_dwordx4 v11, s[20:23], s47 offen lds
    v_mfma_f32_16x16x32_bf16 v[44:47], v[24:27], v[184:187], v[44:47]
    ds_read_b64_tr_b16 v[22:23], v3 offset:34816
    s_add_u32 m0, s46, 69632
    s_add_u32 s47, s45, 626688
    buffer_load_dwordx4 v11, s[20:23], s47 offen lds
    s_waitcnt lgkmcnt(4)
    v_mfma_f32_16x16x32_bf16 v[40:43], v[28:31], v[188:191], v[40:43]
    ds_read_b64_tr_b16 v[24:25], v3 offset:36864
    s_add_u32 s45, s62, s75
    s_add_u32 m0, s46, 122880
    s_add_u32 s47, s45, 0
    buffer_load_dwordx4 v11, s[12:15], s47 offen lds
    v_mfma_f32_16x16x32_bf16 v[44:47], v[28:31], v[192:195], v[44:47]
    ds_read_b64_tr_b16 v[26:27], v3 offset:38912
    s_add_u32 m0, s46, 126976
    s_add_u32 s47, s45, 36864
    buffer_load_dwordx4 v11, s[12:15], s47 offen lds
    s_waitcnt lgkmcnt(4)
    v_mfma_f32_16x16x32_bf16 v[40:43], v[16:19], v[196:199], v[40:43]
    ds_read_b64_tr_b16 v[28:29], v3 offset:40960
    s_add_u32 s45, s62, s76
    s_mov_b32 m0, 131072
    s_add_u32 s47, s45, 0
    s_mov_b64 exec, s[78:79]
    buffer_load_dwordx4 v11, s[12:15], s47 offen lds
    s_mov_b64 exec, -1
    v_mfma_f32_16x16x32_bf16 v[44:47], v[16:19], v[200:203], v[44:47]
    ds_read_b64_tr_b16 v[30:31], v3 offset:43008
    s_waitcnt lgkmcnt(4)
    v_mfma_f32_16x16x32_bf16 v[40:43], v[20:23], v[204:207], v[40:43]
    ds_read_b64_tr_b16 v[16:17], v3 offset:45056
    v_mfma_f32_16x16x32_bf16 v[44:47], v[20:23], v[208:211], v[44:47]
    ds_read_b64_tr_b16 v[18:19], v3 offset:47104
    s_waitcnt lgkmcnt(4)
    v_mfma_f32_16x16x32_bf16 v[40:43], v[24:27], v[212:215], v[40:43]
    ds_read_b64_tr_b16 v[20:21], v4 offset:33792
    v_mfma_f32_16x16x32_bf16 v[44:47], v[24:27], v[216:219], v[44:47]
    ds_read_b64_tr_b16 v[22:23], v5 offset:36352
    s_waitcnt lgkmcnt(4)
    v_mfma_f32_16x16x32_bf16 v[40:43], v[28:31], v[220:223], v[40:43]
    ds_read_b64_tr_b16 v[24:25], v5 offset:38400
    v_mfma_f32_16x16x32_bf16 v[44:47], v[28:31], v[224:227], v[44:47]
    ds_read_b64_tr_b16 v[26:27], v4 offset:40960
    s_waitcnt lgkmcnt(4)
    v_mfma_f32_16x16x32_bf16 v[40:43], v[16:19], v[228:231], v[40:43]
    ds_read_b64_tr_b16 v[28:29], v6 offset:33792
    v_mfma_f32_16x16x32_bf16 v[44:47], v[16:19], v[232:235], v[44:47]
    s_waitcnt vmcnt(16)
    s_barrier
    s_waitcnt lgkmcnt(3)
    v_mfma_f32_16x16x32_bf16 v[40:43], v[20:23], v[56:59], v[40:43]
    ds_read_b64_tr_b16 v[16:17], v2 offset:0
    s_add_u32 s45, s63, s74
    s_add_u32 m0, s46, 98304
    s_add_u32 s47, s45, 0
    buffer_load_dwordx4 v11, s[20:23], s47 offen lds
    v_mfma_f32_16x16x32_bf16 v[44:47], v[20:23], v[60:63], v[44:47]
    ds_read_b64_tr_b16 v[18:19], v2 offset:2048
    s_add_u32 m0, s46, 102400
    s_add_u32 s47, s45, 36864
    buffer_load_dwordx4 v11, s[20:23], s47 offen lds
    s_waitcnt lgkmcnt(3)
    v_mfma_f32_16x16x32_bf16 v[40:43], v[24:27], v[64:67], v[40:43]
    ds_read_b64_tr_b16 v[20:21], v2 offset:4096
    s_add_u32 m0, s46, 106496
    s_add_u32 s47, s45, 73728
    buffer_load_dwordx4 v11, s[20:23], s47 offen lds
    v_mfma_f32_16x16x32_bf16 v[44:47], v[24:27], v[68:71], v[44:47]
    ds_read_b64_tr_b16 v[22:23], v2 offset:6144
    s_add_u32 m0, s46, 110592
    s_add_u32 s47, s45, 110592
    buffer_load_dwordx4 v11, s[20:23], s47 offen lds
    s_waitcnt lgkmcnt(4)
    v_mfma_f32_16x16x32_bf16 v[40:43], v[28:31], v[72:75], v[40:43]
    ds_read_b64_tr_b16 v[24:25], v2 offset:8192
    s_add_u32 m0, s46, 114688
    s_add_u32 s47, s45, 147456
    buffer_load_dwordx4 v11, s[20:23], s47 offen lds
    v_mfma_f32_16x16x32_bf16 v[44:47], v[28:31], v[76:79], v[44:47]
    ds_read_b64_tr_b16 v[26:27], v2 offset:10240
    s_add_u32 m0, s46, 118784
    s_add_u32 s47, s45, 184320
    buffer_load_dwordx4 v11, s[20:23], s47 offen lds
    s_waitcnt lgkmcnt(4)
    v_mfma_f32_16x16x32_bf16 v[32:35], v[16:19], v[92:95], 0
    ds_read_b64_tr_b16 v[28:29], v2 offset:12288
    v_mfma_f32_16x16x32_bf16 v[36:39], v[16:19], v[96:99], 0
    ds_read_b64_tr_b16 v[30:31], v2 offset:14336
    s_waitcnt lgkmcnt(4)
    v_mfma_f32_16x16x32_bf16 v[32:35], v[20:23], v[100:103], v[32:35]
    ds_read_b64_tr_b16 v[16:17], v2 offset:16384
    v_mfma_f32_16x16x32_bf16 v[36:39], v[20:23], v[104:107], v[36:39]
    ds_read_b64_tr_b16 v[18:19], v2 offset:18432
    s_waitcnt lgkmcnt(4)
    s_nop 0
    v_mfma_f32_16x16x32_bf16 v[32:35], v[24:27], v[108:111], v[32:35]
    ds_read_b64_tr_b16 v[20:21], v2 offset:20480
    v_cvt_pk_bf16_f32 v88, v40, v41
    v_mfma_f32_16x16x32_bf16 v[36:39], v[24:27], v[112:115], v[36:39]
    ds_read_b64_tr_b16 v[22:23], v2 offset:22528
    v_cvt_pk_bf16_f32 v89, v42, v43
    v_cvt_pk_bf16_f32 v90, v44, v45
    v_cvt_pk_bf16_f32 v91, v46, v47
    s_lshl_b32 s42, s61, 6
    s_mul_i32 s43, s38, 73728
    s_add_u32 s44, s42, s43
    buffer_store_dwordx4 v[88:91], v53, s[68:71], s44 offen sc1
    s_waitcnt vmcnt(16)
    s_barrier
    s_waitcnt lgkmcnt(4)
    v_mfma_f32_16x16x32_bf16 v[32:35], v[28:31], v[116:119], v[32:35]
    ds_read_b64_tr_b16 v[24:25], v2 offset:24576
    s_add_u32 s45, s63, s74
    s_add_u32 m0, s46, 73728
    s_add_u32 s47, s45, 221184
    buffer_load_dwordx4 v11, s[20:23], s47 offen lds
    v_mfma_f32_16x16x32_bf16 v[36:39], v[28:31], v[120:123], v[36:39]
    ds_read_b64_tr_b16 v[26:27], v2 offset:26624
    s_add_u32 m0, s46, 77824
    s_add_u32 s47, s45, 258048
    buffer_load_dwordx4 v11, s[20:23], s47 offen lds
    s_waitcnt lgkmcnt(4)
    v_mfma_f32_16x16x32_bf16 v[32:35], v[16:19], v[124:127], v[32:35]
    ds_read_b64_tr_b16 v[28:29], v2 offset:28672
    s_add_u32 m0, s46, 81920
    s_add_u32 s47, s45, 294912
    buffer_load_dwordx4 v11, s[20:23], s47 offen lds
    v_mfma_f32_16x16x32_bf16 v[36:39], v[16:19], v[128:131], v[36:39]
    ds_read_b64_tr_b16 v[30:31], v2 offset:30720
    s_add_u32 m0, s46, 86016
    s_add_u32 s47, s45, 331776
    buffer_load_dwordx4 v11, s[20:23], s47 offen lds
    s_waitcnt lgkmcnt(4)
    v_mfma_f32_16x16x32_bf16 v[32:35], v[20:23], v[132:135], v[32:35]
    ds_read_b64_tr_b16 v[16:17], v2 offset:32768
    s_add_u32 m0, s46, 90112
    s_add_u32 s47, s45, 368640
    buffer_load_dwordx4 v11, s[20:23], s47 offen lds
    v_mfma_f32_16x16x32_bf16 v[36:39], v[20:23], v[136:139], v[36:39]
    ds_read_b64_tr_b16 v[18:19], v2 offset:34816
    s_add_u32 m0, s46, 94208
    s_add_u32 s47, s45, 405504
    buffer_load_dwordx4 v11, s[20:23], s47 offen lds
    s_waitcnt lgkmcnt(4)
    v_mfma_f32_16x16x32_bf16 v[32:35], v[24:27], v[140:143], v[32:35]
    ds_read_b64_tr_b16 v[20:21], v2 offset:36864
    v_mfma_f32_16x16x32_bf16 v[36:39], v[24:27], v[144:147], v[36:39]
    ds_read_b64_tr_b16 v[22:23], v2 offset:38912
    s_waitcnt lgkmcnt(4)
    v_mfma_f32_16x16x32_bf16 v[32:35], v[28:31], v[148:151], v[32:35]
    ds_read_b64_tr_b16 v[24:25], v2 offset:40960
    v_mfma_f32_16x16x32_bf16 v[36:39], v[28:31], v[152:155], v[36:39]
    ds_read_b64_tr_b16 v[26:27], v2 offset:43008
    s_waitcnt lgkmcnt(4)
    v_mfma_f32_16x16x32_bf16 v[32:35], v[16:19], v[156:159], v[32:35]
    ds_read_b64_tr_b16 v[28:29], v2 offset:45056
    v_mfma_f32_16x16x32_bf16 v[36:39], v[16:19], v[160:163], v[36:39]
    ds_read_b64_tr_b16 v[30:31], v2 offset:47104
    s_waitcnt vmcnt(13)
    s_barrier
    s_waitcnt lgkmcnt(4)
    v_mfma_f32_16x16x32_bf16 v[32:35], v[20:23], v[164:167], v[32:35]
    ds_read_b64_tr_b16 v[16:17], v3 offset:0
    s_add_u32 s45, s63, s74
    s_add_u32 m0, s46, 0
    s_add_u32 s47, s45, 442368
    buffer_load_dwordx4 v11, s[20:23], s47 offen lds
    v_mfma_f32_16x16x32_bf16 v[36:39], v[20:23], v[168:171], v[36:39]
    ds_read_b64_tr_b16 v[18:19], v3 offset:2048
    s_add_u32 m0, s46, 4096
    s_add_u32 s47, s45, 479232
    buffer_load_dwordx4 v11, s[20:23], s47 offen lds
    s_waitcnt lgkmcnt(4)
    v_mfma_f32_16x16x32_bf16 v[32:35], v[24:27], v[172:175], v[32:35]
    ds_read_b64_tr_b16 v[20:21], v3 offset:4096
    s_add_u32 m0, s46, 8192
    s_add_u32 s47, s45, 516096
    buffer_load_dwordx4 v11, s[20:23], s47 offen lds
    v_mfma_f32_16x16x32_bf16 v[36:39], v[24:27], v[176:179], v[36:39]
    ds_read_b64_tr_b16 v[22:23], v3 offset:6144
    s_add_u32 m0, s46, 12288
    s_add_u32 s47, s45, 552960
    buffer_load_dwordx4 v11, s[20:23], s47 offen lds
    s_waitcnt lgkmcnt(4)
    v_mfma_f32_16x16x32_bf16 v[32:35], v[28:31], v[180:183], v[32:35]
    ds_read_b64_tr_b16 v[24:25], v3 offset:8192
    s_add_u32 m0, s46, 16384
    s_add_u32 s47, s45, 589824
    buffer_load_dwordx4 v11, s[20:23], s47 offen lds
    v_mfma_f32_16x16x32_bf16 v[36:39], v[28:31], v[184:187], v[36:39]
    ds_read_b64_tr_b16 v[26:27], v3 offset:10240
    s_add_u32 m0, s46, 20480
    s_add_u32 s47, s45, 626688
    buffer_load_dwordx4 v11, s[20:23], s47 offen lds
    s_waitcnt lgkmcnt(4)
    v_mfma_f32_16x16x32_bf16 v[32:35], v[16:19], v[188:191], v[32:35]
    ds_read_b64_tr_b16 v[28:29], v3 offset:12288
    s_add_u32 s45, s63, s75
    s_add_u32 m0, s46, 132096
    s_add_u32 s47, s45, 0
    buffer_load_dwordx4 v11, s[12:15], s47 offen lds
    v_mfma_f32_16x16x32_bf16 v[36:39], v[16:19], v[192:195], v[36:39]
    ds_read_b64_tr_b16 v[30:31], v3 offset:14336
    s_add_u32 m0, s46, 136192
    s_add_u32 s47, s45, 36864
    buffer_load_dwordx4 v11, s[12:15], s47 offen lds
    s_waitcnt lgkmcnt(4)
    v_mfma_f32_16x16x32_bf16 v[32:35], v[20:23], v[196:199], v[32:35]
    ds_read_b64_tr_b16 v[16:17], v3 offset:16384
    s_add_u32 s45, s63, s76
    s_mov_b32 m0, 140288
    s_add_u32 s47, s45, 0
    s_mov_b64 exec, s[78:79]
    buffer_load_dwordx4 v11, s[12:15], s47 offen lds
    s_mov_b64 exec, -1
    v_mfma_f32_16x16x32_bf16 v[36:39], v[20:23], v[200:203], v[36:39]
    ds_read_b64_tr_b16 v[18:19], v3 offset:18432
    s_waitcnt lgkmcnt(4)
    v_mfma_f32_16x16x32_bf16 v[32:35], v[24:27], v[204:207], v[32:35]
    ds_read_b64_tr_b16 v[20:21], v3 offset:20480
    v_mfma_f32_16x16x32_bf16 v[36:39], v[24:27], v[208:211], v[36:39]
    ds_read_b64_tr_b16 v[22:23], v3 offset:22528
    s_waitcnt lgkmcnt(4)
    v_mfma_f32_16x16x32_bf16 v[32:35], v[28:31], v[212:215], v[32:35]
    ds_read_b64_tr_b16 v[24:25], v4 offset:24576
    v_mfma_f32_16x16x32_bf16 v[36:39], v[28:31], v[216:219], v[36:39]
    ds_read_b64_tr_b16 v[26:27], v5 offset:27136
    s_waitcnt lgkmcnt(4)
    v_mfma_f32_16x16x32_bf16 v[32:35], v[16:19], v[220:223], v[32:35]
    ds_read_b64_tr_b16 v[28:29], v5 offset:29184
    v_mfma_f32_16x16x32_bf16 v[36:39], v[16:19], v[224:227], v[36:39]
    ds_read_b64_tr_b16 v[30:31], v4 offset:31744
    s_waitcnt lgkmcnt(4)
    v_mfma_f32_16x16x32_bf16 v[32:35], v[20:23], v[228:231], v[32:35]
    ds_read_b64_tr_b16 v[16:17], v6 offset:24576
    v_mfma_f32_16x16x32_bf16 v[36:39], v[20:23], v[232:235], v[36:39]
    s_waitcnt vmcnt(16)
    s_barrier
    s_waitcnt lgkmcnt(3)
    v_mfma_f32_16x16x32_bf16 v[32:35], v[24:27], v[56:59], v[32:35]
    ds_read_b64_tr_b16 v[20:21], v4 offset:0
    s_add_u32 s45, s64, s74
    s_add_u32 m0, s46, 24576
    s_add_u32 s47, s45, 0
    buffer_load_dwordx4 v11, s[20:23], s47 offen lds
    v_mfma_f32_16x16x32_bf16 v[36:39], v[24:27], v[60:63], v[36:39]
    ds_read_b64_tr_b16 v[22:23], v4 offset:2048
    s_add_u32 m0, s46, 28672
    s_add_u32 s47, s45, 36864
    buffer_load_dwordx4 v11, s[20:23], s47 offen lds
    s_waitcnt lgkmcnt(3)
    v_mfma_f32_16x16x32_bf16 v[32:35], v[28:31], v[64:67], v[32:35]
    ds_read_b64_tr_b16 v[24:25], v4 offset:4096
    s_add_u32 m0, s46, 32768
    s_add_u32 s47, s45, 73728
    buffer_load_dwordx4 v11, s[20:23], s47 offen lds
    v_mfma_f32_16x16x32_bf16 v[36:39], v[28:31], v[68:71], v[36:39]
    ds_read_b64_tr_b16 v[26:27], v4 offset:6144
    s_add_u32 m0, s46, 36864
    s_add_u32 s47, s45, 110592
    buffer_load_dwordx4 v11, s[20:23], s47 offen lds
    s_waitcnt lgkmcnt(4)
    v_mfma_f32_16x16x32_bf16 v[32:35], v[16:19], v[72:75], v[32:35]
    ds_read_b64_tr_b16 v[28:29], v4 offset:8192
    s_add_u32 m0, s46, 40960
    s_add_u32 s47, s45, 147456
    buffer_load_dwordx4 v11, s[20:23], s47 offen lds
    v_mfma_f32_16x16x32_bf16 v[36:39], v[16:19], v[76:79], v[36:39]
    ds_read_b64_tr_b16 v[30:31], v4 offset:10240
    s_add_u32 m0, s46, 45056
    s_add_u32 s47, s45, 184320
    buffer_load_dwordx4 v11, s[20:23], s47 offen lds
    s_waitcnt lgkmcnt(4)
    v_mfma_f32_16x16x32_bf16 v[40:43], v[20:23], v[92:95], 0
    ds_read_b64_tr_b16 v[16:17], v4 offset:12288
    v_mfma_f32_16x16x32_bf16 v[44:47], v[20:23], v[96:99], 0
    ds_read_b64_tr_b16 v[18:19], v4 offset:14336
    s_waitcnt lgkmcnt(4)
    v_mfma_f32_16x16x32_bf16 v[40:43], v[24:27], v[100:103], v[40:43]
    ds_read_b64_tr_b16 v[20:21], v4 offset:16384
    v_mfma_f32_16x16x32_bf16 v[44:47], v[24:27], v[104:107], v[44:47]
    ds_read_b64_tr_b16 v[22:23], v4 offset:18432
    s_waitcnt lgkmcnt(4)
    v_mfma_f32_16x16x32_bf16 v[40:43], v[28:31], v[108:111], v[40:43]
    ds_read_b64_tr_b16 v[24:25], v4 offset:20480
    v_cvt_pk_bf16_f32 v88, v32, v33
    v_mfma_f32_16x16x32_bf16 v[44:47], v[28:31], v[112:115], v[44:47]
    ds_read_b64_tr_b16 v[26:27], v4 offset:22528
    v_cvt_pk_bf16_f32 v89, v34, v35
    v_cvt_pk_bf16_f32 v90, v36, v37
    v_cvt_pk_bf16_f32 v91, v38, v39
    s_lshl_b32 s42, s62, 6
    s_mul_i32 s43, s38, 73728
    s_add_u32 s44, s42, s43
    buffer_store_dwordx4 v[88:91], v53, s[68:71], s44 offen sc1
    s_waitcnt vmcnt(16)
    s_barrier
    s_waitcnt lgkmcnt(4)
    v_mfma_f32_16x16x32_bf16 v[40:43], v[16:19], v[116:119], v[40:43]
    ds_read_b64_tr_b16 v[28:29], v3 offset:24576
    s_add_u32 s45, s64, s74
    s_add_u32 m0, s46, 49152
    s_add_u32 s47, s45, 221184
    buffer_load_dwordx4 v11, s[20:23], s47 offen lds
    v_mfma_f32_16x16x32_bf16 v[44:47], v[16:19], v[120:123], v[44:47]
    ds_read_b64_tr_b16 v[30:31], v3 offset:26624
    s_add_u32 m0, s46, 53248
    s_add_u32 s47, s45, 258048
    buffer_load_dwordx4 v11, s[20:23], s47 offen lds
    s_waitcnt lgkmcnt(4)
    v_mfma_f32_16x16x32_bf16 v[40:43], v[20:23], v[124:127], v[40:43]
    ds_read_b64_tr_b16 v[16:17], v3 offset:28672
    s_add_u32 m0, s46, 57344
    s_add_u32 s47, s45, 294912
    buffer_load_dwordx4 v11, s[20:23], s47 offen lds
    v_mfma_f32_16x16x32_bf16 v[44:47], v[20:23], v[128:131], v[44:47]
    ds_read_b64_tr_b16 v[18:19], v3 offset:30720
    s_add_u32 m0, s46, 61440
    s_add_u32 s47, s45, 331776
    buffer_load_dwordx4 v11, s[20:23], s47 offen lds
    s_waitcnt lgkmcnt(4)
    v_mfma_f32_16x16x32_bf16 v[40:43], v[24:27], v[132:135], v[40:43]
    ds_read_b64_tr_b16 v[20:21], v3 offset:32768
    s_add_u32 m0, s46, 65536
    s_add_u32 s47, s45, 368640
    buffer_load_dwordx4 v11, s[20:23], s47 offen lds
    v_mfma_f32_16x16x32_bf16 v[44:47], v[24:27], v[136:139], v[44:47]
    ds_read_b64_tr_b16 v[22:23], v3 offset:34816
    s_add_u32 m0, s46, 69632
    s_add_u32 s47, s45, 405504
    buffer_load_dwordx4 v11, s[20:23], s47 offen lds
    s_waitcnt lgkmcnt(4)
    v_mfma_f32_16x16x32_bf16 v[40:43], v[28:31], v[140:143], v[40:43]
    ds_read_b64_tr_b16 v[24:25], v3 offset:36864
    v_mfma_f32_16x16x32_bf16 v[44:47], v[28:31], v[144:147], v[44:47]
    ds_read_b64_tr_b16 v[26:27], v3 offset:38912
    s_waitcnt lgkmcnt(4)
    v_mfma_f32_16x16x32_bf16 v[40:43], v[16:19], v[148:151], v[40:43]
    ds_read_b64_tr_b16 v[28:29], v3 offset:40960
    v_mfma_f32_16x16x32_bf16 v[44:47], v[16:19], v[152:155], v[44:47]
    ds_read_b64_tr_b16 v[30:31], v3 offset:43008
    s_waitcnt lgkmcnt(4)
    v_mfma_f32_16x16x32_bf16 v[40:43], v[20:23], v[156:159], v[40:43]
    ds_read_b64_tr_b16 v[16:17], v3 offset:45056
    v_mfma_f32_16x16x32_bf16 v[44:47], v[20:23], v[160:163], v[44:47]
    ds_read_b64_tr_b16 v[18:19], v3 offset:47104
    s_waitcnt vmcnt(13)
    s_barrier
    s_waitcnt lgkmcnt(4)
    v_mfma_f32_16x16x32_bf16 v[40:43], v[24:27], v[164:167], v[40:43]
    ds_read_b64_tr_b16 v[20:21], v2 offset:0
    s_add_u32 s45, s64, s74
    s_add_u32 m0, s46, 98304
    s_add_u32 s47, s45, 442368
    buffer_load_dwordx4 v11, s[20:23], s47 offen lds
    v_mfma_f32_16x16x32_bf16 v[44:47], v[24:27], v[168:171], v[44:47]
    ds_read_b64_tr_b16 v[22:23], v2 offset:2048
    s_add_u32 m0, s46, 102400
    s_add_u32 s47, s45, 479232
    buffer_load_dwordx4 v11, s[20:23], s47 offen lds
    s_waitcnt lgkmcnt(4)
    v_mfma_f32_16x16x32_bf16 v[40:43], v[28:31], v[172:175], v[40:43]
    ds_read_b64_tr_b16 v[24:25], v2 offset:4096
    s_add_u32 m0, s46, 106496
    s_add_u32 s47, s45, 516096
    buffer_load_dwordx4 v11, s[20:23], s47 offen lds
    v_mfma_f32_16x16x32_bf16 v[44:47], v[28:31], v[176:179], v[44:47]
    ds_read_b64_tr_b16 v[26:27], v2 offset:6144
    s_add_u32 m0, s46, 110592
    s_add_u32 s47, s45, 552960
    buffer_load_dwordx4 v11, s[20:23], s47 offen lds
    s_waitcnt lgkmcnt(4)
    v_mfma_f32_16x16x32_bf16 v[40:43], v[16:19], v[180:183], v[40:43]
    ds_read_b64_tr_b16 v[28:29], v2 offset:8192
    s_add_u32 m0, s46, 114688
    s_add_u32 s47, s45, 589824
    buffer_load_dwordx4 v11, s[20:23], s47 offen lds
    v_mfma_f32_16x16x32_bf16 v[44:47], v[16:19], v[184:187], v[44:47]
    ds_read_b64_tr_b16 v[30:31], v2 offset:10240
    s_add_u32 m0, s46, 118784
    s_add_u32 s47, s45, 626688
    buffer_load_dwordx4 v11, s[20:23], s47 offen lds
    s_waitcnt lgkmcnt(4)
    v_mfma_f32_16x16x32_bf16 v[40:43], v[20:23], v[188:191], v[40:43]
    ds_read_b64_tr_b16 v[16:17], v2 offset:12288
    s_add_u32 s45, s64, s75
    s_add_u32 m0, s46, 122880
    s_add_u32 s47, s45, 0
    buffer_load_dwordx4 v11, s[12:15], s47 offen lds
    v_mfma_f32_16x16x32_bf16 v[44:47], v[20:23], v[192:195], v[44:47]
    ds_read_b64_tr_b16 v[18:19], v2 offset:14336
    s_add_u32 m0, s46, 126976
    s_add_u32 s47, s45, 36864
    buffer_load_dwordx4 v11, s[12:15], s47 offen lds
    s_waitcnt lgkmcnt(4)
    v_mfma_f32_16x16x32_bf16 v[40:43], v[24:27], v[196:199], v[40:43]
    ds_read_b64_tr_b16 v[20:21], v2 offset:16384
    s_add_u32 s45, s64, s76
    s_mov_b32 m0, 131072
    s_add_u32 s47, s45, 0
    s_mov_b64 exec, s[78:79]
    buffer_load_dwordx4 v11, s[12:15], s47 offen lds
    s_mov_b64 exec, -1
    v_mfma_f32_16x16x32_bf16 v[44:47], v[24:27], v[200:203], v[44:47]
    ds_read_b64_tr_b16 v[22:23], v2 offset:18432
    s_waitcnt lgkmcnt(4)
    v_mfma_f32_16x16x32_bf16 v[40:43], v[28:31], v[204:207], v[40:43]
    ds_read_b64_tr_b16 v[24:25], v2 offset:20480
    v_mfma_f32_16x16x32_bf16 v[44:47], v[28:31], v[208:211], v[44:47]
    ds_read_b64_tr_b16 v[26:27], v2 offset:22528
    s_waitcnt lgkmcnt(4)
    v_mfma_f32_16x16x32_bf16 v[40:43], v[16:19], v[212:215], v[40:43]
    ds_read_b64_tr_b16 v[28:29], v4 offset:33792
    v_mfma_f32_16x16x32_bf16 v[44:47], v[16:19], v[216:219], v[44:47]
    ds_read_b64_tr_b16 v[30:31], v5 offset:36352
    s_waitcnt lgkmcnt(4)
    v_mfma_f32_16x16x32_bf16 v[40:43], v[20:23], v[220:223], v[40:43]
    ds_read_b64_tr_b16 v[16:17], v5 offset:38400
    v_mfma_f32_16x16x32_bf16 v[44:47], v[20:23], v[224:227], v[44:47]
    ds_read_b64_tr_b16 v[18:19], v4 offset:40960
    s_waitcnt lgkmcnt(4)
    v_mfma_f32_16x16x32_bf16 v[40:43], v[24:27], v[228:231], v[40:43]
    ds_read_b64_tr_b16 v[20:21], v6 offset:33792
    v_mfma_f32_16x16x32_bf16 v[44:47], v[24:27], v[232:235], v[44:47]
    s_waitcnt vmcnt(16)
    s_barrier
    s_waitcnt lgkmcnt(3)
    v_mfma_f32_16x16x32_bf16 v[40:43], v[28:31], v[56:59], v[40:43]
    ds_read_b64_tr_b16 v[24:25], v2 offset:24576
    s_add_u32 s45, s65, s74
    s_add_u32 m0, s46, 73728
    s_add_u32 s47, s45, 0
    buffer_load_dwordx4 v11, s[20:23], s47 offen lds
    v_mfma_f32_16x16x32_bf16 v[44:47], v[28:31], v[60:63], v[44:47]
    ds_read_b64_tr_b16 v[26:27], v2 offset:26624
    s_add_u32 m0, s46, 77824
    s_add_u32 s47, s45, 36864
    buffer_load_dwordx4 v11, s[20:23], s47 offen lds
    s_waitcnt lgkmcnt(3)
    v_mfma_f32_16x16x32_bf16 v[40:43], v[16:19], v[64:67], v[40:43]
    ds_read_b64_tr_b16 v[28:29], v2 offset:28672
    s_add_u32 m0, s46, 81920
    s_add_u32 s47, s45, 73728
    buffer_load_dwordx4 v11, s[20:23], s47 offen lds
    v_mfma_f32_16x16x32_bf16 v[44:47], v[16:19], v[68:71], v[44:47]
    ds_read_b64_tr_b16 v[30:31], v2 offset:30720
    s_add_u32 m0, s46, 86016
    s_add_u32 s47, s45, 110592
    buffer_load_dwordx4 v11, s[20:23], s47 offen lds
    s_waitcnt lgkmcnt(4)
    v_mfma_f32_16x16x32_bf16 v[40:43], v[20:23], v[72:75], v[40:43]
    ds_read_b64_tr_b16 v[16:17], v2 offset:32768
    s_add_u32 m0, s46, 90112
    s_add_u32 s47, s45, 147456
    buffer_load_dwordx4 v11, s[20:23], s47 offen lds
    v_mfma_f32_16x16x32_bf16 v[44:47], v[20:23], v[76:79], v[44:47]
    ds_read_b64_tr_b16 v[18:19], v2 offset:34816
    s_add_u32 m0, s46, 94208
    s_add_u32 s47, s45, 184320
    buffer_load_dwordx4 v11, s[20:23], s47 offen lds
    s_waitcnt lgkmcnt(4)
    v_mfma_f32_16x16x32_bf16 v[32:35], v[24:27], v[92:95], 0
    ds_read_b64_tr_b16 v[20:21], v2 offset:36864
    s_lshr_b32 s42, s59, 7
    s_lshl_b32 s43, s38, 1
    s_sub_u32 s42, s43, s42
    s_and_b32 s42, s42, 7
    s_mul_i32 s42, s42, 73728
    s_add_u32 s42, s42, s57
    buffer_load_dwordx4 v[12:15], v53, s[68:71], s42 offen sc1
    v_mfma_f32_16x16x32_bf16 v[36:39], v[24:27], v[96:99], 0
    ds_read_b64_tr_b16 v[22:23], v2 offset:38912
    s_waitcnt lgkmcnt(4)
    v_mfma_f32_16x16x32_bf16 v[32:35], v[28:31], v[100:103], v[32:35]
    ds_read_b64_tr_b16 v[24:25], v2 offset:40960
    v_mfma_f32_16x16x32_bf16 v[36:39], v[28:31], v[104:107], v[36:39]
    ds_read_b64_tr_b16 v[26:27], v2 offset:43008
    s_waitcnt lgkmcnt(4)
    v_mfma_f32_16x16x32_bf16 v[32:35], v[16:19], v[108:111], v[32:35]
    ds_read_b64_tr_b16 v[28:29], v2 offset:45056
    v_cvt_pk_bf16_f32 v88, v40, v41
    v_mfma_f32_16x16x32_bf16 v[36:39], v[16:19], v[112:115], v[36:39]
    ds_read_b64_tr_b16 v[30:31], v2 offset:47104
    v_cvt_pk_bf16_f32 v89, v42, v43
    v_cvt_pk_bf16_f32 v90, v44, v45
    v_cvt_pk_bf16_f32 v91, v46, v47
    s_lshl_b32 s42, s63, 6
    s_mul_i32 s43, s38, 73728
    s_add_u32 s44, s42, s43
    buffer_store_dwordx4 v[88:91], v53, s[68:71], s44 offen sc1
    s_waitcnt vmcnt(17)
    s_barrier
    s_waitcnt lgkmcnt(4)
    v_mfma_f32_16x16x32_bf16 v[32:35], v[20:23], v[116:119], v[32:35]
    ds_read_b64_tr_b16 v[16:17], v3 offset:0
    s_add_u32 s45, s65, s74
    s_add_u32 m0, s46, 0
    s_add_u32 s47, s45, 221184
    buffer_load_dwordx4 v11, s[20:23], s47 offen lds
    v_mfma_f32_16x16x32_bf16 v[36:39], v[20:23], v[120:123], v[36:39]
    ds_read_b64_tr_b16 v[18:19], v3 offset:2048
    s_add_u32 m0, s46, 4096
    s_add_u32 s47, s45, 258048
    buffer_load_dwordx4 v11, s[20:23], s47 offen lds
    s_waitcnt lgkmcnt(4)
    v_mfma_f32_16x16x32_bf16 v[32:35], v[24:27], v[124:127], v[32:35]
    ds_read_b64_tr_b16 v[20:21], v3 offset:4096
    s_add_u32 m0, s46, 8192
    s_add_u32 s47, s45, 294912
    buffer_load_dwordx4 v11, s[20:23], s47 offen lds
    v_mfma_f32_16x16x32_bf16 v[36:39], v[24:27], v[128:131], v[36:39]
    ds_read_b64_tr_b16 v[22:23], v3 offset:6144
    s_add_u32 m0, s46, 12288
    s_add_u32 s47, s45, 331776
    buffer_load_dwordx4 v11, s[20:23], s47 offen lds
    s_waitcnt lgkmcnt(4)
    v_mfma_f32_16x16x32_bf16 v[32:35], v[28:31], v[132:135], v[32:35]
    ds_read_b64_tr_b16 v[24:25], v3 offset:8192
    s_add_u32 m0, s46, 16384
    s_add_u32 s47, s45, 368640
    buffer_load_dwordx4 v11, s[20:23], s47 offen lds
    v_mfma_f32_16x16x32_bf16 v[36:39], v[28:31], v[136:139], v[36:39]
    ds_read_b64_tr_b16 v[26:27], v3 offset:10240
    s_add_u32 m0, s46, 20480
    s_add_u32 s47, s45, 405504
    buffer_load_dwordx4 v11, s[20:23], s47 offen lds
    s_waitcnt lgkmcnt(4)
    v_mfma_f32_16x16x32_bf16 v[32:35], v[16:19], v[140:143], v[32:35]
    ds_read_b64_tr_b16 v[28:29], v3 offset:12288
    v_mfma_f32_16x16x32_bf16 v[36:39], v[16:19], v[144:147], v[36:39]
    ds_read_b64_tr_b16 v[30:31], v3 offset:14336
    s_waitcnt lgkmcnt(4)
    v_mfma_f32_16x16x32_bf16 v[32:35], v[20:23], v[148:151], v[32:35]
    ds_read_b64_tr_b16 v[16:17], v3 offset:16384
    v_mfma_f32_16x16x32_bf16 v[36:39], v[20:23], v[152:155], v[36:39]
    ds_read_b64_tr_b16 v[18:19], v3 offset:18432
    s_waitcnt lgkmcnt(4)
    v_mfma_f32_16x16x32_bf16 v[32:35], v[24:27], v[156:159], v[32:35]
    ds_read_b64_tr_b16 v[20:21], v3 offset:20480
    v_mfma_f32_16x16x32_bf16 v[36:39], v[24:27], v[160:163], v[36:39]
    ds_read_b64_tr_b16 v[22:23], v3 offset:22528
    s_waitcnt vmcnt(14)
    s_barrier
    s_waitcnt lgkmcnt(4)
    v_mfma_f32_16x16x32_bf16 v[32:35], v[28:31], v[164:167], v[32:35]
    ds_read_b64_tr_b16 v[24:25], v4 offset:0
    s_add_u32 s45, s65, s74
    s_add_u32 m0, s46, 24576
    s_add_u32 s47, s45, 442368
    buffer_load_dwordx4 v11, s[20:23], s47 offen lds
    v_mfma_f32_16x16x32_bf16 v[36:39], v[28:31], v[168:171], v[36:39]
    ds_read_b64_tr_b16 v[26:27], v4 offset:2048
    s_add_u32 m0, s46, 28672
    s_add_u32 s47, s45, 479232
    buffer_load_dwordx4 v11, s[20:23], s47 offen lds
    s_waitcnt lgkmcnt(4)
    v_mfma_f32_16x16x32_bf16 v[32:35], v[16:19], v[172:175], v[32:35]
    ds_read_b64_tr_b16 v[28:29], v4 offset:4096
    s_add_u32 m0, s46, 32768
    s_add_u32 s47, s45, 516096
    buffer_load_dwordx4 v11, s[20:23], s47 offen lds
    v_mfma_f32_16x16x32_bf16 v[36:39], v[16:19], v[176:179], v[36:39]
    ds_read_b64_tr_b16 v[30:31], v4 offset:6144
    s_add_u32 m0, s46, 36864
    s_add_u32 s47, s45, 552960
    buffer_load_dwordx4 v11, s[20:23], s47 offen lds
    s_waitcnt lgkmcnt(4)
    v_mfma_f32_16x16x32_bf16 v[32:35], v[20:23], v[180:183], v[32:35]
    ds_read_b64_tr_b16 v[16:17], v4 offset:8192
    s_add_u32 m0, s46, 40960
    s_add_u32 s47, s45, 589824
    buffer_load_dwordx4 v11, s[20:23], s47 offen lds
    v_mfma_f32_16x16x32_bf16 v[36:39], v[20:23], v[184:187], v[36:39]
    ds_read_b64_tr_b16 v[18:19], v4 offset:10240
    s_add_u32 m0, s46, 45056
    s_add_u32 s47, s45, 626688
    buffer_load_dwordx4 v11, s[20:23], s47 offen lds
    s_waitcnt lgkmcnt(4)
    v_mfma_f32_16x16x32_bf16 v[32:35], v[24:27], v[188:191], v[32:35]
    ds_read_b64_tr_b16 v[20:21], v4 offset:12288
    s_add_u32 s45, s65, s75
    s_add_u32 m0, s46, 132096
    s_add_u32 s47, s45, 0
    buffer_load_dwordx4 v11, s[12:15], s47 offen lds
    v_mfma_f32_16x16x32_bf16 v[36:39], v[24:27], v[192:195], v[36:39]
    ds_read_b64_tr_b16 v[22:23], v4 offset:14336
    s_add_u32 m0, s46, 136192
    s_add_u32 s47, s45, 36864
    buffer_load_dwordx4 v11, s[12:15], s47 offen lds
    s_waitcnt lgkmcnt(4)
    v_mfma_f32_16x16x32_bf16 v[32:35], v[28:31], v[196:199], v[32:35]
    ds_read_b64_tr_b16 v[24:25], v4 offset:16384
    s_add_u32 s45, s65, s76
    s_mov_b32 m0, 140288
    s_add_u32 s47, s45, 0
    s_mov_b64 exec, s[78:79]
    buffer_load_dwordx4 v11, s[12:15], s47 offen lds
    s_mov_b64 exec, -1
    v_mfma_f32_16x16x32_bf16 v[36:39], v[28:31], v[200:203], v[36:39]
    ds_read_b64_tr_b16 v[26:27], v4 offset:18432
    s_waitcnt lgkmcnt(4)
    v_mfma_f32_16x16x32_bf16 v[32:35], v[16:19], v[204:207], v[32:35]
    ds_read_b64_tr_b16 v[28:29], v4 offset:20480
    v_mfma_f32_16x16x32_bf16 v[36:39], v[16:19], v[208:211], v[36:39]
    ds_read_b64_tr_b16 v[30:31], v4 offset:22528
    s_waitcnt lgkmcnt(4)
    v_mfma_f32_16x16x32_bf16 v[32:35], v[20:23], v[212:215], v[32:35]
    ds_read_b64_tr_b16 v[16:17], v4 offset:24576
    v_mfma_f32_16x16x32_bf16 v[36:39], v[20:23], v[216:219], v[36:39]
    ds_read_b64_tr_b16 v[18:19], v5 offset:27136
    s_waitcnt lgkmcnt(4)
    v_mfma_f32_16x16x32_bf16 v[32:35], v[24:27], v[220:223], v[32:35]
    ds_read_b64_tr_b16 v[20:21], v5 offset:29184
    v_mfma_f32_16x16x32_bf16 v[36:39], v[24:27], v[224:227], v[36:39]
    ds_read_b64_tr_b16 v[22:23], v4 offset:31744
    s_waitcnt lgkmcnt(4)
    v_mfma_f32_16x16x32_bf16 v[32:35], v[28:31], v[228:231], v[32:35]
    ds_read_b64_tr_b16 v[24:25], v6 offset:24576
    v_mfma_f32_16x16x32_bf16 v[36:39], v[28:31], v[232:235], v[36:39]
    s_waitcnt vmcnt(17)
    s_barrier
    s_waitcnt lgkmcnt(3)
    v_mfma_f32_16x16x32_bf16 v[32:35], v[16:19], v[56:59], v[32:35]
    ds_read_b64_tr_b16 v[28:29], v3 offset:24576
    s_add_u32 s45, s66, s74
    s_add_u32 m0, s46, 49152
    s_add_u32 s47, s45, 0
    buffer_load_dwordx4 v11, s[20:23], s47 offen lds
    v_mfma_f32_16x16x32_bf16 v[36:39], v[16:19], v[60:63], v[36:39]
    ds_read_b64_tr_b16 v[30:31], v3 offset:26624
    s_add_u32 m0, s46, 53248
    s_add_u32 s47, s45, 36864
    buffer_load_dwordx4 v11, s[20:23], s47 offen lds
    s_waitcnt lgkmcnt(3)
    v_mfma_f32_16x16x32_bf16 v[32:35], v[20:23], v[64:67], v[32:35]
    ds_read_b64_tr_b16 v[16:17], v3 offset:28672
    s_add_u32 m0, s46, 57344
    s_add_u32 s47, s45, 73728
    buffer_load_dwordx4 v11, s[20:23], s47 offen lds
    v_mfma_f32_16x16x32_bf16 v[36:39], v[20:23], v[68:71], v[36:39]
    ds_read_b64_tr_b16 v[18:19], v3 offset:30720
    s_add_u32 m0, s46, 61440
    s_add_u32 s47, s45, 110592
    buffer_load_dwordx4 v11, s[20:23], s47 offen lds
    s_waitcnt lgkmcnt(4)
    v_mfma_f32_16x16x32_bf16 v[32:35], v[24:27], v[72:75], v[32:35]
    ds_read_b64_tr_b16 v[20:21], v3 offset:32768
    s_add_u32 m0, s46, 65536
    s_add_u32 s47, s45, 147456
    buffer_load_dwordx4 v11, s[20:23], s47 offen lds
    v_mfma_f32_16x16x32_bf16 v[36:39], v[24:27], v[76:79], v[36:39]
    ds_read_b64_tr_b16 v[22:23], v3 offset:34816
    s_add_u32 m0, s46, 69632
    s_add_u32 s47, s45, 184320
    buffer_load_dwordx4 v11, s[20:23], s47 offen lds
    s_waitcnt lgkmcnt(4)
    v_mfma_f32_16x16x32_bf16 v[40:43], v[28:31], v[92:95], 0
    ds_read_b64_tr_b16 v[24:25], v3 offset:36864
    s_waitcnt vmcnt(22)
    s_nop 0
    v_mfma_f32_16x16x32_bf16 v[44:47], v[28:31], v[96:99], 0
    ds_read_b64_tr_b16 v[26:27], v3 offset:38912
    v_dot2_f32_bf16 v240, v12, s94, 0
    v_dot2_f32_bf16 v241, v12, s95, 0
    v_dot2_f32_bf16 v242, v13, s94, 0
    v_dot2_f32_bf16 v243, v13, s95, 0
    s_waitcnt lgkmcnt(4)
    s_nop 0
    v_mfma_f32_16x16x32_bf16 v[40:43], v[16:19], v[100:103], v[40:43]
    ds_read_b64_tr_b16 v[28:29], v3 offset:40960
    v_dot2_f32_bf16 v244, v14, s94, 0
    v_dot2_f32_bf16 v245, v14, s95, 0
    v_dot2_f32_bf16 v246, v15, s94, 0
    v_dot2_f32_bf16 v247, v15, s95, 0
    v_mfma_f32_16x16x32_bf16 v[44:47], v[16:19], v[104:107], v[44:47]
    ds_read_b64_tr_b16 v[30:31], v3 offset:43008
    s_lshr_b32 s42, s60, 7
    s_lshl_b32 s43, s38, 1
    s_sub_u32 s42, s43, s42
    s_and_b32 s42, s42, 7
    s_mul_i32 s42, s42, 73728
    s_add_u32 s42, s42, s57
    buffer_load_dwordx4 v[12:15], v53, s[68:71], s42 offen sc1
    s_waitcnt lgkmcnt(4)
    v_mfma_f32_16x16x32_bf16 v[40:43], v[20:23], v[108:111], v[40:43]
    ds_read_b64_tr_b16 v[16:17], v3 offset:45056
    v_cvt_pk_bf16_f32 v88, v32, v33
    v_mfma_f32_16x16x32_bf16 v[44:47], v[20:23], v[112:115], v[44:47]
    ds_read_b64_tr_b16 v[18:19], v3 offset:47104
    v_cvt_pk_bf16_f32 v89, v34, v35
    v_cvt_pk_bf16_f32 v90, v36, v37
    v_cvt_pk_bf16_f32 v91, v38, v39
    s_lshl_b32 s42, s64, 6
    s_mul_i32 s43, s38, 73728
    s_add_u32 s44, s42, s43
    buffer_store_dwordx4 v[88:91], v53, s[68:71], s44 offen sc1
    s_waitcnt vmcnt(17)
    s_barrier
    s_waitcnt lgkmcnt(4)
    v_mfma_f32_16x16x32_bf16 v[40:43], v[24:27], v[116:119], v[40:43]
    ds_read_b64_tr_b16 v[20:21], v2 offset:0
    s_add_u32 s45, s66, s74
    s_add_u32 m0, s46, 98304
    s_add_u32 s47, s45, 221184
    buffer_load_dwordx4 v11, s[20:23], s47 offen lds
    v_mfma_f32_16x16x32_bf16 v[44:47], v[24:27], v[120:123], v[44:47]
    ds_read_b64_tr_b16 v[22:23], v2 offset:2048
    s_add_u32 m0, s46, 102400
    s_add_u32 s47, s45, 258048
    buffer_load_dwordx4 v11, s[20:23], s47 offen lds
    s_waitcnt lgkmcnt(4)
    v_mfma_f32_16x16x32_bf16 v[40:43], v[28:31], v[124:127], v[40:43]
    ds_read_b64_tr_b16 v[24:25], v2 offset:4096
    s_add_u32 m0, s46, 106496
    s_add_u32 s47, s45, 294912
    buffer_load_dwordx4 v11, s[20:23], s47 offen lds
    v_mfma_f32_16x16x32_bf16 v[44:47], v[28:31], v[128:131], v[44:47]
    ds_read_b64_tr_b16 v[26:27], v2 offset:6144
    s_add_u32 m0, s46, 110592
    s_add_u32 s47, s45, 331776
    buffer_load_dwordx4 v11, s[20:23], s47 offen lds
    s_waitcnt lgkmcnt(4)
    v_mfma_f32_16x16x32_bf16 v[40:43], v[16:19], v[132:135], v[40:43]
    ds_read_b64_tr_b16 v[28:29], v2 offset:8192
    s_add_u32 m0, s46, 114688
    s_add_u32 s47, s45, 368640
    buffer_load_dwordx4 v11, s[20:23], s47 offen lds
    v_mfma_f32_16x16x32_bf16 v[44:47], v[16:19], v[136:139], v[44:47]
    ds_read_b64_tr_b16 v[30:31], v2 offset:10240
    s_add_u32 m0, s46, 118784
    s_add_u32 s47, s45, 405504
    buffer_load_dwordx4 v11, s[20:23], s47 offen lds
    s_waitcnt lgkmcnt(4)
    v_mfma_f32_16x16x32_bf16 v[40:43], v[20:23], v[140:143], v[40:43]
    ds_read_b64_tr_b16 v[16:17], v2 offset:12288
    v_mfma_f32_16x16x32_bf16 v[44:47], v[20:23], v[144:147], v[44:47]
    ds_read_b64_tr_b16 v[18:19], v2 offset:14336
    s_waitcnt lgkmcnt(4)
    v_mfma_f32_16x16x32_bf16 v[40:43], v[24:27], v[148:151], v[40:43]
    ds_read_b64_tr_b16 v[20:21], v2 offset:16384
    v_mfma_f32_16x16x32_bf16 v[44:47], v[24:27], v[152:155], v[44:47]
    ds_read_b64_tr_b16 v[22:23], v2 offset:18432
    s_waitcnt lgkmcnt(4)
    v_mfma_f32_16x16x32_bf16 v[40:43], v[28:31], v[156:159], v[40:43]
    ds_read_b64_tr_b16 v[24:25], v2 offset:20480
    v_mfma_f32_16x16x32_bf16 v[44:47], v[28:31], v[160:163], v[44:47]
    ds_read_b64_tr_b16 v[26:27], v2 offset:22528
    s_waitcnt vmcnt(14)
    s_barrier
    s_waitcnt lgkmcnt(4)
    v_mfma_f32_16x16x32_bf16 v[40:43], v[16:19], v[164:167], v[40:43]
    ds_read_b64_tr_b16 v[28:29], v2 offset:24576
    s_add_u32 s45, s66, s74
    s_add_u32 m0, s46, 73728
    s_add_u32 s47, s45, 442368
    buffer_load_dwordx4 v11, s[20:23], s47 offen lds
    v_mfma_f32_16x16x32_bf16 v[44:47], v[16:19], v[168:171], v[44:47]
    ds_read_b64_tr_b16 v[30:31], v2 offset:26624
    s_add_u32 m0, s46, 77824
    s_add_u32 s47, s45, 479232
    buffer_load_dwordx4 v11, s[20:23], s47 offen lds
    s_waitcnt lgkmcnt(4)
    v_mfma_f32_16x16x32_bf16 v[40:43], v[20:23], v[172:175], v[40:43]
    ds_read_b64_tr_b16 v[16:17], v2 offset:28672
    s_add_u32 m0, s46, 81920
    s_add_u32 s47, s45, 516096
    buffer_load_dwordx4 v11, s[20:23], s47 offen lds
    v_mfma_f32_16x16x32_bf16 v[44:47], v[20:23], v[176:179], v[44:47]
    ds_read_b64_tr_b16 v[18:19], v2 offset:30720
    s_add_u32 m0, s46, 86016
    s_add_u32 s47, s45, 552960
    buffer_load_dwordx4 v11, s[20:23], s47 offen lds
    s_waitcnt lgkmcnt(4)
    v_mfma_f32_16x16x32_bf16 v[40:43], v[24:27], v[180:183], v[40:43]
    ds_read_b64_tr_b16 v[20:21], v2 offset:32768
    s_add_u32 m0, s46, 90112
    s_add_u32 s47, s45, 589824
    buffer_load_dwordx4 v11, s[20:23], s47 offen lds
    v_mfma_f32_16x16x32_bf16 v[44:47], v[24:27], v[184:187], v[44:47]
    ds_read_b64_tr_b16 v[22:23], v2 offset:34816
    s_add_u32 m0, s46, 94208
    s_add_u32 s47, s45, 626688
    buffer_load_dwordx4 v11, s[20:23], s47 offen lds
    s_waitcnt lgkmcnt(4)
    v_mfma_f32_16x16x32_bf16 v[40:43], v[28:31], v[188:191], v[40:43]
    ds_read_b64_tr_b16 v[24:25], v2 offset:36864
    s_add_u32 s45, s66, s75
    s_add_u32 m0, s46, 122880
    s_add_u32 s47, s45, 0
    buffer_load_dwordx4 v11, s[12:15], s47 offen lds
    v_mfma_f32_16x16x32_bf16 v[44:47], v[28:31], v[192:195], v[44:47]
    ds_read_b64_tr_b16 v[26:27], v2 offset:38912
    s_add_u32 m0, s46, 126976
    s_add_u32 s47, s45, 36864
    buffer_load_dwordx4 v11, s[12:15], s47 offen lds
    s_waitcnt lgkmcnt(4)
    v_mfma_f32_16x16x32_bf16 v[40:43], v[16:19], v[196:199], v[40:43]
    ds_read_b64_tr_b16 v[28:29], v2 offset:40960
    s_add_u32 s45, s66, s76
    s_mov_b32 m0, 131072
    s_add_u32 s47, s45, 0
    s_mov_b64 exec, s[78:79]
    buffer_load_dwordx4 v11, s[12:15], s47 offen lds
    s_mov_b64 exec, -1
    v_mfma_f32_16x16x32_bf16 v[44:47], v[16:19], v[200:203], v[44:47]
    ds_read_b64_tr_b16 v[30:31], v2 offset:43008
    s_waitcnt lgkmcnt(4)
    v_mfma_f32_16x16x32_bf16 v[40:43], v[20:23], v[204:207], v[40:43]
    ds_read_b64_tr_b16 v[16:17], v2 offset:45056
    v_mfma_f32_16x16x32_bf16 v[44:47], v[20:23], v[208:211], v[44:47]
    ds_read_b64_tr_b16 v[18:19], v2 offset:47104
    s_waitcnt lgkmcnt(4)
    v_mfma_f32_16x16x32_bf16 v[40:43], v[24:27], v[212:215], v[40:43]
    ds_read_b64_tr_b16 v[20:21], v4 offset:33792
    v_mfma_f32_16x16x32_bf16 v[44:47], v[24:27], v[216:219], v[44:47]
    ds_read_b64_tr_b16 v[22:23], v5 offset:36352
    s_waitcnt lgkmcnt(4)
    v_mfma_f32_16x16x32_bf16 v[40:43], v[28:31], v[220:223], v[40:43]
    ds_read_b64_tr_b16 v[24:25], v5 offset:38400
    v_mfma_f32_16x16x32_bf16 v[44:47], v[28:31], v[224:227], v[44:47]
    ds_read_b64_tr_b16 v[26:27], v4 offset:40960
    s_waitcnt lgkmcnt(4)
    v_mfma_f32_16x16x32_bf16 v[40:43], v[16:19], v[228:231], v[40:43]
    ds_read_b64_tr_b16 v[28:29], v6 offset:33792
    v_mfma_f32_16x16x32_bf16 v[44:47], v[16:19], v[232:235], v[44:47]
    s_waitcnt vmcnt(17)
    s_barrier
    s_waitcnt lgkmcnt(3)
    v_mfma_f32_16x16x32_bf16 v[40:43], v[20:23], v[56:59], v[40:43]
    ds_read_b64_tr_b16 v[16:17], v3 offset:0
    s_waitcnt vmcnt(16)
    s_nop 0
    v_mfma_f32_16x16x32_bf16 v[44:47], v[20:23], v[60:63], v[44:47]
    ds_read_b64_tr_b16 v[18:19], v3 offset:2048
    v_dot2_f32_bf16 v240, v12, s94, v240
    v_dot2_f32_bf16 v241, v12, s95, v241
    v_dot2_f32_bf16 v242, v13, s94, v242
    v_dot2_f32_bf16 v243, v13, s95, v243
    s_waitcnt lgkmcnt(3)
    s_nop 0
    v_mfma_f32_16x16x32_bf16 v[40:43], v[24:27], v[64:67], v[40:43]
    ds_read_b64_tr_b16 v[20:21], v3 offset:4096
    v_dot2_f32_bf16 v244, v14, s94, v244
    v_dot2_f32_bf16 v245, v14, s95, v245
    v_dot2_f32_bf16 v246, v15, s94, v246
    v_dot2_f32_bf16 v247, v15, s95, v247
    v_mfma_f32_16x16x32_bf16 v[44:47], v[24:27], v[68:71], v[44:47]
    ds_read_b64_tr_b16 v[22:23], v3 offset:6144
    s_lshr_b32 s42, s61, 7
    s_lshl_b32 s43, s38, 1
    s_sub_u32 s42, s43, s42
    s_and_b32 s42, s42, 7
    s_mul_i32 s42, s42, 73728
    s_add_u32 s42, s42, s57
    buffer_load_dwordx4 v[12:15], v53, s[68:71], s42 offen sc1
    s_waitcnt lgkmcnt(4)
    v_mfma_f32_16x16x32_bf16 v[40:43], v[28:31], v[72:75], v[40:43]
    ds_read_b64_tr_b16 v[24:25], v3 offset:8192
    v_mfma_f32_16x16x32_bf16 v[44:47], v[28:31], v[76:79], v[44:47]
    ds_read_b64_tr_b16 v[26:27], v3 offset:10240
    s_waitcnt lgkmcnt(4)
    v_mfma_f32_16x16x32_bf16 v[32:35], v[16:19], v[92:95], 0
    ds_read_b64_tr_b16 v[28:29], v3 offset:12288
    v_mfma_f32_16x16x32_bf16 v[36:39], v[16:19], v[96:99], 0
    ds_read_b64_tr_b16 v[30:31], v3 offset:14336
    s_waitcnt lgkmcnt(4)
    v_mfma_f32_16x16x32_bf16 v[32:35], v[20:23], v[100:103], v[32:35]
    ds_read_b64_tr_b16 v[16:17], v3 offset:16384
    v_mfma_f32_16x16x32_bf16 v[36:39], v[20:23], v[104:107], v[36:39]
    ds_read_b64_tr_b16 v[18:19], v3 offset:18432
    s_waitcnt lgkmcnt(4)
    s_nop 0
    v_mfma_f32_16x16x32_bf16 v[32:35], v[24:27], v[108:111], v[32:35]
    ds_read_b64_tr_b16 v[20:21], v3 offset:20480
    v_cvt_pk_bf16_f32 v88, v40, v41
    v_mfma_f32_16x16x32_bf16 v[36:39], v[24:27], v[112:115], v[36:39]
    ds_read_b64_tr_b16 v[22:23], v3 offset:22528
    v_cvt_pk_bf16_f32 v89, v42, v43
    v_cvt_pk_bf16_f32 v90, v44, v45
    v_cvt_pk_bf16_f32 v91, v46, v47
    s_lshl_b32 s42, s65, 6
    s_mul_i32 s43, s38, 73728
    s_add_u32 s44, s42, s43
    buffer_store_dwordx4 v[88:91], v53, s[68:71], s44 offen sc1
    s_waitcnt vmcnt(11)
    s_barrier
    s_waitcnt lgkmcnt(4)
    v_mfma_f32_16x16x32_bf16 v[32:35], v[28:31], v[116:119], v[32:35]
    ds_read_b64_tr_b16 v[24:25], v4 offset:0
    v_mfma_f32_16x16x32_bf16 v[36:39], v[28:31], v[120:123], v[36:39]
    ds_read_b64_tr_b16 v[26:27], v4 offset:2048
    s_waitcnt lgkmcnt(4)
    v_mfma_f32_16x16x32_bf16 v[32:35], v[16:19], v[124:127], v[32:35]
    ds_read_b64_tr_b16 v[28:29], v4 offset:4096
    v_mfma_f32_16x16x32_bf16 v[36:39], v[16:19], v[128:131], v[36:39]
    ds_read_b64_tr_b16 v[30:31], v4 offset:6144
    s_waitcnt lgkmcnt(4)
    v_mfma_f32_16x16x32_bf16 v[32:35], v[20:23], v[132:135], v[32:35]
    ds_read_b64_tr_b16 v[16:17], v4 offset:8192
    v_mfma_f32_16x16x32_bf16 v[36:39], v[20:23], v[136:139], v[36:39]
    ds_read_b64_tr_b16 v[18:19], v4 offset:10240
    s_waitcnt lgkmcnt(4)
    v_mfma_f32_16x16x32_bf16 v[32:35], v[24:27], v[140:143], v[32:35]
    ds_read_b64_tr_b16 v[20:21], v4 offset:12288
    v_and_b32_e64 v104, 15, v1
    v_mul_u32_u24 v104, 1152, v104
    v_lshrrev_b32_e64 v105, 4, v1
    v_lshl_add_u32 v104, v105, 3, v104
    s_lshl_b32 s42, s39, 1
    s_add_u32 s42, s42, 0
    s_mul_i32 s42, s42, 36864
    s_lshl_b32 s43, s41, 5
    s_add_u32 s42, s42, s43
    v_add_u32 v104, s42, v104
    v_add_u32 v105, s66, v104
    v_add_u32 v106, 18432, v105
    v_and_b32 v116, 15, v1
    v_lshlrev_b32 v116, 7, v116
    v_lshrrev_b32_e64 v117, 4, v1
    v_lshl_add_u32 v116, v117, 3, v116
    s_add_u32 s43, s43, 155648
    v_add_u32_e64 v116, s43, v116
    ds_read_b64 v[100:101], v116 offset:0
    ds_read_b64 v[102:103], v116 offset:2048
    v_mfma_f32_16x16x32_bf16 v[36:39], v[24:27], v[144:147], v[36:39]
    ds_read_b64_tr_b16 v[22:23], v4 offset:14336
    s_lshr_b32 s42, s62, 7
    s_lshl_b32 s43, s38, 1
    s_sub_u32 s42, s43, s42
    s_and_b32 s42, s42, 7
    s_mul_i32 s42, s42, 73728
    s_add_u32 s42, s42, s57
    buffer_load_dwordx4 v[120:123], v53, s[68:71], s42 offen sc1
    s_waitcnt lgkmcnt(6)
    v_mfma_f32_16x16x32_bf16 v[32:35], v[28:31], v[148:151], v[32:35]
    ds_read_b64_tr_b16 v[24:25], v4 offset:16384
    s_lshr_b32 s42, s63, 7
    s_lshl_b32 s43, s38, 1
    s_sub_u32 s42, s43, s42
    s_and_b32 s42, s42, 7
    s_mul_i32 s42, s42, 73728
    s_add_u32 s42, s42, s57
    buffer_load_dwordx4 v[124:127], v53, s[68:71], s42 offen sc1
    v_mfma_f32_16x16x32_bf16 v[36:39], v[28:31], v[152:155], v[36:39]
    ds_read_b64_tr_b16 v[26:27], v4 offset:18432
    s_lshr_b32 s42, s64, 7
    s_lshl_b32 s43, s38, 1
    s_sub_u32 s42, s43, s42
    s_and_b32 s42, s42, 7
    s_mul_i32 s42, s42, 73728
    s_add_u32 s42, s42, s57
    buffer_load_dwordx4 v[128:131], v53, s[68:71], s42 offen sc1
    s_waitcnt lgkmcnt(6)
    v_mfma_f32_16x16x32_bf16 v[32:35], v[16:19], v[156:159], v[32:35]
    ds_read_b64_tr_b16 v[28:29], v4 offset:20480
    v_mfma_f32_16x16x32_bf16 v[36:39], v[16:19], v[160:163], v[36:39]
    ds_read_b64_tr_b16 v[30:31], v4 offset:22528
    s_waitcnt vmcnt(5)
    s_barrier
    s_waitcnt lgkmcnt(4)
    v_mfma_f32_16x16x32_bf16 v[32:35], v[20:23], v[164:167], v[32:35]
    ds_read_b64_tr_b16 v[16:17], v3 offset:24576
    v_mfma_f32_16x16x32_bf16 v[36:39], v[20:23], v[168:171], v[36:39]
    ds_read_b64_tr_b16 v[18:19], v3 offset:26624
    s_waitcnt lgkmcnt(4)
    v_mfma_f32_16x16x32_bf16 v[32:35], v[24:27], v[172:175], v[32:35]
    ds_read_b64_tr_b16 v[20:21], v3 offset:28672
    v_mfma_f32_16x16x32_bf16 v[36:39], v[24:27], v[176:179], v[36:39]
    ds_read_b64_tr_b16 v[22:23], v3 offset:30720
    s_waitcnt lgkmcnt(4)
    v_mfma_f32_16x16x32_bf16 v[32:35], v[28:31], v[180:183], v[32:35]
    ds_read_b64_tr_b16 v[24:25], v3 offset:32768
    v_mfma_f32_16x16x32_bf16 v[36:39], v[28:31], v[184:187], v[36:39]
    ds_read_b64_tr_b16 v[26:27], v3 offset:34816
    s_waitcnt lgkmcnt(4)
    v_mfma_f32_16x16x32_bf16 v[32:35], v[16:19], v[188:191], v[32:35]
    ds_read_b64_tr_b16 v[28:29], v3 offset:36864
    s_cmp_lg_u32 s40, s38
    s_cbranch_scc1 LD_ns1
    v_add_u32 v116, 1024, v104
    v_add_u32 v117, 18432, v116
    global_load_dwordx2 v[168:169], v116, s[4:5]
    global_load_dwordx2 v[170:171], v117, s[4:5]
    s_mov_b32 s100, 65536
    s_lshr_b32 s42, s59, 7
    s_lshl_b32 s43, s38, 1
    s_sub_u32 s42, s43, s42
    s_and_b32 s42, s42, 7
    s_mul_i32 s42, s42, 73728
    s_add_u32 s42, s42, s100
    buffer_load_dwordx4 v[140:143], v53, s[68:71], s42 offen sc1
    s_lshr_b32 s42, s60, 7
    s_lshl_b32 s43, s38, 1
    s_sub_u32 s42, s43, s42
    s_and_b32 s42, s42, 7
    s_mul_i32 s42, s42, 73728
    s_add_u32 s42, s42, s100
    buffer_load_dwordx4 v[144:147], v53, s[68:71], s42 offen sc1
    s_lshr_b32 s42, s61, 7
    s_lshl_b32 s43, s38, 1
    s_sub_u32 s42, s43, s42
    s_and_b32 s42, s42, 7
    s_mul_i32 s42, s42, 73728
    s_add_u32 s42, s42, s100
    buffer_load_dwordx4 v[148:151], v53, s[68:71], s42 offen sc1
    s_lshr_b32 s42, s62, 7
    s_lshl_b32 s43, s38, 1
    s_sub_u32 s42, s43, s42
    s_and_b32 s42, s42, 7
    s_mul_i32 s42, s42, 73728
    s_add_u32 s42, s42, s100
    buffer_load_dwordx4 v[152:155], v53, s[68:71], s42 offen sc1
    s_lshr_b32 s42, s63, 7
    s_lshl_b32 s43, s38, 1
    s_sub_u32 s42, s43, s42
    s_and_b32 s42, s42, 7
    s_mul_i32 s42, s42, 73728
    s_add_u32 s42, s42, s100
    buffer_load_dwordx4 v[156:159], v53, s[68:71], s42 offen sc1
    s_lshr_b32 s42, s64, 7
    s_lshl_b32 s43, s38, 1
    s_sub_u32 s42, s43, s42
    s_and_b32 s42, s42, 7
    s_mul_i32 s42, s42, 73728
    s_add_u32 s42, s42, s100
    buffer_load_dwordx4 v[160:163], v53, s[68:71], s42 offen sc1
    s_lshr_b32 s42, s65, 7
    s_lshl_b32 s43, s38, 1
    s_sub_u32 s42, s43, s42
    s_and_b32 s42, s42, 7
    s_mul_i32 s42, s42, 73728
    s_add_u32 s42, s42, s100
    buffer_load_dwordx4 v[164:167], v53, s[68:71], s42 offen sc1
LD_ns1:
    v_mfma_f32_16x16x32_bf16 v[36:39], v[16:19], v[192:195], v[36:39]
    ds_read_b64_tr_b16 v[30:31], v3 offset:38912
    s_waitcnt lgkmcnt(4)
    v_mfma_f32_16x16x32_bf16 v[32:35], v[20:23], v[196:199], v[32:35]
    ds_read_b64_tr_b16 v[16:17], v3 offset:40960
    v_mfma_f32_16x16x32_bf16 v[36:39], v[20:23], v[200:203], v[36:39]
    ds_read_b64_tr_b16 v[18:19], v3 offset:43008
    s_waitcnt lgkmcnt(4)
    v_mfma_f32_16x16x32_bf16 v[32:35], v[24:27], v[204:207], v[32:35]
    ds_read_b64_tr_b16 v[20:21], v3 offset:45056
    v_mfma_f32_16x16x32_bf16 v[36:39], v[24:27], v[208:211], v[36:39]
    ds_read_b64_tr_b16 v[22:23], v3 offset:47104
    s_waitcnt lgkmcnt(4)
    v_mfma_f32_16x16x32_bf16 v[32:35], v[28:31], v[212:215], v[32:35]
    ds_read_b64_tr_b16 v[24:25], v4 offset:24576
    v_mfma_f32_16x16x32_bf16 v[36:39], v[28:31], v[216:219], v[36:39]
    ds_read_b64_tr_b16 v[26:27], v5 offset:27136
    s_waitcnt lgkmcnt(4)
    v_mfma_f32_16x16x32_bf16 v[32:35], v[16:19], v[220:223], v[32:35]
    ds_read_b64_tr_b16 v[28:29], v5 offset:29184
    s_lshr_b32 s42, s65, 7
    s_lshl_b32 s43, s38, 1
    s_sub_u32 s42, s43, s42
    s_and_b32 s42, s42, 7
    s_mul_i32 s42, s42, 73728
    s_add_u32 s42, s42, s57
    buffer_load_dwordx4 v[132:135], v53, s[68:71], s42 offen sc1
    v_mfma_f32_16x16x32_bf16 v[36:39], v[16:19], v[224:227], v[36:39]
    ds_read_b64_tr_b16 v[30:31], v4 offset:31744
    s_waitcnt lgkmcnt(4)
    v_mfma_f32_16x16x32_bf16 v[32:35], v[20:23], v[228:231], v[32:35]
    ds_read_b64_tr_b16 v[16:17], v6 offset:24576
    v_mfma_f32_16x16x32_bf16 v[36:39], v[20:23], v[232:235], v[36:39]
    s_waitcnt lgkmcnt(3)
    v_mfma_f32_16x16x32_bf16 v[32:35], v[24:27], v[56:59], v[32:35]
    v_mfma_f32_16x16x32_bf16 v[36:39], v[24:27], v[60:63], v[36:39]
    s_waitcnt lgkmcnt(1)
    v_mfma_f32_16x16x32_bf16 v[32:35], v[28:31], v[64:67], v[32:35]
    v_mfma_f32_16x16x32_bf16 v[36:39], v[28:31], v[68:71], v[36:39]
    s_waitcnt lgkmcnt(0)
    v_mfma_f32_16x16x32_bf16 v[32:35], v[16:19], v[72:75], v[32:35]
    v_mfma_f32_16x16x32_bf16 v[36:39], v[16:19], v[76:79], v[36:39]
    s_waitcnt vmcnt(5)
    v_dot2_f32_bf16 v240, v12, s94, v240
    v_dot2_f32_bf16 v241, v12, s95, v241
    v_dot2_f32_bf16 v242, v13, s94, v242
    v_dot2_f32_bf16 v243, v13, s95, v243
    v_dot2_f32_bf16 v244, v14, s94, v244
    v_dot2_f32_bf16 v245, v14, s95, v245
    v_dot2_f32_bf16 v246, v15, s94, v246
    v_dot2_f32_bf16 v247, v15, s95, v247
    v_dot2_f32_bf16 v240, v100, s94, v240
    v_dot2_f32_bf16 v241, v100, s95, v241
    v_dot2_f32_bf16 v242, v101, s94, v242
    v_dot2_f32_bf16 v243, v101, s95, v243
    v_dot2_f32_bf16 v244, v102, s94, v244
    v_dot2_f32_bf16 v245, v102, s95, v245
    v_dot2_f32_bf16 v246, v103, s94, v246
    v_dot2_f32_bf16 v247, v103, s95, v247
    s_movk_i32 s86, 4000
LD_c1a:
    s_waitcnt vmcnt(0)
LD_c1c:
    v_max3_u32 v239, v120, v121, v122
    v_max3_u32 v239, v123, v124, v239
    v_max3_u32 v239, v125, v126, v239
    v_max3_u32 v239, v127, v128, v239
    v_max3_u32 v239, v129, v130, v239
    v_max3_u32 v239, v131, v132, v239
    v_max3_u32 v239, v133, v134, v239
    v_max_u32 v239, v135, v239
    v_cmp_eq_u32 vcc, -1, v239
    s_nop 4
    s_cbranch_vccz LD_c1b
    s_lshr_b32 s42, s62, 7
    s_lshl_b32 s43, s38, 1
    s_sub_u32 s42, s43, s42
    s_and_b32 s42, s42, 7
    s_mul_i32 s42, s42, 73728
    s_add_u32 s42, s42, s57
    buffer_load_dwordx4 v[120:123], v53, s[68:71], s42 offen sc1
    s_lshr_b32 s42, s63, 7
    s_lshl_b32 s43, s38, 1
    s_sub_u32 s42, s43, s42
    s_and_b32 s42, s42, 7
    s_mul_i32 s42, s42, 73728
    s_add_u32 s42, s42, s57
    buffer_load_dwordx4 v[124:127], v53, s[68:71], s42 offen sc1
    s_lshr_b32 s42, s64, 7
    s_lshl_b32 s43, s38, 1
    s_sub_u32 s42, s43, s42
    s_and_b32 s42, s42, 7
    s_mul_i32 s42, s42, 73728
    s_add_u32 s42, s42, s57
    buffer_load_dwordx4 v[128:131], v53, s[68:71], s42 offen sc1
    s_lshr_b32 s42, s65, 7
    s_lshl_b32 s43, s38, 1
    s_sub_u32 s42, s43, s42
    s_and_b32 s42, s42, 7
    s_mul_i32 s42, s42, 73728
    s_add_u32 s42, s42, s57
    buffer_load_dwordx4 v[132:135], v53, s[68:71], s42 offen sc1
    s_sub_u32 s86, s86, 1
    s_cbranch_scc0 LD_c1a
    s_waitcnt vmcnt(0)
LD_c1b:
    s_nop 0
    v_dot2_f32_bf16 v240, v120, s94, v240
    v_dot2_f32_bf16 v241, v120, s95, v241
    v_dot2_f32_bf16 v242, v121, s94, v242
    v_dot2_f32_bf16 v243, v121, s95, v243
    v_dot2_f32_bf16 v244, v122, s94, v244
    v_dot2_f32_bf16 v245, v122, s95, v245
    v_dot2_f32_bf16 v246, v123, s94, v246
    v_dot2_f32_bf16 v247, v123, s95, v247
    v_dot2_f32_bf16 v240, v124, s94, v240
    v_dot2_f32_bf16 v241, v124, s95, v241
    v_dot2_f32_bf16 v242, v125, s94, v242
    v_dot2_f32_bf16 v243, v125, s95, v243
    v_dot2_f32_bf16 v244, v126, s94, v244
    v_dot2_f32_bf16 v245, v126, s95, v245
    v_dot2_f32_bf16 v246, v127, s94, v246
    v_dot2_f32_bf16 v247, v127, s95, v247
    v_dot2_f32_bf16 v240, v128, s94, v240
    v_dot2_f32_bf16 v241, v128, s95, v241
    v_dot2_f32_bf16 v242, v129, s94, v242
    v_dot2_f32_bf16 v243, v129, s95, v243
    v_dot2_f32_bf16 v244, v130, s94, v244
    v_dot2_f32_bf16 v245, v130, s95, v245
    v_dot2_f32_bf16 v246, v131, s94, v246
    v_dot2_f32_bf16 v247, v131, s95, v247
    v_dot2_f32_bf16 v240, v132, s94, v240
    v_dot2_f32_bf16 v241, v132, s95, v241
    v_dot2_f32_bf16 v242, v133, s94, v242
    v_dot2_f32_bf16 v243, v133, s95, v243
    v_dot2_f32_bf16 v244, v134, s94, v244
    v_dot2_f32_bf16 v245, v134, s95, v245
    v_dot2_f32_bf16 v246, v135, s94, v246
    v_dot2_f32_bf16 v247, v135, s95, v247
    s_nop 2
    s_nop 0
    v_pk_add_f32 v[32:33], v[32:33], v[240:241]
    v_pk_add_f32 v[34:35], v[34:35], v[242:243]
    v_pk_add_f32 v[36:37], v[36:37], v[244:245]
    v_pk_add_f32 v[38:39], v[38:39], v[246:247]
    s_nop 2
    s_nop 0
    v_cvt_pk_bf16_f32 v32, v32, v33
    v_cvt_pk_bf16_f32 v33, v34, v35
    global_store_dwordx2 v105, v[32:33], s[32:33]
    v_cvt_pk_bf16_f32 v36, v36, v37
    v_cvt_pk_bf16_f32 v37, v38, v39
    global_store_dwordx2 v106, v[36:37], s[32:33]
    s_cmp_lg_u32 s40, s38
    s_cbranch_scc1 LD_end
    s_waitcnt vmcnt(2)
    s_nop 0
    v_dot2_f32_bf16 v80, v140, s94, v80
    v_dot2_f32_bf16 v81, v140, s95, v81
    v_dot2_f32_bf16 v82, v141, s94, v82
    v_dot2_f32_bf16 v83, v141, s95, v83
    v_dot2_f32_bf16 v84, v142, s94, v84
    v_dot2_f32_bf16 v85, v142, s95, v85
    v_dot2_f32_bf16 v86, v143, s94, v86
    v_dot2_f32_bf16 v87, v143, s95, v87
    v_dot2_f32_bf16 v80, v144, s94, v80
    v_dot2_f32_bf16 v81, v144, s95, v81
    v_dot2_f32_bf16 v82, v145, s94, v82
    v_dot2_f32_bf16 v83, v145, s95, v83
    v_dot2_f32_bf16 v84, v146, s94, v84
    v_dot2_f32_bf16 v85, v146, s95, v85
    v_dot2_f32_bf16 v86, v147, s94, v86
    v_dot2_f32_bf16 v87, v147, s95, v87
    v_dot2_f32_bf16 v80, v148, s94, v80
    v_dot2_f32_bf16 v81, v148, s95, v81
    v_dot2_f32_bf16 v82, v149, s94, v82
    v_dot2_f32_bf16 v83, v149, s95, v83
    v_dot2_f32_bf16 v84, v150, s94, v84
    v_dot2_f32_bf16 v85, v150, s95, v85
    v_dot2_f32_bf16 v86, v151, s94, v86
    v_dot2_f32_bf16 v87, v151, s95, v87
    v_dot2_f32_bf16 v80, v152, s94, v80
    v_dot2_f32_bf16 v81, v152, s95, v81
    v_dot2_f32_bf16 v82, v153, s94, v82
    v_dot2_f32_bf16 v83, v153, s95, v83
    v_dot2_f32_bf16 v84, v154, s94, v84
    v_dot2_f32_bf16 v85, v154, s95, v85
    v_dot2_f32_bf16 v86, v155, s94, v86
    v_dot2_f32_bf16 v87, v155, s95, v87
    v_dot2_f32_bf16 v80, v156, s94, v80
    v_dot2_f32_bf16 v81, v156, s95, v81
    v_dot2_f32_bf16 v82, v157, s94, v82
    v_dot2_f32_bf16 v83, v157, s95, v83
    v_dot2_f32_bf16 v84, v158, s94, v84
    v_dot2_f32_bf16 v85, v158, s95, v85
    v_dot2_f32_bf16 v86, v159, s94, v86
    v_dot2_f32_bf16 v87, v159, s95, v87
    v_dot2_f32_bf16 v80, v160, s94, v80
    v_dot2_f32_bf16 v81, v160, s95, v81
    v_dot2_f32_bf16 v82, v161, s94, v82
    v_dot2_f32_bf16 v83, v161, s95, v83
    v_dot2_f32_bf16 v84, v162, s94, v84
    v_dot2_f32_bf16 v85, v162, s95, v85
    v_dot2_f32_bf16 v86, v163, s94, v86
    v_dot2_f32_bf16 v87, v163, s95, v87
    v_dot2_f32_bf16 v80, v164, s94, v80
    v_dot2_f32_bf16 v81, v164, s95, v81
    v_dot2_f32_bf16 v82, v165, s94, v82
    v_dot2_f32_bf16 v83, v165, s95, v83
    v_dot2_f32_bf16 v84, v166, s94, v84
    v_dot2_f32_bf16 v85, v166, s95, v85
    v_dot2_f32_bf16 v86, v167, s94, v86
    v_dot2_f32_bf16 v87, v167, s95, v87
    v_dot2_f32_bf16 v80, v168, s94, v80
    v_dot2_f32_bf16 v81, v168, s95, v81
    v_dot2_f32_bf16 v82, v169, s94, v82
    v_dot2_f32_bf16 v83, v169, s95, v83
    v_dot2_f32_bf16 v84, v170, s94, v84
    v_dot2_f32_bf16 v85, v170, s95, v85
    v_dot2_f32_bf16 v86, v171, s94, v86
    v_dot2_f32_bf16 v87, v171, s95, v87
    s_nop 2
    s_nop 0
    v_cvt_pk_bf16_f32 v80, v80, v81
    v_cvt_pk_bf16_f32 v81, v82, v83
    global_store_dwordx2 v116, v[80:81], s[32:33]
    v_cvt_pk_bf16_f32 v84, v84, v85
    v_cvt_pk_bf16_f32 v85, v86, v87
    global_store_dwordx2 v117, v[84:85], s[32:33]
LD_end:
    s_endpgm
LD_sm:
    ds_read_b64 v[16:17], v12 offset:36864
    ds_read_b32 v18, v13 offset:36864
    ds_read_b64 v[20:21], v12 offset:37376
    ds_read_b32 v22, v13 offset:36992
    ds_read_b64 v[24:25], v12 offset:32256
    ds_read_b32 v26, v13 offset:32256
    ds_read_b64 v[28:29], v12 offset:32768
    ds_read_b32 v30, v13 offset:32384
    ds_read_b64 v[92:93], v12 offset:27648
    ds_read_b32 v94, v13 offset:27648
    ds_read_b64 v[96:97], v12 offset:28160
    ds_read_b32 v98, v13 offset:27776
    v_add_u32 v8, s46, v8
    v_subrev_u32 v8, 45056, v8
    s_add_u32 m0, s46, 73728
    s_nop 0
    buffer_load_dwordx4 v8, s[28:31], 0 offen sc1 lds
    v_add_u32 v8, 4096, v8
    s_add_u32 m0, s46, 77824
    s_nop 0
    buffer_load_dwordx4 v8, s[28:31], 0 offen sc1 lds
    v_add_u32 v8, 4096, v8
    s_add_u32 m0, s46, 81920
    s_nop 0
    s_nop 0
    buffer_load_dwordx4 v8, s[28:31], 0 offen sc1 lds
    v_cvt_pk_bf16_f32 v88, v32, v33
    v_cvt_pk_bf16_f32 v89, v34, v35
    v_cvt_pk_bf16_f32 v90, v36, v37
    v_cvt_pk_bf16_f32 v91, v38, v39
    v_pk_max_i16 v88, v88, 0
    v_pk_max_i16 v89, v89, 0
    v_pk_max_i16 v90, v90, 0
    v_pk_max_i16 v91, v91, 0
    ds_read_b64 v[100:101], v12 offset:23040
    ds_read_b32 v102, v13 offset:23040
    s_waitcnt lgkmcnt(12)
    v_mfma_f32_16x16x32_bf16 v[220:223], v[16:19], v[48:51], v[40:43]
    v_add_u32 v8, 4096, v8
    s_add_u32 m0, s46, 86016
    s_nop 0
    buffer_load_dwordx4 v8, s[28:31], 0 offen sc1 lds
    v_mfma_f32_16x16x32_bf16 v[228:231], v[16:19], v[52:55], 0
    v_add_u32 v8, 4096, v8
    s_add_u32 m0, s46, 90112
    s_nop 0
    buffer_load_dwordx4 v8, s[28:31], 0 offen sc1 lds
    ds_read_b64 v[104:105], v12 offset:23552
    ds_read_b32 v106, v13 offset:23168
    s_waitcnt lgkmcnt(12)
    v_mfma_f32_16x16x32_bf16 v[232:235], v[20:23], v[52:55], v[40:43]
    v_add_u32 v8, 4096, v8
    s_add_u32 m0, s46, 94208
    s_nop 0
    buffer_load_dwordx4 v8, s[28:31], 0 offen sc1 lds
    s_cmp_ge_u32 s57, 1
    s_cselect_b32 s42, 0, s81
    v_mov_b32 v244, s42
    v_mov_b32 v245, s42
    v_mov_b32 v246, s42
    v_mov_b32 v247, s42
    s_nop 1
    ds_read_b64 v[108:109], v12 offset:18432
    ds_read_b32 v110, v13 offset:18432
    s_waitcnt lgkmcnt(12)
    v_mfma_f32_16x16x32_bf16 v[204:207], v[24:27], v[48:51], v[244:247]
    v_add_u32 v8, 4096, v8
    s_add_u32 m0, s46, 98304
    s_nop 0
    buffer_load_dwordx4 v8, s[28:31], 0 offen sc1 lds
    v_mfma_f32_16x16x32_bf16 v[212:215], v[24:27], v[52:55], v[244:247]
    v_add_u32 v8, 4096, v8
    s_add_u32 m0, s46, 102400
    s_nop 0
    buffer_load_dwordx4 v8, s[28:31], 0 offen sc1 lds
    ds_read_b64 v[112:113], v12 offset:18944
    ds_read_b32 v114, v13 offset:18560
    s_waitcnt lgkmcnt(12)
    v_mfma_f32_16x16x32_bf16 v[208:211], v[28:31], v[48:51], v[244:247]
    v_add_u32 v8, 4096, v8
    s_add_u32 m0, s46, 106496
    s_nop 0
    buffer_load_dwordx4 v8, s[28:31], 0 offen sc1 lds
    v_mfma_f32_16x16x32_bf16 v[216:219], v[28:31], v[52:55], v[244:247]
    v_add_u32 v8, 4096, v8
    s_add_u32 m0, s46, 110592
    s_nop 0
    buffer_load_dwordx4 v8, s[28:31], 0 offen sc1 lds
    s_cmp_ge_u32 s57, 2
    s_cselect_b32 s42, 0, s81
    v_mov_b32 v240, s42
    v_mov_b32 v241, s42
    v_mov_b32 v242, s42
    v_mov_b32_e64 v243, s42
    s_nop 1
    ds_read_b64 v[116:117], v12 offset:13824
    ds_read_b32 v118, v13 offset:13824
    s_waitcnt lgkmcnt(12)
    v_mfma_f32_16x16x32_bf16 v[188:191], v[92:95], v[48:51], v[240:243]
    v_max_f32 v248, v220, v221
    v_max_f32_e64 v249, v222, v223
    v_add_u32 v8, 4096, v8
    s_add_u32 m0, s46, 114688
    s_nop 0
    buffer_load_dwordx4 v8, s[28:31], 0 offen sc1 lds
    v_mfma_f32_16x16x32_bf16 v[196:199], v[92:95], v[52:55], v[240:243]
    v_max_f32 v250, v228, v229
    v_max_f32 v251, v230, v231
    v_subrev_u32 v8, s46, v8
    v_add_u32 v8, 4096, v8
    s_mov_b32 m0, 118784
    s_mov_b64 exec, s[78:79]
    buffer_load_dwordx4 v8, s[28:31], 0 offen sc1 lds
    s_mov_b64 exec, -1
    ds_read_b64 v[120:121], v12 offset:14336
    ds_read_b32 v122, v13 offset:13952
    s_waitcnt lgkmcnt(12)
    v_mfma_f32_16x16x32_bf16 v[192:195], v[96:99], v[48:51], v[240:243]
    v_max3_f32 v250, v232, v233, v250
    v_max3_f32 v251, v234, v235, v251
    v_mfma_f32_16x16x32_bf16 v[200:203], v[96:99], v[52:55], v[240:243]
    s_cmp_ge_u32 s57, 3
    s_cselect_b32 s42, 0, s81
    v_mov_b32 v244, s42
    v_mov_b32 v245, s42
    v_mov_b32 v246, s42
    v_mov_b32 v247, s42
    s_nop 1
    ds_read_b64 v[16:17], v12 offset:9216
    ds_read_b32 v18, v13 offset:9216
    s_waitcnt lgkmcnt(12)
    s_nop 0
    v_mfma_f32_16x16x32_bf16 v[172:175], v[100:103], v[48:51], v[244:247]
    v_max3_f32 v248, v204, v205, v248
    v_max3_f32 v249, v206, v207, v249
    v_mfma_f32_16x16x32_bf16 v[180:183], v[100:103], v[52:55], v[244:247]
    v_max3_f32 v250, v212, v213, v250
    v_max3_f32 v251, v214, v215, v251
    ds_read_b64 v[20:21], v12 offset:9728
    ds_read_b32 v22, v13 offset:9344
    s_waitcnt lgkmcnt(12)
    s_nop 0
    v_mfma_f32_16x16x32_bf16 v[176:179], v[104:107], v[48:51], v[244:247]
    v_max3_f32 v248, v208, v209, v248
    v_max3_f32 v249, v210, v211, v249
    v_mfma_f32_16x16x32_bf16 v[184:187], v[104:107], v[52:55], v[244:247]
    v_max3_f32 v250, v216, v217, v250
    v_max3_f32 v251, v218, v219, v251
    s_cmp_ge_u32 s57, 4
    s_cselect_b32 s42, 0, s81
    v_mov_b32 v240, s42
    v_mov_b32 v241, s42
    v_mov_b32 v242, s42
    v_mov_b32_e64 v243, s42
    s_nop 1
    ds_read_b64 v[24:25], v12 offset:4608
    ds_read_b32 v26, v13 offset:4608
    s_waitcnt lgkmcnt(12)
    s_nop 0
    v_mfma_f32_16x16x32_bf16 v[156:159], v[108:111], v[48:51], v[240:243]
    v_max3_f32 v248, v188, v189, v248
    v_max3_f32 v249, v190, v191, v249
    v_mfma_f32_16x16x32_bf16 v[164:167], v[108:111], v[52:55], v[240:243]
    v_max3_f32 v250, v196, v197, v250
    v_max3_f32 v251, v198, v199, v251
    ds_read_b64 v[28:29], v12 offset:5120
    ds_read_b32 v30, v13 offset:4736
    s_waitcnt lgkmcnt(12)
    s_nop 0
    v_mfma_f32_16x16x32_bf16 v[160:163], v[112:115], v[48:51], v[240:243]
    v_max3_f32 v248, v192, v193, v248
    v_max3_f32 v249, v194, v195, v249
    v_mfma_f32_16x16x32_bf16 v[168:171], v[112:115], v[52:55], v[240:243]
    v_max3_f32 v250, v200, v201, v250
    v_max3_f32 v251, v202, v203, v251
    s_cmp_ge_u32 s57, 5
    s_cselect_b32 s42, 0, s81
    v_mov_b32 v244, s42
    v_mov_b32 v245, s42
    v_mov_b32 v246, s42
    v_mov_b32 v247, s42
    s_nop 1
    s_waitcnt lgkmcnt(10)
    v_mfma_f32_16x16x32_bf16 v[140:143], v[116:119], v[48:51], v[244:247]
    v_max3_f32 v248, v172, v173, v248
    v_max3_f32 v249, v174, v175, v249
    v_mfma_f32_16x16x32_bf16 v[148:151], v[116:119], v[52:55], v[244:247]
    v_max3_f32 v250, v180, v181, v250
    v_max3_f32 v251, v182, v183, v251
    s_waitcnt lgkmcnt(8)
    s_nop 0
    v_mfma_f32_16x16x32_bf16 v[144:147], v[120:123], v[48:51], v[244:247]
    v_max3_f32 v248, v176, v177, v248
    v_max3_f32 v249, v178, v179, v249
    v_mfma_f32_16x16x32_bf16 v[152:155], v[120:123], v[52:55], v[244:247]
    v_max3_f32 v250, v184, v185, v250
    v_max3_f32 v251, v186, v187, v251
    s_cmp_ge_u32 s57, 6
    s_cselect_b32 s42, 0, s81
    v_mov_b32 v240, s42
    v_mov_b32 v241, s42
    v_mov_b32 v242, s42
    v_mov_b32 v243, s42
    s_nop 1
    s_waitcnt lgkmcnt(6)
    v_mfma_f32_16x16x32_bf16 v[124:127], v[16:19], v[48:51], v[240:243]
    v_max3_f32 v248, v156, v157, v248
    v_max3_f32 v249, v158, v159, v249
    v_mfma_f32_16x16x32_bf16 v[132:135], v[16:19], v[52:55], v[240:243]
    v_max3_f32 v250, v164, v165, v250
    v_max3_f32 v251, v166, v167, v251
    ds_read_b64 v[16:17], v12 offset:0
    ds_read_b32 v18, v13 offset:0
    s_waitcnt lgkmcnt(6)
    s_nop 0
    v_mfma_f32_16x16x32_bf16 v[128:131], v[20:23], v[48:51], v[240:243]
    v_max3_f32 v248, v160, v161, v248
    v_max3_f32 v249, v162, v163, v249
    v_mfma_f32_16x16x32_bf16 v[136:139], v[20:23], v[52:55], v[240:243]
    v_max3_f32 v250, v168, v169, v250
    v_max3_f32 v251, v170, v171, v251
    s_cmp_ge_u32 s57, 7
    s_cselect_b32 s42, 0, s81
    v_mov_b32 v244, s42
    v_mov_b32 v245, s42
    v_mov_b32 v246, s42
    v_mov_b32_e64 v247, s42
    s_nop 1
    ds_read_b64 v[20:21], v12 offset:512
    ds_read_b32 v22, v13 offset:128
    s_waitcnt lgkmcnt(6)
    s_nop 0
    v_mfma_f32_16x16x32_bf16 v[108:111], v[24:27], v[48:51], v[244:247]
    v_max3_f32 v248, v140, v141, v248
    v_max3_f32 v249, v142, v143, v249
    v_mfma_f32_16x16x32_bf16 v[116:119], v[24:27], v[52:55], v[244:247]
    v_max3_f32 v250, v148, v149, v250
    v_max3_f32 v251, v150, v151, v251
    s_waitcnt lgkmcnt(4)
    s_nop 0
    v_mfma_f32_16x16x32_bf16 v[112:115], v[28:31], v[48:51], v[244:247]
    v_max3_f32 v248, v144, v145, v248
    v_max3_f32 v249, v146, v147, v249
    v_mfma_f32_16x16x32_bf16 v[120:123], v[28:31], v[52:55], v[244:247]
    v_max3_f32 v250, v152, v153, v250
    v_max3_f32 v251, v154, v155, v251
    s_cmp_ge_u32 s57, 8
    s_cselect_b32 s42, 0, s81
    v_mov_b32 v240, s42
    v_mov_b32 v241, s42
    v_mov_b32 v242, s42
    v_mov_b32 v243, s42
    s_nop 1
    s_waitcnt lgkmcnt(2)
    v_mfma_f32_16x16x32_bf16 v[92:95], v[16:19], v[48:51], v[44:47]
    v_max3_f32 v248, v124, v125, v248
    v_max3_f32 v249, v126, v127, v249
    s_waitcnt lgkmcnt(0)
    s_nop 0
    v_mfma_f32_16x16x32_bf16 v[96:99], v[20:23], v[48:51], v[240:243]
    v_max3_f32 v250, v132, v133, v250
    v_max3_f32 v251, v134, v135, v251
    v_mfma_f32_16x16x32_bf16 v[104:107], v[20:23], v[52:55], v[44:47]
    v_max3_f32 v248, v128, v129, v248
    v_max3_f32 v249, v130, v131, v249
    v_max3_f32 v250, v136, v137, v250
    v_max3_f32 v251, v138, v139, v251
    v_max3_f32 v248, v108, v109, v248
    v_max3_f32 v249, v110, v111, v249
    v_max3_f32 v250, v116, v117, v250
    v_max3_f32 v251, v118, v119, v251
    v_max3_f32 v248, v112, v113, v248
    v_max3_f32 v249, v114, v115, v249
    v_max3_f32 v250, v120, v121, v250
    v_max3_f32 v251, v122, v123, v251
    v_mov_b32 v20, 0x3f803f80
    v_mov_b32 v28, 0x3f803f80
    v_mov_b32 v21, 0x3f803f80
    v_mov_b32 v29, 0x3f803f80
    v_mov_b32 v22, 0x3f803f80
    v_mov_b32 v30, 0x3f803f80
    v_mov_b32 v23, 0x3f803f80
    v_mov_b32 v31, 0x3f803f80
    v_max3_f32 v248, v92, v93, v248
    v_max3_f32 v249, v94, v95, v249
    v_max3_f32 v248, v96, v97, v248
    v_max3_f32 v249, v98, v99, v249
    v_max3_f32 v250, v104, v105, v250
    v_max3_f32 v251, v106, v107, v251
    s_branch LD_sj
LS_start:
    s_lshl_b32 s42, s41, 10
    s_waitcnt lgkmcnt(0)
    s_lshr_b32 s42, s41, 1
    s_mul_i32 s42, s42, 9216
    s_and_b32 s43, s41, 1
    s_lshl_b32 s43, s43, 11
    s_add_u32 s42, s42, s43
    s_add_u32 s42, s42, 127488
    s_lshl_b32 s42, s38, 6
    s_add_u32 s42, s42, s39
    s_lshr_b32 s43, s41, 1
    s_lshl_b32 s43, s43, 5
    s_add_u32 s42, s42, s43
    s_mul_i32 s42, s42, 9216
    s_add_u32 s42, s42, 4608
    s_add_u32 s82, s36, s42
    s_addc_u32 s83, s37, 0
    s_and_b32 s43, s41, 1
    s_lshl_b32 s43, s43, 11
    v_lshl_add_u32 v13, v1, 4, s43
    v_and_b32_e64 v12, 1, v1
    v_mul_u32_u24 v12, 504, v12
    v_lshl_add_u32 v12, v1, 3, v12
    v_add_u32 v12, s43, v12
    s_barrier
    s_load_dwordx2 s[98:99], s[34:35], 0
    ds_read_b128 v[92:95], v14 offset:0
    ds_read_b128 v[96:99], v14 offset:18432
    ds_read_b128 v[100:103], v15 offset:1024
    ds_read_b128 v[104:107], v15 offset:19456
    ds_read_b128 v[108:111], v14 offset:2048
    ds_read_b128 v[112:115], v14 offset:20480
    ds_read_b128 v[116:119], v15 offset:3072
    ds_read_b128 v[120:123], v15 offset:21504
    ds_read_b64_tr_b16 v[16:17], v48 offset:21504
    ds_read_b64_tr_b16 v[18:19], v48 offset:29184
    ds_read_b128 v[124:127], v14 offset:4096
    ds_read_b128 v[128:131], v14 offset:22528
    ds_read_b128 v[132:135], v15 offset:5120
    ds_read_b128 v[136:139], v15 offset:23552
    ds_read_b128 v[140:143], v14 offset:6144
    ds_read_b128 v[144:147], v14 offset:24576
    ds_read_b128 v[148:151], v15 offset:7168
    ds_read_b128 v[152:155], v15 offset:25600
    ds_read_b128 v[156:159], v14 offset:8192
    ds_read_b128 v[160:163], v14 offset:26624
    ds_read_b64_tr_b16 v[20:21], v53 offset:21504
    ds_read_b64_tr_b16 v[22:23], v53 offset:29184
    ds_read_b128 v[164:167], v15 offset:9216
    ds_read_b128 v[168:171], v15 offset:27648
    ds_read_b128 v[172:175], v14 offset:10240
    ds_read_b128 v[176:179], v14 offset:28672
    ds_read_b128 v[180:183], v15 offset:11264
    ds_read_b128 v[184:187], v15 offset:29696
    ds_read_b128 v[188:191], v14 offset:12288
    ds_read_b128 v[192:195], v14 offset:30720
    ds_read_b128 v[196:199], v15 offset:13312
    ds_read_b128 v[200:203], v15 offset:31744
    ds_read_b64_tr_b16 v[24:25], v53 offset:21544
    ds_read_b64_tr_b16 v[26:27], v53 offset:29224
    v_mfma_f32_16x16x32_bf16 v[56:59], v[16:19], v[92:95], 0
    ds_read_b128 v[204:207], v14 offset:14336
    ds_read_b128 v[208:211], v14 offset:32768
    ds_read_b128 v[212:215], v15 offset:15360
    ds_read_b128 v[216:219], v15 offset:33792
    ds_read_b128 v[220:223], v14 offset:16384
    ds_read_b128 v[224:227], v14 offset:34816
    ds_read_b128 v[228:231], v15 offset:17408
    ds_read_b128 v[232:235], v15 offset:35840
    ds_read_b64_tr_b16 v[28:29], v49 offset:21504
    v_mfma_f32_16x16x32_bf16 v[60:63], v[16:19], v[96:99], 0
    ds_read_b64_tr_b16 v[30:31], v49 offset:29184
    s_waitcnt lgkmcnt(2)
    s_barrier
    s_bitcmp1_b32 s38, 2
    s_cbranch_scc1 LS_odd
    v_mfma_f32_16x16x32_bf16 v[64:67], v[20:23], v[92:95], 0
    ds_read_b64_tr_b16 v[16:17], v48 offset:36864
    v_mfma_f32_16x16x32_bf16 v[68:71], v[20:23], v[96:99], 0
    ds_read_b64_tr_b16 v[18:19], v48 offset:44544
    v_mfma_f32_16x16x32_bf16 v[72:75], v[24:27], v[92:95], 0
    ds_read_b64_tr_b16 v[20:21], v53 offset:36864
    v_mfma_f32_16x16x32_bf16 v[76:79], v[24:27], v[96:99], 0
    ds_read_b64_tr_b16 v[22:23], v53 offset:44544
    s_waitcnt lgkmcnt(4)
    v_mfma_f32_16x16x32_bf16 v[80:83], v[28:31], v[92:95], 0
    ds_read_b64_tr_b16 v[24:25], v53 offset:36904
    v_mfma_f32_16x16x32_bf16 v[84:87], v[28:31], v[96:99], 0
    ds_read_b64_tr_b16 v[26:27], v53 offset:44584
    s_waitcnt lgkmcnt(4)
    v_mfma_f32_16x16x32_bf16 v[56:59], v[16:19], v[100:103], v[56:59]
    ds_read_b64_tr_b16 v[28:29], v49 offset:36864
    v_mfma_f32_16x16x32_bf16 v[60:63], v[16:19], v[104:107], v[60:63]
    ds_read_b64_tr_b16 v[30:31], v49 offset:44544
    s_barrier
    s_waitcnt lgkmcnt(4)
    v_mfma_f32_16x16x32_bf16 v[64:67], v[20:23], v[100:103], v[64:67]
    ds_read_b64_tr_b16 v[16:17], v50 offset:0
    v_mfma_f32_16x16x32_bf16 v[68:71], v[20:23], v[104:107], v[68:71]
    ds_read_b64_tr_b16 v[18:19], v50 offset:7680
    s_waitcnt lgkmcnt(4)
    v_mfma_f32_16x16x32_bf16 v[72:75], v[24:27], v[100:103], v[72:75]
    ds_read_b64_tr_b16 v[20:21], v54 offset:0
    v_mfma_f32_16x16x32_bf16 v[76:79], v[24:27], v[104:107], v[76:79]
    ds_read_b64_tr_b16 v[22:23], v54 offset:7680
    s_waitcnt lgkmcnt(4)
    v_mfma_f32_16x16x32_bf16 v[80:83], v[28:31], v[100:103], v[80:83]
    ds_read_b64_tr_b16 v[24:25], v54 offset:40
    v_mfma_f32_16x16x32_bf16 v[84:87], v[28:31], v[104:107], v[84:87]
    ds_read_b64_tr_b16 v[26:27], v54 offset:7720
    s_waitcnt lgkmcnt(4)
    v_mfma_f32_16x16x32_bf16 v[56:59], v[16:19], v[108:111], v[56:59]
    ds_read_b64_tr_b16 v[28:29], v51 offset:0
    v_mfma_f32_16x16x32_bf16 v[60:63], v[16:19], v[112:115], v[60:63]
    ds_read_b64_tr_b16 v[30:31], v51 offset:7680
    s_barrier
    s_waitcnt lgkmcnt(4)
    v_mfma_f32_16x16x32_bf16 v[64:67], v[20:23], v[108:111], v[64:67]
    ds_read_b64_tr_b16 v[16:17], v50 offset:18432
    v_mfma_f32_16x16x32_bf16 v[68:71], v[20:23], v[112:115], v[68:71]
    ds_read_b64_tr_b16 v[18:19], v50 offset:26112
    s_waitcnt lgkmcnt(4)
    v_mfma_f32_16x16x32_bf16 v[72:75], v[24:27], v[108:111], v[72:75]
    ds_read_b64_tr_b16 v[20:21], v54 offset:18432
    v_mfma_f32_16x16x32_bf16 v[76:79], v[24:27], v[112:115], v[76:79]
    ds_read_b64_tr_b16 v[22:23], v54 offset:26112
    s_waitcnt lgkmcnt(4)
    v_mfma_f32_16x16x32_bf16 v[80:83], v[28:31], v[108:111], v[80:83]
    ds_read_b64_tr_b16 v[24:25], v54 offset:18472
    v_mfma_f32_16x16x32_bf16 v[84:87], v[28:31], v[112:115], v[84:87]
    ds_read_b64_tr_b16 v[26:27], v54 offset:26152
    s_waitcnt lgkmcnt(4)
    v_mfma_f32_16x16x32_bf16 v[56:59], v[16:19], v[116:119], v[56:59]
    ds_read_b64_tr_b16 v[28:29], v51 offset:18432
    v_mfma_f32_16x16x32_bf16 v[60:63], v[16:19], v[120:123], v[60:63]
    ds_read_b64_tr_b16 v[30:31], v51 offset:26112
    s_barrier
    s_waitcnt lgkmcnt(4)
    v_mfma_f32_16x16x32_bf16 v[64:67], v[20:23], v[116:119], v[64:67]
    ds_read_b64_tr_b16 v[16:17], v50 offset:33792
    v_mfma_f32_16x16x32_bf16 v[68:71], v[20:23], v[120:123], v[68:71]
    ds_read_b64_tr_b16 v[18:19], v50 offset:41472
    s_waitcnt lgkmcnt(4)
    v_mfma_f32_16x16x32_bf16 v[72:75], v[24:27], v[116:119], v[72:75]
    ds_read_b64_tr_b16 v[20:21], v54 offset:33792
    v_mfma_f32_16x16x32_bf16 v[76:79], v[24:27], v[120:123], v[76:79]
    ds_read_b64_tr_b16 v[22:23], v54 offset:41472
    s_waitcnt lgkmcnt(4)
    v_mfma_f32_16x16x32_bf16 v[80:83], v[28:31], v[116:119], v[80:83]
    ds_read_b64_tr_b16 v[24:25], v54 offset:33832
    v_mfma_f32_16x16x32_bf16 v[84:87], v[28:31], v[120:123], v[84:87]
    ds_read_b64_tr_b16 v[26:27], v54 offset:41512
    s_waitcnt lgkmcnt(4)
    v_mfma_f32_16x16x32_bf16 v[56:59], v[16:19], v[124:127], v[56:59]
    ds_read_b64_tr_b16 v[28:29], v51 offset:33792
    v_mfma_f32_16x16x32_bf16 v[60:63], v[16:19], v[128:131], v[60:63]
    ds_read_b64_tr_b16 v[30:31], v51 offset:41472
    s_barrier
    s_waitcnt lgkmcnt(4)
    v_mfma_f32_16x16x32_bf16 v[64:67], v[20:23], v[124:127], v[64:67]
    ds_read_b64_tr_b16 v[16:17], v48 offset:0
    v_mfma_f32_16x16x32_bf16 v[68:71], v[20:23], v[128:131], v[68:71]
    ds_read_b64_tr_b16 v[18:19], v48 offset:7680
    s_waitcnt lgkmcnt(4)
    v_mfma_f32_16x16x32_bf16 v[72:75], v[24:27], v[124:127], v[72:75]
    ds_read_b64_tr_b16 v[20:21], v53 offset:0
    v_mfma_f32_16x16x32_bf16 v[76:79], v[24:27], v[128:131], v[76:79]
    ds_read_b64_tr_b16 v[22:23], v53 offset:7680
    s_waitcnt lgkmcnt(4)
    v_mfma_f32_16x16x32_bf16 v[80:83], v[28:31], v[124:127], v[80:83]
    ds_read_b64_tr_b16 v[24:25], v53 offset:40
    v_mfma_f32_16x16x32_bf16 v[84:87], v[28:31], v[128:131], v[84:87]
    ds_read_b64_tr_b16 v[26:27], v53 offset:7720
    s_waitcnt lgkmcnt(4)
    v_mfma_f32_16x16x32_bf16 v[56:59], v[16:19], v[132:135], v[56:59]
    ds_read_b64_tr_b16 v[28:29], v49 offset:0
    v_mfma_f32_16x16x32_bf16 v[60:63], v[16:19], v[136:139], v[60:63]
    ds_read_b64_tr_b16 v[30:31], v49 offset:7680
    s_barrier
    s_waitcnt lgkmcnt(4)
    v_mfma_f32_16x16x32_bf16 v[64:67], v[20:23], v[132:135], v[64:67]
    ds_read_b64_tr_b16 v[16:17], v5 offset:0
    v_mfma_f32_16x16x32_bf16 v[68:71], v[20:23], v[136:139], v[68:71]
    ds_read_b64_tr_b16 v[18:19], v5 offset:7680
    s_waitcnt lgkmcnt(4)
    v_mfma_f32_16x16x32_bf16 v[72:75], v[24:27], v[132:135], v[72:75]
    ds_read_b64_tr_b16 v[20:21], v52 offset:0
    v_mfma_f32_16x16x32_bf16 v[76:79], v[24:27], v[136:139], v[76:79]
    ds_read_b64_tr_b16 v[22:23], v52 offset:7680
    s_waitcnt lgkmcnt(4)
    v_mfma_f32_16x16x32_bf16 v[80:83], v[28:31], v[132:135], v[80:83]
    ds_read_b64_tr_b16 v[24:25], v52 offset:40
    v_mfma_f32_16x16x32_bf16 v[84:87], v[28:31], v[136:139], v[84:87]
    ds_read_b64_tr_b16 v[26:27], v52 offset:7720
    s_waitcnt lgkmcnt(4)
    v_mfma_f32_16x16x32_bf16 v[56:59], v[16:19], v[140:143], v[56:59]
    ds_read_b64_tr_b16 v[28:29], v6 offset:0
    v_mfma_f32_16x16x32_bf16 v[60:63], v[16:19], v[144:147], v[60:63]
    ds_read_b64_tr_b16 v[30:31], v6 offset:7680
    s_barrier
    s_waitcnt lgkmcnt(4)
    v_mfma_f32_16x16x32_bf16 v[64:67], v[20:23], v[140:143], v[64:67]
    ds_read_b64_tr_b16 v[16:17], v5 offset:15360
    v_mfma_f32_16x16x32_bf16 v[68:71], v[20:23], v[144:147], v[68:71]
    ds_read_b64_tr_b16 v[18:19], v5 offset:23040
    s_waitcnt lgkmcnt(4)
    v_mfma_f32_16x16x32_bf16 v[72:75], v[24:27], v[140:143], v[72:75]
    ds_read_b64_tr_b16 v[20:21], v52 offset:15360
    v_mfma_f32_16x16x32_bf16 v[76:79], v[24:27], v[144:147], v[76:79]
    ds_read_b64_tr_b16 v[22:23], v52 offset:23040
    s_waitcnt lgkmcnt(4)
    v_mfma_f32_16x16x32_bf16 v[80:83], v[28:31], v[140:143], v[80:83]
    ds_read_b64_tr_b16 v[24:25], v52 offset:15400
    v_mfma_f32_16x16x32_bf16 v[84:87], v[28:31], v[144:147], v[84:87]
    ds_read_b64_tr_b16 v[26:27], v52 offset:23080
    s_waitcnt lgkmcnt(4)
    v_mfma_f32_16x16x32_bf16 v[56:59], v[16:19], v[148:151], v[56:59]
    ds_read_b64_tr_b16 v[28:29], v6 offset:15360
    v_mfma_f32_16x16x32_bf16 v[60:63], v[16:19], v[152:155], v[60:63]
    ds_read_b64_tr_b16 v[30:31], v6 offset:23040
    s_barrier
    s_waitcnt lgkmcnt(4)
    v_mfma_f32_16x16x32_bf16 v[64:67], v[20:23], v[148:151], v[64:67]
    ds_read_b64_tr_b16 v[16:17], v5 offset:30720
    v_mfma_f32_16x16x32_bf16 v[68:71], v[20:23], v[152:155], v[68:71]
    ds_read_b64_tr_b16 v[18:19], v5 offset:38400
    s_waitcnt lgkmcnt(4)
    v_mfma_f32_16x16x32_bf16 v[72:75], v[24:27], v[148:151], v[72:75]
    ds_read_b64_tr_b16 v[20:21], v52 offset:30720
    v_mfma_f32_16x16x32_bf16 v[76:79], v[24:27], v[152:155], v[76:79]
    ds_read_b64_tr_b16 v[22:23], v52 offset:38400
    s_waitcnt lgkmcnt(4)
    v_mfma_f32_16x16x32_bf16 v[80:83], v[28:31], v[148:151], v[80:83]
    ds_read_b64_tr_b16 v[24:25], v52 offset:30760
    v_mfma_f32_16x16x32_bf16 v[84:87], v[28:31], v[152:155], v[84:87]
    ds_read_b64_tr_b16 v[26:27], v52 offset:38440
    s_waitcnt lgkmcnt(4)
    v_mfma_f32_16x16x32_bf16 v[56:59], v[16:19], v[156:159], v[56:59]
    ds_read_b64_tr_b16 v[28:29], v6 offset:30720
    v_mfma_f32_16x16x32_bf16 v[60:63], v[16:19], v[160:163], v[60:63]
    ds_read_b64_tr_b16 v[30:31], v6 offset:38400
    s_barrier
    s_waitcnt lgkmcnt(4)
    v_mfma_f32_16x16x32_bf16 v[64:67], v[20:23], v[156:159], v[64:67]
    ds_read_b64_tr_b16 v[16:17], v50 offset:18432
    v_mfma_f32_16x16x32_bf16 v[68:71], v[20:23], v[160:163], v[68:71]
    ds_read_b64_tr_b16 v[18:19], v50 offset:26112
    s_waitcnt lgkmcnt(4)
    v_mfma_f32_16x16x32_bf16 v[72:75], v[24:27], v[156:159], v[72:75]
    ds_read_b64_tr_b16 v[20:21], v54 offset:18432
    v_mfma_f32_16x16x32_bf16 v[76:79], v[24:27], v[160:163], v[76:79]
    ds_read_b64_tr_b16 v[22:23], v54 offset:26112
    s_waitcnt lgkmcnt(4)
    v_mfma_f32_16x16x32_bf16 v[80:83], v[28:31], v[156:159], v[80:83]
    ds_read_b64_tr_b16 v[24:25], v54 offset:18472
    v_mfma_f32_16x16x32_bf16 v[84:87], v[28:31], v[160:163], v[84:87]
    ds_read_b64_tr_b16 v[26:27], v54 offset:26152
    s_waitcnt lgkmcnt(4)
    v_mfma_f32_16x16x32_bf16 v[56:59], v[16:19], v[164:167], v[56:59]
    ds_read_b64_tr_b16 v[28:29], v51 offset:18432
    v_mfma_f32_16x16x32_bf16 v[60:63], v[16:19], v[168:171], v[60:63]
    ds_read_b64_tr_b16 v[30:31], v51 offset:26112
    s_barrier
    s_waitcnt lgkmcnt(4)
    v_mfma_f32_16x16x32_bf16 v[64:67], v[20:23], v[164:167], v[64:67]
    ds_read_b64_tr_b16 v[16:17], v50 offset:33792
    v_mfma_f32_16x16x32_bf16 v[68:71], v[20:23], v[168:171], v[68:71]
    ds_read_b64_tr_b16 v[18:19], v50 offset:41472
    s_waitcnt lgkmcnt(4)
    v_mfma_f32_16x16x32_bf16 v[72:75], v[24:27], v[164:167], v[72:75]
    ds_read_b64_tr_b16 v[20:21], v54 offset:33792
    v_mfma_f32_16x16x32_bf16 v[76:79], v[24:27], v[168:171], v[76:79]
    ds_read_b64_tr_b16 v[22:23], v54 offset:41472
    s_waitcnt lgkmcnt(4)
    v_mfma_f32_16x16x32_bf16 v[80:83], v[28:31], v[164:167], v[80:83]
    ds_read_b64_tr_b16 v[24:25], v54 offset:33832
    v_mfma_f32_16x16x32_bf16 v[84:87], v[28:31], v[168:171], v[84:87]
    ds_read_b64_tr_b16 v[26:27], v54 offset:41512
    s_waitcnt lgkmcnt(4)
    v_mfma_f32_16x16x32_bf16 v[56:59], v[16:19], v[172:175], v[56:59]
    ds_read_b64_tr_b16 v[28:29], v51 offset:33792
    v_mfma_f32_16x16x32_bf16 v[60:63], v[16:19], v[176:179], v[60:63]
    ds_read_b64_tr_b16 v[30:31], v51 offset:41472
    s_barrier
    s_waitcnt lgkmcnt(4)
    v_mfma_f32_16x16x32_bf16 v[64:67], v[20:23], v[172:175], v[64:67]
    ds_read_b64_tr_b16 v[16:17], v48 offset:0
    v_mfma_f32_16x16x32_bf16 v[68:71], v[20:23], v[176:179], v[68:71]
    ds_read_b64_tr_b16 v[18:19], v48 offset:7680
    s_waitcnt lgkmcnt(4)
    v_mfma_f32_16x16x32_bf16 v[72:75], v[24:27], v[172:175], v[72:75]
    ds_read_b64_tr_b16 v[20:21], v53 offset:0
    v_mfma_f32_16x16x32_bf16 v[76:79], v[24:27], v[176:179], v[76:79]
    ds_read_b64_tr_b16 v[22:23], v53 offset:7680
    s_waitcnt lgkmcnt(4)
    v_mfma_f32_16x16x32_bf16 v[80:83], v[28:31], v[172:175], v[80:83]
    ds_read_b64_tr_b16 v[24:25], v53 offset:40
    v_mfma_f32_16x16x32_bf16 v[84:87], v[28:31], v[176:179], v[84:87]
    ds_read_b64_tr_b16 v[26:27], v53 offset:7720
    s_waitcnt lgkmcnt(4)
    v_mfma_f32_16x16x32_bf16 v[56:59], v[16:19], v[180:183], v[56:59]
    ds_read_b64_tr_b16 v[28:29], v49 offset:0
    v_mfma_f32_16x16x32_bf16 v[60:63], v[16:19], v[184:187], v[60:63]
    ds_read_b64_tr_b16 v[30:31], v49 offset:7680
    s_barrier
    s_waitcnt lgkmcnt(4)
    v_mfma_f32_16x16x32_bf16 v[64:67], v[20:23], v[180:183], v[64:67]
    ds_read_b64_tr_b16 v[16:17], v5 offset:0
    v_mfma_f32_16x16x32_bf16 v[68:71], v[20:23], v[184:187], v[68:71]
    ds_read_b64_tr_b16 v[18:19], v5 offset:7680
    s_waitcnt lgkmcnt(4)
    v_mfma_f32_16x16x32_bf16 v[72:75], v[24:27], v[180:183], v[72:75]
    ds_read_b64_tr_b16 v[20:21], v52 offset:0
    v_mfma_f32_16x16x32_bf16 v[76:79], v[24:27], v[184:187], v[76:79]
    ds_read_b64_tr_b16 v[22:23], v52 offset:7680
    s_waitcnt lgkmcnt(4)
    v_mfma_f32_16x16x32_bf16 v[80:83], v[28:31], v[180:183], v[80:83]
    ds_read_b64_tr_b16 v[24:25], v52 offset:40
    v_mfma_f32_16x16x32_bf16 v[84:87], v[28:31], v[184:187], v[84:87]
    ds_read_b64_tr_b16 v[26:27], v52 offset:7720
    s_waitcnt lgkmcnt(4)
    v_mfma_f32_16x16x32_bf16 v[56:59], v[16:19], v[188:191], v[56:59]
    ds_read_b64_tr_b16 v[28:29], v6 offset:0
    v_mfma_f32_16x16x32_bf16 v[60:63], v[16:19], v[192:195], v[60:63]
    ds_read_b64_tr_b16 v[30:31], v6 offset:7680
    s_barrier
    s_waitcnt lgkmcnt(4)
    v_mfma_f32_16x16x32_bf16 v[64:67], v[20:23], v[188:191], v[64:67]
    ds_read_b64_tr_b16 v[16:17], v5 offset:15360
    v_mfma_f32_16x16x32_bf16 v[68:71], v[20:23], v[192:195], v[68:71]
    ds_read_b64_tr_b16 v[18:19], v5 offset:23040
    s_waitcnt lgkmcnt(4)
    v_mfma_f32_16x16x32_bf16 v[72:75], v[24:27], v[188:191], v[72:75]
    ds_read_b64_tr_b16 v[20:21], v52 offset:15360
    v_mfma_f32_16x16x32_bf16 v[76:79], v[24:27], v[192:195], v[76:79]
    ds_read_b64_tr_b16 v[22:23], v52 offset:23040
    s_waitcnt lgkmcnt(4)
    v_mfma_f32_16x16x32_bf16 v[80:83], v[28:31], v[188:191], v[80:83]
    ds_read_b64_tr_b16 v[24:25], v52 offset:15400
    v_mfma_f32_16x16x32_bf16 v[84:87], v[28:31], v[192:195], v[84:87]
    ds_read_b64_tr_b16 v[26:27], v52 offset:23080
    s_waitcnt lgkmcnt(4)
    v_mfma_f32_16x16x32_bf16 v[56:59], v[16:19], v[196:199], v[56:59]
    ds_read_b64_tr_b16 v[28:29], v6 offset:15360
    v_mfma_f32_16x16x32_bf16 v[60:63], v[16:19], v[200:203], v[60:63]
    ds_read_b64_tr_b16 v[30:31], v6 offset:23040
    s_barrier
    s_waitcnt lgkmcnt(4)
    v_mfma_f32_16x16x32_bf16 v[64:67], v[20:23], v[196:199], v[64:67]
    ds_read_b64_tr_b16 v[16:17], v5 offset:30720
    v_mfma_f32_16x16x32_bf16 v[68:71], v[20:23], v[200:203], v[68:71]
    ds_read_b64_tr_b16 v[18:19], v5 offset:38400
    s_waitcnt lgkmcnt(4)
    v_mfma_f32_16x16x32_bf16 v[72:75], v[24:27], v[196:199], v[72:75]
    ds_read_b64_tr_b16 v[20:21], v52 offset:30720
    v_mfma_f32_16x16x32_bf16 v[76:79], v[24:27], v[200:203], v[76:79]
    ds_read_b64_tr_b16 v[22:23], v52 offset:38400
    s_waitcnt lgkmcnt(4)
    v_mfma_f32_16x16x32_bf16 v[80:83], v[28:31], v[196:199], v[80:83]
    ds_read_b64_tr_b16 v[24:25], v52 offset:30760
    v_mfma_f32_16x16x32_bf16 v[84:87], v[28:31], v[200:203], v[84:87]
    ds_read_b64_tr_b16 v[26:27], v52 offset:38440
    s_waitcnt lgkmcnt(4)
    v_mfma_f32_16x16x32_bf16 v[56:59], v[16:19], v[204:207], v[56:59]
    ds_read_b64_tr_b16 v[28:29], v6 offset:30720
    v_mfma_f32_16x16x32_bf16 v[60:63], v[16:19], v[208:211], v[60:63]
    ds_read_b64_tr_b16 v[30:31], v6 offset:38400
    s_barrier
    s_waitcnt lgkmcnt(4)
    v_mfma_f32_16x16x32_bf16 v[64:67], v[20:23], v[204:207], v[64:67]
    ds_read_b64_tr_b16 v[16:17], v50 offset:18432
    v_mfma_f32_16x16x32_bf16 v[68:71], v[20:23], v[208:211], v[68:71]
    ds_read_b64_tr_b16 v[18:19], v50 offset:26112
    s_waitcnt lgkmcnt(4)
    v_mfma_f32_16x16x32_bf16 v[72:75], v[24:27], v[204:207], v[72:75]
    ds_read_b64_tr_b16 v[20:21], v54 offset:18432
    v_mfma_f32_16x16x32_bf16 v[76:79], v[24:27], v[208:211], v[76:79]
    ds_read_b64_tr_b16 v[22:23], v54 offset:26112
    s_waitcnt lgkmcnt(4)
    v_mfma_f32_16x16x32_bf16 v[80:83], v[28:31], v[204:207], v[80:83]
    ds_read_b64_tr_b16 v[24:25], v54 offset:18472
    v_mfma_f32_16x16x32_bf16 v[84:87], v[28:31], v[208:211], v[84:87]
    ds_read_b64_tr_b16 v[26:27], v54 offset:26152
    s_waitcnt lgkmcnt(4)
    v_mfma_f32_16x16x32_bf16 v[56:59], v[16:19], v[212:215], v[56:59]
    ds_read_b64_tr_b16 v[28:29], v51 offset:18432
    v_mfma_f32_16x16x32_bf16 v[60:63], v[16:19], v[216:219], v[60:63]
    ds_read_b64_tr_b16 v[30:31], v51 offset:26112
    s_barrier
    s_waitcnt lgkmcnt(4)
    v_mfma_f32_16x16x32_bf16 v[64:67], v[20:23], v[212:215], v[64:67]
    ds_read_b64_tr_b16 v[16:17], v50 offset:33792
    v_mfma_f32_16x16x32_bf16 v[68:71], v[20:23], v[216:219], v[68:71]
    ds_read_b64_tr_b16 v[18:19], v50 offset:41472
    s_waitcnt lgkmcnt(4)
    v_mfma_f32_16x16x32_bf16 v[72:75], v[24:27], v[212:215], v[72:75]
    ds_read_b64_tr_b16 v[20:21], v54 offset:33792
    v_mfma_f32_16x16x32_bf16 v[76:79], v[24:27], v[216:219], v[76:79]
    ds_read_b64_tr_b16 v[22:23], v54 offset:41472
    s_waitcnt lgkmcnt(4)
    v_mfma_f32_16x16x32_bf16 v[80:83], v[28:31], v[212:215], v[80:83]
    ds_read_b64_tr_b16 v[24:25], v54 offset:33832
    v_mfma_f32_16x16x32_bf16 v[84:87], v[28:31], v[216:219], v[84:87]
    ds_read_b64_tr_b16 v[26:27], v54 offset:41512
    s_waitcnt lgkmcnt(4)
    v_mfma_f32_16x16x32_bf16 v[56:59], v[16:19], v[220:223], v[56:59]
    ds_read_b64_tr_b16 v[28:29], v51 offset:33792
    v_mfma_f32_16x16x32_bf16 v[60:63], v[16:19], v[224:227], v[60:63]
    ds_read_b64_tr_b16 v[30:31], v51 offset:41472
    s_barrier
    s_waitcnt lgkmcnt(4)
    v_mfma_f32_16x16x32_bf16 v[64:67], v[20:23], v[220:223], v[64:67]
    ds_read_b64_tr_b16 v[16:17], v48 offset:0
    v_mfma_f32_16x16x32_bf16 v[68:71], v[20:23], v[224:227], v[68:71]
    ds_read_b64_tr_b16 v[18:19], v48 offset:7680
    s_waitcnt lgkmcnt(4)
    v_mfma_f32_16x16x32_bf16 v[72:75], v[24:27], v[220:223], v[72:75]
    ds_read_b64_tr_b16 v[20:21], v53 offset:0
    v_mfma_f32_16x16x32_bf16 v[76:79], v[24:27], v[224:227], v[76:79]
    ds_read_b64_tr_b16 v[22:23], v53 offset:7680
    s_waitcnt lgkmcnt(4)
    v_mfma_f32_16x16x32_bf16 v[80:83], v[28:31], v[220:223], v[80:83]
    ds_read_b64_tr_b16 v[24:25], v53 offset:40
    v_mfma_f32_16x16x32_bf16 v[84:87], v[28:31], v[224:227], v[84:87]
    ds_read_b64_tr_b16 v[26:27], v53 offset:7720
    s_waitcnt lgkmcnt(4)
    v_mfma_f32_16x16x32_bf16 v[56:59], v[16:19], v[228:231], v[56:59]
    ds_read_b64_tr_b16 v[28:29], v49 offset:0
    v_mfma_f32_16x16x32_bf16 v[60:63], v[16:19], v[232:235], v[60:63]
    ds_read_b64_tr_b16 v[30:31], v49 offset:7680
    s_barrier
    s_waitcnt lgkmcnt(4)
    v_mfma_f32_16x16x32_bf16 v[64:67], v[20:23], v[228:231], v[64:67]
    ds_read_b64_tr_b16 v[16:17], v3 offset:24576
    v_mfma_f32_16x16x32_bf16 v[68:71], v[20:23], v[232:235], v[68:71]
    ds_read_b64_tr_b16 v[18:19], v3 offset:26624
    s_waitcnt lgkmcnt(4)
    v_mfma_f32_16x16x32_bf16 v[72:75], v[24:27], v[228:231], v[72:75]
    ds_read_b64_tr_b16 v[20:21], v3 offset:28672
    v_mfma_f32_16x16x32_bf16 v[76:79], v[24:27], v[232:235], v[76:79]
    ds_read_b64_tr_b16 v[22:23], v3 offset:30720
    s_waitcnt lgkmcnt(4)
    v_mfma_f32_16x16x32_bf16 v[80:83], v[28:31], v[228:231], v[80:83]
    ds_read_b64_tr_b16 v[24:25], v3 offset:32768
    v_mfma_f32_16x16x32_bf16 v[84:87], v[28:31], v[232:235], v[84:87]
    ds_read_b64_tr_b16 v[26:27], v3 offset:34816
    s_waitcnt lgkmcnt(4)
    v_mfma_f32_16x16x32_bf16 v[32:35], v[16:19], v[92:95], 0
    ds_read_b64_tr_b16 v[28:29], v3 offset:36864
    v_mfma_f32_16x16x32_bf16 v[36:39], v[16:19], v[96:99], 0
    ds_read_b64_tr_b16 v[30:31], v3 offset:38912
    s_waitcnt lgkmcnt(4)
    v_mfma_f32_16x16x32_bf16 v[32:35], v[20:23], v[100:103], v[32:35]
    ds_read_b64_tr_b16 v[16:17], v3 offset:40960
    v_mfma_f32_16x16x32_bf16 v[36:39], v[20:23], v[104:107], v[36:39]
    ds_read_b64_tr_b16 v[18:19], v3 offset:43008
    s_waitcnt lgkmcnt(4)
    v_mfma_f32_16x16x32_bf16 v[32:35], v[24:27], v[108:111], v[32:35]
    ds_read_b64_tr_b16 v[20:21], v3 offset:45056
    v_cvt_pk_bf16_f32 v236, v64, v65
    v_mfma_f32_16x16x32_bf16 v[36:39], v[24:27], v[112:115], v[36:39]
    ds_read_b64_tr_b16 v[22:23], v3 offset:47104
    v_cvt_pk_bf16_f32 v237, v66, v67
    s_barrier
    s_waitcnt lgkmcnt(4)
    v_mfma_f32_16x16x32_bf16 v[32:35], v[28:31], v[116:119], v[32:35]
    ds_read_b64_tr_b16 v[24:25], v4 offset:0
    v_cvt_pk_bf16_f32 v238, v68, v69
    v_mfma_f32_16x16x32_bf16 v[36:39], v[28:31], v[120:123], v[36:39]
    ds_read_b64_tr_b16 v[26:27], v4 offset:2048
    v_cvt_pk_bf16_f32 v239, v70, v71
    s_waitcnt lgkmcnt(4)
    v_mfma_f32_16x16x32_bf16 v[32:35], v[16:19], v[124:127], v[32:35]
    ds_read_b64_tr_b16 v[28:29], v4 offset:4096
    v_mfma_f32_16x16x32_bf16 v[36:39], v[16:19], v[128:131], v[36:39]
    ds_read_b64_tr_b16 v[30:31], v4 offset:6144
    s_mov_b32 vcc_lo, 0x55555555
    s_mov_b32 vcc_hi, 0x55555555
    v_cndmask_b32_dpp v248, v238, v236, vcc quad_perm:[1,0,3,2] row_mask:0xf bank_mask:0xf
    v_cndmask_b32_dpp v249, v239, v237, vcc quad_perm:[1,0,3,2] row_mask:0xf bank_mask:0xf
    s_not_b64 vcc, vcc
    v_cndmask_b32_dpp v250, v236, v238, vcc quad_perm:[1,0,3,2] row_mask:0xf bank_mask:0xf
    v_cndmask_b32_dpp v251, v237, v239, vcc quad_perm:[1,0,3,2] row_mask:0xf bank_mask:0xf
    global_store_dwordx4 v12, v[248:251], s[82:83] offset:0 sc1
    s_waitcnt lgkmcnt(4)
    v_mfma_f32_16x16x32_bf16 v[32:35], v[20:23], v[132:135], v[32:35]
    ds_read_b64_tr_b16 v[16:17], v4 offset:8192
    v_cvt_pk_bf16_f32 v240, v72, v73
    v_mfma_f32_16x16x32_bf16 v[36:39], v[20:23], v[136:139], v[36:39]
    ds_read_b64_tr_b16 v[18:19], v4 offset:10240
    v_cvt_pk_bf16_f32 v241, v74, v75
    s_waitcnt lgkmcnt(4)
    v_mfma_f32_16x16x32_bf16 v[32:35], v[24:27], v[140:143], v[32:35]
    ds_read_b64_tr_b16 v[20:21], v4 offset:12288
    v_cvt_pk_bf16_f32 v242, v76, v77
    v_mfma_f32_16x16x32_bf16 v[36:39], v[24:27], v[144:147], v[36:39]
    ds_read_b64_tr_b16 v[22:23], v4 offset:14336
    v_cvt_pk_bf16_f32 v243, v78, v79
    s_waitcnt lgkmcnt(4)
    v_mfma_f32_16x16x32_bf16 v[32:35], v[28:31], v[148:151], v[32:35]
    ds_read_b64_tr_b16 v[24:25], v4 offset:16384
    v_mfma_f32_16x16x32_bf16 v[36:39], v[28:31], v[152:155], v[36:39]
    ds_read_b64_tr_b16 v[26:27], v4 offset:18432
    s_mov_b32 vcc_lo, 0x55555555
    s_mov_b32 vcc_hi, 0x55555555
    v_cndmask_b32_dpp v248, v242, v240, vcc quad_perm:[1,0,3,2] row_mask:0xf bank_mask:0xf
    v_cndmask_b32_dpp v249, v243, v241, vcc quad_perm:[1,0,3,2] row_mask:0xf bank_mask:0xf
    s_not_b64 vcc, vcc
    v_cndmask_b32_dpp v250, v240, v242, vcc quad_perm:[1,0,3,2] row_mask:0xf bank_mask:0xf
    v_cndmask_b32_dpp v251, v241, v243, vcc quad_perm:[1,0,3,2] row_mask:0xf bank_mask:0xf
    global_store_dwordx4 v12, v[248:251], s[82:83] offset:1024 sc1
    s_waitcnt lgkmcnt(4)
    v_mfma_f32_16x16x32_bf16 v[32:35], v[16:19], v[156:159], v[32:35]
    ds_read_b64_tr_b16 v[28:29], v4 offset:20480
    v_cvt_pk_bf16_f32 v252, v80, v81
    v_mfma_f32_16x16x32_bf16 v[36:39], v[16:19], v[160:163], v[36:39]
    ds_read_b64_tr_b16 v[30:31], v4 offset:22528
    v_cvt_pk_bf16_f32 v253, v82, v83
    v_cvt_pk_bf16_f32 v254, v84, v85
    v_cvt_pk_bf16_f32 v255, v86, v87
    s_and_b32 s42, s41, 1
    s_lshl_b32 s42, s42, 8
    s_add_u32 s42, s42, 3968
    s_lshl_b32 s43, s40, 8
    s_add_u32 s43, s43, 141312
    v_lshl_add_u32 v15, v1, 3, s43
    v_lshl_add_u32 v14, v1, 3, s42
    s_mov_b64 exec, 0xffff
    ds_write_b64 v15, v[252:253] offset:0
    ds_write_b64 v15, v[254:255] offset:128
    s_mov_b64 exec, 0xffff0000
    global_store_dwordx2 v14, v[252:253], s[82:83] offset:0 sc1
    global_store_dwordx2 v14, v[254:255], s[82:83] offset:128 sc1
    s_branch LS_join
LS_odd:
    v_mfma_f32_16x16x32_bf16 v[64:67], v[92:95], v[20:23], 0
    ds_read_b64_tr_b16 v[16:17], v48 offset:36864
    v_mfma_f32_16x16x32_bf16 v[68:71], v[96:99], v[20:23], 0
    ds_read_b64_tr_b16 v[18:19], v48 offset:44544
    v_mfma_f32_16x16x32_bf16 v[72:75], v[92:95], v[24:27], 0
    ds_read_b64_tr_b16 v[20:21], v53 offset:36864
    v_mfma_f32_16x16x32_bf16 v[76:79], v[96:99], v[24:27], 0
    ds_read_b64_tr_b16 v[22:23], v53 offset:44544
    s_waitcnt lgkmcnt(4)
    v_mfma_f32_16x16x32_bf16 v[80:83], v[92:95], v[28:31], 0
    ds_read_b64_tr_b16 v[24:25], v53 offset:36904
    v_mfma_f32_16x16x32_bf16 v[84:87], v[96:99], v[28:31], 0
    ds_read_b64_tr_b16 v[26:27], v53 offset:44584
    s_waitcnt lgkmcnt(4)
    v_mfma_f32_16x16x32_bf16 v[56:59], v[16:19], v[100:103], v[56:59]
    ds_read_b64_tr_b16 v[28:29], v49 offset:36864
    v_mfma_f32_16x16x32_bf16 v[60:63], v[16:19], v[104:107], v[60:63]
    ds_read_b64_tr_b16 v[30:31], v49 offset:44544
    s_barrier
    s_waitcnt lgkmcnt(4)
    v_mfma_f32_16x16x32_bf16 v[64:67], v[100:103], v[20:23], v[64:67]
    ds_read_b64_tr_b16 v[16:17], v50 offset:0
    v_mfma_f32_16x16x32_bf16 v[68:71], v[104:107], v[20:23], v[68:71]
    ds_read_b64_tr_b16 v[18:19], v50 offset:7680
    s_waitcnt lgkmcnt(4)
    v_mfma_f32_16x16x32_bf16 v[72:75], v[100:103], v[24:27], v[72:75]
    ds_read_b64_tr_b16 v[20:21], v54 offset:0
    v_mfma_f32_16x16x32_bf16 v[76:79], v[104:107], v[24:27], v[76:79]
    ds_read_b64_tr_b16 v[22:23], v54 offset:7680
    s_waitcnt lgkmcnt(4)
    v_mfma_f32_16x16x32_bf16 v[80:83], v[100:103], v[28:31], v[80:83]
    ds_read_b64_tr_b16 v[24:25], v54 offset:40
    v_mfma_f32_16x16x32_bf16 v[84:87], v[104:107], v[28:31], v[84:87]
    ds_read_b64_tr_b16 v[26:27], v54 offset:7720
    s_waitcnt lgkmcnt(4)
    v_mfma_f32_16x16x32_bf16 v[56:59], v[16:19], v[108:111], v[56:59]
    ds_read_b64_tr_b16 v[28:29], v51 offset:0
    v_mfma_f32_16x16x32_bf16 v[60:63], v[16:19], v[112:115], v[60:63]
    ds_read_b64_tr_b16 v[30:31], v51 offset:7680
    s_barrier
    s_waitcnt lgkmcnt(4)
    v_mfma_f32_16x16x32_bf16 v[64:67], v[108:111], v[20:23], v[64:67]
    ds_read_b64_tr_b16 v[16:17], v50 offset:18432
    v_mfma_f32_16x16x32_bf16 v[68:71], v[112:115], v[20:23], v[68:71]
    ds_read_b64_tr_b16 v[18:19], v50 offset:26112
    s_waitcnt lgkmcnt(4)
    v_mfma_f32_16x16x32_bf16 v[72:75], v[108:111], v[24:27], v[72:75]
    ds_read_b64_tr_b16 v[20:21], v54 offset:18432
    v_mfma_f32_16x16x32_bf16 v[76:79], v[112:115], v[24:27], v[76:79]
    ds_read_b64_tr_b16 v[22:23], v54 offset:26112
    s_waitcnt lgkmcnt(4)
    v_mfma_f32_16x16x32_bf16 v[80:83], v[108:111], v[28:31], v[80:83]
    ds_read_b64_tr_b16 v[24:25], v54 offset:18472
    v_mfma_f32_16x16x32_bf16 v[84:87], v[112:115], v[28:31], v[84:87]
    ds_read_b64_tr_b16 v[26:27], v54 offset:26152
    s_waitcnt lgkmcnt(4)
    v_mfma_f32_16x16x32_bf16 v[56:59], v[16:19], v[116:119], v[56:59]
    ds_read_b64_tr_b16 v[28:29], v51 offset:18432
    v_mfma_f32_16x16x32_bf16 v[60:63], v[16:19], v[120:123], v[60:63]
    ds_read_b64_tr_b16 v[30:31], v51 offset:26112
    s_barrier
    s_waitcnt lgkmcnt(4)
    v_mfma_f32_16x16x32_bf16 v[64:67], v[116:119], v[20:23], v[64:67]
    ds_read_b64_tr_b16 v[16:17], v50 offset:33792
    v_mfma_f32_16x16x32_bf16 v[68:71], v[120:123], v[20:23], v[68:71]
    ds_read_b64_tr_b16 v[18:19], v50 offset:41472
    s_waitcnt lgkmcnt(4)
    v_mfma_f32_16x16x32_bf16 v[72:75], v[116:119], v[24:27], v[72:75]
    ds_read_b64_tr_b16 v[20:21], v54 offset:33792
    v_mfma_f32_16x16x32_bf16 v[76:79], v[120:123], v[24:27], v[76:79]
    ds_read_b64_tr_b16 v[22:23], v54 offset:41472
    s_waitcnt lgkmcnt(4)
    v_mfma_f32_16x16x32_bf16 v[80:83], v[116:119], v[28:31], v[80:83]
    ds_read_b64_tr_b16 v[24:25], v54 offset:33832
    v_mfma_f32_16x16x32_bf16 v[84:87], v[120:123], v[28:31], v[84:87]
    ds_read_b64_tr_b16 v[26:27], v54 offset:41512
    s_waitcnt lgkmcnt(4)
    v_mfma_f32_16x16x32_bf16 v[56:59], v[16:19], v[124:127], v[56:59]
    ds_read_b64_tr_b16 v[28:29], v51 offset:33792
    v_mfma_f32_16x16x32_bf16 v[60:63], v[16:19], v[128:131], v[60:63]
    ds_read_b64_tr_b16 v[30:31], v51 offset:41472
    s_barrier
    s_waitcnt lgkmcnt(4)
    v_mfma_f32_16x16x32_bf16 v[64:67], v[124:127], v[20:23], v[64:67]
    ds_read_b64_tr_b16 v[16:17], v48 offset:0
    v_mfma_f32_16x16x32_bf16 v[68:71], v[128:131], v[20:23], v[68:71]
    ds_read_b64_tr_b16 v[18:19], v48 offset:7680
    s_waitcnt lgkmcnt(4)
    v_mfma_f32_16x16x32_bf16 v[72:75], v[124:127], v[24:27], v[72:75]
    ds_read_b64_tr_b16 v[20:21], v53 offset:0
    v_mfma_f32_16x16x32_bf16 v[76:79], v[128:131], v[24:27], v[76:79]
    ds_read_b64_tr_b16 v[22:23], v53 offset:7680
    s_waitcnt lgkmcnt(4)
    v_mfma_f32_16x16x32_bf16 v[80:83], v[124:127], v[28:31], v[80:83]
    ds_read_b64_tr_b16 v[24:25], v53 offset:40
    v_mfma_f32_16x16x32_bf16 v[84:87], v[128:131], v[28:31], v[84:87]
    ds_read_b64_tr_b16 v[26:27], v53 offset:7720
    s_waitcnt lgkmcnt(4)
    v_mfma_f32_16x16x32_bf16 v[56:59], v[16:19], v[132:135], v[56:59]
    ds_read_b64_tr_b16 v[28:29], v49 offset:0
    v_mfma_f32_16x16x32_bf16 v[60:63], v[16:19], v[136:139], v[60:63]
    ds_read_b64_tr_b16 v[30:31], v49 offset:7680
    s_barrier
    s_waitcnt lgkmcnt(4)
    v_mfma_f32_16x16x32_bf16 v[64:67], v[132:135], v[20:23], v[64:67]
    ds_read_b64_tr_b16 v[16:17], v5 offset:0
    v_mfma_f32_16x16x32_bf16 v[68:71], v[136:139], v[20:23], v[68:71]
    ds_read_b64_tr_b16 v[18:19], v5 offset:7680
    s_waitcnt lgkmcnt(4)
    v_mfma_f32_16x16x32_bf16 v[72:75], v[132:135], v[24:27], v[72:75]
    ds_read_b64_tr_b16 v[20:21], v52 offset:0
    v_mfma_f32_16x16x32_bf16 v[76:79], v[136:139], v[24:27], v[76:79]
    ds_read_b64_tr_b16 v[22:23], v52 offset:7680
    s_waitcnt lgkmcnt(4)
    v_mfma_f32_16x16x32_bf16 v[80:83], v[132:135], v[28:31], v[80:83]
    ds_read_b64_tr_b16 v[24:25], v52 offset:40
    v_mfma_f32_16x16x32_bf16 v[84:87], v[136:139], v[28:31], v[84:87]
    ds_read_b64_tr_b16 v[26:27], v52 offset:7720
    s_waitcnt lgkmcnt(4)
    v_mfma_f32_16x16x32_bf16 v[56:59], v[16:19], v[140:143], v[56:59]
    ds_read_b64_tr_b16 v[28:29], v6 offset:0
    v_mfma_f32_16x16x32_bf16 v[60:63], v[16:19], v[144:147], v[60:63]
    ds_read_b64_tr_b16 v[30:31], v6 offset:7680
    s_barrier
    s_waitcnt lgkmcnt(4)
    v_mfma_f32_16x16x32_bf16 v[64:67], v[140:143], v[20:23], v[64:67]
    ds_read_b64_tr_b16 v[16:17], v5 offset:15360
    v_mfma_f32_16x16x32_bf16 v[68:71], v[144:147], v[20:23], v[68:71]
    ds_read_b64_tr_b16 v[18:19], v5 offset:23040
    s_waitcnt lgkmcnt(4)
    v_mfma_f32_16x16x32_bf16 v[72:75], v[140:143], v[24:27], v[72:75]
    ds_read_b64_tr_b16 v[20:21], v52 offset:15360
    v_mfma_f32_16x16x32_bf16 v[76:79], v[144:147], v[24:27], v[76:79]
    ds_read_b64_tr_b16 v[22:23], v52 offset:23040
    s_waitcnt lgkmcnt(4)
    v_mfma_f32_16x16x32_bf16 v[80:83], v[140:143], v[28:31], v[80:83]
    ds_read_b64_tr_b16 v[24:25], v52 offset:15400
    v_mfma_f32_16x16x32_bf16 v[84:87], v[144:147], v[28:31], v[84:87]
    ds_read_b64_tr_b16 v[26:27], v52 offset:23080
    s_waitcnt lgkmcnt(4)
    v_mfma_f32_16x16x32_bf16 v[56:59], v[16:19], v[148:151], v[56:59]
    ds_read_b64_tr_b16 v[28:29], v6 offset:15360
    v_mfma_f32_16x16x32_bf16 v[60:63], v[16:19], v[152:155], v[60:63]
    ds_read_b64_tr_b16 v[30:31], v6 offset:23040
    s_barrier
    s_waitcnt lgkmcnt(4)
    v_mfma_f32_16x16x32_bf16 v[64:67], v[148:151], v[20:23], v[64:67]
    ds_read_b64_tr_b16 v[16:17], v5 offset:30720
    v_mfma_f32_16x16x32_bf16 v[68:71], v[152:155], v[20:23], v[68:71]
    ds_read_b64_tr_b16 v[18:19], v5 offset:38400
    s_waitcnt lgkmcnt(4)
    v_mfma_f32_16x16x32_bf16 v[72:75], v[148:151], v[24:27], v[72:75]
    ds_read_b64_tr_b16 v[20:21], v52 offset:30720
    v_mfma_f32_16x16x32_bf16 v[76:79], v[152:155], v[24:27], v[76:79]
    ds_read_b64_tr_b16 v[22:23], v52 offset:38400
    s_waitcnt lgkmcnt(4)
    v_mfma_f32_16x16x32_bf16 v[80:83], v[148:151], v[28:31], v[80:83]
    ds_read_b64_tr_b16 v[24:25], v52 offset:30760
    v_mfma_f32_16x16x32_bf16 v[84:87], v[152:155], v[28:31], v[84:87]
    ds_read_b64_tr_b16 v[26:27], v52 offset:38440
    s_waitcnt lgkmcnt(4)
    v_mfma_f32_16x16x32_bf16 v[56:59], v[16:19], v[156:159], v[56:59]
    ds_read_b64_tr_b16 v[28:29], v6 offset:30720
    v_mfma_f32_16x16x32_bf16 v[60:63], v[16:19], v[160:163], v[60:63]
    ds_read_b64_tr_b16 v[30:31], v6 offset:38400
    s_barrier
    s_waitcnt lgkmcnt(4)
    v_mfma_f32_16x16x32_bf16 v[64:67], v[156:159], v[20:23], v[64:67]
    ds_read_b64_tr_b16 v[16:17], v50 offset:18432
    v_mfma_f32_16x16x32_bf16 v[68:71], v[160:163], v[20:23], v[68:71]
    ds_read_b64_tr_b16 v[18:19], v50 offset:26112
    s_waitcnt lgkmcnt(4)
    v_mfma_f32_16x16x32_bf16 v[72:75], v[156:159], v[24:27], v[72:75]
    ds_read_b64_tr_b16 v[20:21], v54 offset:18432
    v_mfma_f32_16x16x32_bf16 v[76:79], v[160:163], v[24:27], v[76:79]
    ds_read_b64_tr_b16 v[22:23], v54 offset:26112
    s_waitcnt lgkmcnt(4)
    v_mfma_f32_16x16x32_bf16 v[80:83], v[156:159], v[28:31], v[80:83]
    ds_read_b64_tr_b16 v[24:25], v54 offset:18472
    v_mfma_f32_16x16x32_bf16 v[84:87], v[160:163], v[28:31], v[84:87]
    ds_read_b64_tr_b16 v[26:27], v54 offset:26152
    s_waitcnt lgkmcnt(4)
    v_mfma_f32_16x16x32_bf16 v[56:59], v[16:19], v[164:167], v[56:59]
    ds_read_b64_tr_b16 v[28:29], v51 offset:18432
    v_mfma_f32_16x16x32_bf16 v[60:63], v[16:19], v[168:171], v[60:63]
    ds_read_b64_tr_b16 v[30:31], v51 offset:26112
    s_barrier
    s_waitcnt lgkmcnt(4)
    v_mfma_f32_16x16x32_bf16 v[64:67], v[164:167], v[20:23], v[64:67]
    ds_read_b64_tr_b16 v[16:17], v50 offset:33792
    v_mfma_f32_16x16x32_bf16 v[68:71], v[168:171], v[20:23], v[68:71]
    ds_read_b64_tr_b16 v[18:19], v50 offset:41472
    s_waitcnt lgkmcnt(4)
    v_mfma_f32_16x16x32_bf16 v[72:75], v[164:167], v[24:27], v[72:75]
    ds_read_b64_tr_b16 v[20:21], v54 offset:33792
    v_mfma_f32_16x16x32_bf16 v[76:79], v[168:171], v[24:27], v[76:79]
    ds_read_b64_tr_b16 v[22:23], v54 offset:41472
    s_waitcnt lgkmcnt(4)
    v_mfma_f32_16x16x32_bf16 v[80:83], v[164:167], v[28:31], v[80:83]
    ds_read_b64_tr_b16 v[24:25], v54 offset:33832
    v_mfma_f32_16x16x32_bf16 v[84:87], v[168:171], v[28:31], v[84:87]
    ds_read_b64_tr_b16 v[26:27], v54 offset:41512
    s_waitcnt lgkmcnt(4)
    v_mfma_f32_16x16x32_bf16 v[56:59], v[16:19], v[172:175], v[56:59]
    ds_read_b64_tr_b16 v[28:29], v51 offset:33792
    v_mfma_f32_16x16x32_bf16 v[60:63], v[16:19], v[176:179], v[60:63]
    ds_read_b64_tr_b16 v[30:31], v51 offset:41472
    s_barrier
    s_waitcnt lgkmcnt(4)
    v_mfma_f32_16x16x32_bf16 v[64:67], v[172:175], v[20:23], v[64:67]
    ds_read_b64_tr_b16 v[16:17], v48 offset:0
    v_mfma_f32_16x16x32_bf16 v[68:71], v[176:179], v[20:23], v[68:71]
    ds_read_b64_tr_b16 v[18:19], v48 offset:7680
    s_waitcnt lgkmcnt(4)
    v_mfma_f32_16x16x32_bf16 v[72:75], v[172:175], v[24:27], v[72:75]
    ds_read_b64_tr_b16 v[20:21], v53 offset:0
    v_mfma_f32_16x16x32_bf16 v[76:79], v[176:179], v[24:27], v[76:79]
    ds_read_b64_tr_b16 v[22:23], v53 offset:7680
    s_waitcnt lgkmcnt(4)
    v_mfma_f32_16x16x32_bf16 v[80:83], v[172:175], v[28:31], v[80:83]
    ds_read_b64_tr_b16 v[24:25], v53 offset:40
    v_mfma_f32_16x16x32_bf16 v[84:87], v[176:179], v[28:31], v[84:87]
    ds_read_b64_tr_b16 v[26:27], v53 offset:7720
    s_waitcnt lgkmcnt(4)
    v_mfma_f32_16x16x32_bf16 v[56:59], v[16:19], v[180:183], v[56:59]
    ds_read_b64_tr_b16 v[28:29], v49 offset:0
    v_mfma_f32_16x16x32_bf16 v[60:63], v[16:19], v[184:187], v[60:63]
    ds_read_b64_tr_b16 v[30:31], v49 offset:7680
    s_barrier
    s_waitcnt lgkmcnt(4)
    v_mfma_f32_16x16x32_bf16 v[64:67], v[180:183], v[20:23], v[64:67]
    ds_read_b64_tr_b16 v[16:17], v5 offset:0
    v_mfma_f32_16x16x32_bf16 v[68:71], v[184:187], v[20:23], v[68:71]
    ds_read_b64_tr_b16 v[18:19], v5 offset:7680
    s_waitcnt lgkmcnt(4)
    v_mfma_f32_16x16x32_bf16 v[72:75], v[180:183], v[24:27], v[72:75]
    ds_read_b64_tr_b16 v[20:21], v52 offset:0
    v_mfma_f32_16x16x32_bf16 v[76:79], v[184:187], v[24:27], v[76:79]
    ds_read_b64_tr_b16 v[22:23], v52 offset:7680
    s_waitcnt lgkmcnt(4)
    v_mfma_f32_16x16x32_bf16 v[80:83], v[180:183], v[28:31], v[80:83]
    ds_read_b64_tr_b16 v[24:25], v52 offset:40
    v_mfma_f32_16x16x32_bf16 v[84:87], v[184:187], v[28:31], v[84:87]
    ds_read_b64_tr_b16 v[26:27], v52 offset:7720
    s_waitcnt lgkmcnt(4)
    v_mfma_f32_16x16x32_bf16 v[56:59], v[16:19], v[188:191], v[56:59]
    ds_read_b64_tr_b16 v[28:29], v6 offset:0
    v_mfma_f32_16x16x32_bf16 v[60:63], v[16:19], v[192:195], v[60:63]
    ds_read_b64_tr_b16 v[30:31], v6 offset:7680
    s_barrier
    s_waitcnt lgkmcnt(4)
    v_mfma_f32_16x16x32_bf16 v[64:67], v[188:191], v[20:23], v[64:67]
    ds_read_b64_tr_b16 v[16:17], v5 offset:15360
    v_mfma_f32_16x16x32_bf16 v[68:71], v[192:195], v[20:23], v[68:71]
    ds_read_b64_tr_b16 v[18:19], v5 offset:23040
    s_waitcnt lgkmcnt(4)
    v_mfma_f32_16x16x32_bf16 v[72:75], v[188:191], v[24:27], v[72:75]
    ds_read_b64_tr_b16 v[20:21], v52 offset:15360
    v_mfma_f32_16x16x32_bf16 v[76:79], v[192:195], v[24:27], v[76:79]
    ds_read_b64_tr_b16 v[22:23], v52 offset:23040
    s_waitcnt lgkmcnt(4)
    v_mfma_f32_16x16x32_bf16 v[80:83], v[188:191], v[28:31], v[80:83]
    ds_read_b64_tr_b16 v[24:25], v52 offset:15400
    v_mfma_f32_16x16x32_bf16 v[84:87], v[192:195], v[28:31], v[84:87]
    ds_read_b64_tr_b16 v[26:27], v52 offset:23080
    s_waitcnt lgkmcnt(4)
    v_mfma_f32_16x16x32_bf16 v[56:59], v[16:19], v[196:199], v[56:59]
    ds_read_b64_tr_b16 v[28:29], v6 offset:15360
    v_mfma_f32_16x16x32_bf16 v[60:63], v[16:19], v[200:203], v[60:63]
    ds_read_b64_tr_b16 v[30:31], v6 offset:23040
    s_barrier
    s_waitcnt lgkmcnt(4)
    v_mfma_f32_16x16x32_bf16 v[64:67], v[196:199], v[20:23], v[64:67]
    ds_read_b64_tr_b16 v[16:17], v5 offset:30720
    v_mfma_f32_16x16x32_bf16 v[68:71], v[200:203], v[20:23], v[68:71]
    ds_read_b64_tr_b16 v[18:19], v5 offset:38400
    s_waitcnt lgkmcnt(4)
    v_mfma_f32_16x16x32_bf16 v[72:75], v[196:199], v[24:27], v[72:75]
    ds_read_b64_tr_b16 v[20:21], v52 offset:30720
    v_mfma_f32_16x16x32_bf16 v[76:79], v[200:203], v[24:27], v[76:79]
    ds_read_b64_tr_b16 v[22:23], v52 offset:38400
    s_waitcnt lgkmcnt(4)
    v_mfma_f32_16x16x32_bf16 v[80:83], v[196:199], v[28:31], v[80:83]
    ds_read_b64_tr_b16 v[24:25], v52 offset:30760
    v_mfma_f32_16x16x32_bf16 v[84:87], v[200:203], v[28:31], v[84:87]
    ds_read_b64_tr_b16 v[26:27], v52 offset:38440
    s_waitcnt lgkmcnt(4)
    v_mfma_f32_16x16x32_bf16 v[56:59], v[16:19], v[204:207], v[56:59]
    ds_read_b64_tr_b16 v[28:29], v6 offset:30720
    v_mfma_f32_16x16x32_bf16 v[60:63], v[16:19], v[208:211], v[60:63]
    ds_read_b64_tr_b16 v[30:31], v6 offset:38400
    s_barrier
    s_waitcnt lgkmcnt(4)
    v_mfma_f32_16x16x32_bf16 v[64:67], v[204:207], v[20:23], v[64:67]
    ds_read_b64_tr_b16 v[16:17], v50 offset:18432
    v_mfma_f32_16x16x32_bf16 v[68:71], v[208:211], v[20:23], v[68:71]
    ds_read_b64_tr_b16 v[18:19], v50 offset:26112
    s_waitcnt lgkmcnt(4)
    v_mfma_f32_16x16x32_bf16 v[72:75], v[204:207], v[24:27], v[72:75]
    ds_read_b64_tr_b16 v[20:21], v54 offset:18432
    v_mfma_f32_16x16x32_bf16 v[76:79], v[208:211], v[24:27], v[76:79]
    ds_read_b64_tr_b16 v[22:23], v54 offset:26112
    s_waitcnt lgkmcnt(4)
    v_mfma_f32_16x16x32_bf16 v[80:83], v[204:207], v[28:31], v[80:83]
    ds_read_b64_tr_b16 v[24:25], v54 offset:18472
    v_mfma_f32_16x16x32_bf16 v[84:87], v[208:211], v[28:31], v[84:87]
    ds_read_b64_tr_b16 v[26:27], v54 offset:26152
    s_waitcnt lgkmcnt(4)
    v_mfma_f32_16x16x32_bf16 v[56:59], v[16:19], v[212:215], v[56:59]
    ds_read_b64_tr_b16 v[28:29], v51 offset:18432
    v_mfma_f32_16x16x32_bf16 v[60:63], v[16:19], v[216:219], v[60:63]
    ds_read_b64_tr_b16 v[30:31], v51 offset:26112
    s_barrier
    s_waitcnt lgkmcnt(4)
    v_mfma_f32_16x16x32_bf16 v[64:67], v[212:215], v[20:23], v[64:67]
    ds_read_b64_tr_b16 v[16:17], v50 offset:33792
    v_mfma_f32_16x16x32_bf16 v[68:71], v[216:219], v[20:23], v[68:71]
    ds_read_b64_tr_b16 v[18:19], v50 offset:41472
    s_waitcnt lgkmcnt(4)
    v_mfma_f32_16x16x32_bf16 v[72:75], v[212:215], v[24:27], v[72:75]
    ds_read_b64_tr_b16 v[20:21], v54 offset:33792
    v_mfma_f32_16x16x32_bf16 v[76:79], v[216:219], v[24:27], v[76:79]
    ds_read_b64_tr_b16 v[22:23], v54 offset:41472
    s_waitcnt lgkmcnt(4)
    v_mfma_f32_16x16x32_bf16 v[80:83], v[212:215], v[28:31], v[80:83]
    ds_read_b64_tr_b16 v[24:25], v54 offset:33832
    v_mfma_f32_16x16x32_bf16 v[84:87], v[216:219], v[28:31], v[84:87]
    ds_read_b64_tr_b16 v[26:27], v54 offset:41512
    s_waitcnt lgkmcnt(4)
    v_mfma_f32_16x16x32_bf16 v[56:59], v[16:19], v[220:223], v[56:59]
    ds_read_b64_tr_b16 v[28:29], v51 offset:33792
    v_mfma_f32_16x16x32_bf16 v[60:63], v[16:19], v[224:227], v[60:63]
    ds_read_b64_tr_b16 v[30:31], v51 offset:41472
    s_barrier
    s_waitcnt lgkmcnt(4)
    v_mfma_f32_16x16x32_bf16 v[64:67], v[220:223], v[20:23], v[64:67]
    ds_read_b64_tr_b16 v[16:17], v48 offset:0
    v_mfma_f32_16x16x32_bf16 v[68:71], v[224:227], v[20:23], v[68:71]
    ds_read_b64_tr_b16 v[18:19], v48 offset:7680
    s_waitcnt lgkmcnt(4)
    v_mfma_f32_16x16x32_bf16 v[72:75], v[220:223], v[24:27], v[72:75]
    ds_read_b64_tr_b16 v[20:21], v53 offset:0
    v_mfma_f32_16x16x32_bf16 v[76:79], v[224:227], v[24:27], v[76:79]
    ds_read_b64_tr_b16 v[22:23], v53 offset:7680
    s_waitcnt lgkmcnt(4)
    v_mfma_f32_16x16x32_bf16 v[80:83], v[220:223], v[28:31], v[80:83]
    ds_read_b64_tr_b16 v[24:25], v53 offset:40
    v_mfma_f32_16x16x32_bf16 v[84:87], v[224:227], v[28:31], v[84:87]
    ds_read_b64_tr_b16 v[26:27], v53 offset:7720
    s_waitcnt lgkmcnt(4)
    v_mfma_f32_16x16x32_bf16 v[56:59], v[16:19], v[228:231], v[56:59]
    ds_read_b64_tr_b16 v[28:29], v49 offset:0
    v_mfma_f32_16x16x32_bf16 v[60:63], v[16:19], v[232:235], v[60:63]
    ds_read_b64_tr_b16 v[30:31], v49 offset:7680
    s_barrier
    s_waitcnt lgkmcnt(4)
    v_mfma_f32_16x16x32_bf16 v[64:67], v[228:231], v[20:23], v[64:67]
    ds_read_b64_tr_b16 v[16:17], v3 offset:24576
    v_mfma_f32_16x16x32_bf16 v[68:71], v[232:235], v[20:23], v[68:71]
    ds_read_b64_tr_b16 v[18:19], v3 offset:26624
    s_waitcnt lgkmcnt(4)
    v_mfma_f32_16x16x32_bf16 v[72:75], v[228:231], v[24:27], v[72:75]
    ds_read_b64_tr_b16 v[20:21], v3 offset:28672
    v_mfma_f32_16x16x32_bf16 v[76:79], v[232:235], v[24:27], v[76:79]
    ds_read_b64_tr_b16 v[22:23], v3 offset:30720
    s_waitcnt lgkmcnt(4)
    v_mfma_f32_16x16x32_bf16 v[80:83], v[228:231], v[28:31], v[80:83]
    ds_read_b64_tr_b16 v[24:25], v3 offset:32768
    v_mfma_f32_16x16x32_bf16 v[84:87], v[232:235], v[28:31], v[84:87]
    ds_read_b64_tr_b16 v[26:27], v3 offset:34816
    s_waitcnt lgkmcnt(4)
    v_mfma_f32_16x16x32_bf16 v[32:35], v[16:19], v[92:95], 0
    ds_read_b64_tr_b16 v[28:29], v3 offset:36864
    v_mfma_f32_16x16x32_bf16 v[36:39], v[16:19], v[96:99], 0
    ds_read_b64_tr_b16 v[30:31], v3 offset:38912
    s_waitcnt lgkmcnt(4)
    v_mfma_f32_16x16x32_bf16 v[32:35], v[20:23], v[100:103], v[32:35]
    ds_read_b64_tr_b16 v[16:17], v3 offset:40960
    v_mfma_f32_16x16x32_bf16 v[36:39], v[20:23], v[104:107], v[36:39]
    ds_read_b64_tr_b16 v[18:19], v3 offset:43008
    s_waitcnt lgkmcnt(4)
    v_mfma_f32_16x16x32_bf16 v[32:35], v[24:27], v[108:111], v[32:35]
    ds_read_b64_tr_b16 v[20:21], v3 offset:45056
    v_cvt_pk_bf16_f32 v236, v64, v65
    v_mfma_f32_16x16x32_bf16 v[36:39], v[24:27], v[112:115], v[36:39]
    ds_read_b64_tr_b16 v[22:23], v3 offset:47104
    v_cvt_pk_bf16_f32 v237, v66, v67
    s_barrier
    s_waitcnt lgkmcnt(4)
    v_mfma_f32_16x16x32_bf16 v[32:35], v[28:31], v[116:119], v[32:35]
    ds_read_b64_tr_b16 v[24:25], v4 offset:0
    v_cvt_pk_bf16_f32 v238, v68, v69
    v_mfma_f32_16x16x32_bf16 v[36:39], v[28:31], v[120:123], v[36:39]
    ds_read_b64_tr_b16 v[26:27], v4 offset:2048
    v_cvt_pk_bf16_f32 v239, v70, v71
    s_waitcnt lgkmcnt(4)
    v_mfma_f32_16x16x32_bf16 v[32:35], v[16:19], v[124:127], v[32:35]
    ds_read_b64_tr_b16 v[28:29], v4 offset:4096
    v_mfma_f32_16x16x32_bf16 v[36:39], v[16:19], v[128:131], v[36:39]
    ds_read_b64_tr_b16 v[30:31], v4 offset:6144
    global_store_dwordx4 v13, v[236:239], s[82:83] offset:0 sc1
    s_waitcnt lgkmcnt(4)
    v_mfma_f32_16x16x32_bf16 v[32:35], v[20:23], v[132:135], v[32:35]
    ds_read_b64_tr_b16 v[16:17], v4 offset:8192
    v_cvt_pk_bf16_f32 v240, v72, v73
    v_mfma_f32_16x16x32_bf16 v[36:39], v[20:23], v[136:139], v[36:39]
    ds_read_b64_tr_b16 v[18:19], v4 offset:10240
    v_cvt_pk_bf16_f32 v241, v74, v75
    s_waitcnt lgkmcnt(4)
    v_mfma_f32_16x16x32_bf16 v[32:35], v[24:27], v[140:143], v[32:35]
    ds_read_b64_tr_b16 v[20:21], v4 offset:12288
    v_cvt_pk_bf16_f32 v242, v76, v77
    v_mfma_f32_16x16x32_bf16 v[36:39], v[24:27], v[144:147], v[36:39]
    ds_read_b64_tr_b16 v[22:23], v4 offset:14336
    v_cvt_pk_bf16_f32 v243, v78, v79
    s_waitcnt lgkmcnt(4)
    v_mfma_f32_16x16x32_bf16 v[32:35], v[28:31], v[148:151], v[32:35]
    ds_read_b64_tr_b16 v[24:25], v4 offset:16384
    v_mfma_f32_16x16x32_bf16 v[36:39], v[28:31], v[152:155], v[36:39]
    ds_read_b64_tr_b16 v[26:27], v4 offset:18432
    global_store_dwordx4 v13, v[240:243], s[82:83] offset:1024 sc1
    s_waitcnt lgkmcnt(4)
    v_mfma_f32_16x16x32_bf16 v[32:35], v[16:19], v[156:159], v[32:35]
    ds_read_b64_tr_b16 v[28:29], v4 offset:20480
    v_cvt_pk_bf16_f32 v252, v80, v81
    v_mfma_f32_16x16x32_bf16 v[36:39], v[16:19], v[160:163], v[36:39]
    ds_read_b64_tr_b16 v[30:31], v4 offset:22528
    v_cvt_pk_bf16_f32 v253, v82, v83
    v_cvt_pk_bf16_f32 v254, v84, v85
    v_cvt_pk_bf16_f32 v255, v86, v87
    s_and_b32 s42, s41, 1
    s_lshl_b32 s42, s42, 8
    s_add_u32 s42, s42, 3840
    s_lshl_b32 s43, s40, 8
    s_add_u32 s43, s43, 141312
    v_and_b32 v244, 15, v1
    v_and_b32_e64 v245, 48, v1
    v_add_lshl_u32 v15, v244, v245, 1
    v_add_u32_e64 v15, s43, v15
    v_lshl_add_u32 v14, v244, 6, s42
    v_add_u32_e64 v14, v14, v245
    s_mov_b32 exec_lo, 0x000f000f
    s_mov_b32 exec_hi, 0x000f000f
    ds_write_b16 v15, v252 offset:0
    ds_write_b16_d16_hi v15, v252 offset:8
    ds_write_b16 v15, v253 offset:16
    ds_write_b16_d16_hi v15, v253 offset:24
    ds_write_b16 v15, v254 offset:128
    ds_write_b16_d16_hi v15, v254 offset:136
    ds_write_b16 v15, v255 offset:144
    ds_write_b16_d16_hi v15, v255 offset:152
    s_mov_b32 exec_lo, 0x00f000f0
    s_mov_b32 exec_hi, 0x00f000f0
    global_store_dwordx2 v14, v[252:253], s[82:83] offset:0 sc1
    global_store_dwordx2 v14, v[254:255], s[82:83] offset:8 sc1
LS_join:
    s_mov_b64 exec, -1
    v_cvt_pk_bf16_f32 v48, v56, v57
    v_cvt_pk_bf16_f32 v49, v58, v59
    v_mov_b32 v50, 0
    v_mov_b32_e64 v51, 0
    v_cvt_pk_bf16_f32 v52, v60, v61
    v_cvt_pk_bf16_f32 v53, v62, v63
    v_mov_b32 v54, 0
    v_mov_b32 v55, 0
    s_waitcnt lgkmcnt(0)
    s_barrier
    v_mfma_f32_16x16x32_bf16 v[32:35], v[20:23], v[164:167], v[32:35]
    ds_read_b64_tr_b16 v[16:17], v2 offset:0
    s_lshl_b32 s42, s40, 8
    s_and_b32 s43, s41, 1
    s_lshl_b32 s43, s43, 2
    s_add_u32 s42, s42, s43
    s_add_u32 s42, s42, 141312
    v_lshl_add_u32 v14, v1, 3, s42
    s_mov_b64 exec, 0xffff
    ds_read_b32 v50, v14 offset:0
    ds_read_b32 v54, v14 offset:128
    s_mov_b64 exec, -1
    v_mfma_f32_16x16x32_bf16 v[36:39], v[20:23], v[168:171], v[36:39]
    ds_read_b64_tr_b16 v[18:19], v2 offset:2048
    v_mfma_f32_16x16x32_bf16 v[32:35], v[24:27], v[172:175], v[32:35]
    ds_read_b64_tr_b16 v[20:21], v2 offset:4096
    v_mfma_f32_16x16x32_bf16 v[36:39], v[24:27], v[176:179], v[36:39]
    ds_read_b64_tr_b16 v[22:23], v2 offset:6144
    v_mfma_f32_16x16x32_bf16 v[32:35], v[28:31], v[180:183], v[32:35]
    ds_read_b64_tr_b16 v[24:25], v2 offset:8192
    v_mfma_f32_16x16x32_bf16 v[36:39], v[28:31], v[184:187], v[36:39]
    ds_read_b64_tr_b16 v[26:27], v2 offset:10240
    s_waitcnt lgkmcnt(4)
    v_mfma_f32_16x16x32_bf16 v[32:35], v[16:19], v[188:191], v[32:35]
    ds_read_b64_tr_b16 v[28:29], v2 offset:12288
    v_mfma_f32_16x16x32_bf16 v[36:39], v[16:19], v[192:195], v[36:39]
    ds_read_b64_tr_b16 v[30:31], v2 offset:14336
    s_waitcnt lgkmcnt(4)
    v_mfma_f32_16x16x32_bf16 v[32:35], v[20:23], v[196:199], v[32:35]
    ds_read_b64_tr_b16 v[16:17], v2 offset:16384
    v_mfma_f32_16x16x32_bf16 v[36:39], v[20:23], v[200:203], v[36:39]
    ds_read_b64_tr_b16 v[18:19], v2 offset:18432
    s_waitcnt lgkmcnt(4)
    v_mfma_f32_16x16x32_bf16 v[32:35], v[24:27], v[204:207], v[32:35]
    ds_read_b64_tr_b16 v[20:21], v2 offset:20480
    v_mfma_f32_16x16x32_bf16 v[36:39], v[24:27], v[208:211], v[36:39]
    ds_read_b64_tr_b16 v[22:23], v2 offset:22528
    s_barrier
    s_waitcnt lgkmcnt(4)
    v_mfma_f32_16x16x32_bf16 v[32:35], v[28:31], v[212:215], v[32:35]
    ds_read_b64_tr_b16 v[24:25], v2 offset:24576
    v_mfma_f32_16x16x32_bf16 v[36:39], v[28:31], v[216:219], v[36:39]
    ds_read_b64_tr_b16 v[26:27], v2 offset:26624
    s_waitcnt lgkmcnt(4)
    v_mfma_f32_16x16x32_bf16 v[32:35], v[16:19], v[220:223], v[32:35]
    ds_read_b64_tr_b16 v[28:29], v2 offset:28672
    v_mfma_f32_16x16x32_bf16 v[36:39], v[16:19], v[224:227], v[36:39]
    ds_read_b64_tr_b16 v[30:31], v2 offset:30720
    s_waitcnt lgkmcnt(4)
    v_mfma_f32_16x16x32_bf16 v[32:35], v[20:23], v[228:231], v[32:35]
    ds_read_b64_tr_b16 v[16:17], v2 offset:32768
    v_mfma_f32_16x16x32_bf16 v[36:39], v[20:23], v[232:235], v[36:39]
    ds_read_b64_tr_b16 v[18:19], v2 offset:34816
    s_waitcnt lgkmcnt(4)
    v_mfma_f32_16x16x32_bf16 v[40:43], v[24:27], v[92:95], 0
    ds_read_b64_tr_b16 v[20:21], v2 offset:36864
    v_mfma_f32_16x16x32_bf16 v[44:47], v[24:27], v[96:99], 0
    ds_read_b64_tr_b16 v[22:23], v2 offset:38912
    s_waitcnt lgkmcnt(4)
    v_mfma_f32_16x16x32_bf16 v[40:43], v[28:31], v[100:103], v[40:43]
    ds_read_b64_tr_b16 v[24:25], v2 offset:40960
    v_mfma_f32_16x16x32_bf16 v[44:47], v[28:31], v[104:107], v[44:47]
    ds_read_b64_tr_b16 v[26:27], v2 offset:43008
    s_waitcnt lgkmcnt(4)
    v_mfma_f32_16x16x32_bf16 v[40:43], v[16:19], v[108:111], v[40:43]
    ds_read_b64_tr_b16 v[28:29], v2 offset:45056
    v_cvt_pk_bf16_f32 v56, v32, v33
    v_mfma_f32_16x16x32_bf16 v[44:47], v[16:19], v[112:115], v[44:47]
    ds_read_b64_tr_b16 v[30:31], v2 offset:47104
    v_cvt_pk_bf16_f32 v57, v34, v35
    s_barrier
    s_waitcnt lgkmcnt(4)
    v_mfma_f32_16x16x32_bf16 v[40:43], v[20:23], v[116:119], v[40:43]
    ds_read_b64_tr_b16 v[16:17], v3 offset:0
    v_cvt_pk_bf16_f32 v58, v36, v37
    v_mfma_f32_16x16x32_bf16 v[44:47], v[20:23], v[120:123], v[44:47]
    ds_read_b64_tr_b16 v[18:19], v3 offset:2048
    v_cvt_pk_bf16_f32 v59, v38, v39
    s_waitcnt lgkmcnt(4)
    v_mfma_f32_16x16x32_bf16 v[40:43], v[24:27], v[124:127], v[40:43]
    ds_read_b64_tr_b16 v[20:21], v3 offset:4096
    v_pk_max_i16 v56, v56, 0
    v_mfma_f32_16x16x32_bf16 v[44:47], v[24:27], v[128:131], v[44:47]
    ds_read_b64_tr_b16 v[22:23], v3 offset:6144
    v_pk_max_i16 v57, v57, 0
    s_waitcnt lgkmcnt(4)
    v_mfma_f32_16x16x32_bf16 v[40:43], v[28:31], v[132:135], v[40:43]
    ds_read_b64_tr_b16 v[24:25], v3 offset:8192
    v_pk_max_i16 v58, v58, 0
    v_mfma_f32_16x16x32_bf16 v[44:47], v[28:31], v[136:139], v[44:47]
    ds_read_b64_tr_b16 v[26:27], v3 offset:10240
    v_pk_max_i16 v59, v59, 0
    s_waitcnt lgkmcnt(4)
    v_mfma_f32_16x16x32_bf16 v[40:43], v[16:19], v[140:143], v[40:43]
    ds_read_b64_tr_b16 v[28:29], v3 offset:12288
    v_mfma_f32_16x16x32_bf16 v[44:47], v[16:19], v[144:147], v[44:47]
    ds_read_b64_tr_b16 v[30:31], v3 offset:14336
    s_waitcnt lgkmcnt(4)
    v_mfma_f32_16x16x32_bf16 v[40:43], v[20:23], v[148:151], v[40:43]
    ds_read_b64_tr_b16 v[16:17], v3 offset:16384
    v_mfma_f32_16x16x32_bf16 v[44:47], v[20:23], v[152:155], v[44:47]
    ds_read_b64_tr_b16 v[18:19], v3 offset:18432
    s_waitcnt lgkmcnt(4)
    v_mfma_f32_16x16x32_bf16 v[40:43], v[24:27], v[156:159], v[40:43]
    ds_read_b64_tr_b16 v[20:21], v3 offset:20480
    v_mfma_f32_16x16x32_bf16 v[44:47], v[24:27], v[160:163], v[44:47]
    ds_read_b64_tr_b16 v[22:23], v3 offset:22528
    s_barrier
    s_waitcnt lgkmcnt(4)
    v_mfma_f32_16x16x32_bf16 v[40:43], v[28:31], v[164:167], v[40:43]
    ds_read_b64_tr_b16 v[24:25], v3 offset:24576
    v_mfma_f32_16x16x32_bf16 v[44:47], v[28:31], v[168:171], v[44:47]
    ds_read_b64_tr_b16 v[26:27], v3 offset:26624
    s_waitcnt lgkmcnt(4)
    v_mfma_f32_16x16x32_bf16 v[40:43], v[16:19], v[172:175], v[40:43]
    ds_read_b64_tr_b16 v[28:29], v3 offset:28672
    v_mfma_f32_16x16x32_bf16 v[44:47], v[16:19], v[176:179], v[44:47]
    ds_read_b64_tr_b16 v[30:31], v3 offset:30720
    s_waitcnt lgkmcnt(4)
    v_mfma_f32_16x16x32_bf16 v[40:43], v[20:23], v[180:183], v[40:43]
    ds_read_b64_tr_b16 v[16:17], v3 offset:32768
    v_mfma_f32_16x16x32_bf16 v[44:47], v[20:23], v[184:187], v[44:47]
    ds_read_b64_tr_b16 v[18:19], v3 offset:34816
    s_waitcnt lgkmcnt(4)
    v_mfma_f32_16x16x32_bf16 v[40:43], v[24:27], v[188:191], v[40:43]
    ds_read_b64_tr_b16 v[20:21], v3 offset:36864
    v_mfma_f32_16x16x32_bf16 v[44:47], v[24:27], v[192:195], v[44:47]
    ds_read_b64_tr_b16 v[22:23], v3 offset:38912
    s_waitcnt lgkmcnt(4)
    v_mfma_f32_16x16x32_bf16 v[40:43], v[28:31], v[196:199], v[40:43]
    ds_read_b64_tr_b16 v[24:25], v3 offset:40960
    v_mfma_f32_16x16x32_bf16 v[44:47], v[28:31], v[200:203], v[44:47]
    ds_read_b64_tr_b16 v[26:27], v3 offset:43008
    s_waitcnt lgkmcnt(4)
    v_mfma_f32_16x16x32_bf16 v[40:43], v[16:19], v[204:207], v[40:43]
    ds_read_b64_tr_b16 v[28:29], v3 offset:45056
    v_mfma_f32_16x16x32_bf16 v[44:47], v[16:19], v[208:211], v[44:47]
    ds_read_b64_tr_b16 v[30:31], v3 offset:47104
    s_barrier
    s_waitcnt lgkmcnt(4)
    v_mfma_f32_16x16x32_bf16 v[40:43], v[20:23], v[212:215], v[40:43]
    ds_read_b64_tr_b16 v[16:17], v4 offset:0
    v_mfma_f32_16x16x32_bf16 v[44:47], v[20:23], v[216:219], v[44:47]
    ds_read_b64_tr_b16 v[18:19], v4 offset:2048
    s_waitcnt lgkmcnt(4)
    v_mfma_f32_16x16x32_bf16 v[40:43], v[24:27], v[220:223], v[40:43]
    ds_read_b64_tr_b16 v[20:21], v4 offset:4096
    v_mfma_f32_16x16x32_bf16 v[44:47], v[24:27], v[224:227], v[44:47]
    ds_read_b64_tr_b16 v[22:23], v4 offset:6144
    s_waitcnt lgkmcnt(4)
    v_mfma_f32_16x16x32_bf16 v[40:43], v[28:31], v[228:231], v[40:43]
    ds_read_b64_tr_b16 v[24:25], v4 offset:8192
    v_mfma_f32_16x16x32_bf16 v[44:47], v[28:31], v[232:235], v[44:47]
    ds_read_b64_tr_b16 v[26:27], v4 offset:10240
    s_waitcnt lgkmcnt(4)
    v_mfma_f32_16x16x32_bf16 v[32:35], v[16:19], v[92:95], 0
    ds_read_b64_tr_b16 v[28:29], v4 offset:12288
    v_mfma_f32_16x16x32_bf16 v[36:39], v[16:19], v[96:99], 0
    ds_read_b64_tr_b16 v[30:31], v4 offset:14336
    s_waitcnt lgkmcnt(4)
    v_mfma_f32_16x16x32_bf16 v[32:35], v[20:23], v[100:103], v[32:35]
    ds_read_b64_tr_b16 v[16:17], v4 offset:16384
    v_mfma_f32_16x16x32_bf16 v[36:39], v[20:23], v[104:107], v[36:39]
    ds_read_b64_tr_b16 v[18:19], v4 offset:18432
    s_waitcnt lgkmcnt(4)
    v_mfma_f32_16x16x32_bf16 v[32:35], v[24:27], v[108:111], v[32:35]
    ds_read_b64_tr_b16 v[20:21], v4 offset:20480
    v_cvt_pk_bf16_f32 v60, v40, v41
    v_mfma_f32_16x16x32_bf16 v[36:39], v[24:27], v[112:115], v[36:39]
    ds_read_b64_tr_b16 v[22:23], v4 offset:22528
    v_cvt_pk_bf16_f32 v61, v42, v43
    s_barrier
    s_waitcnt lgkmcnt(4)
    v_mfma_f32_16x16x32_bf16 v[32:35], v[28:31], v[116:119], v[32:35]
    ds_read_b64_tr_b16 v[24:25], v2 offset:0
    v_cvt_pk_bf16_f32 v62, v44, v45
    v_mfma_f32_16x16x32_bf16 v[36:39], v[28:31], v[120:123], v[36:39]
    ds_read_b64_tr_b16 v[26:27], v2 offset:2048
    v_cvt_pk_bf16_f32 v63, v46, v47
    s_waitcnt lgkmcnt(4)
    v_mfma_f32_16x16x32_bf16 v[32:35], v[16:19], v[124:127], v[32:35]
    ds_read_b64_tr_b16 v[28:29], v2 offset:4096
    v_pk_max_i16 v60, v60, 0
    v_mfma_f32_16x16x32_bf16 v[36:39], v[16:19], v[128:131], v[36:39]
    ds_read_b64_tr_b16 v[30:31], v2 offset:6144
    v_pk_max_i16 v61, v61, 0
    s_waitcnt lgkmcnt(4)
    v_mfma_f32_16x16x32_bf16 v[32:35], v[20:23], v[132:135], v[32:35]
    ds_read_b64_tr_b16 v[16:17], v2 offset:8192
    v_pk_max_i16 v62, v62, 0
    v_mfma_f32_16x16x32_bf16 v[36:39], v[20:23], v[136:139], v[36:39]
    ds_read_b64_tr_b16 v[18:19], v2 offset:10240
    v_pk_max_i16 v63, v63, 0
    s_waitcnt lgkmcnt(4)
    v_mfma_f32_16x16x32_bf16 v[32:35], v[24:27], v[140:143], v[32:35]
    ds_read_b64_tr_b16 v[20:21], v2 offset:12288
    v_mfma_f32_16x16x32_bf16 v[36:39], v[24:27], v[144:147], v[36:39]
    ds_read_b64_tr_b16 v[22:23], v2 offset:14336
    s_waitcnt lgkmcnt(4)
    v_mfma_f32_16x16x32_bf16 v[32:35], v[28:31], v[148:151], v[32:35]
    ds_read_b64_tr_b16 v[24:25], v2 offset:16384
    v_mfma_f32_16x16x32_bf16 v[36:39], v[28:31], v[152:155], v[36:39]
    ds_read_b64_tr_b16 v[26:27], v2 offset:18432
    s_waitcnt lgkmcnt(4)
    v_mfma_f32_16x16x32_bf16 v[32:35], v[16:19], v[156:159], v[32:35]
    ds_read_b64_tr_b16 v[28:29], v2 offset:20480
    v_mfma_f32_16x16x32_bf16 v[36:39], v[16:19], v[160:163], v[36:39]
    ds_read_b64_tr_b16 v[30:31], v2 offset:22528
    s_waitcnt vmcnt(0)
    s_waitcnt lgkmcnt(0)
    s_cmp_lg_u32 s98, 0
    s_cbranch_scc1 LS_n1k
    s_mov_b32 s86, 100000
    v_mov_b32 v254, 0
LS_n1l:
    global_load_dwordx2 v[252:253], v254, s[34:35] sc1
    s_waitcnt vmcnt(0)
    v_readfirstlane_b32 s98, v252
    v_readfirstlane_b32 s99, v253
    s_nop 1
    s_cmp_lg_u32 s98, 0
    s_cbranch_scc1 LS_n1k
    s_sub_u32 s86, s86, 1
    s_cbranch_scc0 LS_n1l
LS_n1k:
    s_barrier
    v_mfma_f32_16x16x32_bf16 v[32:35], v[20:23], v[164:167], v[32:35]
    ds_read_b64_tr_b16 v[16:17], v2 offset:24576
    s_cmp_lg_u32 s40, 4
    s_cbranch_scc1 LS_nf
    s_mul_i32 s100, s38, 36
    s_add_u32 s100, s100, s39
    s_lshl_b32 s100, s100, 3
    s_add_u32 s100, s100, 4718592
    s_add_u32 s42, s100, 32
    v_mov_b32 v252, s98
    v_mov_b32 v253, s99
    v_mov_b32_e64 v254, s42
    s_mov_b64 exec, 1
    global_store_dwordx2 v254, v[252:253], s[36:37] sc1
    s_mov_b64 exec, -1
LS_nf:
    v_mfma_f32_16x16x32_bf16 v[36:39], v[20:23], v[168:171], v[36:39]
    ds_read_b64_tr_b16 v[18:19], v2 offset:26624
    v_mfma_f32_16x16x32_bf16 v[32:35], v[24:27], v[172:175], v[32:35]
    ds_read_b64_tr_b16 v[20:21], v2 offset:28672
    v_mfma_f32_16x16x32_bf16 v[36:39], v[24:27], v[176:179], v[36:39]
    ds_read_b64_tr_b16 v[22:23], v2 offset:30720
    v_mfma_f32_16x16x32_bf16 v[32:35], v[28:31], v[180:183], v[32:35]
    ds_read_b64_tr_b16 v[24:25], v2 offset:32768
    v_mfma_f32_16x16x32_bf16 v[36:39], v[28:31], v[184:187], v[36:39]
    ds_read_b64_tr_b16 v[26:27], v2 offset:34816
    s_waitcnt lgkmcnt(4)
    v_mfma_f32_16x16x32_bf16 v[32:35], v[16:19], v[188:191], v[32:35]
    ds_read_b64_tr_b16 v[28:29], v2 offset:36864
    v_mfma_f32_16x16x32_bf16 v[36:39], v[16:19], v[192:195], v[36:39]
    ds_read_b64_tr_b16 v[30:31], v2 offset:38912
    s_waitcnt lgkmcnt(4)
    v_mfma_f32_16x16x32_bf16 v[32:35], v[20:23], v[196:199], v[32:35]
    ds_read_b64_tr_b16 v[16:17], v2 offset:40960
    v_mfma_f32_16x16x32_bf16 v[36:39], v[20:23], v[200:203], v[36:39]
    ds_read_b64_tr_b16 v[18:19], v2 offset:43008
    s_waitcnt lgkmcnt(4)
    v_mfma_f32_16x16x32_bf16 v[32:35], v[24:27], v[204:207], v[32:35]
    ds_read_b64_tr_b16 v[20:21], v2 offset:45056
    v_mfma_f32_16x16x32_bf16 v[36:39], v[24:27], v[208:211], v[36:39]
    ds_read_b64_tr_b16 v[22:23], v2 offset:47104
    s_barrier
    s_waitcnt lgkmcnt(4)
    v_mfma_f32_16x16x32_bf16 v[32:35], v[28:31], v[212:215], v[32:35]
    ds_read_b64_tr_b16 v[24:25], v3 offset:0
    v_mfma_f32_16x16x32_bf16 v[36:39], v[28:31], v[216:219], v[36:39]
    ds_read_b64_tr_b16 v[26:27], v3 offset:2048
    s_waitcnt lgkmcnt(4)
    v_mfma_f32_16x16x32_bf16 v[32:35], v[16:19], v[220:223], v[32:35]
    ds_read_b64_tr_b16 v[28:29], v3 offset:4096
    v_mfma_f32_16x16x32_bf16 v[36:39], v[16:19], v[224:227], v[36:39]
    ds_read_b64_tr_b16 v[30:31], v3 offset:6144
    s_waitcnt lgkmcnt(4)
    v_mfma_f32_16x16x32_bf16 v[32:35], v[20:23], v[228:231], v[32:35]
    ds_read_b64_tr_b16 v[16:17], v3 offset:8192
    v_mfma_f32_16x16x32_bf16 v[36:39], v[20:23], v[232:235], v[36:39]
    ds_read_b64_tr_b16 v[18:19], v3 offset:10240
    s_waitcnt lgkmcnt(4)
    v_mfma_f32_16x16x32_bf16 v[40:43], v[24:27], v[92:95], 0
    ds_read_b64_tr_b16 v[20:21], v3 offset:12288
    v_mfma_f32_16x16x32_bf16 v[44:47], v[24:27], v[96:99], 0
    ds_read_b64_tr_b16 v[22:23], v3 offset:14336
    s_waitcnt lgkmcnt(4)
    v_mfma_f32_16x16x32_bf16 v[40:43], v[28:31], v[100:103], v[40:43]
    ds_read_b64_tr_b16 v[24:25], v3 offset:16384
    v_mfma_f32_16x16x32_bf16 v[44:47], v[28:31], v[104:107], v[44:47]
    ds_read_b64_tr_b16 v[26:27], v3 offset:18432
    s_waitcnt lgkmcnt(4)
    v_mfma_f32_16x16x32_bf16 v[40:43], v[16:19], v[108:111], v[40:43]
    ds_read_b64_tr_b16 v[28:29], v3 offset:20480
    v_cvt_pk_bf16_f32 v64, v32, v33
    v_mfma_f32_16x16x32_bf16 v[44:47], v[16:19], v[112:115], v[44:47]
    ds_read_b64_tr_b16 v[30:31], v3 offset:22528
    v_cvt_pk_bf16_f32 v65, v34, v35
    s_barrier
    s_waitcnt lgkmcnt(4)
    v_mfma_f32_16x16x32_bf16 v[40:43], v[20:23], v[116:119], v[40:43]
    ds_read_b64_tr_b16 v[16:17], v3 offset:24576
    v_cvt_pk_bf16_f32 v66, v36, v37
    v_mfma_f32_16x16x32_bf16 v[44:47], v[20:23], v[120:123], v[44:47]
    ds_read_b64_tr_b16 v[18:19], v3 offset:26624
    v_cvt_pk_bf16_f32 v67, v38, v39
    s_waitcnt lgkmcnt(4)
    v_mfma_f32_16x16x32_bf16 v[40:43], v[24:27], v[124:127], v[40:43]
    ds_read_b64_tr_b16 v[20:21], v3 offset:28672
    v_pk_max_i16 v64, v64, 0
    v_mfma_f32_16x16x32_bf16 v[44:47], v[24:27], v[128:131], v[44:47]
    ds_read_b64_tr_b16 v[22:23], v3 offset:30720
    v_pk_max_i16 v65, v65, 0
    s_waitcnt lgkmcnt(4)
    v_mfma_f32_16x16x32_bf16 v[40:43], v[28:31], v[132:135], v[40:43]
    ds_read_b64_tr_b16 v[24:25], v3 offset:32768
    v_pk_max_i16 v66, v66, 0
    v_mfma_f32_16x16x32_bf16 v[44:47], v[28:31], v[136:139], v[44:47]
    ds_read_b64_tr_b16 v[26:27], v3 offset:34816
    v_pk_max_i16 v67, v67, 0
    s_waitcnt lgkmcnt(4)
    v_mfma_f32_16x16x32_bf16 v[40:43], v[16:19], v[140:143], v[40:43]
    ds_read_b64_tr_b16 v[28:29], v3 offset:36864
    v_mfma_f32_16x16x32_bf16 v[44:47], v[16:19], v[144:147], v[44:47]
    ds_read_b64_tr_b16 v[30:31], v3 offset:38912
    s_waitcnt lgkmcnt(4)
    v_mfma_f32_16x16x32_bf16 v[40:43], v[20:23], v[148:151], v[40:43]
    ds_read_b64_tr_b16 v[16:17], v3 offset:40960
    v_mfma_f32_16x16x32_bf16 v[44:47], v[20:23], v[152:155], v[44:47]
    ds_read_b64_tr_b16 v[18:19], v3 offset:43008
    s_waitcnt lgkmcnt(4)
    v_mfma_f32_16x16x32_bf16 v[40:43], v[24:27], v[156:159], v[40:43]
    ds_read_b64_tr_b16 v[20:21], v3 offset:45056
    v_mfma_f32_16x16x32_bf16 v[44:47], v[24:27], v[160:163], v[44:47]
    ds_read_b64_tr_b16 v[22:23], v3 offset:47104
    s_barrier
    s_waitcnt lgkmcnt(4)
    v_mfma_f32_16x16x32_bf16 v[40:43], v[28:31], v[164:167], v[40:43]
    ds_read_b64_tr_b16 v[24:25], v4 offset:0
    v_mfma_f32_16x16x32_bf16 v[44:47], v[28:31], v[168:171], v[44:47]
    ds_read_b64_tr_b16 v[26:27], v4 offset:2048
    s_waitcnt lgkmcnt(4)
    v_mfma_f32_16x16x32_bf16 v[40:43], v[16:19], v[172:175], v[40:43]
    ds_read_b64_tr_b16 v[28:29], v4 offset:4096
    v_mfma_f32_16x16x32_bf16 v[44:47], v[16:19], v[176:179], v[44:47]
    ds_read_b64_tr_b16 v[30:31], v4 offset:6144
    s_waitcnt lgkmcnt(4)
    v_mfma_f32_16x16x32_bf16 v[40:43], v[20:23], v[180:183], v[40:43]
    ds_read_b64_tr_b16 v[16:17], v4 offset:8192
    v_mfma_f32_16x16x32_bf16 v[44:47], v[20:23], v[184:187], v[44:47]
    ds_read_b64_tr_b16 v[18:19], v4 offset:10240
    s_waitcnt lgkmcnt(4)
    v_mfma_f32_16x16x32_bf16 v[40:43], v[24:27], v[188:191], v[40:43]
    ds_read_b64_tr_b16 v[20:21], v4 offset:12288
    v_mfma_f32_16x16x32_bf16 v[44:47], v[24:27], v[192:195], v[44:47]
    ds_read_b64_tr_b16 v[22:23], v4 offset:14336
    s_waitcnt lgkmcnt(4)
    v_mfma_f32_16x16x32_bf16 v[40:43], v[28:31], v[196:199], v[40:43]
    ds_read_b64_tr_b16 v[24:25], v4 offset:16384
    v_mfma_f32_16x16x32_bf16 v[44:47], v[28:31], v[200:203], v[44:47]
    ds_read_b64_tr_b16 v[26:27], v4 offset:18432
    s_waitcnt lgkmcnt(4)
    v_mfma_f32_16x16x32_bf16 v[40:43], v[16:19], v[204:207], v[40:43]
    ds_read_b64_tr_b16 v[28:29], v4 offset:20480
    v_mfma_f32_16x16x32_bf16 v[44:47], v[16:19], v[208:211], v[44:47]
    ds_read_b64_tr_b16 v[30:31], v4 offset:22528
    s_barrier
    s_waitcnt lgkmcnt(4)
    v_mfma_f32_16x16x32_bf16 v[40:43], v[20:23], v[212:215], v[40:43]
    ds_read_b64_tr_b16 v[16:17], v2 offset:0
    v_mfma_f32_16x16x32_bf16 v[44:47], v[20:23], v[216:219], v[44:47]
    ds_read_b64_tr_b16 v[18:19], v2 offset:2048
    s_waitcnt lgkmcnt(4)
    v_mfma_f32_16x16x32_bf16 v[40:43], v[24:27], v[220:223], v[40:43]
    ds_read_b64_tr_b16 v[20:21], v2 offset:4096
    v_mfma_f32_16x16x32_bf16 v[44:47], v[24:27], v[224:227], v[44:47]
    ds_read_b64_tr_b16 v[22:23], v2 offset:6144
    s_waitcnt lgkmcnt(4)
    v_mfma_f32_16x16x32_bf16 v[40:43], v[28:31], v[228:231], v[40:43]
    ds_read_b64_tr_b16 v[24:25], v2 offset:8192
    v_mfma_f32_16x16x32_bf16 v[44:47], v[28:31], v[232:235], v[44:47]
    ds_read_b64_tr_b16 v[26:27], v2 offset:10240
    s_waitcnt lgkmcnt(4)
    v_mfma_f32_16x16x32_bf16 v[32:35], v[16:19], v[92:95], 0
    ds_read_b64_tr_b16 v[28:29], v2 offset:12288
    v_mfma_f32_16x16x32_bf16 v[36:39], v[16:19], v[96:99], 0
    ds_read_b64_tr_b16 v[30:31], v2 offset:14336
    s_waitcnt lgkmcnt(4)
    v_mfma_f32_16x16x32_bf16 v[32:35], v[20:23], v[100:103], v[32:35]
    ds_read_b64_tr_b16 v[16:17], v2 offset:16384
    v_mfma_f32_16x16x32_bf16 v[36:39], v[20:23], v[104:107], v[36:39]
    ds_read_b64_tr_b16 v[18:19], v2 offset:18432
    s_waitcnt lgkmcnt(4)
    v_mfma_f32_16x16x32_bf16 v[32:35], v[24:27], v[108:111], v[32:35]
    ds_read_b64_tr_b16 v[20:21], v2 offset:20480
    v_cvt_pk_bf16_f32 v68, v40, v41
    v_mfma_f32_16x16x32_bf16 v[36:39], v[24:27], v[112:115], v[36:39]
    ds_read_b64_tr_b16 v[22:23], v2 offset:22528
    v_cvt_pk_bf16_f32 v69, v42, v43
    s_barrier
    s_waitcnt lgkmcnt(4)
    v_mfma_f32_16x16x32_bf16 v[32:35], v[28:31], v[116:119], v[32:35]
    ds_read_b64_tr_b16 v[24:25], v2 offset:24576
    v_cvt_pk_bf16_f32 v70, v44, v45
    v_mfma_f32_16x16x32_bf16 v[36:39], v[28:31], v[120:123], v[36:39]
    ds_read_b64_tr_b16 v[26:27], v2 offset:26624
    v_cvt_pk_bf16_f32 v71, v46, v47
    s_waitcnt lgkmcnt(4)
    v_mfma_f32_16x16x32_bf16 v[32:35], v[16:19], v[124:127], v[32:35]
    ds_read_b64_tr_b16 v[28:29], v2 offset:28672
    v_pk_max_i16 v68, v68, 0
    v_mfma_f32_16x16x32_bf16 v[36:39], v[16:19], v[128:131], v[36:39]
    ds_read_b64_tr_b16 v[30:31], v2 offset:30720
    v_pk_max_i16 v69, v69, 0
    s_waitcnt lgkmcnt(4)
    v_mfma_f32_16x16x32_bf16 v[32:35], v[20:23], v[132:135], v[32:35]
    ds_read_b64_tr_b16 v[16:17], v2 offset:32768
    v_pk_max_i16 v70, v70, 0
    v_mfma_f32_16x16x32_bf16 v[36:39], v[20:23], v[136:139], v[36:39]
    ds_read_b64_tr_b16 v[18:19], v2 offset:34816
    v_pk_max_i16 v71, v71, 0
    s_waitcnt lgkmcnt(4)
    v_mfma_f32_16x16x32_bf16 v[32:35], v[24:27], v[140:143], v[32:35]
    ds_read_b64_tr_b16 v[20:21], v2 offset:36864
    v_mfma_f32_16x16x32_bf16 v[36:39], v[24:27], v[144:147], v[36:39]
    ds_read_b64_tr_b16 v[22:23], v2 offset:38912
    s_waitcnt lgkmcnt(4)
    v_mfma_f32_16x16x32_bf16 v[32:35], v[28:31], v[148:151], v[32:35]
    ds_read_b64_tr_b16 v[24:25], v2 offset:40960
    v_mfma_f32_16x16x32_bf16 v[36:39], v[28:31], v[152:155], v[36:39]
    ds_read_b64_tr_b16 v[26:27], v2 offset:43008
    s_waitcnt lgkmcnt(4)
    v_mfma_f32_16x16x32_bf16 v[32:35], v[16:19], v[156:159], v[32:35]
    ds_read_b64_tr_b16 v[28:29], v2 offset:45056
    v_mfma_f32_16x16x32_bf16 v[36:39], v[16:19], v[160:163], v[36:39]
    ds_read_b64_tr_b16 v[30:31], v2 offset:47104
    s_barrier
    s_waitcnt lgkmcnt(4)
    v_mfma_f32_16x16x32_bf16 v[32:35], v[20:23], v[164:167], v[32:35]
    ds_read_b64_tr_b16 v[16:17], v3 offset:0
    v_mfma_f32_16x16x32_bf16 v[36:39], v[20:23], v[168:171], v[36:39]
    ds_read_b64_tr_b16 v[18:19], v3 offset:2048
    s_waitcnt lgkmcnt(4)
    v_mfma_f32_16x16x32_bf16 v[32:35], v[24:27], v[172:175], v[32:35]
    ds_read_b64_tr_b16 v[20:21], v3 offset:4096
    v_mfma_f32_16x16x32_bf16 v[36:39], v[24:27], v[176:179], v[36:39]
    ds_read_b64_tr_b16 v[22:23], v3 offset:6144
    s_waitcnt lgkmcnt(4)
    v_mfma_f32_16x16x32_bf16 v[32:35], v[28:31], v[180:183], v[32:35]
    ds_read_b64_tr_b16 v[24:25], v3 offset:8192
    v_mfma_f32_16x16x32_bf16 v[36:39], v[28:31], v[184:187], v[36:39]
    ds_read_b64_tr_b16 v[26:27], v3 offset:10240
    s_waitcnt lgkmcnt(4)
    v_mfma_f32_16x16x32_bf16 v[32:35], v[16:19], v[188:191], v[32:35]
    ds_read_b64_tr_b16 v[28:29], v3 offset:12288
    v_mfma_f32_16x16x32_bf16 v[36:39], v[16:19], v[192:195], v[36:39]
    ds_read_b64_tr_b16 v[30:31], v3 offset:14336
    s_waitcnt lgkmcnt(4)
    v_mfma_f32_16x16x32_bf16 v[32:35], v[20:23], v[196:199], v[32:35]
    ds_read_b64_tr_b16 v[16:17], v3 offset:16384
    v_mfma_f32_16x16x32_bf16 v[36:39], v[20:23], v[200:203], v[36:39]
    ds_read_b64_tr_b16 v[18:19], v3 offset:18432
    s_waitcnt lgkmcnt(4)
    v_mfma_f32_16x16x32_bf16 v[32:35], v[24:27], v[204:207], v[32:35]
    ds_read_b64_tr_b16 v[20:21], v3 offset:20480
    v_mfma_f32_16x16x32_bf16 v[36:39], v[24:27], v[208:211], v[36:39]
    ds_read_b64_tr_b16 v[22:23], v3 offset:22528
    s_barrier
    s_waitcnt lgkmcnt(4)
    v_mfma_f32_16x16x32_bf16 v[32:35], v[28:31], v[212:215], v[32:35]
    ds_read_b64_tr_b16 v[24:25], v3 offset:24576
    v_mfma_f32_16x16x32_bf16 v[36:39], v[28:31], v[216:219], v[36:39]
    ds_read_b64_tr_b16 v[26:27], v3 offset:26624
    s_waitcnt lgkmcnt(4)
    v_mfma_f32_16x16x32_bf16 v[32:35], v[16:19], v[220:223], v[32:35]
    ds_read_b64_tr_b16 v[28:29], v3 offset:28672
    v_mfma_f32_16x16x32_bf16 v[36:39], v[16:19], v[224:227], v[36:39]
    ds_read_b64_tr_b16 v[30:31], v3 offset:30720
    s_waitcnt lgkmcnt(4)
    v_mfma_f32_16x16x32_bf16 v[32:35], v[20:23], v[228:231], v[32:35]
    ds_read_b64_tr_b16 v[16:17], v3 offset:32768
    v_mfma_f32_16x16x32_bf16 v[36:39], v[20:23], v[232:235], v[36:39]
    ds_read_b64_tr_b16 v[18:19], v3 offset:34816
    s_waitcnt lgkmcnt(4)
    v_mfma_f32_16x16x32_bf16 v[40:43], v[24:27], v[92:95], 0
    ds_read_b64_tr_b16 v[20:21], v3 offset:36864
    v_mfma_f32_16x16x32_bf16 v[44:47], v[24:27], v[96:99], 0
    ds_read_b64_tr_b16 v[22:23], v3 offset:38912
    s_waitcnt lgkmcnt(4)
    v_mfma_f32_16x16x32_bf16 v[40:43], v[28:31], v[100:103], v[40:43]
    ds_read_b64_tr_b16 v[24:25], v3 offset:40960
    v_mfma_f32_16x16x32_bf16 v[44:47], v[28:31], v[104:107], v[44:47]
    ds_read_b64_tr_b16 v[26:27], v3 offset:43008
    s_waitcnt lgkmcnt(4)
    v_mfma_f32_16x16x32_bf16 v[40:43], v[16:19], v[108:111], v[40:43]
    ds_read_b64_tr_b16 v[28:29], v3 offset:45056
    v_cvt_pk_bf16_f32 v72, v32, v33
    v_mfma_f32_16x16x32_bf16 v[44:47], v[16:19], v[112:115], v[44:47]
    ds_read_b64_tr_b16 v[30:31], v3 offset:47104
    v_cvt_pk_bf16_f32 v73, v34, v35
    s_barrier
    s_waitcnt lgkmcnt(4)
    v_mfma_f32_16x16x32_bf16 v[40:43], v[20:23], v[116:119], v[40:43]
    ds_read_b64_tr_b16 v[16:17], v4 offset:0
    v_cvt_pk_bf16_f32 v74, v36, v37
    v_mfma_f32_16x16x32_bf16 v[44:47], v[20:23], v[120:123], v[44:47]
    ds_read_b64_tr_b16 v[18:19], v4 offset:2048
    v_cvt_pk_bf16_f32 v75, v38, v39
    s_waitcnt lgkmcnt(4)
    v_mfma_f32_16x16x32_bf16 v[40:43], v[24:27], v[124:127], v[40:43]
    ds_read_b64_tr_b16 v[20:21], v4 offset:4096
    v_pk_max_i16 v72, v72, 0
    v_mfma_f32_16x16x32_bf16 v[44:47], v[24:27], v[128:131], v[44:47]
    ds_read_b64_tr_b16 v[22:23], v4 offset:6144
    v_pk_max_i16 v73, v73, 0
    s_waitcnt lgkmcnt(4)
    v_mfma_f32_16x16x32_bf16 v[40:43], v[28:31], v[132:135], v[40:43]
    ds_read_b64_tr_b16 v[24:25], v4 offset:8192
    v_pk_max_i16 v74, v74, 0
    v_mfma_f32_16x16x32_bf16 v[44:47], v[28:31], v[136:139], v[44:47]
    ds_read_b64_tr_b16 v[26:27], v4 offset:10240
    v_pk_max_i16 v75, v75, 0
    s_waitcnt lgkmcnt(4)
    v_mfma_f32_16x16x32_bf16 v[40:43], v[16:19], v[140:143], v[40:43]
    ds_read_b64_tr_b16 v[28:29], v4 offset:12288
    v_mfma_f32_16x16x32_bf16 v[44:47], v[16:19], v[144:147], v[44:47]
    ds_read_b64_tr_b16 v[30:31], v4 offset:14336
    s_waitcnt lgkmcnt(4)
    v_mfma_f32_16x16x32_bf16 v[40:43], v[20:23], v[148:151], v[40:43]
    ds_read_b64_tr_b16 v[16:17], v4 offset:16384
    v_mfma_f32_16x16x32_bf16 v[44:47], v[20:23], v[152:155], v[44:47]
    ds_read_b64_tr_b16 v[18:19], v4 offset:18432
    s_waitcnt lgkmcnt(4)
    v_mfma_f32_16x16x32_bf16 v[40:43], v[24:27], v[156:159], v[40:43]
    ds_read_b64_tr_b16 v[20:21], v4 offset:20480
    v_mfma_f32_16x16x32_bf16 v[44:47], v[24:27], v[160:163], v[44:47]
    ds_read_b64_tr_b16 v[22:23], v4 offset:22528
    s_barrier
    s_waitcnt lgkmcnt(4)
    v_mfma_f32_16x16x32_bf16 v[40:43], v[28:31], v[164:167], v[40:43]
    ds_read_b64_tr_b16 v[24:25], v2 offset:0
    v_mfma_f32_16x16x32_bf16 v[44:47], v[28:31], v[168:171], v[44:47]
    ds_read_b64_tr_b16 v[26:27], v2 offset:2048
    s_waitcnt lgkmcnt(4)
    v_mfma_f32_16x16x32_bf16 v[40:43], v[16:19], v[172:175], v[40:43]
    ds_read_b64_tr_b16 v[28:29], v2 offset:4096
    v_mfma_f32_16x16x32_bf16 v[44:47], v[16:19], v[176:179], v[44:47]
    ds_read_b64_tr_b16 v[30:31], v2 offset:6144
    s_waitcnt lgkmcnt(4)
    v_mfma_f32_16x16x32_bf16 v[40:43], v[20:23], v[180:183], v[40:43]
    ds_read_b64_tr_b16 v[16:17], v2 offset:8192
    v_mfma_f32_16x16x32_bf16 v[44:47], v[20:23], v[184:187], v[44:47]
    ds_read_b64_tr_b16 v[18:19], v2 offset:10240
    s_waitcnt lgkmcnt(4)
    v_mfma_f32_16x16x32_bf16 v[40:43], v[24:27], v[188:191], v[40:43]
    ds_read_b64_tr_b16 v[20:21], v2 offset:12288
    v_mfma_f32_16x16x32_bf16 v[44:47], v[24:27], v[192:195], v[44:47]
    ds_read_b64_tr_b16 v[22:23], v2 offset:14336
    s_waitcnt lgkmcnt(4)
    v_mfma_f32_16x16x32_bf16 v[40:43], v[28:31], v[196:199], v[40:43]
    ds_read_b64_tr_b16 v[24:25], v2 offset:16384
    v_mfma_f32_16x16x32_bf16 v[44:47], v[28:31], v[200:203], v[44:47]
    ds_read_b64_tr_b16 v[26:27], v2 offset:18432
    s_waitcnt lgkmcnt(4)
    v_mfma_f32_16x16x32_bf16 v[40:43], v[16:19], v[204:207], v[40:43]
    ds_read_b64_tr_b16 v[28:29], v2 offset:20480
    v_mfma_f32_16x16x32_bf16 v[44:47], v[16:19], v[208:211], v[44:47]
    ds_read_b64_tr_b16 v[30:31], v2 offset:22528
    s_barrier
    s_waitcnt lgkmcnt(4)
    v_mfma_f32_16x16x32_bf16 v[40:43], v[20:23], v[212:215], v[40:43]
    ds_read_b64_tr_b16 v[16:17], v2 offset:24576
    s_lshr_b32 s42, s38, 1
    s_mul_i32 s42, s42, 36
    s_add_u32 s42, s42, s39
    s_lshl_b32 s42, s42, 3
    s_add_u32 s42, s42, 4718592
    v_lshrrev_b32 v248, 3, v1
    v_mul_u32_u24 v248, 1088, v248
    v_lshl_add_u32 v248, v1, 3, v248
    v_add_u32_e64 v248, s42, v248
    s_min_u32 s42, s39, 4
    s_sub_u32 s42, 4, s42
    s_lshl_b32 s42, 31, s42
    s_and_b32 s42, s42, 31
    s_mul_i32 s82, s42, 257
    s_mov_b32 s83, 0
    s_cmp_lg_u32 s40, 4
    s_cbranch_scc1 LS_np
    s_mov_b64 exec, s[82:83]
    global_load_dwordx2 v[250:251], v248, s[36:37] sc1
    s_mov_b64 exec, -1
LS_np:
    v_mfma_f32_16x16x32_bf16 v[44:47], v[20:23], v[216:219], v[44:47]
    ds_read_b64_tr_b16 v[18:19], v2 offset:26624
    s_waitcnt lgkmcnt(4)
    v_mfma_f32_16x16x32_bf16 v[40:43], v[24:27], v[220:223], v[40:43]
    ds_read_b64_tr_b16 v[20:21], v2 offset:28672
    v_mfma_f32_16x16x32_bf16 v[44:47], v[24:27], v[224:227], v[44:47]
    ds_read_b64_tr_b16 v[22:23], v2 offset:30720
    s_waitcnt lgkmcnt(4)
    v_mfma_f32_16x16x32_bf16 v[40:43], v[28:31], v[228:231], v[40:43]
    ds_read_b64_tr_b16 v[24:25], v2 offset:32768
    v_mfma_f32_16x16x32_bf16 v[44:47], v[28:31], v[232:235], v[44:47]
    ds_read_b64_tr_b16 v[26:27], v2 offset:34816
    s_waitcnt lgkmcnt(4)
    v_mfma_f32_16x16x32_bf16 v[32:35], v[16:19], v[92:95], 0
    ds_read_b64_tr_b16 v[28:29], v2 offset:36864
    v_mfma_f32_16x16x32_bf16 v[36:39], v[16:19], v[96:99], 0
    ds_read_b64_tr_b16 v[30:31], v2 offset:38912
    s_waitcnt lgkmcnt(4)
    v_mfma_f32_16x16x32_bf16 v[32:35], v[20:23], v[100:103], v[32:35]
    ds_read_b64_tr_b16 v[16:17], v2 offset:40960
    v_mfma_f32_16x16x32_bf16 v[36:39], v[20:23], v[104:107], v[36:39]
    ds_read_b64_tr_b16 v[18:19], v2 offset:43008
    s_waitcnt lgkmcnt(4)
    v_mfma_f32_16x16x32_bf16 v[32:35], v[24:27], v[108:111], v[32:35]
    ds_read_b64_tr_b16 v[20:21], v2 offset:45056
    v_cvt_pk_bf16_f32 v76, v40, v41
    v_mfma_f32_16x16x32_bf16 v[36:39], v[24:27], v[112:115], v[36:39]
    ds_read_b64_tr_b16 v[22:23], v2 offset:47104
    v_cvt_pk_bf16_f32 v77, v42, v43
    s_barrier
    s_waitcnt lgkmcnt(4)
    v_mfma_f32_16x16x32_bf16 v[32:35], v[28:31], v[116:119], v[32:35]
    ds_read_b64_tr_b16 v[24:25], v3 offset:0
    v_cvt_pk_bf16_f32 v78, v44, v45
    v_mfma_f32_16x16x32_bf16 v[36:39], v[28:31], v[120:123], v[36:39]
    ds_read_b64_tr_b16 v[26:27], v3 offset:2048
    v_cvt_pk_bf16_f32 v79, v46, v47
    s_waitcnt lgkmcnt(4)
    v_mfma_f32_16x16x32_bf16 v[32:35], v[16:19], v[124:127], v[32:35]
    ds_read_b64_tr_b16 v[28:29], v3 offset:4096
    v_pk_max_i16 v76, v76, 0
    v_mfma_f32_16x16x32_bf16 v[36:39], v[16:19], v[128:131], v[36:39]
    ds_read_b64_tr_b16 v[30:31], v3 offset:6144
    v_pk_max_i16 v77, v77, 0
    s_waitcnt lgkmcnt(4)
    v_mfma_f32_16x16x32_bf16 v[32:35], v[20:23], v[132:135], v[32:35]
    ds_read_b64_tr_b16 v[16:17], v3 offset:8192
    v_pk_max_i16 v78, v78, 0
    v_mfma_f32_16x16x32_bf16 v[36:39], v[20:23], v[136:139], v[36:39]
    ds_read_b64_tr_b16 v[18:19], v3 offset:10240
    v_pk_max_i16 v79, v79, 0
    s_waitcnt lgkmcnt(4)
    v_mfma_f32_16x16x32_bf16 v[32:35], v[24:27], v[140:143], v[32:35]
    ds_read_b64_tr_b16 v[20:21], v3 offset:12288
    v_mfma_f32_16x16x32_bf16 v[36:39], v[24:27], v[144:147], v[36:39]
    ds_read_b64_tr_b16 v[22:23], v3 offset:14336
    s_waitcnt lgkmcnt(4)
    v_mfma_f32_16x16x32_bf16 v[32:35], v[28:31], v[148:151], v[32:35]
    ds_read_b64_tr_b16 v[24:25], v3 offset:16384
    v_mfma_f32_16x16x32_bf16 v[36:39], v[28:31], v[152:155], v[36:39]
    ds_read_b64_tr_b16 v[26:27], v3 offset:18432
    s_waitcnt lgkmcnt(4)
    v_mfma_f32_16x16x32_bf16 v[32:35], v[16:19], v[156:159], v[32:35]
    ds_read_b64_tr_b16 v[28:29], v3 offset:20480
    v_mfma_f32_16x16x32_bf16 v[36:39], v[16:19], v[160:163], v[36:39]
    ds_read_b64_tr_b16 v[30:31], v3 offset:22528
    s_barrier
    s_waitcnt lgkmcnt(4)
    v_mfma_f32_16x16x32_bf16 v[32:35], v[20:23], v[164:167], v[32:35]
    ds_read_b64_tr_b16 v[16:17], v3 offset:24576
    v_mfma_f32_16x16x32_bf16 v[36:39], v[20:23], v[168:171], v[36:39]
    ds_read_b64_tr_b16 v[18:19], v3 offset:26624
    s_waitcnt lgkmcnt(4)
    v_mfma_f32_16x16x32_bf16 v[32:35], v[24:27], v[172:175], v[32:35]
    ds_read_b64_tr_b16 v[20:21], v3 offset:28672
    v_mfma_f32_16x16x32_bf16 v[36:39], v[24:27], v[176:179], v[36:39]
    ds_read_b64_tr_b16 v[22:23], v3 offset:30720
    s_waitcnt lgkmcnt(4)
    v_mfma_f32_16x16x32_bf16 v[32:35], v[28:31], v[180:183], v[32:35]
    ds_read_b64_tr_b16 v[24:25], v3 offset:32768
    v_mfma_f32_16x16x32_bf16 v[36:39], v[28:31], v[184:187], v[36:39]
    ds_read_b64_tr_b16 v[26:27], v3 offset:34816
    s_waitcnt lgkmcnt(4)
    v_mfma_f32_16x16x32_bf16 v[32:35], v[16:19], v[188:191], v[32:35]
    ds_read_b64_tr_b16 v[28:29], v3 offset:36864
    v_mfma_f32_16x16x32_bf16 v[36:39], v[16:19], v[192:195], v[36:39]
    ds_read_b64_tr_b16 v[30:31], v3 offset:38912
    s_waitcnt lgkmcnt(4)
    v_mfma_f32_16x16x32_bf16 v[32:35], v[20:23], v[196:199], v[32:35]
    ds_read_b64_tr_b16 v[16:17], v3 offset:40960
    v_mfma_f32_16x16x32_bf16 v[36:39], v[20:23], v[200:203], v[36:39]
    ds_read_b64_tr_b16 v[18:19], v3 offset:43008
    s_waitcnt lgkmcnt(4)
    v_mfma_f32_16x16x32_bf16 v[32:35], v[24:27], v[204:207], v[32:35]
    ds_read_b64_tr_b16 v[20:21], v3 offset:45056
    v_mfma_f32_16x16x32_bf16 v[36:39], v[24:27], v[208:211], v[36:39]
    ds_read_b64_tr_b16 v[22:23], v3 offset:47104
    s_cmp_lg_u32 s40, 4
    s_cbranch_scc1 LS_nc
    s_mov_b32 s86, 100000
    s_mov_b64 exec, s[82:83]
LS_pl:
    s_waitcnt vmcnt(0)
    v_cmp_ne_u64 vcc, s[98:99], v[250:251]
    s_nop 4
    s_cbranch_vccz LS_pk
    global_load_dwordx2 v[250:251], v248, s[36:37] sc1
    s_sub_u32 s86, s86, 1
    s_cbranch_scc0 LS_pl
    s_waitcnt vmcnt(0)
LS_pk:
    s_mov_b64 exec, -1
LS_nc:
    s_barrier
    s_waitcnt lgkmcnt(4)
    v_mfma_f32_16x16x32_bf16 v[32:35], v[28:31], v[212:215], v[32:35]
    ds_read_b64_tr_b16 v[24:25], v4 offset:0
    v_mfma_f32_16x16x32_bf16 v[36:39], v[28:31], v[216:219], v[36:39]
    ds_read_b64_tr_b16 v[26:27], v4 offset:2048
    s_waitcnt lgkmcnt(4)
    v_mfma_f32_16x16x32_bf16 v[32:35], v[16:19], v[220:223], v[32:35]
    ds_read_b64_tr_b16 v[28:29], v4 offset:4096
    v_mfma_f32_16x16x32_bf16 v[36:39], v[16:19], v[224:227], v[36:39]
    ds_read_b64_tr_b16 v[30:31], v4 offset:6144
    s_waitcnt lgkmcnt(4)
    v_mfma_f32_16x16x32_bf16 v[32:35], v[20:23], v[228:231], v[32:35]
    ds_read_b64_tr_b16 v[16:17], v4 offset:8192
    v_mfma_f32_16x16x32_bf16 v[36:39], v[20:23], v[232:235], v[36:39]
    ds_read_b64_tr_b16 v[18:19], v4 offset:10240
    s_waitcnt lgkmcnt(4)
    v_mfma_f32_16x16x32_bf16 v[40:43], v[24:27], v[92:95], 0
    ds_read_b64_tr_b16 v[20:21], v4 offset:12288
    v_mfma_f32_16x16x32_bf16 v[44:47], v[24:27], v[96:99], 0
    ds_read_b64_tr_b16 v[22:23], v4 offset:14336
    s_waitcnt lgkmcnt(4)
    v_mfma_f32_16x16x32_bf16 v[40:43], v[28:31], v[100:103], v[40:43]
    ds_read_b64_tr_b16 v[24:25], v4 offset:16384
    v_mfma_f32_16x16x32_bf16 v[44:47], v[28:31], v[104:107], v[44:47]
    ds_read_b64_tr_b16 v[26:27], v4 offset:18432
    s_waitcnt lgkmcnt(4)
    v_mfma_f32_16x16x32_bf16 v[40:43], v[16:19], v[108:111], v[40:43]
    ds_read_b64_tr_b16 v[28:29], v4 offset:20480
    v_cvt_pk_bf16_f32 v80, v32, v33
    v_mfma_f32_16x16x32_bf16 v[44:47], v[16:19], v[112:115], v[44:47]
    ds_read_b64_tr_b16 v[30:31], v4 offset:22528
    v_cvt_pk_bf16_f32 v81, v34, v35
    s_barrier
    s_waitcnt lgkmcnt(4)
    v_mfma_f32_16x16x32_bf16 v[40:43], v[20:23], v[116:119], v[40:43]
    ds_read_b64_tr_b16 v[16:17], v2 offset:0
    v_cvt_pk_bf16_f32 v82, v36, v37
    v_mfma_f32_16x16x32_bf16 v[44:47], v[20:23], v[120:123], v[44:47]
    ds_read_b64_tr_b16 v[18:19], v2 offset:2048
    v_cvt_pk_bf16_f32 v83, v38, v39
    s_waitcnt lgkmcnt(4)
    v_mfma_f32_16x16x32_bf16 v[40:43], v[24:27], v[124:127], v[40:43]
    ds_read_b64_tr_b16 v[20:21], v2 offset:4096
    v_pk_max_i16 v80, v80, 0
    v_mfma_f32_16x16x32_bf16 v[44:47], v[24:27], v[128:131], v[44:47]
    ds_read_b64_tr_b16 v[22:23], v2 offset:6144
    v_pk_max_i16 v81, v81, 0
    s_waitcnt lgkmcnt(4)
    v_mfma_f32_16x16x32_bf16 v[40:43], v[28:31], v[132:135], v[40:43]
    ds_read_b64_tr_b16 v[24:25], v2 offset:8192
    v_pk_max_i16 v82, v82, 0
    v_mfma_f32_16x16x32_bf16 v[44:47], v[28:31], v[136:139], v[44:47]
    ds_read_b64_tr_b16 v[26:27], v2 offset:10240
    v_pk_max_i16 v83, v83, 0
    s_waitcnt lgkmcnt(4)
    v_mfma_f32_16x16x32_bf16 v[40:43], v[16:19], v[140:143], v[40:43]
    ds_read_b64_tr_b16 v[28:29], v2 offset:12288
    s_lshl_b32 s42, s41, 10
    v_lshl_add_u32 v12, v1, 3, s42
    v_lshl_add_u32 v14, v1, 4, s42
    v_mfma_f32_16x16x32_bf16 v[44:47], v[16:19], v[144:147], v[44:47]
    ds_read_b64_tr_b16 v[30:31], v2 offset:14336
    v_and_b32 v236, 15, v1
    s_lshr_b32 s42, s41, 1
    s_lshl_b32 s42, s42, 8
    s_waitcnt lgkmcnt(4)
    v_mfma_f32_16x16x32_bf16 v[40:43], v[20:23], v[148:151], v[40:43]
    ds_read_b64_tr_b16 v[16:17], v2 offset:16384
    s_add_u32 s42, s42, 4096
    s_and_b32 s43, s41, 1
    s_lshl_b32 s44, s43, 2
    v_mfma_f32_16x16x32_bf16 v[44:47], v[20:23], v[152:155], v[44:47]
    ds_read_b64_tr_b16 v[18:19], v2 offset:18432
    s_add_u32 s44, s44, s42
    v_lshl_add_u32 v13, v236, 3, s44
    s_lshl_b32 s43, s43, 7
    s_waitcnt lgkmcnt(4)
    v_mfma_f32_16x16x32_bf16 v[40:43], v[24:27], v[156:159], v[40:43]
    ds_read_b64_tr_b16 v[20:21], v2 offset:20480
    s_add_u32 s43, s43, s42
    v_lshl_add_u32 v15, v236, 6, s43
    v_and_b32_e64 v237, 48, v1
    v_mfma_f32_16x16x32_bf16 v[44:47], v[24:27], v[160:163], v[44:47]
    ds_read_b64_tr_b16 v[22:23], v2 offset:22528
    v_add_u32_e64 v15, v15, v237
    v_add_u32 v14, 73728, v14
    v_add_u32 v15, 73728, v15
    v_xor_b32 v5, 64, v4
    v_lshrrev_b32 v240, 4, v1
    v_lshrrev_b32_e64 v241, 1, v240
    s_barrier
    s_waitcnt lgkmcnt(4)
    v_mfma_f32_16x16x32_bf16 v[40:43], v[28:31], v[164:167], v[40:43]
    ds_read_b64_tr_b16 v[24:25], v2 offset:24576
    v_mfma_f32_16x16x32_bf16 v[44:47], v[28:31], v[168:171], v[44:47]
    ds_read_b64_tr_b16 v[26:27], v2 offset:26624
    s_waitcnt lgkmcnt(4)
    v_mfma_f32_16x16x32_bf16 v[40:43], v[16:19], v[172:175], v[40:43]
    ds_read_b64_tr_b16 v[28:29], v2 offset:28672
    v_mul_u32_u24 v241, 36, v241
    v_and_b32_e64 v240, 1, v240
    v_lshl_add_u32 v241, v240, 1, v241
    v_mfma_f32_16x16x32_bf16 v[44:47], v[16:19], v[176:179], v[44:47]
    ds_read_b64_tr_b16 v[30:31], v2 offset:30720
    v_bfe_u32 v240, v1, 2, 2
    v_add3_u32 v241, v241, v240, 16
    v_bfe_u32 v240, v241, 1, 2
    s_waitcnt lgkmcnt(4)
    v_mfma_f32_16x16x32_bf16 v[40:43], v[20:23], v[180:183], v[40:43]
    ds_read_b64_tr_b16 v[16:17], v2 offset:32768
    v_xor_b32 v240, s41, v240
    v_lshlrev_b32_e64 v240, 5, v240
    v_lshl_add_u32 v240, v241, 7, v240
    v_mfma_f32_16x16x32_bf16 v[44:47], v[20:23], v[184:187], v[44:47]
    ds_read_b64_tr_b16 v[18:19], v2 offset:34816
    v_and_b32_e64 v242, 3, v1
    v_lshl_add_u32 v240, v242, 3, v240
    v_add_u32 v6, 98304, v240
    s_waitcnt lgkmcnt(4)
    v_mfma_f32_16x16x32_bf16 v[40:43], v[24:27], v[188:191], v[40:43]
    ds_read_b64_tr_b16 v[20:21], v2 offset:36864
    v_lshrrev_b32 v237, 2, v237
    s_lshl_b32 s57, s39, 1
    s_add_u32 s57, s57, 1
    v_mfma_f32_16x16x32_bf16 v[44:47], v[24:27], v[192:195], v[44:47]
    ds_read_b64_tr_b16 v[22:23], v2 offset:38912
    v_mov_b32 v238, s81
    v_mov_b32_e64 v252, s80
    s_waitcnt lgkmcnt(4)
    v_mfma_f32_16x16x32_bf16 v[40:43], v[28:31], v[196:199], v[40:43]
    ds_read_b64_tr_b16 v[24:25], v2 offset:40960
    v_mfma_f32_16x16x32_bf16 v[44:47], v[28:31], v[200:203], v[44:47]
    ds_read_b64_tr_b16 v[26:27], v2 offset:43008
    s_waitcnt lgkmcnt(4)
    v_mfma_f32_16x16x32_bf16 v[40:43], v[16:19], v[204:207], v[40:43]
    ds_read_b64_tr_b16 v[28:29], v2 offset:45056
    v_mfma_f32_16x16x32_bf16 v[44:47], v[16:19], v[208:211], v[44:47]
    ds_read_b64_tr_b16 v[30:31], v2 offset:47104
    s_barrier
    s_waitcnt lgkmcnt(4)
    v_mfma_f32_16x16x32_bf16 v[40:43], v[20:23], v[212:215], v[40:43]
    ds_read_b64_tr_b16 v[16:17], v3 offset:0
    v_mfma_f32_16x16x32_bf16 v[44:47], v[20:23], v[216:219], v[44:47]
    ds_read_b64_tr_b16 v[18:19], v3 offset:2048
    s_waitcnt lgkmcnt(4)
    v_mfma_f32_16x16x32_bf16 v[40:43], v[24:27], v[220:223], v[40:43]
    ds_read_b64_tr_b16 v[20:21], v3 offset:4096
    v_mfma_f32_16x16x32_bf16 v[44:47], v[24:27], v[224:227], v[44:47]
    ds_read_b64_tr_b16 v[22:23], v3 offset:6144
    s_waitcnt lgkmcnt(4)
    v_mfma_f32_16x16x32_bf16 v[40:43], v[28:31], v[228:231], v[40:43]
    ds_read_b64_tr_b16 v[24:25], v3 offset:8192
    v_mfma_f32_16x16x32_bf16 v[44:47], v[28:31], v[232:235], v[44:47]
    ds_read_b64_tr_b16 v[26:27], v3 offset:10240
    s_waitcnt lgkmcnt(4)
    v_mfma_f32_16x16x32_bf16 v[32:35], v[16:19], v[92:95], 0
    ds_read_b64_tr_b16 v[28:29], v3 offset:12288
    v_mfma_f32_16x16x32_bf16 v[36:39], v[16:19], v[96:99], 0
    ds_read_b64_tr_b16 v[30:31], v3 offset:14336
    s_waitcnt lgkmcnt(4)
    v_mfma_f32_16x16x32_bf16 v[32:35], v[20:23], v[100:103], v[32:35]
    ds_read_b64_tr_b16 v[16:17], v3 offset:16384
    v_mfma_f32_16x16x32_bf16 v[36:39], v[20:23], v[104:107], v[36:39]
    ds_read_b64_tr_b16 v[18:19], v3 offset:18432
    s_waitcnt lgkmcnt(4)
    v_mfma_f32_16x16x32_bf16 v[32:35], v[24:27], v[108:111], v[32:35]
    ds_read_b64_tr_b16 v[20:21], v3 offset:20480
    v_cvt_pk_bf16_f32 v84, v40, v41
    v_mfma_f32_16x16x32_bf16 v[36:39], v[24:27], v[112:115], v[36:39]
    ds_read_b64_tr_b16 v[22:23], v3 offset:22528
    v_cvt_pk_bf16_f32 v85, v42, v43
    s_barrier
    s_waitcnt lgkmcnt(4)
    v_mfma_f32_16x16x32_bf16 v[32:35], v[28:31], v[116:119], v[32:35]
    ds_read_b64_tr_b16 v[24:25], v3 offset:24576
    v_cvt_pk_bf16_f32 v86, v44, v45
    v_mfma_f32_16x16x32_bf16 v[36:39], v[28:31], v[120:123], v[36:39]
    ds_read_b64_tr_b16 v[26:27], v3 offset:26624
    v_cvt_pk_bf16_f32 v87, v46, v47
    s_waitcnt lgkmcnt(4)
    v_mfma_f32_16x16x32_bf16 v[32:35], v[16:19], v[124:127], v[32:35]
    ds_read_b64_tr_b16 v[28:29], v3 offset:28672
    v_pk_max_i16 v84, v84, 0
    v_mfma_f32_16x16x32_bf16 v[36:39], v[16:19], v[128:131], v[36:39]
    ds_read_b64_tr_b16 v[30:31], v3 offset:30720
    v_pk_max_i16 v85, v85, 0
    s_waitcnt lgkmcnt(4)
    v_mfma_f32_16x16x32_bf16 v[32:35], v[20:23], v[132:135], v[32:35]
    ds_read_b64_tr_b16 v[16:17], v3 offset:32768
    v_pk_max_i16 v86, v86, 0
    v_mfma_f32_16x16x32_bf16 v[36:39], v[20:23], v[136:139], v[36:39]
    ds_read_b64_tr_b16 v[18:19], v3 offset:34816
    v_pk_max_i16 v87, v87, 0
    s_waitcnt lgkmcnt(4)
    v_mfma_f32_16x16x32_bf16 v[32:35], v[24:27], v[140:143], v[32:35]
    ds_read_b64_tr_b16 v[20:21], v3 offset:36864
    s_cmp_ge_u32 s57, 8
    s_cselect_b32 s42, 0, s81
    v_mov_b32 v239, s42
    v_add_u32_e64 v248, 0, v237
    v_cmp_le_u32 vcc, v248, v236
    s_nop 1
    v_cndmask_b32 v40, v238, 0, vcc
    v_cndmask_b32 v44, v239, v238, vcc
    v_mfma_f32_16x16x32_bf16 v[36:39], v[24:27], v[144:147], v[36:39]
    ds_read_b64_tr_b16 v[22:23], v3 offset:38912
    v_add_u32 v248, 1, v237
    v_cmp_le_u32 vcc, v248, v236
    s_nop 1
    v_cndmask_b32 v41, v238, 0, vcc
    v_cndmask_b32 v45, v239, v238, vcc
    s_waitcnt lgkmcnt(4)
    v_mfma_f32_16x16x32_bf16 v[32:35], v[28:31], v[148:151], v[32:35]
    ds_read_b64_tr_b16 v[24:25], v3 offset:40960
    v_add_u32_e64 v248, 2, v237
    v_cmp_le_u32 vcc, v248, v236
    s_nop 1
    v_cndmask_b32 v42, v238, 0, vcc
    v_cndmask_b32 v46, v239, v238, vcc
    v_mfma_f32_16x16x32_bf16 v[36:39], v[28:31], v[152:155], v[36:39]
    ds_read_b64_tr_b16 v[26:27], v3 offset:43008
    v_add_u32 v248, 3, v237
    v_cmp_le_u32 vcc, v248, v236
    s_nop 1
    v_cndmask_b32 v43, v238, 0, vcc
    v_cndmask_b32 v47, v239, v238, vcc
    s_waitcnt lgkmcnt(4)
    v_mfma_f32_16x16x32_bf16 v[32:35], v[16:19], v[156:159], v[32:35]
    ds_read_b64_tr_b16 v[28:29], v3 offset:45056
    v_mfma_f32_16x16x32_bf16 v[36:39], v[16:19], v[160:163], v[36:39]
    ds_read_b64_tr_b16 v[30:31], v3 offset:47104
    s_barrier
    s_waitcnt lgkmcnt(4)
    v_mfma_f32_16x16x32_bf16 v[32:35], v[20:23], v[164:167], v[32:35]
    ds_read_b64_tr_b16 v[16:17], v4 offset:0
    s_mul_i32 s42, s97, 41472
    s_add_u32 s42, s42, s74
    s_add_u32 s42, s42, 0
    s_mul_i32 s43, s41, 3456
    s_add_u32 s42, s42, s43
    v_min_u32 v244, 26, v1
    v_lshlrev_b32_e64 v244, 7, v244
    buffer_load_dword v253, v244, s[20:23], s42 offen
    v_mfma_f32_16x16x32_bf16 v[36:39], v[20:23], v[168:171], v[36:39]
    ds_read_b64_tr_b16 v[18:19], v4 offset:2048
    s_mul_i32 s42, s97, 41472
    s_add_u32 s42, s42, s74
    s_add_u32 s42, s42, 13824
    s_mul_i32 s43, s41, 3456
    s_add_u32 s42, s42, s43
    v_min_u32 v245, 26, v1
    v_lshlrev_b32 v245, 7, v245
    buffer_load_dword v253, v245, s[20:23], s42 offen
    s_waitcnt lgkmcnt(4)
    v_mfma_f32_16x16x32_bf16 v[32:35], v[24:27], v[172:175], v[32:35]
    ds_read_b64_tr_b16 v[20:21], v4 offset:4096
    v_mfma_f32_16x16x32_bf16 v[36:39], v[24:27], v[176:179], v[36:39]
    ds_read_b64_tr_b16 v[22:23], v4 offset:6144
    s_waitcnt lgkmcnt(4)
    v_mfma_f32_16x16x32_bf16 v[32:35], v[28:31], v[180:183], v[32:35]
    ds_read_b64_tr_b16 v[24:25], v4 offset:8192
    v_mfma_f32_16x16x32_bf16 v[36:39], v[28:31], v[184:187], v[36:39]
    ds_read_b64_tr_b16 v[26:27], v4 offset:10240
    s_waitcnt lgkmcnt(4)
    v_mfma_f32_16x16x32_bf16 v[32:35], v[16:19], v[188:191], v[32:35]
    ds_read_b64_tr_b16 v[28:29], v4 offset:12288
    v_mfma_f32_16x16x32_bf16 v[36:39], v[16:19], v[192:195], v[36:39]
    ds_read_b64_tr_b16 v[30:31], v4 offset:14336
    s_waitcnt lgkmcnt(4)
    v_mfma_f32_16x16x32_bf16 v[32:35], v[20:23], v[196:199], v[32:35]
    ds_read_b64_tr_b16 v[16:17], v4 offset:16384
    v_mfma_f32_16x16x32_bf16 v[36:39], v[20:23], v[200:203], v[36:39]
    ds_read_b64_tr_b16 v[18:19], v4 offset:18432
    s_waitcnt lgkmcnt(4)
    v_mfma_f32_16x16x32_bf16 v[32:35], v[24:27], v[204:207], v[32:35]
    ds_read_b64_tr_b16 v[20:21], v4 offset:20480
    v_mfma_f32_16x16x32_bf16 v[36:39], v[24:27], v[208:211], v[36:39]
    ds_read_b64_tr_b16 v[22:23], v4 offset:22528
    s_waitcnt lgkmcnt(4)
    v_mfma_f32_16x16x32_bf16 v[32:35], v[28:31], v[212:215], v[32:35]
    v_mfma_f32_16x16x32_bf16 v[36:39], v[28:31], v[216:219], v[36:39]
    s_waitcnt lgkmcnt(2)
    v_mfma_f32_16x16x32_bf16 v[32:35], v[16:19], v[220:223], v[32:35]
    v_mfma_f32_16x16x32_bf16 v[36:39], v[16:19], v[224:227], v[36:39]
    s_waitcnt lgkmcnt(0)
    v_mfma_f32_16x16x32_bf16 v[32:35], v[20:23], v[228:231], v[32:35]
    v_mfma_f32_16x16x32_bf16 v[36:39], v[20:23], v[232:235], v[36:39]
    s_barrier
    s_cmp_lt_u32 s57, 8
    s_cbranch_scc1 LS_sm
    s_nop 0
    ds_read_b64 v[16:17], v12 offset:41472
    ds_read_b32 v18, v13 offset:41472
    ds_read_b64 v[20:21], v12 offset:41984
    ds_read_b32 v22, v13 offset:41600
    ds_read_b64 v[24:25], v12 offset:36864
    ds_read_b32 v26, v13 offset:36864
    ds_read_b64 v[28:29], v12 offset:37376
    ds_read_b32 v30, v13 offset:36992
    ds_read_b64 v[92:93], v12 offset:32256
    ds_read_b32 v94, v13 offset:32256
    ds_read_b64 v[96:97], v12 offset:32768
    ds_read_b32 v98, v13 offset:32384
    v_cvt_pk_bf16_f32 v88, v32, v33
    v_cvt_pk_bf16_f32 v89, v34, v35
    v_cvt_pk_bf16_f32 v90, v36, v37
    v_cvt_pk_bf16_f32 v91, v38, v39
    v_pk_max_i16 v88, v88, 0
    v_pk_max_i16 v89, v89, 0
    v_pk_max_i16 v90, v90, 0
    v_pk_max_i16 v91, v91, 0
    ds_read_b64 v[100:101], v12 offset:27648
    ds_read_b32 v102, v13 offset:27648
    s_waitcnt lgkmcnt(12)
    v_mfma_f32_16x16x32_bf16 v[220:223], v[16:19], v[48:51], v[40:43]
    v_mfma_f32_16x16x32_bf16 v[228:231], v[16:19], v[52:55], 0
    ds_read_b64 v[104:105], v12 offset:28160
    ds_read_b32 v106, v13 offset:27776
    s_waitcnt lgkmcnt(12)
    v_mfma_f32_16x16x32_bf16 v[232:235], v[20:23], v[52:55], v[40:43]
    ds_read_b64 v[108:109], v12 offset:23040
    ds_read_b32 v110, v13 offset:23040
    s_waitcnt lgkmcnt(12)
    v_mfma_f32_16x16x32_bf16 v[204:207], v[24:27], v[48:51], 0
    v_mfma_f32_16x16x32_bf16 v[212:215], v[24:27], v[52:55], 0
    ds_read_b64 v[112:113], v12 offset:23552
    ds_read_b32 v114, v13 offset:23168
    s_waitcnt lgkmcnt(12)
    v_mfma_f32_16x16x32_bf16 v[208:211], v[28:31], v[48:51], 0
    v_mfma_f32_16x16x32_bf16 v[216:219], v[28:31], v[52:55], 0
    ds_read_b64 v[116:117], v12 offset:18432
    ds_read_b32 v118, v13 offset:18432
    s_waitcnt lgkmcnt(12)
    v_mfma_f32_16x16x32_bf16 v[188:191], v[92:95], v[48:51], 0
    v_max_f32 v248, v220, v221
    v_max_f32_e64 v249, v222, v223
    v_mfma_f32_16x16x32_bf16 v[196:199], v[92:95], v[52:55], 0
    v_max_f32 v250, v228, v229
    v_max_f32 v251, v230, v231
    ds_read_b64 v[120:121], v12 offset:18944
    ds_read_b32 v122, v13 offset:18560
    s_waitcnt lgkmcnt(12)
    v_mfma_f32_16x16x32_bf16 v[192:195], v[96:99], v[48:51], 0
    v_max3_f32 v250, v232, v233, v250
    v_max3_f32 v251, v234, v235, v251
    v_mfma_f32_16x16x32_bf16 v[200:203], v[96:99], v[52:55], 0
    ds_read_b64 v[16:17], v12 offset:13824
    ds_read_b32 v18, v13 offset:13824
    s_waitcnt lgkmcnt(12)
    v_mfma_f32_16x16x32_bf16 v[172:175], v[100:103], v[48:51], 0
    v_max3_f32 v248, v204, v205, v248
    v_max3_f32 v249, v206, v207, v249
    v_mfma_f32_16x16x32_bf16 v[180:183], v[100:103], v[52:55], 0
    v_max3_f32 v250, v212, v213, v250
    v_max3_f32 v251, v214, v215, v251
    ds_read_b64 v[20:21], v12 offset:14336
    ds_read_b32 v22, v13 offset:13952
    s_waitcnt lgkmcnt(12)
    s_nop 0
    v_mfma_f32_16x16x32_bf16 v[176:179], v[104:107], v[48:51], 0
    v_max3_f32 v248, v208, v209, v248
    v_max3_f32 v249, v210, v211, v249
    v_mfma_f32_16x16x32_bf16 v[184:187], v[104:107], v[52:55], 0
    v_max3_f32 v250, v216, v217, v250
    v_max3_f32 v251, v218, v219, v251
    ds_read_b64 v[24:25], v12 offset:9216
    ds_read_b32 v26, v13 offset:9216
    s_waitcnt lgkmcnt(12)
    s_nop 0
    v_mfma_f32_16x16x32_bf16 v[156:159], v[108:111], v[48:51], 0
    v_max3_f32 v248, v188, v189, v248
    v_max3_f32 v249, v190, v191, v249
    v_mfma_f32_16x16x32_bf16 v[164:167], v[108:111], v[52:55], 0
    v_max3_f32 v250, v196, v197, v250
    v_max3_f32 v251, v198, v199, v251
    ds_read_b64 v[28:29], v12 offset:9728
    ds_read_b32 v30, v13 offset:9344
    s_waitcnt lgkmcnt(12)
    s_nop 0
    v_mfma_f32_16x16x32_bf16 v[160:163], v[112:115], v[48:51], 0
    v_max3_f32 v248, v192, v193, v248
    v_max3_f32 v249, v194, v195, v249
    v_mfma_f32_16x16x32_bf16 v[168:171], v[112:115], v[52:55], 0
    v_max3_f32 v250, v200, v201, v250
    v_max3_f32 v251, v202, v203, v251
    s_waitcnt lgkmcnt(10)
    s_nop 0
    v_mfma_f32_16x16x32_bf16 v[140:143], v[116:119], v[48:51], 0
    v_max3_f32 v248, v172, v173, v248
    v_max3_f32 v249, v174, v175, v249
    v_mfma_f32_16x16x32_bf16 v[148:151], v[116:119], v[52:55], 0
    v_max3_f32 v250, v180, v181, v250
    v_max3_f32 v251, v182, v183, v251
    s_waitcnt lgkmcnt(8)
    s_nop 0
    v_mfma_f32_16x16x32_bf16 v[144:147], v[120:123], v[48:51], 0
    v_max3_f32 v248, v176, v177, v248
    v_max3_f32 v249, v178, v179, v249
    v_mfma_f32_16x16x32_bf16 v[152:155], v[120:123], v[52:55], 0
    v_max3_f32 v250, v184, v185, v250
    v_max3_f32 v251, v186, v187, v251
    s_waitcnt lgkmcnt(6)
    s_nop 0
    v_mfma_f32_16x16x32_bf16 v[124:127], v[16:19], v[48:51], 0
    v_max3_f32 v248, v156, v157, v248
    v_max3_f32 v249, v158, v159, v249
    v_mfma_f32_16x16x32_bf16 v[132:135], v[16:19], v[52:55], 0
    v_max3_f32 v250, v164, v165, v250
    v_max3_f32 v251, v166, v167, v251
    ds_read_b64 v[16:17], v12 offset:4608
    ds_read_b32 v18, v13 offset:4608
    s_waitcnt lgkmcnt(6)
    s_nop 0
    v_mfma_f32_16x16x32_bf16 v[128:131], v[20:23], v[48:51], 0
    v_max3_f32 v248, v160, v161, v248
    v_max3_f32 v249, v162, v163, v249
    v_mfma_f32_16x16x32_bf16 v[136:139], v[20:23], v[52:55], 0
    v_max3_f32 v250, v168, v169, v250
    v_max3_f32 v251, v170, v171, v251
    ds_read_b64 v[20:21], v12 offset:5120
    ds_read_b32 v22, v13 offset:4736
    s_waitcnt lgkmcnt(6)
    s_nop 0
    v_mfma_f32_16x16x32_bf16 v[108:111], v[24:27], v[48:51], 0
    v_max3_f32 v248, v140, v141, v248
    v_max3_f32 v249, v142, v143, v249
    v_mfma_f32_16x16x32_bf16 v[116:119], v[24:27], v[52:55], 0
    v_max3_f32 v250, v148, v149, v250
    v_max3_f32 v251, v150, v151, v251
    s_waitcnt lgkmcnt(4)
    s_nop 0
    v_mfma_f32_16x16x32_bf16 v[112:115], v[28:31], v[48:51], 0
    v_max3_f32 v248, v144, v145, v248
    v_max3_f32 v249, v146, v147, v249
    v_mfma_f32_16x16x32_bf16 v[120:123], v[28:31], v[52:55], 0
    v_max3_f32 v250, v152, v153, v250
    v_max3_f32 v251, v154, v155, v251
    s_waitcnt lgkmcnt(2)
    v_mfma_f32_16x16x32_bf16 v[92:95], v[16:19], v[48:51], v[44:47]
    v_max3_f32 v248, v124, v125, v248
    v_max3_f32 v249, v126, v127, v249
    s_waitcnt lgkmcnt(0)
    v_mfma_f32_16x16x32_bf16 v[96:99], v[20:23], v[48:51], 0
    v_max3_f32 v250, v132, v133, v250
    v_max3_f32 v251, v134, v135, v251
    v_mfma_f32_16x16x32_bf16 v[104:107], v[20:23], v[52:55], v[44:47]
    v_max3_f32 v248, v128, v129, v248
    v_max3_f32 v249, v130, v131, v249
    v_max3_f32 v250, v136, v137, v250
    v_max3_f32 v251, v138, v139, v251
    v_max3_f32 v248, v108, v109, v248
    v_max3_f32 v249, v110, v111, v249
    v_max3_f32 v250, v116, v117, v250
    v_max3_f32 v251, v118, v119, v251
    v_max3_f32 v248, v112, v113, v248
    v_max3_f32 v249, v114, v115, v249
    v_max3_f32 v250, v120, v121, v250
    v_max3_f32 v251, v122, v123, v251
    v_mov_b32 v20, 0x3f803f80
    v_mov_b32 v28, 0x3f803f80
    v_mov_b32 v21, 0x3f803f80
    v_mov_b32 v29, 0x3f803f80
    v_mov_b32 v22, 0x3f803f80
    v_mov_b32 v30, 0x3f803f80
    v_mov_b32 v23, 0x3f803f80
    v_mov_b32 v31, 0x3f803f80
    v_max3_f32 v248, v92, v93, v248
    v_max3_f32 v249, v94, v95, v249
    v_max3_f32 v248, v96, v97, v248
    v_max3_f32 v249, v98, v99, v249
    v_max3_f32 v250, v104, v105, v250
    v_max3_f32 v251, v106, v107, v251
LS_sj:
    v_max_f32 v248, v248, v249
    v_max_f32 v250, v250, v251
    v_mov_b32 v249, v248
    v_mov_b32 v251, v250
    s_nop 1
    v_permlane16_swap_b32 v248, v249
    v_permlane16_swap_b32 v250, v251
    v_max_f32 v248, v248, v249
    v_max_f32 v250, v250, v251
    v_mov_b32 v249, v248
    v_mov_b32 v251, v250
    s_nop 1
    v_permlane32_swap_b32 v248, v249
    v_permlane32_swap_b32 v250, v251
    v_max_f32 v248, v248, v249
    v_max_f32 v250, v250, v251
    v_mul_f32 v248, s80, v248
    v_mul_f32_e64 v250, s80, v250
    s_lshr_b32 s42, s41, 1
    s_lshl_b32 s43, s42, 10
    s_and_b32 s44, s41, 1
    s_lshl_b32 s44, s44, 3
    s_add_u32 s43, s43, s44
    s_add_u32 s43, s43, 36864
    v_lshl_add_u32 v12, v1, 4, s43
    s_lshl_b32 s43, s42, 11
    s_add_u32 s43, s43, s44
    s_add_u32 s43, s43, 146432
    v_lshl_add_u32 v13, v1, 4, s43
    s_lshl_b32 s43, s41, 2
    s_add_u32 s43, s43, 151040
    v_lshl_add_u32 v9, v1, 4, s43
    s_lshl_b32 s42, s41, 10
    s_add_u32 s42, s42, 151552
    v_lshl_add_u32 v52, v1, 4, s42
    s_lshl_b32 s42, s40, 10
    v_lshl_add_u32 v53, v1, 4, s42
    v_subrev_u32 v54, 4096, v53
    v_mov_b32 v48, -1
    v_mov_b32 v49, -1
    v_mov_b32 v50, -1
    v_mov_b32 v51, -1
    v_and_b32 v55, 15, v1
    v_lshlrev_b32 v55, 4, v55
    v_lshrrev_b32 v236, 4, v1
    v_lshl_add_u32 v55, v236, 2, v55
    v_add_u32 v55, 151040, v55
    v_mov_b32 v244, 0x3f803f80
    v_mov_b32 v245, 0x3f803f80
    v_mov_b32 v246, 0x3f803f80
    v_mov_b32 v247, 0x3f803f80
    v_pk_fma_f32 v[220:221], v[220:221], v[252:253], v[248:249] op_sel_hi:[1,0,0] neg_lo:[0,0,1] neg_hi:[0,0,1]
    v_pk_fma_f32 v[222:223], v[222:223], v[252:253], v[248:249] op_sel_hi:[1,0,0] neg_lo:[0,0,1] neg_hi:[0,0,1]
    v_exp_f32 v220, v220
    v_exp_f32 v221, v221
    v_exp_f32 v222, v222
    v_exp_f32 v223, v223
    v_cvt_pk_bf16_f32 v220, v220, v221
    v_cvt_pk_bf16_f32 v221, v222, v223
    v_mov_b32 v222, 0
    v_mov_b32 v223, 0
    v_pk_fma_f32 v[228:229], v[228:229], v[252:253], v[250:251] op_sel_hi:[1,0,0] neg_lo:[0,0,1] neg_hi:[0,0,1]
    v_pk_fma_f32 v[230:231], v[230:231], v[252:253], v[250:251] op_sel_hi:[1,0,0] neg_lo:[0,0,1] neg_hi:[0,0,1]
    v_pk_fma_f32 v[232:233], v[232:233], v[252:253], v[250:251] op_sel_hi:[1,0,0] neg_lo:[0,0,1] neg_hi:[0,0,1]
    v_pk_fma_f32 v[234:235], v[234:235], v[252:253], v[250:251] op_sel_hi:[1,0,0] neg_lo:[0,0,1] neg_hi:[0,0,1]
    v_exp_f32 v228, v228
    v_exp_f32 v229, v229
    s_mul_i32 s42, s97, 41472
    s_add_u32 s42, s42, s74
    s_add_u32 s42, s42, 27648
    s_mul_i32 s43, s41, 3456
    s_add_u32 s42, s42, s43
    v_min_u32 v254, 26, v1
    v_lshlrev_b32 v254, 7, v254
    buffer_load_dword v253, v254, s[20:23], s42 offen
    v_exp_f32 v230, v230
    v_exp_f32 v231, v231
    v_exp_f32 v232, v232
    v_exp_f32 v233, v233
    v_exp_f32 v234, v234
    v_exp_f32 v235, v235
    v_cvt_pk_bf16_f32 v228, v228, v229
    v_cvt_pk_bf16_f32 v229, v230, v231
    v_cvt_pk_bf16_f32 v230, v232, v233
    v_cvt_pk_bf16_f32 v231, v234, v235
    v_pk_fma_f32 v[204:205], v[204:205], v[252:253], v[248:249] op_sel_hi:[1,0,0] neg_lo:[0,0,1] neg_hi:[0,0,1]
    v_pk_fma_f32 v[206:207], v[206:207], v[252:253], v[248:249] op_sel_hi:[1,0,0] neg_lo:[0,0,1] neg_hi:[0,0,1]
    v_pk_fma_f32 v[208:209], v[208:209], v[252:253], v[248:249] op_sel_hi:[1,0,0] neg_lo:[0,0,1] neg_hi:[0,0,1]
    v_pk_fma_f32 v[210:211], v[210:211], v[252:253], v[248:249] op_sel_hi:[1,0,0] neg_lo:[0,0,1] neg_hi:[0,0,1]
    v_exp_f32 v204, v204
    v_exp_f32 v205, v205
    v_exp_f32 v206, v206
    v_exp_f32 v207, v207
    v_exp_f32 v208, v208
    v_exp_f32 v209, v209
    v_exp_f32 v210, v210
    v_exp_f32 v211, v211
    v_cvt_pk_bf16_f32 v204, v204, v205
    v_cvt_pk_bf16_f32 v205, v206, v207
    v_cvt_pk_bf16_f32 v206, v208, v209
    v_cvt_pk_bf16_f32 v207, v210, v211
    s_mul_i32 s42, s97, 5248
    s_add_u32 s42, s42, s75
    s_mul_i32 s43, s41, 1408
    s_add_u32 s42, s42, s43
    v_min_u32 v255, 10, v1
    v_lshlrev_b32 v255, 7, v255
    buffer_load_dword v253, v255, s[12:15], s42 offen
    v_pk_fma_f32 v[212:213], v[212:213], v[252:253], v[250:251] op_sel_hi:[1,0,0] neg_lo:[0,0,1] neg_hi:[0,0,1]
    v_pk_fma_f32 v[214:215], v[214:215], v[252:253], v[250:251] op_sel_hi:[1,0,0] neg_lo:[0,0,1] neg_hi:[0,0,1]
    v_pk_fma_f32 v[216:217], v[216:217], v[252:253], v[250:251] op_sel_hi:[1,0,0] neg_lo:[0,0,1] neg_hi:[0,0,1]
    v_pk_fma_f32 v[218:219], v[218:219], v[252:253], v[250:251] op_sel_hi:[1,0,0] neg_lo:[0,0,1] neg_hi:[0,0,1]
    v_exp_f32 v212, v212
    v_exp_f32 v213, v213
    v_exp_f32 v214, v214
    v_exp_f32 v215, v215
    v_exp_f32 v216, v216
    v_exp_f32 v217, v217
    v_exp_f32 v218, v218
    v_exp_f32 v219, v219
    v_cvt_pk_bf16_f32 v212, v212, v213
    v_cvt_pk_bf16_f32 v213, v214, v215
    v_cvt_pk_bf16_f32 v214, v216, v217
    v_cvt_pk_bf16_f32 v215, v218, v219
    v_pk_fma_f32 v[188:189], v[188:189], v[252:253], v[248:249] op_sel_hi:[1,0,0] neg_lo:[0,0,1] neg_hi:[0,0,1]
    v_pk_fma_f32 v[190:191], v[190:191], v[252:253], v[248:249] op_sel_hi:[1,0,0] neg_lo:[0,0,1] neg_hi:[0,0,1]
    v_pk_fma_f32 v[192:193], v[192:193], v[252:253], v[248:249] op_sel_hi:[1,0,0] neg_lo:[0,0,1] neg_hi:[0,0,1]
    v_pk_fma_f32 v[194:195], v[194:195], v[252:253], v[248:249] op_sel_hi:[1,0,0] neg_lo:[0,0,1] neg_hi:[0,0,1]
    v_exp_f32 v188, v188
    v_exp_f32 v189, v189
    v_exp_f32 v190, v190
    v_exp_f32 v191, v191
    v_exp_f32 v192, v192
    v_exp_f32 v193, v193
    v_exp_f32 v194, v194
    v_exp_f32 v195, v195
    v_cvt_pk_bf16_f32 v188, v188, v189
    v_cvt_pk_bf16_f32 v189, v190, v191
    v_cvt_pk_bf16_f32 v190, v192, v193
    v_cvt_pk_bf16_f32 v191, v194, v195
    v_pk_fma_f32 v[196:197], v[196:197], v[252:253], v[250:251] op_sel_hi:[1,0,0] neg_lo:[0,0,1] neg_hi:[0,0,1]
    v_pk_fma_f32 v[198:199], v[198:199], v[252:253], v[250:251] op_sel_hi:[1,0,0] neg_lo:[0,0,1] neg_hi:[0,0,1]
    v_pk_fma_f32 v[200:201], v[200:201], v[252:253], v[250:251] op_sel_hi:[1,0,0] neg_lo:[0,0,1] neg_hi:[0,0,1]
    v_pk_fma_f32 v[202:203], v[202:203], v[252:253], v[250:251] op_sel_hi:[1,0,0] neg_lo:[0,0,1] neg_hi:[0,0,1]
    v_exp_f32 v196, v196
    v_exp_f32 v197, v197
    v_exp_f32 v198, v198
    v_exp_f32 v199, v199
    v_exp_f32 v200, v200
    v_exp_f32 v201, v201
    v_exp_f32 v202, v202
    v_exp_f32 v203, v203
    v_cvt_pk_bf16_f32 v196, v196, v197
    v_cvt_pk_bf16_f32 v197, v198, v199
    v_cvt_pk_bf16_f32 v198, v200, v201
    v_cvt_pk_bf16_f32 v199, v202, v203
    v_pk_fma_f32 v[172:173], v[172:173], v[252:253], v[248:249] op_sel_hi:[1,0,0] neg_lo:[0,0,1] neg_hi:[0,0,1]
    v_pk_fma_f32 v[174:175], v[174:175], v[252:253], v[248:249] op_sel_hi:[1,0,0] neg_lo:[0,0,1] neg_hi:[0,0,1]
    v_pk_fma_f32 v[176:177], v[176:177], v[252:253], v[248:249] op_sel_hi:[1,0,0] neg_lo:[0,0,1] neg_hi:[0,0,1]
    v_pk_fma_f32 v[178:179], v[178:179], v[252:253], v[248:249] op_sel_hi:[1,0,0] neg_lo:[0,0,1] neg_hi:[0,0,1]
    v_exp_f32 v172, v172
    v_exp_f32 v173, v173
    v_exp_f32 v174, v174
    v_exp_f32 v175, v175
    v_exp_f32 v176, v176
    v_exp_f32 v177, v177
    v_exp_f32 v178, v178
    v_exp_f32 v179, v179
    v_cvt_pk_bf16_f32 v172, v172, v173
    v_cvt_pk_bf16_f32 v173, v174, v175
    v_cvt_pk_bf16_f32 v174, v176, v177
    v_cvt_pk_bf16_f32 v175, v178, v179
    v_pk_fma_f32 v[180:181], v[180:181], v[252:253], v[250:251] op_sel_hi:[1,0,0] neg_lo:[0,0,1] neg_hi:[0,0,1]
    v_pk_fma_f32 v[182:183], v[182:183], v[252:253], v[250:251] op_sel_hi:[1,0,0] neg_lo:[0,0,1] neg_hi:[0,0,1]
    v_pk_fma_f32 v[184:185], v[184:185], v[252:253], v[250:251] op_sel_hi:[1,0,0] neg_lo:[0,0,1] neg_hi:[0,0,1]
    v_pk_fma_f32 v[186:187], v[186:187], v[252:253], v[250:251] op_sel_hi:[1,0,0] neg_lo:[0,0,1] neg_hi:[0,0,1]
    v_exp_f32 v180, v180
    v_exp_f32 v181, v181
    v_exp_f32 v182, v182
    v_exp_f32 v183, v183
    v_exp_f32 v184, v184
    v_exp_f32 v185, v185
    v_exp_f32 v186, v186
    v_exp_f32 v187, v187
    v_cvt_pk_bf16_f32 v180, v180, v181
    v_cvt_pk_bf16_f32 v181, v182, v183
    v_cvt_pk_bf16_f32 v182, v184, v185
    v_cvt_pk_bf16_f32 v183, v186, v187
    s_barrier
    ds_read_b128 v[16:19], v14 offset:41472
    s_mov_b32 exec_lo, 0x00030003
    s_mov_b32 exec_hi, 0x00030003
    ds_read_b128 v[20:23], v15 offset:41472
    s_mov_b64 exec, -1
    ds_read_b128 v[24:27], v14 offset:36864
    s_mov_b32 exec_lo, 0x00030003
    s_mov_b32 exec_hi, 0x00030003
    ds_read_b128 v[28:31], v15 offset:36864
    s_mov_b64 exec, -1
    s_waitcnt lgkmcnt(2)
    v_mfma_f32_16x16x32_bf16 v[32:35], v[16:19], v[220:223], 0
    ds_read_b128 v[240:243], v14 offset:32256
    s_mov_b32 exec_lo, 0x00030003
    s_mov_b32 exec_hi, 0x00030003
    ds_read_b128 v[244:247], v15 offset:32256
    s_mov_b64 exec, -1
    s_lshl_b32 s42, s48, 11
    v_add_u32_e64 v236, s42, v12
    ds_write_b64 v236, v[56:57] offset:0
    ds_write_b64 v236, v[58:59] offset:18432
    v_pk_fma_f32 v[156:157], v[156:157], v[252:253], v[248:249] op_sel_hi:[1,0,0] neg_lo:[0,0,1] neg_hi:[0,0,1]
    v_pk_fma_f32 v[158:159], v[158:159], v[252:253], v[248:249] op_sel_hi:[1,0,0] neg_lo:[0,0,1] neg_hi:[0,0,1]
    v_pk_fma_f32 v[160:161], v[160:161], v[252:253], v[248:249] op_sel_hi:[1,0,0] neg_lo:[0,0,1] neg_hi:[0,0,1]
    v_pk_fma_f32 v[162:163], v[162:163], v[252:253], v[248:249] op_sel_hi:[1,0,0] neg_lo:[0,0,1] neg_hi:[0,0,1]
    v_exp_f32 v156, v156
    v_exp_f32 v157, v157
    v_exp_f32 v158, v158
    v_exp_f32 v159, v159
    v_mfma_f32_16x16x32_bf16 v[40:43], v[20:23], v[220:223], 0
    s_lshl_b32 s42, s49, 11
    v_add_u32 v237, s42, v12
    ds_write_b64 v237, v[60:61] offset:0
    ds_write_b64 v237, v[62:63] offset:18432
    v_exp_f32 v160, v160
    v_exp_f32 v161, v161
    v_exp_f32 v162, v162
    v_exp_f32 v163, v163
    v_cvt_pk_bf16_f32 v156, v156, v157
    v_cvt_pk_bf16_f32 v157, v158, v159
    v_cvt_pk_bf16_f32 v158, v160, v161
    v_cvt_pk_bf16_f32 v159, v162, v163
    v_mfma_f32_16x16x32_bf16 v[36:39], v[16:19], v[228:231], 0
    s_lshl_b32 s42, s50, 11
    v_add_u32 v236, s42, v12
    ds_write_b64 v236, v[64:65] offset:0
    ds_write_b64 v236, v[66:67] offset:18432
    v_pk_fma_f32 v[164:165], v[164:165], v[252:253], v[250:251] op_sel_hi:[1,0,0] neg_lo:[0,0,1] neg_hi:[0,0,1]
    v_pk_fma_f32 v[166:167], v[166:167], v[252:253], v[250:251] op_sel_hi:[1,0,0] neg_lo:[0,0,1] neg_hi:[0,0,1]
    v_pk_fma_f32 v[168:169], v[168:169], v[252:253], v[250:251] op_sel_hi:[1,0,0] neg_lo:[0,0,1] neg_hi:[0,0,1]
    v_pk_fma_f32 v[170:171], v[170:171], v[252:253], v[250:251] op_sel_hi:[1,0,0] neg_lo:[0,0,1] neg_hi:[0,0,1]
    v_exp_f32 v164, v164
    v_exp_f32 v165, v165
    v_exp_f32 v166, v166
    v_exp_f32 v167, v167
    v_mfma_f32_16x16x32_bf16 v[44:47], v[20:23], v[228:231], 0
    s_lshl_b32 s42, s51, 11
    v_add_u32 v237, s42, v12
    ds_write_b64 v237, v[68:69] offset:0
    ds_write_b64 v237, v[70:71] offset:18432
    v_exp_f32 v168, v168
    v_exp_f32 v169, v169
    v_exp_f32 v170, v170
    v_exp_f32 v171, v171
    v_cvt_pk_bf16_f32 v164, v164, v165
    v_cvt_pk_bf16_f32 v165, v166, v167
    v_cvt_pk_bf16_f32 v166, v168, v169
    v_cvt_pk_bf16_f32 v167, v170, v171
    s_waitcnt lgkmcnt(10)
    v_mfma_f32_16x16x32_bf16 v[32:35], v[24:27], v[204:207], v[32:35]
    ds_read_b128 v[16:19], v14 offset:27648
    s_mov_b32 exec_lo, 0x00030003
    s_mov_b32 exec_hi, 0x00030003
    ds_read_b128 v[20:23], v15 offset:27648
    s_mov_b64 exec, -1
    s_lshl_b32 s42, s52, 11
    v_add_u32 v236, s42, v12
    ds_write_b64 v236, v[72:73] offset:0
    ds_write_b64 v236, v[74:75] offset:18432
    v_pk_fma_f32 v[140:141], v[140:141], v[252:253], v[248:249] op_sel_hi:[1,0,0] neg_lo:[0,0,1] neg_hi:[0,0,1]
    v_pk_fma_f32 v[142:143], v[142:143], v[252:253], v[248:249] op_sel_hi:[1,0,0] neg_lo:[0,0,1] neg_hi:[0,0,1]
    v_pk_fma_f32 v[144:145], v[144:145], v[252:253], v[248:249] op_sel_hi:[1,0,0] neg_lo:[0,0,1] neg_hi:[0,0,1]
    v_pk_fma_f32 v[146:147], v[146:147], v[252:253], v[248:249] op_sel_hi:[1,0,0] neg_lo:[0,0,1] neg_hi:[0,0,1]
    v_exp_f32 v140, v140
    v_exp_f32 v141, v141
    v_exp_f32 v142, v142
    v_exp_f32 v143, v143
    v_mfma_f32_16x16x32_bf16 v[40:43], v[28:31], v[204:207], v[40:43]
    s_lshl_b32 s42, s53, 11
    v_add_u32 v237, s42, v12
    ds_write_b64 v237, v[76:77] offset:0
    ds_write_b64 v237, v[78:79] offset:18432
    v_exp_f32 v144, v144
    v_exp_f32 v145, v145
    v_exp_f32 v146, v146
    v_exp_f32 v147, v147
    v_cvt_pk_bf16_f32 v140, v140, v141
    v_cvt_pk_bf16_f32 v141, v142, v143
    v_cvt_pk_bf16_f32 v142, v144, v145
    v_cvt_pk_bf16_f32 v143, v146, v147
    v_mfma_f32_16x16x32_bf16 v[36:39], v[24:27], v[212:215], v[36:39]
    s_lshl_b32 s42, s54, 11
    v_add_u32 v236, s42, v12
    ds_write_b64 v236, v[80:81] offset:0
    ds_write_b64 v236, v[82:83] offset:18432
    v_pk_fma_f32 v[148:149], v[148:149], v[252:253], v[250:251] op_sel_hi:[1,0,0] neg_lo:[0,0,1] neg_hi:[0,0,1]
    v_pk_fma_f32 v[150:151], v[150:151], v[252:253], v[250:251] op_sel_hi:[1,0,0] neg_lo:[0,0,1] neg_hi:[0,0,1]
    v_pk_fma_f32 v[152:153], v[152:153], v[252:253], v[250:251] op_sel_hi:[1,0,0] neg_lo:[0,0,1] neg_hi:[0,0,1]
    v_pk_fma_f32 v[154:155], v[154:155], v[252:253], v[250:251] op_sel_hi:[1,0,0] neg_lo:[0,0,1] neg_hi:[0,0,1]
    v_exp_f32 v148, v148
    v_exp_f32 v149, v149
    v_exp_f32 v150, v150
    v_exp_f32 v151, v151
    v_mfma_f32_16x16x32_bf16 v[44:47], v[28:31], v[212:215], v[44:47]
    s_lshl_b32 s42, s55, 11
    v_add_u32 v237, s42, v12
    ds_write_b64 v237, v[84:85] offset:0
    ds_write_b64 v237, v[86:87] offset:18432
    v_exp_f32 v152, v152
    v_exp_f32 v153, v153
    v_exp_f32 v154, v154
    v_exp_f32 v155, v155
    v_cvt_pk_bf16_f32 v148, v148, v149
    v_cvt_pk_bf16_f32 v149, v150, v151
    v_cvt_pk_bf16_f32 v150, v152, v153
    v_cvt_pk_bf16_f32 v151, v154, v155
    v_mfma_f32_16x16x32_bf16 v[32:35], v[240:243], v[188:191], v[32:35]
    ds_read_b128 v[24:27], v14 offset:23040
    s_mov_b32 exec_lo, 0x00030003
    s_mov_b32 exec_hi, 0x00030003
    ds_read_b128 v[28:31], v15 offset:23040
    s_mov_b64 exec, -1
    s_lshl_b32 s42, s56, 11
    v_add_u32_e64 v236, s42, v12
    ds_write_b64 v236, v[88:89] offset:0
    ds_write_b64 v236, v[90:91] offset:18432
    v_pk_fma_f32 v[124:125], v[124:125], v[252:253], v[248:249] op_sel_hi:[1,0,0] neg_lo:[0,0,1] neg_hi:[0,0,1]
    v_pk_fma_f32 v[126:127], v[126:127], v[252:253], v[248:249] op_sel_hi:[1,0,0] neg_lo:[0,0,1] neg_hi:[0,0,1]
    v_pk_fma_f32 v[128:129], v[128:129], v[252:253], v[248:249] op_sel_hi:[1,0,0] neg_lo:[0,0,1] neg_hi:[0,0,1]
    v_pk_fma_f32 v[130:131], v[130:131], v[252:253], v[248:249] op_sel_hi:[1,0,0] neg_lo:[0,0,1] neg_hi:[0,0,1]
    v_exp_f32 v124, v124
    v_exp_f32 v125, v125
    v_exp_f32 v126, v126
    v_exp_f32 v127, v127
    v_mfma_f32_16x16x32_bf16 v[40:43], v[244:247], v[188:191], v[40:43]
    v_exp_f32 v128, v128
    v_exp_f32 v129, v129
    v_exp_f32 v130, v130
    v_exp_f32 v131, v131
    v_cvt_pk_bf16_f32 v124, v124, v125
    v_cvt_pk_bf16_f32 v125, v126, v127
    v_cvt_pk_bf16_f32 v126, v128, v129
    v_cvt_pk_bf16_f32 v127, v130, v131
    v_mfma_f32_16x16x32_bf16 v[36:39], v[240:243], v[196:199], v[36:39]
    v_pk_fma_f32 v[132:133], v[132:133], v[252:253], v[250:251] op_sel_hi:[1,0,0] neg_lo:[0,0,1] neg_hi:[0,0,1]
    v_pk_fma_f32 v[134:135], v[134:135], v[252:253], v[250:251] op_sel_hi:[1,0,0] neg_lo:[0,0,1] neg_hi:[0,0,1]
    v_pk_fma_f32 v[136:137], v[136:137], v[252:253], v[250:251] op_sel_hi:[1,0,0] neg_lo:[0,0,1] neg_hi:[0,0,1]
    v_pk_fma_f32 v[138:139], v[138:139], v[252:253], v[250:251] op_sel_hi:[1,0,0] neg_lo:[0,0,1] neg_hi:[0,0,1]
    v_exp_f32 v132, v132
    v_exp_f32 v133, v133
    v_exp_f32 v134, v134
    v_exp_f32 v135, v135
    v_mfma_f32_16x16x32_bf16 v[44:47], v[244:247], v[196:199], v[44:47]
    v_exp_f32 v136, v136
    v_exp_f32 v137, v137
    v_exp_f32 v138, v138
    v_exp_f32 v139, v139
    v_cvt_pk_bf16_f32 v132, v132, v133
    v_cvt_pk_bf16_f32 v133, v134, v135
    v_cvt_pk_bf16_f32 v134, v136, v137
    v_cvt_pk_bf16_f32 v135, v138, v139
    s_waitcnt lgkmcnt(12)
    v_mfma_f32_16x16x32_bf16 v[32:35], v[16:19], v[172:175], v[32:35]
    ds_read_b128 v[240:243], v14 offset:18432
    s_mov_b32 exec_lo, 0x00030003
    s_mov_b32 exec_hi, 0x00030003
    ds_read_b128 v[244:247], v15 offset:18432
    s_mov_b64 exec, -1
    v_pk_fma_f32 v[108:109], v[108:109], v[252:253], v[248:249] op_sel_hi:[1,0,0] neg_lo:[0,0,1] neg_hi:[0,0,1]
    v_pk_fma_f32 v[110:111], v[110:111], v[252:253], v[248:249] op_sel_hi:[1,0,0] neg_lo:[0,0,1] neg_hi:[0,0,1]
    v_pk_fma_f32 v[112:113], v[112:113], v[252:253], v[248:249] op_sel_hi:[1,0,0] neg_lo:[0,0,1] neg_hi:[0,0,1]
    v_pk_fma_f32 v[114:115], v[114:115], v[252:253], v[248:249] op_sel_hi:[1,0,0] neg_lo:[0,0,1] neg_hi:[0,0,1]
    v_exp_f32 v108, v108
    v_exp_f32 v109, v109
    v_exp_f32 v110, v110
    v_exp_f32 v111, v111
    v_mfma_f32_16x16x32_bf16 v[40:43], v[20:23], v[172:175], v[40:43]
    v_exp_f32 v112, v112
    v_exp_f32 v113, v113
    v_exp_f32 v114, v114
    v_exp_f32 v115, v115
    v_cvt_pk_bf16_f32 v108, v108, v109
    v_cvt_pk_bf16_f32 v109, v110, v111
    v_cvt_pk_bf16_f32 v110, v112, v113
    v_cvt_pk_bf16_f32 v111, v114, v115
    v_mfma_f32_16x16x32_bf16 v[36:39], v[16:19], v[180:183], v[36:39]
    v_pk_fma_f32 v[116:117], v[116:117], v[252:253], v[250:251] op_sel_hi:[1,0,0] neg_lo:[0,0,1] neg_hi:[0,0,1]
    v_pk_fma_f32 v[118:119], v[118:119], v[252:253], v[250:251] op_sel_hi:[1,0,0] neg_lo:[0,0,1] neg_hi:[0,0,1]
    v_pk_fma_f32 v[120:121], v[120:121], v[252:253], v[250:251] op_sel_hi:[1,0,0] neg_lo:[0,0,1] neg_hi:[0,0,1]
    v_pk_fma_f32 v[122:123], v[122:123], v[252:253], v[250:251] op_sel_hi:[1,0,0] neg_lo:[0,0,1] neg_hi:[0,0,1]
    v_exp_f32 v116, v116
    v_exp_f32 v117, v117
    v_exp_f32 v118, v118
    v_exp_f32 v119, v119
    v_mfma_f32_16x16x32_bf16 v[44:47], v[20:23], v[180:183], v[44:47]
    v_exp_f32 v120, v120
    v_exp_f32 v121, v121
    v_exp_f32 v122, v122
    v_exp_f32 v123, v123
    v_cvt_pk_bf16_f32 v116, v116, v117
    v_cvt_pk_bf16_f32 v117, v118, v119
    v_cvt_pk_bf16_f32 v118, v120, v121
    v_cvt_pk_bf16_f32 v119, v122, v123
    s_waitcnt lgkmcnt(4)
    v_mfma_f32_16x16x32_bf16 v[32:35], v[24:27], v[156:159], v[32:35]
    ds_read_b128 v[16:19], v14 offset:13824
    s_mov_b32 exec_lo, 0x00030003
    s_mov_b32 exec_hi, 0x00030003
    ds_read_b128 v[20:23], v15 offset:13824
    s_mov_b64 exec, -1
    v_pk_fma_f32 v[92:93], v[92:93], v[252:253], v[248:249] op_sel_hi:[1,0,0] neg_lo:[0,0,1] neg_hi:[0,0,1]
    v_pk_fma_f32 v[94:95], v[94:95], v[252:253], v[248:249] op_sel_hi:[1,0,0] neg_lo:[0,0,1] neg_hi:[0,0,1]
    v_pk_fma_f32 v[96:97], v[96:97], v[252:253], v[248:249] op_sel_hi:[1,0,0] neg_lo:[0,0,1] neg_hi:[0,0,1]
    v_pk_fma_f32 v[98:99], v[98:99], v[252:253], v[248:249] op_sel_hi:[1,0,0] neg_lo:[0,0,1] neg_hi:[0,0,1]
    v_exp_f32 v92, v92
    v_exp_f32 v93, v93
    v_exp_f32_e64 v94, v94
    v_mfma_f32_16x16x32_bf16 v[40:43], v[28:31], v[156:159], v[40:43]
    v_exp_f32 v95, v95
    v_exp_f32 v96, v96
    v_exp_f32 v97, v97
    v_exp_f32 v98, v98
    v_exp_f32_e64 v99, v99
    v_cvt_pk_bf16_f32 v92, v92, v93
    v_cvt_pk_bf16_f32 v93, v94, v95
    v_mfma_f32_16x16x32_bf16 v[36:39], v[24:27], v[164:167], v[36:39]
    v_cvt_pk_bf16_f32 v94, v96, v97
    v_cvt_pk_bf16_f32 v95, v98, v99
    v_pk_fma_f32 v[104:105], v[104:105], v[252:253], v[250:251] op_sel_hi:[1,0,0] neg_lo:[0,0,1] neg_hi:[0,0,1]
    v_pk_fma_f32 v[106:107], v[106:107], v[252:253], v[250:251] op_sel_hi:[1,0,0] neg_lo:[0,0,1] neg_hi:[0,0,1]
    v_exp_f32 v104, v104
    v_exp_f32 v105, v105
    v_exp_f32_e64 v106, v106
    v_mfma_f32_16x16x32_bf16 v[44:47], v[28:31], v[164:167], v[44:47]
    v_exp_f32 v107, v107
    v_mov_b32 v100, 0
    v_mov_b32_e64 v101, 0
    v_cvt_pk_bf16_f32 v102, v104, v105
    v_cvt_pk_bf16_f32 v103, v106, v107
    s_waitcnt lgkmcnt(4)
    s_barrier
    s_waitcnt lgkmcnt(2)
    v_mfma_f32_16x16x32_bf16 v[32:35], v[240:243], v[140:143], v[32:35]
    ds_read_b128 v[24:27], v14 offset:9216
    s_mov_b32 exec_lo, 0x00030003
    s_mov_b32 exec_hi, 0x00030003
    ds_read_b128 v[28:31], v15 offset:9216
    s_mov_b64 exec, -1
    ds_read_b128 v[220:223], v7 offset:16384
    ds_read_b128 v[224:227], v7 offset:34816
    v_mfma_f32_16x16x32_bf16 v[40:43], v[244:247], v[140:143], v[40:43]
    ds_read_b128 v[228:231], v7 offset:17408
    ds_read_b128 v[232:235], v7 offset:35840
    v_mfma_f32_16x16x32_bf16 v[36:39], v[240:243], v[148:151], v[36:39]
    ds_read_b128 v[204:207], v7 offset:14336
    ds_read_b128 v[208:211], v7 offset:32768
    v_mfma_f32_16x16x32_bf16 v[44:47], v[244:247], v[148:151], v[44:47]
    ds_read_b128 v[212:215], v7 offset:15360
    ds_read_b128 v[216:219], v7 offset:33792
    s_waitcnt lgkmcnt(10)
    v_mfma_f32_16x16x32_bf16 v[32:35], v[16:19], v[124:127], v[32:35]
    ds_read_b128 v[240:243], v14 offset:4608
    s_mov_b32 exec_lo, 0x00030003
    s_mov_b32 exec_hi, 0x00030003
    ds_read_b128 v[244:247], v15 offset:4608
    s_mov_b64 exec, -1
    ds_read_b128 v[188:191], v7 offset:12288
    ds_read_b128 v[192:195], v7 offset:30720
    v_mfma_f32_16x16x32_bf16 v[40:43], v[20:23], v[124:127], v[40:43]
    ds_read_b128 v[196:199], v7 offset:13312
    ds_read_b128 v[200:203], v7 offset:31744
    v_mfma_f32_16x16x32_bf16 v[36:39], v[16:19], v[132:135], v[36:39]
    ds_read_b128 v[172:175], v7 offset:10240
    ds_read_b128 v[176:179], v7 offset:28672
    v_mfma_f32_16x16x32_bf16 v[44:47], v[20:23], v[132:135], v[44:47]
    ds_read_b128 v[180:183], v7 offset:11264
    ds_read_b128 v[184:187], v7 offset:29696
    v_mfma_f32_16x16x32_bf16 v[32:35], v[24:27], v[108:111], v[32:35]
    ds_read_b128 v[156:159], v7 offset:8192
    ds_read_b128 v[160:163], v7 offset:26624
    v_mfma_f32_16x16x32_bf16 v[40:43], v[28:31], v[108:111], v[40:43]
    ds_read_b128 v[164:167], v7 offset:9216
    ds_read_b128 v[168:171], v7 offset:27648
    v_mfma_f32_16x16x32_bf16 v[36:39], v[24:27], v[116:119], v[36:39]
    v_mov_b32 v73, 0
    v_mov_b32 v74, 0
    v_mov_b32 v75, 0
    v_mov_b32 v77, 0
    v_mov_b32 v78, 0
    v_mov_b32 v79, 0
    ds_read_b128 v[140:143], v7 offset:6144
    v_mfma_f32_16x16x32_bf16 v[44:47], v[28:31], v[116:119], v[44:47]
    ds_read_b128 v[144:147], v7 offset:24576
    ds_read_b128 v[148:151], v7 offset:7168
    v_mfma_f32_16x16x32_bf16 v[32:35], v[240:243], v[92:95], v[32:35]
    ds_read_b128 v[152:155], v7 offset:25600
    ds_read_b128 v[124:127], v7 offset:4096
    v_mfma_f32_16x16x32_bf16 v[40:43], v[244:247], v[92:95], v[40:43]
    ds_read_b128 v[128:131], v7 offset:22528
    ds_read_b128 v[132:135], v7 offset:5120
    v_mfma_f32_16x16x32_bf16 v[36:39], v[240:243], v[100:103], v[36:39]
    ds_read_b128 v[136:139], v7 offset:23552
    ds_read_b128 v[108:111], v7 offset:2048
    v_mfma_f32_16x16x32_bf16 v[44:47], v[244:247], v[100:103], v[44:47]
    ds_read_b128 v[112:115], v7 offset:20480
    ds_read_b128 v[116:119], v7 offset:3072
    ds_read_b128 v[120:123], v7 offset:21504
    s_nop 7
    v_rcp_f32 v238, v42
    v_rcp_f32 v240, v46
    s_nop 0
    v_pk_mul_f32 v[32:33], v[32:33], v[238:239] op_sel_hi:[1,0]
    v_pk_mul_f32 v[34:35], v[34:35], v[238:239] op_sel_hi:[1,0]
    v_pk_mul_f32 v[40:41], v[40:41], v[238:239] op_sel_hi:[1,0]
    v_cvt_pk_bf16_f32 v32, v32, v33
    v_cvt_pk_bf16_f32 v33, v34, v35
    v_cvt_pk_bf16_f32 v40, v40, v41
    ds_write_b64 v13, v[32:33] offset:0
    v_pk_mul_f32 v[36:37], v[36:37], v[240:241] op_sel_hi:[1,0]
    v_pk_mul_f32 v[38:39], v[38:39], v[240:241] op_sel_hi:[1,0]
    v_pk_mul_f32 v[44:45], v[44:45], v[240:241] op_sel_hi:[1,0]
    v_cvt_pk_bf16_f32 v36, v36, v37
    v_cvt_pk_bf16_f32 v37, v38, v39
    v_cvt_pk_bf16_f32 v44, v44, v45
    ds_write_b64 v13, v[36:37] offset:1024
    ds_read_b128 v[92:95], v7 offset:0
    ds_read_b128 v[96:99], v7 offset:18432
    ds_read_b128 v[100:103], v7 offset:1024
    ds_read_b128 v[104:107], v7 offset:19456
    s_mov_b64 exec, 0xffff
    ds_write_b32 v9, v40 offset:0
    ds_write_b32 v9, v44 offset:256
    s_mov_b64 exec, -1
    s_waitcnt lgkmcnt(0)
    s_barrier
    s_lshl_b32 s57, s66, 6
    s_mul_i32 s43, s39, 1280
    s_lshl_b32 s42, s41, 3
    s_add_u32 s43, s43, s42
    s_add_u32 s43, s43, 4722688
    s_add_u32 s24, s36, s43
    s_addc_u32 s25, s37, 0
    s_movk_i32 s26, 1280
    s_mov_b32 s27, 0x20000
    v_mov_b32 v238, s98
    v_mov_b32 v239, s99
    v_and_b32 v7, 7, v1
    v_lshlrev_b32_e64 v7, 5, v7
    ds_read_b64_tr_b16 v[16:17], v4 offset:0
    ds_read_b64_tr_b16 v[18:19], v4 offset:2048
    ds_read_b64_tr_b16 v[20:21], v4 offset:4096
    ds_read_b64_tr_b16 v[22:23], v4 offset:6144
    ds_read_b64_tr_b16 v[24:25], v4 offset:8192
    ds_read_b64_tr_b16 v[26:27], v4 offset:10240
    s_waitcnt lgkmcnt(4)
    v_mfma_f32_16x16x32_bf16 v[80:83], v[16:19], v[92:95], 0
    ds_read_b64_tr_b16 v[28:29], v4 offset:12288
    v_mfma_f32_16x16x32_bf16 v[84:87], v[16:19], v[96:99], 0
    ds_read_b64_tr_b16 v[30:31], v4 offset:14336
    s_waitcnt lgkmcnt(4)
    v_mfma_f32_16x16x32_bf16 v[80:83], v[20:23], v[100:103], v[80:83]
    ds_read_b64_tr_b16 v[16:17], v4 offset:16384
    v_mfma_f32_16x16x32_bf16 v[84:87], v[20:23], v[104:107], v[84:87]
    ds_read_b64_tr_b16 v[18:19], v4 offset:18432
    s_waitcnt lgkmcnt(4)
    v_mfma_f32_16x16x32_bf16 v[80:83], v[24:27], v[108:111], v[80:83]
    ds_read_b64_tr_b16 v[20:21], v4 offset:20480
    v_mfma_f32_16x16x32_bf16 v[84:87], v[24:27], v[112:115], v[84:87]
    ds_read_b64_tr_b16 v[22:23], v4 offset:22528
    s_barrier
    s_waitcnt lgkmcnt(4)
    v_mfma_f32_16x16x32_bf16 v[80:83], v[28:31], v[116:119], v[80:83]
    ds_read_b64_tr_b16 v[24:25], v3 offset:24576
    v_mfma_f32_16x16x32_bf16 v[84:87], v[28:31], v[120:123], v[84:87]
    ds_read_b64_tr_b16 v[26:27], v3 offset:26624
    s_waitcnt lgkmcnt(4)
    v_mfma_f32_16x16x32_bf16 v[80:83], v[16:19], v[124:127], v[80:83]
    ds_read_b64_tr_b16 v[28:29], v3 offset:28672
    v_mfma_f32_16x16x32_bf16 v[84:87], v[16:19], v[128:131], v[84:87]
    ds_read_b64_tr_b16 v[30:31], v3 offset:30720
    s_waitcnt lgkmcnt(4)
    v_mfma_f32_16x16x32_bf16 v[80:83], v[20:23], v[132:135], v[80:83]
    ds_read_b64_tr_b16 v[16:17], v3 offset:32768
    v_mfma_f32_16x16x32_bf16 v[84:87], v[20:23], v[136:139], v[84:87]
    ds_read_b64_tr_b16 v[18:19], v3 offset:34816
    s_waitcnt lgkmcnt(4)
    v_mfma_f32_16x16x32_bf16 v[80:83], v[24:27], v[140:143], v[80:83]
    ds_read_b64_tr_b16 v[20:21], v3 offset:36864
    v_mfma_f32_16x16x32_bf16 v[84:87], v[24:27], v[144:147], v[84:87]
    ds_read_b64_tr_b16 v[22:23], v3 offset:38912
    s_waitcnt lgkmcnt(4)
    v_mfma_f32_16x16x32_bf16 v[80:83], v[28:31], v[148:151], v[80:83]
    ds_read_b64_tr_b16 v[24:25], v3 offset:40960
    v_mfma_f32_16x16x32_bf16 v[84:87], v[28:31], v[152:155], v[84:87]
    ds_read_b64_tr_b16 v[26:27], v3 offset:43008
    s_waitcnt lgkmcnt(4)
    v_mfma_f32_16x16x32_bf16 v[80:83], v[16:19], v[156:159], v[80:83]
    ds_read_b64_tr_b16 v[28:29], v3 offset:45056
    v_lshlrev_b32_e64 v236, 4, v1
    v_add_u32 v236, 146432, v236
    ds_read_b128 v[56:59], v236 offset:0
    ds_read_b128 v[60:63], v236 offset:1024
    ds_read_b128 v[64:67], v236 offset:2048
    ds_read_b128 v[68:71], v236 offset:3072
    ds_read_b32 v72, v55 offset:0
    ds_read_b32 v76, v55 offset:256
    v_mfma_f32_16x16x32_bf16 v[84:87], v[16:19], v[160:163], v[84:87]
    ds_read_b64_tr_b16 v[30:31], v3 offset:47104
    s_barrier
    s_waitcnt lgkmcnt(10)
    v_mfma_f32_16x16x32_bf16 v[80:83], v[20:23], v[164:167], v[80:83]
    ds_read_b64_tr_b16 v[16:17], v2 offset:0
    v_mfma_f32_16x16x32_bf16 v[84:87], v[20:23], v[168:171], v[84:87]
    ds_read_b64_tr_b16 v[18:19], v2 offset:2048
    s_waitcnt lgkmcnt(10)
    v_mfma_f32_16x16x32_bf16 v[80:83], v[24:27], v[172:175], v[80:83]
    ds_read_b64_tr_b16 v[20:21], v2 offset:4096
    v_mfma_f32_16x16x32_bf16 v[84:87], v[24:27], v[176:179], v[84:87]
    ds_read_b64_tr_b16 v[22:23], v2 offset:6144
    s_waitcnt lgkmcnt(4)
    v_mfma_f32_16x16x32_bf16 v[80:83], v[28:31], v[180:183], v[80:83]
    ds_read_b64_tr_b16 v[24:25], v2 offset:8192
    v_mfma_f32_16x16x32_bf16 v[84:87], v[28:31], v[184:187], v[84:87]
    ds_read_b64_tr_b16 v[26:27], v2 offset:10240
    s_waitcnt lgkmcnt(4)
    v_mfma_f32_16x16x32_bf16 v[80:83], v[16:19], v[188:191], v[80:83]
    ds_read_b64_tr_b16 v[28:29], v2 offset:12288
    v_mfma_f32_16x16x32_bf16 v[84:87], v[16:19], v[192:195], v[84:87]
    ds_read_b64_tr_b16 v[30:31], v2 offset:14336
    s_waitcnt lgkmcnt(4)
    v_mfma_f32_16x16x32_bf16 v[80:83], v[20:23], v[196:199], v[80:83]
    ds_read_b64_tr_b16 v[16:17], v2 offset:16384
    v_mfma_f32_16x16x32_bf16 v[84:87], v[20:23], v[200:203], v[84:87]
    ds_read_b64_tr_b16 v[18:19], v2 offset:18432
    s_waitcnt lgkmcnt(4)
    v_mfma_f32_16x16x32_bf16 v[80:83], v[24:27], v[204:207], v[80:83]
    ds_read_b64_tr_b16 v[20:21], v2 offset:20480
    v_mfma_f32_16x16x32_bf16 v[84:87], v[24:27], v[208:211], v[84:87]
    ds_read_b64_tr_b16 v[22:23], v2 offset:22528
    s_waitcnt lgkmcnt(4)
    v_mfma_f32_16x16x32_bf16 v[80:83], v[28:31], v[212:215], v[80:83]
    ds_read_b64_tr_b16 v[24:25], v4 offset:24576
    v_mfma_f32_16x16x32_bf16 v[84:87], v[28:31], v[216:219], v[84:87]
    ds_read_b64_tr_b16 v[26:27], v5 offset:27136
    s_waitcnt lgkmcnt(4)
    v_mfma_f32_16x16x32_bf16 v[80:83], v[16:19], v[220:223], v[80:83]
    ds_read_b64_tr_b16 v[28:29], v5 offset:29184
    v_mfma_f32_16x16x32_bf16 v[84:87], v[16:19], v[224:227], v[84:87]
    ds_read_b64_tr_b16 v[30:31], v4 offset:31744
    s_waitcnt lgkmcnt(4)
    v_mfma_f32_16x16x32_bf16 v[80:83], v[20:23], v[228:231], v[80:83]
    ds_read_b64_tr_b16 v[16:17], v6 offset:24576
    v_mfma_f32_16x16x32_bf16 v[84:87], v[20:23], v[232:235], v[84:87]
    s_barrier
    s_waitcnt lgkmcnt(3)
    v_mfma_f32_16x16x32_bf16 v[80:83], v[24:27], v[56:59], v[80:83]
    ds_read_b64_tr_b16 v[20:21], v2 offset:24576
    v_mfma_f32_16x16x32_bf16 v[84:87], v[24:27], v[60:63], v[84:87]
    ds_read_b64_tr_b16 v[22:23], v2 offset:26624
    s_waitcnt lgkmcnt(3)
    v_mfma_f32_16x16x32_bf16 v[80:83], v[28:31], v[64:67], v[80:83]
    ds_read_b64_tr_b16 v[24:25], v2 offset:28672
    v_mfma_f32_16x16x32_bf16 v[84:87], v[28:31], v[68:71], v[84:87]
    ds_read_b64_tr_b16 v[26:27], v2 offset:30720
    s_waitcnt lgkmcnt(4)
    v_mfma_f32_16x16x32_bf16 v[80:83], v[16:19], v[72:75], v[80:83]
    ds_read_b64_tr_b16 v[28:29], v2 offset:32768
    v_mfma_f32_16x16x32_bf16 v[84:87], v[16:19], v[76:79], v[84:87]
    ds_read_b64_tr_b16 v[30:31], v2 offset:34816
    s_waitcnt lgkmcnt(4)
    v_mfma_f32_16x16x32_bf16 v[40:43], v[20:23], v[92:95], 0
    ds_read_b64_tr_b16 v[16:17], v2 offset:36864
    v_mfma_f32_16x16x32_bf16 v[44:47], v[20:23], v[96:99], 0
    ds_read_b64_tr_b16 v[18:19], v2 offset:38912
    s_waitcnt lgkmcnt(4)
    v_mfma_f32_16x16x32_bf16 v[40:43], v[24:27], v[100:103], v[40:43]
    ds_read_b64_tr_b16 v[20:21], v2 offset:40960
    v_mfma_f32_16x16x32_bf16 v[44:47], v[24:27], v[104:107], v[44:47]
    ds_read_b64_tr_b16 v[22:23], v2 offset:43008
    s_waitcnt lgkmcnt(4)
    s_nop 0
    v_mfma_f32_16x16x32_bf16 v[40:43], v[28:31], v[108:111], v[40:43]
    ds_read_b64_tr_b16 v[24:25], v2 offset:45056
    v_cvt_pk_bf16_f32 v88, v80, v81
    v_mfma_f32_16x16x32_bf16 v[44:47], v[28:31], v[112:115], v[44:47]
    ds_read_b64_tr_b16 v[26:27], v2 offset:47104
    v_cvt_pk_bf16_f32 v89, v82, v83
    v_cvt_pk_bf16_f32 v90, v84, v85
    v_cvt_pk_bf16_f32 v91, v86, v87
    s_lshl_b32 s42, s58, 6
    s_mul_i32 s43, s38, 73728
    s_add_u32 s44, s42, s43
    buffer_store_dwordx4 v[88:91], v53, s[68:71], s44 offen sc1
    s_barrier
    s_waitcnt lgkmcnt(4)
    v_mfma_f32_16x16x32_bf16 v[40:43], v[16:19], v[116:119], v[40:43]
    ds_read_b64_tr_b16 v[28:29], v3 offset:0
    v_mfma_f32_16x16x32_bf16 v[44:47], v[16:19], v[120:123], v[44:47]
    ds_read_b64_tr_b16 v[30:31], v3 offset:2048
    s_waitcnt lgkmcnt(4)
    v_mfma_f32_16x16x32_bf16 v[40:43], v[20:23], v[124:127], v[40:43]
    ds_read_b64_tr_b16 v[16:17], v3 offset:4096
    v_mfma_f32_16x16x32_bf16 v[44:47], v[20:23], v[128:131], v[44:47]
    ds_read_b64_tr_b16 v[18:19], v3 offset:6144
    s_waitcnt lgkmcnt(4)
    v_mfma_f32_16x16x32_bf16 v[40:43], v[24:27], v[132:135], v[40:43]
    ds_read_b64_tr_b16 v[20:21], v3 offset:8192
    v_mfma_f32_16x16x32_bf16 v[44:47], v[24:27], v[136:139], v[44:47]
    ds_read_b64_tr_b16 v[22:23], v3 offset:10240
    s_waitcnt lgkmcnt(4)
    v_mfma_f32_16x16x32_bf16 v[40:43], v[28:31], v[140:143], v[40:43]
    ds_read_b64_tr_b16 v[24:25], v3 offset:12288
    v_mfma_f32_16x16x32_bf16 v[44:47], v[28:31], v[144:147], v[44:47]
    ds_read_b64_tr_b16 v[26:27], v3 offset:14336
    s_waitcnt lgkmcnt(4)
    v_mfma_f32_16x16x32_bf16 v[40:43], v[16:19], v[148:151], v[40:43]
    ds_read_b64_tr_b16 v[28:29], v3 offset:16384
    v_mfma_f32_16x16x32_bf16 v[44:47], v[16:19], v[152:155], v[44:47]
    ds_read_b64_tr_b16 v[30:31], v3 offset:18432
    s_waitcnt lgkmcnt(4)
    v_mfma_f32_16x16x32_bf16 v[40:43], v[20:23], v[156:159], v[40:43]
    ds_read_b64_tr_b16 v[16:17], v3 offset:20480
    v_mfma_f32_16x16x32_bf16 v[44:47], v[20:23], v[160:163], v[44:47]
    ds_read_b64_tr_b16 v[18:19], v3 offset:22528
    s_barrier
    s_waitcnt lgkmcnt(4)
    v_mfma_f32_16x16x32_bf16 v[40:43], v[24:27], v[164:167], v[40:43]
    ds_read_b64_tr_b16 v[20:21], v4 offset:0
    v_mfma_f32_16x16x32_bf16 v[44:47], v[24:27], v[168:171], v[44:47]
    ds_read_b64_tr_b16 v[22:23], v4 offset:2048
    s_waitcnt lgkmcnt(4)
    v_mfma_f32_16x16x32_bf16 v[40:43], v[28:31], v[172:175], v[40:43]
    ds_read_b64_tr_b16 v[24:25], v4 offset:4096
    v_mfma_f32_16x16x32_bf16 v[44:47], v[28:31], v[176:179], v[44:47]
    ds_read_b64_tr_b16 v[26:27], v4 offset:6144
    s_waitcnt lgkmcnt(4)
    v_mfma_f32_16x16x32_bf16 v[40:43], v[16:19], v[180:183], v[40:43]
    ds_read_b64_tr_b16 v[28:29], v4 offset:8192
    v_mfma_f32_16x16x32_bf16 v[44:47], v[16:19], v[184:187], v[44:47]
    ds_read_b64_tr_b16 v[30:31], v4 offset:10240
    s_waitcnt lgkmcnt(4)
    v_mfma_f32_16x16x32_bf16 v[40:43], v[20:23], v[188:191], v[40:43]
    ds_read_b64_tr_b16 v[16:17], v4 offset:12288
    v_mfma_f32_16x16x32_bf16 v[44:47], v[20:23], v[192:195], v[44:47]
    ds_read_b64_tr_b16 v[18:19], v4 offset:14336
    s_waitcnt lgkmcnt(4)
    v_mfma_f32_16x16x32_bf16 v[40:43], v[24:27], v[196:199], v[40:43]
    ds_read_b64_tr_b16 v[20:21], v4 offset:16384
    v_mfma_f32_16x16x32_bf16 v[44:47], v[24:27], v[200:203], v[44:47]
    ds_read_b64_tr_b16 v[22:23], v4 offset:18432
    s_waitcnt lgkmcnt(4)
    v_mfma_f32_16x16x32_bf16 v[40:43], v[28:31], v[204:207], v[40:43]
    ds_read_b64_tr_b16 v[24:25], v4 offset:20480
    v_mfma_f32_16x16x32_bf16 v[44:47], v[28:31], v[208:211], v[44:47]
    ds_read_b64_tr_b16 v[26:27], v4 offset:22528
    s_waitcnt lgkmcnt(4)
    v_mfma_f32_16x16x32_bf16 v[40:43], v[16:19], v[212:215], v[40:43]
    ds_read_b64_tr_b16 v[28:29], v4 offset:33792
    v_mfma_f32_16x16x32_bf16 v[44:47], v[16:19], v[216:219], v[44:47]
    ds_read_b64_tr_b16 v[30:31], v5 offset:36352
    s_waitcnt lgkmcnt(4)
    v_mfma_f32_16x16x32_bf16 v[40:43], v[20:23], v[220:223], v[40:43]
    ds_read_b64_tr_b16 v[16:17], v5 offset:38400
    v_mfma_f32_16x16x32_bf16 v[44:47], v[20:23], v[224:227], v[44:47]
    ds_read_b64_tr_b16 v[18:19], v4 offset:40960
    s_waitcnt lgkmcnt(4)
    v_mfma_f32_16x16x32_bf16 v[40:43], v[24:27], v[228:231], v[40:43]
    ds_read_b64_tr_b16 v[20:21], v6 offset:33792
    v_mfma_f32_16x16x32_bf16 v[44:47], v[24:27], v[232:235], v[44:47]
    s_barrier
    s_waitcnt lgkmcnt(3)
    v_mfma_f32_16x16x32_bf16 v[40:43], v[28:31], v[56:59], v[40:43]
    ds_read_b64_tr_b16 v[24:25], v3 offset:24576
    v_mfma_f32_16x16x32_bf16 v[44:47], v[28:31], v[60:63], v[44:47]
    ds_read_b64_tr_b16 v[26:27], v3 offset:26624
    s_waitcnt lgkmcnt(3)
    v_mfma_f32_16x16x32_bf16 v[40:43], v[16:19], v[64:67], v[40:43]
    ds_read_b64_tr_b16 v[28:29], v3 offset:28672
    v_mfma_f32_16x16x32_bf16 v[44:47], v[16:19], v[68:71], v[44:47]
    ds_read_b64_tr_b16 v[30:31], v3 offset:30720
    s_waitcnt lgkmcnt(4)
    v_mfma_f32_16x16x32_bf16 v[40:43], v[20:23], v[72:75], v[40:43]
    ds_read_b64_tr_b16 v[16:17], v3 offset:32768
    v_mfma_f32_16x16x32_bf16 v[44:47], v[20:23], v[76:79], v[44:47]
    ds_read_b64_tr_b16 v[18:19], v3 offset:34816
    s_waitcnt lgkmcnt(4)
    v_mfma_f32_16x16x32_bf16 v[32:35], v[24:27], v[92:95], 0
    ds_read_b64_tr_b16 v[20:21], v3 offset:36864
    v_mfma_f32_16x16x32_bf16 v[36:39], v[24:27], v[96:99], 0
    ds_read_b64_tr_b16 v[22:23], v3 offset:38912
    s_waitcnt lgkmcnt(4)
    v_mfma_f32_16x16x32_bf16 v[32:35], v[28:31], v[100:103], v[32:35]
    ds_read_b64_tr_b16 v[24:25], v3 offset:40960
    v_mfma_f32_16x16x32_bf16 v[36:39], v[28:31], v[104:107], v[36:39]
    ds_read_b64_tr_b16 v[26:27], v3 offset:43008
    s_waitcnt lgkmcnt(4)
    v_mfma_f32_16x16x32_bf16 v[32:35], v[16:19], v[108:111], v[32:35]
    ds_read_b64_tr_b16 v[28:29], v3 offset:45056
    v_cvt_pk_bf16_f32 v88, v40, v41
    v_mfma_f32_16x16x32_bf16 v[36:39], v[16:19], v[112:115], v[36:39]
    ds_read_b64_tr_b16 v[30:31], v3 offset:47104
    v_cvt_pk_bf16_f32 v89, v42, v43
    v_cvt_pk_bf16_f32 v90, v44, v45
    v_cvt_pk_bf16_f32 v91, v46, v47
    s_lshl_b32 s42, s59, 6
    s_mul_i32 s43, s38, 73728
    s_add_u32 s44, s42, s43
    buffer_store_dwordx4 v[88:91], v53, s[68:71], s44 offen sc1
    s_barrier
    s_waitcnt lgkmcnt(4)
    v_mfma_f32_16x16x32_bf16 v[32:35], v[20:23], v[116:119], v[32:35]
    ds_read_b64_tr_b16 v[16:17], v2 offset:0
    s_waitcnt vmcnt(1)
    s_lshl_b32 s42, s38, 5
    s_mov_b64 exec, 1
    buffer_store_dwordx2 v[238:239], off, s[24:27], s42 offset:0 sc1
    s_mov_b64 exec, -1
    v_mfma_f32_16x16x32_bf16 v[36:39], v[20:23], v[120:123], v[36:39]
    ds_read_b64_tr_b16 v[18:19], v2 offset:2048
    s_waitcnt lgkmcnt(4)
    v_mfma_f32_16x16x32_bf16 v[32:35], v[24:27], v[124:127], v[32:35]
    ds_read_b64_tr_b16 v[20:21], v2 offset:4096
    v_mfma_f32_16x16x32_bf16 v[36:39], v[24:27], v[128:131], v[36:39]
    ds_read_b64_tr_b16 v[22:23], v2 offset:6144
    s_waitcnt lgkmcnt(4)
    v_mfma_f32_16x16x32_bf16 v[32:35], v[28:31], v[132:135], v[32:35]
    ds_read_b64_tr_b16 v[24:25], v2 offset:8192
    v_mfma_f32_16x16x32_bf16 v[36:39], v[28:31], v[136:139], v[36:39]
    ds_read_b64_tr_b16 v[26:27], v2 offset:10240
    s_waitcnt lgkmcnt(4)
    v_mfma_f32_16x16x32_bf16 v[32:35], v[16:19], v[140:143], v[32:35]
    ds_read_b64_tr_b16 v[28:29], v2 offset:12288
    v_mfma_f32_16x16x32_bf16 v[36:39], v[16:19], v[144:147], v[36:39]
    ds_read_b64_tr_b16 v[30:31], v2 offset:14336
    s_waitcnt lgkmcnt(4)
    v_mfma_f32_16x16x32_bf16 v[32:35], v[20:23], v[148:151], v[32:35]
    ds_read_b64_tr_b16 v[16:17], v2 offset:16384
    v_mfma_f32_16x16x32_bf16 v[36:39], v[20:23], v[152:155], v[36:39]
    ds_read_b64_tr_b16 v[18:19], v2 offset:18432
    s_waitcnt lgkmcnt(4)
    v_mfma_f32_16x16x32_bf16 v[32:35], v[24:27], v[156:159], v[32:35]
    ds_read_b64_tr_b16 v[20:21], v2 offset:20480
    v_mfma_f32_16x16x32_bf16 v[36:39], v[24:27], v[160:163], v[36:39]
    ds_read_b64_tr_b16 v[22:23], v2 offset:22528
    s_barrier
    s_waitcnt lgkmcnt(4)
    v_mfma_f32_16x16x32_bf16 v[32:35], v[28:31], v[164:167], v[32:35]
    ds_read_b64_tr_b16 v[24:25], v2 offset:24576
    v_mfma_f32_16x16x32_bf16 v[36:39], v[28:31], v[168:171], v[36:39]
    ds_read_b64_tr_b16 v[26:27], v2 offset:26624
    s_waitcnt lgkmcnt(4)
    v_mfma_f32_16x16x32_bf16 v[32:35], v[16:19], v[172:175], v[32:35]
    ds_read_b64_tr_b16 v[28:29], v2 offset:28672
    v_mfma_f32_16x16x32_bf16 v[36:39], v[16:19], v[176:179], v[36:39]
    ds_read_b64_tr_b16 v[30:31], v2 offset:30720
    s_waitcnt lgkmcnt(4)
    v_mfma_f32_16x16x32_bf16 v[32:35], v[20:23], v[180:183], v[32:35]
    ds_read_b64_tr_b16 v[16:17], v2 offset:32768
    v_mfma_f32_16x16x32_bf16 v[36:39], v[20:23], v[184:187], v[36:39]
    ds_read_b64_tr_b16 v[18:19], v2 offset:34816
    s_waitcnt lgkmcnt(4)
    v_mfma_f32_16x16x32_bf16 v[32:35], v[24:27], v[188:191], v[32:35]
    ds_read_b64_tr_b16 v[20:21], v2 offset:36864
    v_mfma_f32_16x16x32_bf16 v[36:39], v[24:27], v[192:195], v[36:39]
    ds_read_b64_tr_b16 v[22:23], v2 offset:38912
    s_waitcnt lgkmcnt(4)
    v_mfma_f32_16x16x32_bf16 v[32:35], v[28:31], v[196:199], v[32:35]
    ds_read_b64_tr_b16 v[24:25], v2 offset:40960
    v_mfma_f32_16x16x32_bf16 v[36:39], v[28:31], v[200:203], v[36:39]
    ds_read_b64_tr_b16 v[26:27], v2 offset:43008
    s_waitcnt lgkmcnt(4)
    v_mfma_f32_16x16x32_bf16 v[32:35], v[16:19], v[204:207], v[32:35]
    ds_read_b64_tr_b16 v[28:29], v2 offset:45056
    v_mfma_f32_16x16x32_bf16 v[36:39], v[16:19], v[208:211], v[36:39]
    ds_read_b64_tr_b16 v[30:31], v2 offset:47104
    s_waitcnt lgkmcnt(4)
    v_mfma_f32_16x16x32_bf16 v[32:35], v[20:23], v[212:215], v[32:35]
    ds_read_b64_tr_b16 v[16:17], v4 offset:24576
    v_mfma_f32_16x16x32_bf16 v[36:39], v[20:23], v[216:219], v[36:39]
    ds_read_b64_tr_b16 v[18:19], v5 offset:27136
    s_waitcnt lgkmcnt(4)
    v_mfma_f32_16x16x32_bf16 v[32:35], v[24:27], v[220:223], v[32:35]
    ds_read_b64_tr_b16 v[20:21], v5 offset:29184
    v_mfma_f32_16x16x32_bf16 v[36:39], v[24:27], v[224:227], v[36:39]
    ds_read_b64_tr_b16 v[22:23], v4 offset:31744
    s_waitcnt lgkmcnt(4)
    v_mfma_f32_16x16x32_bf16 v[32:35], v[28:31], v[228:231], v[32:35]
    ds_read_b64_tr_b16 v[24:25], v6 offset:24576
    v_mfma_f32_16x16x32_bf16 v[36:39], v[28:31], v[232:235], v[36:39]
    s_barrier
    s_waitcnt lgkmcnt(3)
    v_mfma_f32_16x16x32_bf16 v[32:35], v[16:19], v[56:59], v[32:35]
    ds_read_b64_tr_b16 v[28:29], v3 offset:0
    v_mfma_f32_16x16x32_bf16 v[36:39], v[16:19], v[60:63], v[36:39]
    ds_read_b64_tr_b16 v[30:31], v3 offset:2048
    s_waitcnt lgkmcnt(3)
    v_mfma_f32_16x16x32_bf16 v[32:35], v[20:23], v[64:67], v[32:35]
    ds_read_b64_tr_b16 v[16:17], v3 offset:4096
    v_mfma_f32_16x16x32_bf16 v[36:39], v[20:23], v[68:71], v[36:39]
    ds_read_b64_tr_b16 v[18:19], v3 offset:6144
    s_waitcnt lgkmcnt(4)
    v_mfma_f32_16x16x32_bf16 v[32:35], v[24:27], v[72:75], v[32:35]
    ds_read_b64_tr_b16 v[20:21], v3 offset:8192
    v_mfma_f32_16x16x32_bf16 v[36:39], v[24:27], v[76:79], v[36:39]
    ds_read_b64_tr_b16 v[22:23], v3 offset:10240
    s_waitcnt lgkmcnt(4)
    v_mfma_f32_16x16x32_bf16 v[40:43], v[28:31], v[92:95], 0
    ds_read_b64_tr_b16 v[24:25], v3 offset:12288
    v_mfma_f32_16x16x32_bf16 v[44:47], v[28:31], v[96:99], 0
    ds_read_b64_tr_b16 v[26:27], v3 offset:14336
    s_waitcnt lgkmcnt(4)
    v_mfma_f32_16x16x32_bf16 v[40:43], v[16:19], v[100:103], v[40:43]
    ds_read_b64_tr_b16 v[28:29], v3 offset:16384
    v_mfma_f32_16x16x32_bf16 v[44:47], v[16:19], v[104:107], v[44:47]
    ds_read_b64_tr_b16 v[30:31], v3 offset:18432
    s_waitcnt lgkmcnt(4)
    v_mfma_f32_16x16x32_bf16 v[40:43], v[20:23], v[108:111], v[40:43]
    ds_read_b64_tr_b16 v[16:17], v3 offset:20480
    v_cvt_pk_bf16_f32 v88, v32, v33
    v_mfma_f32_16x16x32_bf16 v[44:47], v[20:23], v[112:115], v[44:47]
    ds_read_b64_tr_b16 v[18:19], v3 offset:22528
    v_cvt_pk_bf16_f32 v89, v34, v35
    v_cvt_pk_bf16_f32 v90, v36, v37
    v_cvt_pk_bf16_f32 v91, v38, v39
    s_lshl_b32 s42, s60, 6
    s_mul_i32 s43, s38, 73728
    s_add_u32 s44, s42, s43
    buffer_store_dwordx4 v[88:91], v53, s[68:71], s44 offen sc1
    s_barrier
    s_waitcnt lgkmcnt(4)
    v_mfma_f32_16x16x32_bf16 v[40:43], v[24:27], v[116:119], v[40:43]
    ds_read_b64_tr_b16 v[20:21], v4 offset:0
    s_waitcnt vmcnt(2)
    s_lshl_b32 s42, s38, 5
    s_mov_b64 exec, 1
    buffer_store_dwordx2 v[238:239], off, s[24:27], s42 offset:256 sc1
    s_mov_b64 exec, -1
    v_mfma_f32_16x16x32_bf16 v[44:47], v[24:27], v[120:123], v[44:47]
    ds_read_b64_tr_b16 v[22:23], v4 offset:2048
    s_waitcnt lgkmcnt(4)
    v_mfma_f32_16x16x32_bf16 v[40:43], v[28:31], v[124:127], v[40:43]
    ds_read_b64_tr_b16 v[24:25], v4 offset:4096
    v_mfma_f32_16x16x32_bf16 v[44:47], v[28:31], v[128:131], v[44:47]
    ds_read_b64_tr_b16 v[26:27], v4 offset:6144
    s_waitcnt lgkmcnt(4)
    v_mfma_f32_16x16x32_bf16 v[40:43], v[16:19], v[132:135], v[40:43]
    ds_read_b64_tr_b16 v[28:29], v4 offset:8192
    v_mfma_f32_16x16x32_bf16 v[44:47], v[16:19], v[136:139], v[44:47]
    ds_read_b64_tr_b16 v[30:31], v4 offset:10240
    s_waitcnt lgkmcnt(4)
    v_mfma_f32_16x16x32_bf16 v[40:43], v[20:23], v[140:143], v[40:43]
    ds_read_b64_tr_b16 v[16:17], v4 offset:12288
    v_mfma_f32_16x16x32_bf16 v[44:47], v[20:23], v[144:147], v[44:47]
    ds_read_b64_tr_b16 v[18:19], v4 offset:14336
    s_waitcnt lgkmcnt(4)
    v_mfma_f32_16x16x32_bf16 v[40:43], v[24:27], v[148:151], v[40:43]
    ds_read_b64_tr_b16 v[20:21], v4 offset:16384
    v_mfma_f32_16x16x32_bf16 v[44:47], v[24:27], v[152:155], v[44:47]
    ds_read_b64_tr_b16 v[22:23], v4 offset:18432
    s_waitcnt lgkmcnt(4)
    v_mfma_f32_16x16x32_bf16 v[40:43], v[28:31], v[156:159], v[40:43]
    ds_read_b64_tr_b16 v[24:25], v4 offset:20480
    v_mfma_f32_16x16x32_bf16 v[44:47], v[28:31], v[160:163], v[44:47]
    ds_read_b64_tr_b16 v[26:27], v4 offset:22528
    s_barrier
    s_waitcnt lgkmcnt(4)
    v_mfma_f32_16x16x32_bf16 v[40:43], v[16:19], v[164:167], v[40:43]
    ds_read_b64_tr_b16 v[28:29], v3 offset:24576
    v_mfma_f32_16x16x32_bf16 v[44:47], v[16:19], v[168:171], v[44:47]
    ds_read_b64_tr_b16 v[30:31], v3 offset:26624
    s_waitcnt lgkmcnt(4)
    v_mfma_f32_16x16x32_bf16 v[40:43], v[20:23], v[172:175], v[40:43]
    ds_read_b64_tr_b16 v[16:17], v3 offset:28672
    v_mfma_f32_16x16x32_bf16 v[44:47], v[20:23], v[176:179], v[44:47]
    ds_read_b64_tr_b16 v[18:19], v3 offset:30720
    s_waitcnt lgkmcnt(4)
    v_mfma_f32_16x16x32_bf16 v[40:43], v[24:27], v[180:183], v[40:43]
    ds_read_b64_tr_b16 v[20:21], v3 offset:32768
    v_mfma_f32_16x16x32_bf16 v[44:47], v[24:27], v[184:187], v[44:47]
    ds_read_b64_tr_b16 v[22:23], v3 offset:34816
    s_waitcnt lgkmcnt(4)
    v_mfma_f32_16x16x32_bf16 v[40:43], v[28:31], v[188:191], v[40:43]
    ds_read_b64_tr_b16 v[24:25], v3 offset:36864
    v_mfma_f32_16x16x32_bf16 v[44:47], v[28:31], v[192:195], v[44:47]
    ds_read_b64_tr_b16 v[26:27], v3 offset:38912
    s_waitcnt lgkmcnt(4)
    v_mfma_f32_16x16x32_bf16 v[40:43], v[16:19], v[196:199], v[40:43]
    ds_read_b64_tr_b16 v[28:29], v3 offset:40960
    v_mfma_f32_16x16x32_bf16 v[44:47], v[16:19], v[200:203], v[44:47]
    ds_read_b64_tr_b16 v[30:31], v3 offset:43008
    s_waitcnt lgkmcnt(4)
    v_mfma_f32_16x16x32_bf16 v[40:43], v[20:23], v[204:207], v[40:43]
    ds_read_b64_tr_b16 v[16:17], v3 offset:45056
    v_mfma_f32_16x16x32_bf16 v[44:47], v[20:23], v[208:211], v[44:47]
    ds_read_b64_tr_b16 v[18:19], v3 offset:47104
    s_waitcnt lgkmcnt(4)
    v_mfma_f32_16x16x32_bf16 v[40:43], v[24:27], v[212:215], v[40:43]
    ds_read_b64_tr_b16 v[20:21], v4 offset:33792
    v_mfma_f32_16x16x32_bf16 v[44:47], v[24:27], v[216:219], v[44:47]
    ds_read_b64_tr_b16 v[22:23], v5 offset:36352
    s_waitcnt lgkmcnt(4)
    v_mfma_f32_16x16x32_bf16 v[40:43], v[28:31], v[220:223], v[40:43]
    ds_read_b64_tr_b16 v[24:25], v5 offset:38400
    v_mfma_f32_16x16x32_bf16 v[44:47], v[28:31], v[224:227], v[44:47]
    ds_read_b64_tr_b16 v[26:27], v4 offset:40960
    s_waitcnt lgkmcnt(4)
    v_mfma_f32_16x16x32_bf16 v[40:43], v[16:19], v[228:231], v[40:43]
    ds_read_b64_tr_b16 v[28:29], v6 offset:33792
    v_mfma_f32_16x16x32_bf16 v[44:47], v[16:19], v[232:235], v[44:47]
    s_barrier
    s_waitcnt lgkmcnt(3)
    v_mfma_f32_16x16x32_bf16 v[40:43], v[20:23], v[56:59], v[40:43]
    ds_read_b64_tr_b16 v[16:17], v2 offset:0
    buffer_load_dwordx2 v[236:237], v7, s[24:27], 0 offen sc1
    v_mfma_f32_16x16x32_bf16 v[44:47], v[20:23], v[60:63], v[44:47]
    ds_read_b64_tr_b16 v[18:19], v2 offset:2048
    s_waitcnt lgkmcnt(3)
    v_mfma_f32_16x16x32_bf16 v[40:43], v[24:27], v[64:67], v[40:43]
    ds_read_b64_tr_b16 v[20:21], v2 offset:4096
    v_mfma_f32_16x16x32_bf16 v[44:47], v[24:27], v[68:71], v[44:47]
    ds_read_b64_tr_b16 v[22:23], v2 offset:6144
    s_waitcnt lgkmcnt(4)
    v_mfma_f32_16x16x32_bf16 v[40:43], v[28:31], v[72:75], v[40:43]
    ds_read_b64_tr_b16 v[24:25], v2 offset:8192
    v_mfma_f32_16x16x32_bf16 v[44:47], v[28:31], v[76:79], v[44:47]
    ds_read_b64_tr_b16 v[26:27], v2 offset:10240
    s_waitcnt lgkmcnt(4)
    v_mfma_f32_16x16x32_bf16 v[32:35], v[16:19], v[92:95], 0
    ds_read_b64_tr_b16 v[28:29], v2 offset:12288
    v_mfma_f32_16x16x32_bf16 v[36:39], v[16:19], v[96:99], 0
    ds_read_b64_tr_b16 v[30:31], v2 offset:14336
    s_waitcnt lgkmcnt(4)
    v_mfma_f32_16x16x32_bf16 v[32:35], v[20:23], v[100:103], v[32:35]
    ds_read_b64_tr_b16 v[16:17], v2 offset:16384
    v_mfma_f32_16x16x32_bf16 v[36:39], v[20:23], v[104:107], v[36:39]
    ds_read_b64_tr_b16 v[18:19], v2 offset:18432
    s_waitcnt lgkmcnt(4)
    v_mfma_f32_16x16x32_bf16 v[32:35], v[24:27], v[108:111], v[32:35]
    ds_read_b64_tr_b16 v[20:21], v2 offset:20480
    v_cvt_pk_bf16_f32 v88, v40, v41
    v_mfma_f32_16x16x32_bf16 v[36:39], v[24:27], v[112:115], v[36:39]
    ds_read_b64_tr_b16 v[22:23], v2 offset:22528
    v_cvt_pk_bf16_f32 v89, v42, v43
    v_cvt_pk_bf16_f32 v90, v44, v45
    v_cvt_pk_bf16_f32 v91, v46, v47
    s_lshl_b32 s42, s61, 6
    s_mul_i32 s43, s38, 73728
    s_add_u32 s44, s42, s43
    buffer_store_dwordx4 v[88:91], v53, s[68:71], s44 offen sc1
    s_barrier
    s_waitcnt lgkmcnt(4)
    v_mfma_f32_16x16x32_bf16 v[32:35], v[28:31], v[116:119], v[32:35]
    ds_read_b64_tr_b16 v[24:25], v2 offset:24576
    s_waitcnt vmcnt(3)
    s_lshl_b32 s42, s38, 5
    s_mov_b64 exec, 1
    buffer_store_dwordx2 v[238:239], off, s[24:27], s42 offset:512 sc1
    s_mov_b64 exec, -1
    v_mfma_f32_16x16x32_bf16 v[36:39], v[28:31], v[120:123], v[36:39]
    ds_read_b64_tr_b16 v[26:27], v2 offset:26624
    s_waitcnt lgkmcnt(4)
    v_mfma_f32_16x16x32_bf16 v[32:35], v[16:19], v[124:127], v[32:35]
    ds_read_b64_tr_b16 v[28:29], v2 offset:28672
    v_mfma_f32_16x16x32_bf16 v[36:39], v[16:19], v[128:131], v[36:39]
    ds_read_b64_tr_b16 v[30:31], v2 offset:30720
    s_waitcnt lgkmcnt(4)
    v_mfma_f32_16x16x32_bf16 v[32:35], v[20:23], v[132:135], v[32:35]
    ds_read_b64_tr_b16 v[16:17], v2 offset:32768
    v_mfma_f32_16x16x32_bf16 v[36:39], v[20:23], v[136:139], v[36:39]
    ds_read_b64_tr_b16 v[18:19], v2 offset:34816
    s_waitcnt lgkmcnt(4)
    v_mfma_f32_16x16x32_bf16 v[32:35], v[24:27], v[140:143], v[32:35]
    ds_read_b64_tr_b16 v[20:21], v2 offset:36864
    v_mfma_f32_16x16x32_bf16 v[36:39], v[24:27], v[144:147], v[36:39]
    ds_read_b64_tr_b16 v[22:23], v2 offset:38912
    s_waitcnt lgkmcnt(4)
    v_mfma_f32_16x16x32_bf16 v[32:35], v[28:31], v[148:151], v[32:35]
    ds_read_b64_tr_b16 v[24:25], v2 offset:40960
    v_mfma_f32_16x16x32_bf16 v[36:39], v[28:31], v[152:155], v[36:39]
    ds_read_b64_tr_b16 v[26:27], v2 offset:43008
    s_waitcnt lgkmcnt(4)
    v_mfma_f32_16x16x32_bf16 v[32:35], v[16:19], v[156:159], v[32:35]
    ds_read_b64_tr_b16 v[28:29], v2 offset:45056
    v_mfma_f32_16x16x32_bf16 v[36:39], v[16:19], v[160:163], v[36:39]
    ds_read_b64_tr_b16 v[30:31], v2 offset:47104
    s_barrier
    s_waitcnt lgkmcnt(4)
    v_mfma_f32_16x16x32_bf16 v[32:35], v[20:23], v[164:167], v[32:35]
    ds_read_b64_tr_b16 v[16:17], v3 offset:0
    v_mfma_f32_16x16x32_bf16 v[36:39], v[20:23], v[168:171], v[36:39]
    ds_read_b64_tr_b16 v[18:19], v3 offset:2048
    s_waitcnt lgkmcnt(4)
    v_mfma_f32_16x16x32_bf16 v[32:35], v[24:27], v[172:175], v[32:35]
    ds_read_b64_tr_b16 v[20:21], v3 offset:4096
    v_mfma_f32_16x16x32_bf16 v[36:39], v[24:27], v[176:179], v[36:39]
    ds_read_b64_tr_b16 v[22:23], v3 offset:6144
    s_waitcnt lgkmcnt(4)
    v_mfma_f32_16x16x32_bf16 v[32:35], v[28:31], v[180:183], v[32:35]
    ds_read_b64_tr_b16 v[24:25], v3 offset:8192
    v_mfma_f32_16x16x32_bf16 v[36:39], v[28:31], v[184:187], v[36:39]
    ds_read_b64_tr_b16 v[26:27], v3 offset:10240
    s_waitcnt lgkmcnt(4)
    v_mfma_f32_16x16x32_bf16 v[32:35], v[16:19], v[188:191], v[32:35]
    ds_read_b64_tr_b16 v[28:29], v3 offset:12288
    v_mfma_f32_16x16x32_bf16 v[36:39], v[16:19], v[192:195], v[36:39]
    ds_read_b64_tr_b16 v[30:31], v3 offset:14336
    s_waitcnt lgkmcnt(4)
    v_mfma_f32_16x16x32_bf16 v[32:35], v[20:23], v[196:199], v[32:35]
    ds_read_b64_tr_b16 v[16:17], v3 offset:16384
    v_mfma_f32_16x16x32_bf16 v[36:39], v[20:23], v[200:203], v[36:39]
    ds_read_b64_tr_b16 v[18:19], v3 offset:18432
    s_waitcnt lgkmcnt(4)
    v_mfma_f32_16x16x32_bf16 v[32:35], v[24:27], v[204:207], v[32:35]
    ds_read_b64_tr_b16 v[20:21], v3 offset:20480
    v_mfma_f32_16x16x32_bf16 v[36:39], v[24:27], v[208:211], v[36:39]
    ds_read_b64_tr_b16 v[22:23], v3 offset:22528
    s_waitcnt lgkmcnt(4)
    v_mfma_f32_16x16x32_bf16 v[32:35], v[28:31], v[212:215], v[32:35]
    ds_read_b64_tr_b16 v[24:25], v4 offset:24576
    v_mfma_f32_16x16x32_bf16 v[36:39], v[28:31], v[216:219], v[36:39]
    ds_read_b64_tr_b16 v[26:27], v5 offset:27136
    s_waitcnt lgkmcnt(4)
    v_mfma_f32_16x16x32_bf16 v[32:35], v[16:19], v[220:223], v[32:35]
    ds_read_b64_tr_b16 v[28:29], v5 offset:29184
    v_mfma_f32_16x16x32_bf16 v[36:39], v[16:19], v[224:227], v[36:39]
    ds_read_b64_tr_b16 v[30:31], v4 offset:31744
    s_waitcnt lgkmcnt(4)
    v_mfma_f32_16x16x32_bf16 v[32:35], v[20:23], v[228:231], v[32:35]
    ds_read_b64_tr_b16 v[16:17], v6 offset:24576
    v_mfma_f32_16x16x32_bf16 v[36:39], v[20:23], v[232:235], v[36:39]
    s_mov_b32 s86, 100000
    s_waitcnt vmcnt(2)
LS_f0a:
    v_cmp_ne_u64 vcc, s[98:99], v[236:237]
    s_nop 4
    s_cbranch_vccz LS_f0b
    buffer_load_dwordx2 v[236:237], v7, s[24:27], 0 offen sc1
    s_waitcnt vmcnt(0)
    s_sub_u32 s86, s86, 1
    s_cbranch_scc0 LS_f0a
LS_f0b:
    s_barrier
    s_waitcnt lgkmcnt(3)
    v_mfma_f32_16x16x32_bf16 v[32:35], v[24:27], v[56:59], v[32:35]
    ds_read_b64_tr_b16 v[20:21], v4 offset:0
    s_lshr_b32 s42, s59, 7
    s_lshl_b32 s43, s38, 1
    s_sub_u32 s42, s43, s42
    s_and_b32 s42, s42, 7
    s_lshl_b32 s100, s42, 5
    buffer_load_dwordx2 v[236:237], off, s[24:27], s100 offset:256 sc1
    v_mfma_f32_16x16x32_bf16 v[36:39], v[24:27], v[60:63], v[36:39]
    ds_read_b64_tr_b16 v[22:23], v4 offset:2048
    s_waitcnt lgkmcnt(3)
    v_mfma_f32_16x16x32_bf16 v[32:35], v[28:31], v[64:67], v[32:35]
    ds_read_b64_tr_b16 v[24:25], v4 offset:4096
    v_mfma_f32_16x16x32_bf16 v[36:39], v[28:31], v[68:71], v[36:39]
    ds_read_b64_tr_b16 v[26:27], v4 offset:6144
    s_waitcnt lgkmcnt(4)
    v_mfma_f32_16x16x32_bf16 v[32:35], v[16:19], v[72:75], v[32:35]
    ds_read_b64_tr_b16 v[28:29], v4 offset:8192
    v_mfma_f32_16x16x32_bf16 v[36:39], v[16:19], v[76:79], v[36:39]
    ds_read_b64_tr_b16 v[30:31], v4 offset:10240
    s_waitcnt lgkmcnt(4)
    v_mfma_f32_16x16x32_bf16 v[40:43], v[20:23], v[92:95], 0
    ds_read_b64_tr_b16 v[16:17], v4 offset:12288
    v_mfma_f32_16x16x32_bf16 v[44:47], v[20:23], v[96:99], 0
    ds_read_b64_tr_b16 v[18:19], v4 offset:14336
    s_waitcnt lgkmcnt(4)
    v_mfma_f32_16x16x32_bf16 v[40:43], v[24:27], v[100:103], v[40:43]
    ds_read_b64_tr_b16 v[20:21], v4 offset:16384
    v_mfma_f32_16x16x32_bf16 v[44:47], v[24:27], v[104:107], v[44:47]
    ds_read_b64_tr_b16 v[22:23], v4 offset:18432
    s_waitcnt lgkmcnt(4)
    v_mfma_f32_16x16x32_bf16 v[40:43], v[28:31], v[108:111], v[40:43]
    ds_read_b64_tr_b16 v[24:25], v4 offset:20480
    v_cvt_pk_bf16_f32 v88, v32, v33
    v_mfma_f32_16x16x32_bf16 v[44:47], v[28:31], v[112:115], v[44:47]
    ds_read_b64_tr_b16 v[26:27], v4 offset:22528
    v_cvt_pk_bf16_f32 v89, v34, v35
    v_cvt_pk_bf16_f32 v90, v36, v37
    v_cvt_pk_bf16_f32 v91, v38, v39
    s_lshl_b32 s42, s62, 6
    s_mul_i32 s43, s38, 73728
    s_add_u32 s44, s42, s43
    buffer_store_dwordx4 v[88:91], v53, s[68:71], s44 offen sc1
    s_barrier
    s_waitcnt lgkmcnt(4)
    v_mfma_f32_16x16x32_bf16 v[40:43], v[16:19], v[116:119], v[40:43]
    ds_read_b64_tr_b16 v[28:29], v3 offset:24576
    s_waitcnt vmcnt(3)
    s_lshl_b32 s42, s38, 5
    s_mov_b64 exec, 1
    buffer_store_dwordx2 v[238:239], off, s[24:27], s42 offset:768 sc1
    s_mov_b64 exec, -1
    v_mfma_f32_16x16x32_bf16 v[44:47], v[16:19], v[120:123], v[44:47]
    ds_read_b64_tr_b16 v[30:31], v3 offset:26624
    s_waitcnt lgkmcnt(4)
    v_mfma_f32_16x16x32_bf16 v[40:43], v[20:23], v[124:127], v[40:43]
    ds_read_b64_tr_b16 v[16:17], v3 offset:28672
    v_mfma_f32_16x16x32_bf16 v[44:47], v[20:23], v[128:131], v[44:47]
    ds_read_b64_tr_b16 v[18:19], v3 offset:30720
    s_waitcnt lgkmcnt(4)
    v_mfma_f32_16x16x32_bf16 v[40:43], v[24:27], v[132:135], v[40:43]
    ds_read_b64_tr_b16 v[20:21], v3 offset:32768
    v_mfma_f32_16x16x32_bf16 v[44:47], v[24:27], v[136:139], v[44:47]
    ds_read_b64_tr_b16 v[22:23], v3 offset:34816
    s_waitcnt lgkmcnt(4)
    v_mfma_f32_16x16x32_bf16 v[40:43], v[28:31], v[140:143], v[40:43]
    ds_read_b64_tr_b16 v[24:25], v3 offset:36864
    v_mfma_f32_16x16x32_bf16 v[44:47], v[28:31], v[144:147], v[44:47]
    ds_read_b64_tr_b16 v[26:27], v3 offset:38912
    s_waitcnt lgkmcnt(4)
    v_mfma_f32_16x16x32_bf16 v[40:43], v[16:19], v[148:151], v[40:43]
    ds_read_b64_tr_b16 v[28:29], v3 offset:40960
    v_mfma_f32_16x16x32_bf16 v[44:47], v[16:19], v[152:155], v[44:47]
    ds_read_b64_tr_b16 v[30:31], v3 offset:43008
    s_waitcnt lgkmcnt(4)
    v_mfma_f32_16x16x32_bf16 v[40:43], v[20:23], v[156:159], v[40:43]
    ds_read_b64_tr_b16 v[16:17], v3 offset:45056
    v_mfma_f32_16x16x32_bf16 v[44:47], v[20:23], v[160:163], v[44:47]
    ds_read_b64_tr_b16 v[18:19], v3 offset:47104
    s_barrier
    s_waitcnt lgkmcnt(4)
    v_mfma_f32_16x16x32_bf16 v[40:43], v[24:27], v[164:167], v[40:43]
    ds_read_b64_tr_b16 v[20:21], v2 offset:0
    v_mfma_f32_16x16x32_bf16 v[44:47], v[24:27], v[168:171], v[44:47]
    ds_read_b64_tr_b16 v[22:23], v2 offset:2048
    s_waitcnt lgkmcnt(4)
    v_mfma_f32_16x16x32_bf16 v[40:43], v[28:31], v[172:175], v[40:43]
    ds_read_b64_tr_b16 v[24:25], v2 offset:4096
    v_mfma_f32_16x16x32_bf16 v[44:47], v[28:31], v[176:179], v[44:47]
    ds_read_b64_tr_b16 v[26:27], v2 offset:6144
    s_waitcnt lgkmcnt(4)
    v_mfma_f32_16x16x32_bf16 v[40:43], v[16:19], v[180:183], v[40:43]
    ds_read_b64_tr_b16 v[28:29], v2 offset:8192
    v_mfma_f32_16x16x32_bf16 v[44:47], v[16:19], v[184:187], v[44:47]
    ds_read_b64_tr_b16 v[30:31], v2 offset:10240
    s_waitcnt lgkmcnt(4)
    v_mfma_f32_16x16x32_bf16 v[40:43], v[20:23], v[188:191], v[40:43]
    ds_read_b64_tr_b16 v[16:17], v2 offset:12288
    v_mfma_f32_16x16x32_bf16 v[44:47], v[20:23], v[192:195], v[44:47]
    ds_read_b64_tr_b16 v[18:19], v2 offset:14336
    s_waitcnt lgkmcnt(4)
    v_mfma_f32_16x16x32_bf16 v[40:43], v[24:27], v[196:199], v[40:43]
    ds_read_b64_tr_b16 v[20:21], v2 offset:16384
    v_mfma_f32_16x16x32_bf16 v[44:47], v[24:27], v[200:203], v[44:47]
    ds_read_b64_tr_b16 v[22:23], v2 offset:18432
    s_waitcnt lgkmcnt(4)
    v_mfma_f32_16x16x32_bf16 v[40:43], v[28:31], v[204:207], v[40:43]
    ds_read_b64_tr_b16 v[24:25], v2 offset:20480
    v_mfma_f32_16x16x32_bf16 v[44:47], v[28:31], v[208:211], v[44:47]
    ds_read_b64_tr_b16 v[26:27], v2 offset:22528
    s_waitcnt lgkmcnt(4)
    v_mfma_f32_16x16x32_bf16 v[40:43], v[16:19], v[212:215], v[40:43]
    ds_read_b64_tr_b16 v[28:29], v4 offset:33792
    v_mfma_f32_16x16x32_bf16 v[44:47], v[16:19], v[216:219], v[44:47]
    ds_read_b64_tr_b16 v[30:31], v5 offset:36352
    s_waitcnt lgkmcnt(4)
    v_mfma_f32_16x16x32_bf16 v[40:43], v[20:23], v[220:223], v[40:43]
    ds_read_b64_tr_b16 v[16:17], v5 offset:38400
    v_mfma_f32_16x16x32_bf16 v[44:47], v[20:23], v[224:227], v[44:47]
    ds_read_b64_tr_b16 v[18:19], v4 offset:40960
    s_waitcnt lgkmcnt(4)
    v_mfma_f32_16x16x32_bf16 v[40:43], v[24:27], v[228:231], v[40:43]
    ds_read_b64_tr_b16 v[20:21], v6 offset:33792
    v_mfma_f32_16x16x32_bf16 v[44:47], v[24:27], v[232:235], v[44:47]
    s_mov_b32 s86, 100000
    s_waitcnt vmcnt(2)
LS_f1a:
    v_cmp_ne_u64 vcc, s[98:99], v[236:237]
    s_nop 4
    s_cbranch_vccz LS_f1b
    buffer_load_dwordx2 v[236:237], off, s[24:27], s100 offset:256 sc1
    s_waitcnt vmcnt(0)
    s_sub_u32 s86, s86, 1
    s_cbranch_scc0 LS_f1a
LS_f1b:
    s_barrier
    s_waitcnt lgkmcnt(3)
    v_mfma_f32_16x16x32_bf16 v[40:43], v[28:31], v[56:59], v[40:43]
    ds_read_b64_tr_b16 v[24:25], v2 offset:24576
    s_lshr_b32 s42, s60, 7
    s_lshl_b32 s43, s38, 1
    s_sub_u32 s42, s43, s42
    s_and_b32 s42, s42, 7
    s_lshl_b32 s100, s42, 5
    buffer_load_dwordx2 v[236:237], off, s[24:27], s100 offset:512 sc1
    v_mfma_f32_16x16x32_bf16 v[44:47], v[28:31], v[60:63], v[44:47]
    ds_read_b64_tr_b16 v[26:27], v2 offset:26624
    s_lshr_b32 s42, s59, 7
    s_lshl_b32 s43, s38, 1
    s_sub_u32 s42, s43, s42
    s_and_b32 s42, s42, 7
    s_mul_i32 s42, s42, 73728
    s_add_u32 s42, s42, s57
    buffer_load_dwordx4 v[12:15], v53, s[68:71], s42 offen sc1
    s_waitcnt lgkmcnt(3)
    v_mfma_f32_16x16x32_bf16 v[40:43], v[16:19], v[64:67], v[40:43]
    ds_read_b64_tr_b16 v[28:29], v2 offset:28672
    v_mfma_f32_16x16x32_bf16 v[44:47], v[16:19], v[68:71], v[44:47]
    ds_read_b64_tr_b16 v[30:31], v2 offset:30720
    s_waitcnt lgkmcnt(4)
    v_mfma_f32_16x16x32_bf16 v[40:43], v[20:23], v[72:75], v[40:43]
    ds_read_b64_tr_b16 v[16:17], v2 offset:32768
    v_mfma_f32_16x16x32_bf16 v[44:47], v[20:23], v[76:79], v[44:47]
    ds_read_b64_tr_b16 v[18:19], v2 offset:34816
    s_waitcnt lgkmcnt(4)
    v_mfma_f32_16x16x32_bf16 v[32:35], v[24:27], v[92:95], 0
    ds_read_b64_tr_b16 v[20:21], v2 offset:36864
    v_mfma_f32_16x16x32_bf16 v[36:39], v[24:27], v[96:99], 0
    ds_read_b64_tr_b16 v[22:23], v2 offset:38912
    s_waitcnt lgkmcnt(4)
    v_mfma_f32_16x16x32_bf16 v[32:35], v[28:31], v[100:103], v[32:35]
    ds_read_b64_tr_b16 v[24:25], v2 offset:40960
    v_mfma_f32_16x16x32_bf16 v[36:39], v[28:31], v[104:107], v[36:39]
    ds_read_b64_tr_b16 v[26:27], v2 offset:43008
    s_waitcnt lgkmcnt(4)
    s_nop 0
    v_mfma_f32_16x16x32_bf16 v[32:35], v[16:19], v[108:111], v[32:35]
    ds_read_b64_tr_b16 v[28:29], v2 offset:45056
    v_cvt_pk_bf16_f32 v88, v40, v41
    v_mfma_f32_16x16x32_bf16 v[36:39], v[16:19], v[112:115], v[36:39]
    ds_read_b64_tr_b16 v[30:31], v2 offset:47104
    v_cvt_pk_bf16_f32 v89, v42, v43
    v_cvt_pk_bf16_f32 v90, v44, v45
    v_cvt_pk_bf16_f32 v91, v46, v47
    s_lshl_b32 s42, s63, 6
    s_mul_i32 s43, s38, 73728
    s_add_u32 s44, s42, s43
    buffer_store_dwordx4 v[88:91], v53, s[68:71], s44 offen sc1
    s_barrier
    s_waitcnt lgkmcnt(4)
    v_mfma_f32_16x16x32_bf16 v[32:35], v[20:23], v[116:119], v[32:35]
    ds_read_b64_tr_b16 v[16:17], v3 offset:0
    v_mfma_f32_16x16x32_bf16 v[36:39], v[20:23], v[120:123], v[36:39]
    ds_read_b64_tr_b16 v[18:19], v3 offset:2048
    s_waitcnt lgkmcnt(4)
    v_mfma_f32_16x16x32_bf16 v[32:35], v[24:27], v[124:127], v[32:35]
    ds_read_b64_tr_b16 v[20:21], v3 offset:4096
    v_mfma_f32_16x16x32_bf16 v[36:39], v[24:27], v[128:131], v[36:39]
    ds_read_b64_tr_b16 v[22:23], v3 offset:6144
    s_waitcnt lgkmcnt(4)
    v_mfma_f32_16x16x32_bf16 v[32:35], v[28:31], v[132:135], v[32:35]
    ds_read_b64_tr_b16 v[24:25], v3 offset:8192
    v_mfma_f32_16x16x32_bf16 v[36:39], v[28:31], v[136:139], v[36:39]
    ds_read_b64_tr_b16 v[26:27], v3 offset:10240
    s_waitcnt lgkmcnt(4)
    v_mfma_f32_16x16x32_bf16 v[32:35], v[16:19], v[140:143], v[32:35]
    ds_read_b64_tr_b16 v[28:29], v3 offset:12288
    v_mfma_f32_16x16x32_bf16 v[36:39], v[16:19], v[144:147], v[36:39]
    ds_read_b64_tr_b16 v[30:31], v3 offset:14336
    s_waitcnt lgkmcnt(4)
    v_mfma_f32_16x16x32_bf16 v[32:35], v[20:23], v[148:151], v[32:35]
    ds_read_b64_tr_b16 v[16:17], v3 offset:16384
    v_mfma_f32_16x16x32_bf16 v[36:39], v[20:23], v[152:155], v[36:39]
    ds_read_b64_tr_b16 v[18:19], v3 offset:18432
    s_waitcnt lgkmcnt(4)
    v_mfma_f32_16x16x32_bf16 v[32:35], v[24:27], v[156:159], v[32:35]
    ds_read_b64_tr_b16 v[20:21], v3 offset:20480
    v_mfma_f32_16x16x32_bf16 v[36:39], v[24:27], v[160:163], v[36:39]
    ds_read_b64_tr_b16 v[22:23], v3 offset:22528
    s_barrier
    s_waitcnt lgkmcnt(4)
    v_mfma_f32_16x16x32_bf16 v[32:35], v[28:31], v[164:167], v[32:35]
    ds_read_b64_tr_b16 v[24:25], v4 offset:0
    v_mfma_f32_16x16x32_bf16 v[36:39], v[28:31], v[168:171], v[36:39]
    ds_read_b64_tr_b16 v[26:27], v4 offset:2048
    s_waitcnt lgkmcnt(4)
    v_mfma_f32_16x16x32_bf16 v[32:35], v[16:19], v[172:175], v[32:35]
    ds_read_b64_tr_b16 v[28:29], v4 offset:4096
    v_mfma_f32_16x16x32_bf16 v[36:39], v[16:19], v[176:179], v[36:39]
    ds_read_b64_tr_b16 v[30:31], v4 offset:6144
    s_waitcnt lgkmcnt(4)
    v_mfma_f32_16x16x32_bf16 v[32:35], v[20:23], v[180:183], v[32:35]
    ds_read_b64_tr_b16 v[16:17], v4 offset:8192
    v_mfma_f32_16x16x32_bf16 v[36:39], v[20:23], v[184:187], v[36:39]
    ds_read_b64_tr_b16 v[18:19], v4 offset:10240
    s_waitcnt lgkmcnt(4)
    v_mfma_f32_16x16x32_bf16 v[32:35], v[24:27], v[188:191], v[32:35]
    ds_read_b64_tr_b16 v[20:21], v4 offset:12288
    v_mfma_f32_16x16x32_bf16 v[36:39], v[24:27], v[192:195], v[36:39]
    ds_read_b64_tr_b16 v[22:23], v4 offset:14336
    s_waitcnt lgkmcnt(4)
    v_mfma_f32_16x16x32_bf16 v[32:35], v[28:31], v[196:199], v[32:35]
    ds_read_b64_tr_b16 v[24:25], v4 offset:16384
    v_mfma_f32_16x16x32_bf16 v[36:39], v[28:31], v[200:203], v[36:39]
    ds_read_b64_tr_b16 v[26:27], v4 offset:18432
    s_waitcnt lgkmcnt(4)
    v_mfma_f32_16x16x32_bf16 v[32:35], v[16:19], v[204:207], v[32:35]
    ds_read_b64_tr_b16 v[28:29], v4 offset:20480
    v_mfma_f32_16x16x32_bf16 v[36:39], v[16:19], v[208:211], v[36:39]
    ds_read_b64_tr_b16 v[30:31], v4 offset:22528
    s_waitcnt lgkmcnt(4)
    v_mfma_f32_16x16x32_bf16 v[32:35], v[20:23], v[212:215], v[32:35]
    ds_read_b64_tr_b16 v[16:17], v4 offset:24576
    v_mfma_f32_16x16x32_bf16 v[36:39], v[20:23], v[216:219], v[36:39]
    ds_read_b64_tr_b16 v[18:19], v5 offset:27136
    s_waitcnt lgkmcnt(4)
    v_mfma_f32_16x16x32_bf16 v[32:35], v[24:27], v[220:223], v[32:35]
    ds_read_b64_tr_b16 v[20:21], v5 offset:29184
    v_mfma_f32_16x16x32_bf16 v[36:39], v[24:27], v[224:227], v[36:39]
    ds_read_b64_tr_b16 v[22:23], v4 offset:31744
    s_waitcnt lgkmcnt(4)
    v_mfma_f32_16x16x32_bf16 v[32:35], v[28:31], v[228:231], v[32:35]
    ds_read_b64_tr_b16 v[24:25], v6 offset:24576
    v_mfma_f32_16x16x32_bf16 v[36:39], v[28:31], v[232:235], v[36:39]
    s_mov_b32 s86, 100000
    s_waitcnt vmcnt(2)
LS_f2a:
    v_cmp_ne_u64 vcc, s[98:99], v[236:237]
    s_nop 4
    s_cbranch_vccz LS_f2b
    buffer_load_dwordx2 v[236:237], off, s[24:27], s100 offset:512 sc1
    s_waitcnt vmcnt(0)
    s_sub_u32 s86, s86, 1
    s_cbranch_scc0 LS_f2a
LS_f2b:
    s_barrier
    s_waitcnt lgkmcnt(3)
    v_mfma_f32_16x16x32_bf16 v[32:35], v[16:19], v[56:59], v[32:35]
    ds_read_b64_tr_b16 v[28:29], v3 offset:24576
    s_lshr_b32 s42, s61, 7
    s_lshl_b32 s43, s38, 1
    s_sub_u32 s42, s43, s42
    s_and_b32 s42, s42, 7
    s_lshl_b32 s100, s42, 5
    buffer_load_dwordx2 v[236:237], off, s[24:27], s100 offset:768 sc1
    v_mfma_f32_16x16x32_bf16 v[36:39], v[16:19], v[60:63], v[36:39]
    ds_read_b64_tr_b16 v[30:31], v3 offset:26624
    s_waitcnt vmcnt(2)
    s_waitcnt lgkmcnt(3)
    s_nop 0
    v_mfma_f32_16x16x32_bf16 v[32:35], v[20:23], v[64:67], v[32:35]
    ds_read_b64_tr_b16 v[16:17], v3 offset:28672
    v_dot2_f32_bf16 v240, v12, s94, 0
    v_dot2_f32_bf16 v241, v12, s95, 0
    v_dot2_f32_bf16 v242, v13, s94, 0
    v_dot2_f32_bf16 v243, v13, s95, 0
    v_mfma_f32_16x16x32_bf16 v[36:39], v[20:23], v[68:71], v[36:39]
    ds_read_b64_tr_b16 v[18:19], v3 offset:30720
    v_dot2_f32_bf16 v244, v14, s94, 0
    v_dot2_f32_bf16 v245, v14, s95, 0
    v_dot2_f32_bf16 v246, v15, s94, 0
    v_dot2_f32_bf16 v247, v15, s95, 0
    s_waitcnt lgkmcnt(4)
    v_mfma_f32_16x16x32_bf16 v[32:35], v[24:27], v[72:75], v[32:35]
    ds_read_b64_tr_b16 v[20:21], v3 offset:32768
    s_lshr_b32 s42, s60, 7
    s_lshl_b32 s43, s38, 1
    s_sub_u32 s42, s43, s42
    s_and_b32 s42, s42, 7
    s_mul_i32 s42, s42, 73728
    s_add_u32 s42, s42, s57
    buffer_load_dwordx4 v[12:15], v53, s[68:71], s42 offen sc1
    v_mfma_f32_16x16x32_bf16 v[36:39], v[24:27], v[76:79], v[36:39]
    ds_read_b64_tr_b16 v[22:23], v3 offset:34816
    s_waitcnt lgkmcnt(4)
    v_mfma_f32_16x16x32_bf16 v[40:43], v[28:31], v[92:95], 0
    ds_read_b64_tr_b16 v[24:25], v3 offset:36864
    v_mfma_f32_16x16x32_bf16 v[44:47], v[28:31], v[96:99], 0
    ds_read_b64_tr_b16 v[26:27], v3 offset:38912
    s_waitcnt lgkmcnt(4)
    v_mfma_f32_16x16x32_bf16 v[40:43], v[16:19], v[100:103], v[40:43]
    ds_read_b64_tr_b16 v[28:29], v3 offset:40960
    v_mfma_f32_16x16x32_bf16 v[44:47], v[16:19], v[104:107], v[44:47]
    ds_read_b64_tr_b16 v[30:31], v3 offset:43008
    s_waitcnt lgkmcnt(4)
    s_nop 0
    v_mfma_f32_16x16x32_bf16 v[40:43], v[20:23], v[108:111], v[40:43]
    ds_read_b64_tr_b16 v[16:17], v3 offset:45056
    v_cvt_pk_bf16_f32 v88, v32, v33
    v_mfma_f32_16x16x32_bf16 v[44:47], v[20:23], v[112:115], v[44:47]
    ds_read_b64_tr_b16 v[18:19], v3 offset:47104
    v_cvt_pk_bf16_f32 v89, v34, v35
    v_cvt_pk_bf16_f32 v90, v36, v37
    v_cvt_pk_bf16_f32 v91, v38, v39
    s_lshl_b32 s42, s64, 6
    s_mul_i32 s43, s38, 73728
    s_add_u32 s44, s42, s43
    buffer_store_dwordx4 v[88:91], v53, s[68:71], s44 offen sc1
    s_barrier
    s_waitcnt lgkmcnt(4)
    v_mfma_f32_16x16x32_bf16 v[40:43], v[24:27], v[116:119], v[40:43]
    ds_read_b64_tr_b16 v[20:21], v2 offset:0
    v_mfma_f32_16x16x32_bf16 v[44:47], v[24:27], v[120:123], v[44:47]
    ds_read_b64_tr_b16 v[22:23], v2 offset:2048
    s_waitcnt lgkmcnt(4)
    v_mfma_f32_16x16x32_bf16 v[40:43], v[28:31], v[124:127], v[40:43]
    ds_read_b64_tr_b16 v[24:25], v2 offset:4096
    v_mfma_f32_16x16x32_bf16 v[44:47], v[28:31], v[128:131], v[44:47]
    ds_read_b64_tr_b16 v[26:27], v2 offset:6144
    s_waitcnt lgkmcnt(4)
    v_mfma_f32_16x16x32_bf16 v[40:43], v[16:19], v[132:135], v[40:43]
    ds_read_b64_tr_b16 v[28:29], v2 offset:8192
    v_mfma_f32_16x16x32_bf16 v[44:47], v[16:19], v[136:139], v[44:47]
    ds_read_b64_tr_b16 v[30:31], v2 offset:10240
    s_waitcnt lgkmcnt(4)
    v_mfma_f32_16x16x32_bf16 v[40:43], v[20:23], v[140:143], v[40:43]
    ds_read_b64_tr_b16 v[16:17], v2 offset:12288
    v_mfma_f32_16x16x32_bf16 v[44:47], v[20:23], v[144:147], v[44:47]
    ds_read_b64_tr_b16 v[18:19], v2 offset:14336
    s_waitcnt lgkmcnt(4)
    v_mfma_f32_16x16x32_bf16 v[40:43], v[24:27], v[148:151], v[40:43]
    ds_read_b64_tr_b16 v[20:21], v2 offset:16384
    v_mfma_f32_16x16x32_bf16 v[44:47], v[24:27], v[152:155], v[44:47]
    ds_read_b64_tr_b16 v[22:23], v2 offset:18432
    s_waitcnt lgkmcnt(4)
    v_mfma_f32_16x16x32_bf16 v[40:43], v[28:31], v[156:159], v[40:43]
    ds_read_b64_tr_b16 v[24:25], v2 offset:20480
    v_mfma_f32_16x16x32_bf16 v[44:47], v[28:31], v[160:163], v[44:47]
    ds_read_b64_tr_b16 v[26:27], v2 offset:22528
    s_barrier
    s_waitcnt lgkmcnt(4)
    v_mfma_f32_16x16x32_bf16 v[40:43], v[16:19], v[164:167], v[40:43]
    ds_read_b64_tr_b16 v[28:29], v2 offset:24576
    v_mfma_f32_16x16x32_bf16 v[44:47], v[16:19], v[168:171], v[44:47]
    ds_read_b64_tr_b16 v[30:31], v2 offset:26624
    s_waitcnt lgkmcnt(4)
    v_mfma_f32_16x16x32_bf16 v[40:43], v[20:23], v[172:175], v[40:43]
    ds_read_b64_tr_b16 v[16:17], v2 offset:28672
    v_mfma_f32_16x16x32_bf16 v[44:47], v[20:23], v[176:179], v[44:47]
    ds_read_b64_tr_b16 v[18:19], v2 offset:30720
    s_waitcnt lgkmcnt(4)
    v_mfma_f32_16x16x32_bf16 v[40:43], v[24:27], v[180:183], v[40:43]
    ds_read_b64_tr_b16 v[20:21], v2 offset:32768
    v_mfma_f32_16x16x32_bf16 v[44:47], v[24:27], v[184:187], v[44:47]
    ds_read_b64_tr_b16 v[22:23], v2 offset:34816
    s_waitcnt lgkmcnt(4)
    v_mfma_f32_16x16x32_bf16 v[40:43], v[28:31], v[188:191], v[40:43]
    ds_read_b64_tr_b16 v[24:25], v2 offset:36864
    v_mfma_f32_16x16x32_bf16 v[44:47], v[28:31], v[192:195], v[44:47]
    ds_read_b64_tr_b16 v[26:27], v2 offset:38912
    s_waitcnt lgkmcnt(4)
    v_mfma_f32_16x16x32_bf16 v[40:43], v[16:19], v[196:199], v[40:43]
    ds_read_b64_tr_b16 v[28:29], v2 offset:40960
    v_mfma_f32_16x16x32_bf16 v[44:47], v[16:19], v[200:203], v[44:47]
    ds_read_b64_tr_b16 v[30:31], v2 offset:43008
    s_waitcnt lgkmcnt(4)
    v_mfma_f32_16x16x32_bf16 v[40:43], v[20:23], v[204:207], v[40:43]
    ds_read_b64_tr_b16 v[16:17], v2 offset:45056
    v_mfma_f32_16x16x32_bf16 v[44:47], v[20:23], v[208:211], v[44:47]
    ds_read_b64_tr_b16 v[18:19], v2 offset:47104
    s_waitcnt lgkmcnt(4)
    v_mfma_f32_16x16x32_bf16 v[40:43], v[24:27], v[212:215], v[40:43]
    ds_read_b64_tr_b16 v[20:21], v4 offset:33792
    v_mfma_f32_16x16x32_bf16 v[44:47], v[24:27], v[216:219], v[44:47]
    ds_read_b64_tr_b16 v[22:23], v5 offset:36352
    s_waitcnt lgkmcnt(4)
    v_mfma_f32_16x16x32_bf16 v[40:43], v[28:31], v[220:223], v[40:43]
    ds_read_b64_tr_b16 v[24:25], v5 offset:38400
    v_mfma_f32_16x16x32_bf16 v[44:47], v[28:31], v[224:227], v[44:47]
    ds_read_b64_tr_b16 v[26:27], v4 offset:40960
    s_waitcnt lgkmcnt(4)
    v_mfma_f32_16x16x32_bf16 v[40:43], v[16:19], v[228:231], v[40:43]
    ds_read_b64_tr_b16 v[28:29], v6 offset:33792
    v_mfma_f32_16x16x32_bf16 v[44:47], v[16:19], v[232:235], v[44:47]
    s_mov_b32 s86, 100000
    s_waitcnt vmcnt(2)
LS_f3a:
    v_cmp_ne_u64 vcc, s[98:99], v[236:237]
    s_nop 4
    s_cbranch_vccz LS_f3b
    buffer_load_dwordx2 v[236:237], off, s[24:27], s100 offset:768 sc1
    s_waitcnt vmcnt(0)
    s_sub_u32 s86, s86, 1
    s_cbranch_scc0 LS_f3a
LS_f3b:
    s_barrier
    s_waitcnt lgkmcnt(3)
    v_mfma_f32_16x16x32_bf16 v[40:43], v[20:23], v[56:59], v[40:43]
    ds_read_b64_tr_b16 v[16:17], v3 offset:0
    s_waitcnt vmcnt(1)
    s_nop 0
    v_mfma_f32_16x16x32_bf16 v[44:47], v[20:23], v[60:63], v[44:47]
    ds_read_b64_tr_b16 v[18:19], v3 offset:2048
    v_dot2_f32_bf16 v240, v12, s94, v240
    v_dot2_f32_bf16 v241, v12, s95, v241
    v_dot2_f32_bf16 v242, v13, s94, v242
    v_dot2_f32_bf16 v243, v13, s95, v243
    s_waitcnt lgkmcnt(3)
    s_nop 0
    v_mfma_f32_16x16x32_bf16 v[40:43], v[24:27], v[64:67], v[40:43]
    ds_read_b64_tr_b16 v[20:21], v3 offset:4096
    v_dot2_f32_bf16 v244, v14, s94, v244
    v_dot2_f32_bf16 v245, v14, s95, v245
    v_dot2_f32_bf16 v246, v15, s94, v246
    v_dot2_f32_bf16 v247, v15, s95, v247
    v_mfma_f32_16x16x32_bf16 v[44:47], v[24:27], v[68:71], v[44:47]
    ds_read_b64_tr_b16 v[22:23], v3 offset:6144
    s_lshr_b32 s42, s61, 7
    s_lshl_b32 s43, s38, 1
    s_sub_u32 s42, s43, s42
    s_and_b32 s42, s42, 7
    s_mul_i32 s42, s42, 73728
    s_add_u32 s42, s42, s57
    buffer_load_dwordx4 v[12:15], v53, s[68:71], s42 offen sc1
    s_waitcnt lgkmcnt(4)
    v_mfma_f32_16x16x32_bf16 v[40:43], v[28:31], v[72:75], v[40:43]
    ds_read_b64_tr_b16 v[24:25], v3 offset:8192
    v_mfma_f32_16x16x32_bf16 v[44:47], v[28:31], v[76:79], v[44:47]
    ds_read_b64_tr_b16 v[26:27], v3 offset:10240
    s_waitcnt lgkmcnt(4)
    v_mfma_f32_16x16x32_bf16 v[32:35], v[16:19], v[92:95], 0
    ds_read_b64_tr_b16 v[28:29], v3 offset:12288
    v_mfma_f32_16x16x32_bf16 v[36:39], v[16:19], v[96:99], 0
    ds_read_b64_tr_b16 v[30:31], v3 offset:14336
    s_waitcnt lgkmcnt(4)
    v_mfma_f32_16x16x32_bf16 v[32:35], v[20:23], v[100:103], v[32:35]
    ds_read_b64_tr_b16 v[16:17], v3 offset:16384
    v_mfma_f32_16x16x32_bf16 v[36:39], v[20:23], v[104:107], v[36:39]
    ds_read_b64_tr_b16 v[18:19], v3 offset:18432
    s_waitcnt lgkmcnt(4)
    s_nop 0
    v_mfma_f32_16x16x32_bf16 v[32:35], v[24:27], v[108:111], v[32:35]
    ds_read_b64_tr_b16 v[20:21], v3 offset:20480
    v_cvt_pk_bf16_f32 v88, v40, v41
    v_mfma_f32_16x16x32_bf16 v[36:39], v[24:27], v[112:115], v[36:39]
    ds_read_b64_tr_b16 v[22:23], v3 offset:22528
    v_cvt_pk_bf16_f32 v89, v42, v43
    v_cvt_pk_bf16_f32 v90, v44, v45
    v_cvt_pk_bf16_f32 v91, v46, v47
    s_lshl_b32 s42, s65, 6
    s_mul_i32 s43, s38, 73728
    s_add_u32 s44, s42, s43
    buffer_store_dwordx4 v[88:91], v53, s[68:71], s44 offen sc1
    s_barrier
    s_waitcnt lgkmcnt(4)
    v_mfma_f32_16x16x32_bf16 v[32:35], v[28:31], v[116:119], v[32:35]
    ds_read_b64_tr_b16 v[24:25], v4 offset:0
    v_mfma_f32_16x16x32_bf16 v[36:39], v[28:31], v[120:123], v[36:39]
    ds_read_b64_tr_b16 v[26:27], v4 offset:2048
    s_waitcnt lgkmcnt(4)
    v_mfma_f32_16x16x32_bf16 v[32:35], v[16:19], v[124:127], v[32:35]
    ds_read_b64_tr_b16 v[28:29], v4 offset:4096
    v_mfma_f32_16x16x32_bf16 v[36:39], v[16:19], v[128:131], v[36:39]
    ds_read_b64_tr_b16 v[30:31], v4 offset:6144
    s_waitcnt lgkmcnt(4)
    v_mfma_f32_16x16x32_bf16 v[32:35], v[20:23], v[132:135], v[32:35]
    ds_read_b64_tr_b16 v[16:17], v4 offset:8192
    v_mfma_f32_16x16x32_bf16 v[36:39], v[20:23], v[136:139], v[36:39]
    ds_read_b64_tr_b16 v[18:19], v4 offset:10240
    s_waitcnt lgkmcnt(4)
    v_mfma_f32_16x16x32_bf16 v[32:35], v[24:27], v[140:143], v[32:35]
    ds_read_b64_tr_b16 v[20:21], v4 offset:12288
    v_and_b32 v104, 15, v1
    v_mul_u32_u24 v104, 1152, v104
    v_lshrrev_b32_e64 v105, 4, v1
    v_lshl_add_u32 v104, v105, 3, v104
    s_lshl_b32 s42, s39, 1
    s_add_u32 s42, s42, 1
    s_mul_i32 s42, s42, 36864
    s_lshl_b32 s43, s41, 5
    s_add_u32 s42, s42, s43
    v_add_u32 v104, s42, v104
    v_add_u32 v105, s66, v104
    v_add_u32 v106, 18432, v105
    v_and_b32 v116, 15, v1
    v_lshlrev_b32 v116, 7, v116
    v_lshrrev_b32_e64 v117, 4, v1
    v_lshl_add_u32 v116, v117, 3, v116
    s_add_u32 s43, s43, 159744
    v_add_u32_e64 v116, s43, v116
    ds_read_b64 v[100:101], v116 offset:0
    ds_read_b64 v[102:103], v116 offset:2048
    v_mfma_f32_16x16x32_bf16 v[36:39], v[24:27], v[144:147], v[36:39]
    ds_read_b64_tr_b16 v[22:23], v4 offset:14336
    s_lshr_b32 s42, s62, 7
    s_lshl_b32 s43, s38, 1
    s_sub_u32 s42, s43, s42
    s_and_b32 s42, s42, 7
    s_mul_i32 s42, s42, 73728
    s_add_u32 s42, s42, s57
    buffer_load_dwordx4 v[120:123], v53, s[68:71], s42 offen sc1
    s_waitcnt lgkmcnt(6)
    v_mfma_f32_16x16x32_bf16 v[32:35], v[28:31], v[148:151], v[32:35]
    ds_read_b64_tr_b16 v[24:25], v4 offset:16384
    s_lshr_b32 s42, s63, 7
    s_lshl_b32 s43, s38, 1
    s_sub_u32 s42, s43, s42
    s_and_b32 s42, s42, 7
    s_mul_i32 s42, s42, 73728
    s_add_u32 s42, s42, s57
    buffer_load_dwordx4 v[124:127], v53, s[68:71], s42 offen sc1
    v_mfma_f32_16x16x32_bf16 v[36:39], v[28:31], v[152:155], v[36:39]
    ds_read_b64_tr_b16 v[26:27], v4 offset:18432
    s_lshr_b32 s42, s64, 7
    s_lshl_b32 s43, s38, 1
    s_sub_u32 s42, s43, s42
    s_and_b32 s42, s42, 7
    s_mul_i32 s42, s42, 73728
    s_add_u32 s42, s42, s57
    buffer_load_dwordx4 v[128:131], v53, s[68:71], s42 offen sc1
    s_waitcnt lgkmcnt(6)
    v_mfma_f32_16x16x32_bf16 v[32:35], v[16:19], v[156:159], v[32:35]
    ds_read_b64_tr_b16 v[28:29], v4 offset:20480
    v_mfma_f32_16x16x32_bf16 v[36:39], v[16:19], v[160:163], v[36:39]
    ds_read_b64_tr_b16 v[30:31], v4 offset:22528
    s_barrier
    s_waitcnt lgkmcnt(4)
    v_mfma_f32_16x16x32_bf16 v[32:35], v[20:23], v[164:167], v[32:35]
    ds_read_b64_tr_b16 v[16:17], v3 offset:24576
    v_mfma_f32_16x16x32_bf16 v[36:39], v[20:23], v[168:171], v[36:39]
    ds_read_b64_tr_b16 v[18:19], v3 offset:26624
    s_waitcnt lgkmcnt(4)
    v_mfma_f32_16x16x32_bf16 v[32:35], v[24:27], v[172:175], v[32:35]
    ds_read_b64_tr_b16 v[20:21], v3 offset:28672
    v_mfma_f32_16x16x32_bf16 v[36:39], v[24:27], v[176:179], v[36:39]
    ds_read_b64_tr_b16 v[22:23], v3 offset:30720
    s_waitcnt lgkmcnt(4)
    v_mfma_f32_16x16x32_bf16 v[32:35], v[28:31], v[180:183], v[32:35]
    ds_read_b64_tr_b16 v[24:25], v3 offset:32768
    v_mfma_f32_16x16x32_bf16 v[36:39], v[28:31], v[184:187], v[36:39]
    ds_read_b64_tr_b16 v[26:27], v3 offset:34816
    s_waitcnt lgkmcnt(4)
    v_mfma_f32_16x16x32_bf16 v[32:35], v[16:19], v[188:191], v[32:35]
    ds_read_b64_tr_b16 v[28:29], v3 offset:36864
    s_cmp_lg_u32 s40, s38
    s_cbranch_scc1 LS_ns1
    v_add_u32 v116, 1024, v104
    v_add_u32 v117, 18432, v116
    global_load_dwordx2 v[168:169], v116, s[4:5]
    global_load_dwordx2 v[170:171], v117, s[4:5]
    s_mov_b32 s100, 65536
    s_lshr_b32 s42, s59, 7
    s_lshl_b32 s43, s38, 1
    s_sub_u32 s42, s43, s42
    s_and_b32 s42, s42, 7
    s_mul_i32 s42, s42, 73728
    s_add_u32 s42, s42, s100
    buffer_load_dwordx4 v[140:143], v53, s[68:71], s42 offen sc1
    s_lshr_b32 s42, s60, 7
    s_lshl_b32 s43, s38, 1
    s_sub_u32 s42, s43, s42
    s_and_b32 s42, s42, 7
    s_mul_i32 s42, s42, 73728
    s_add_u32 s42, s42, s100
    buffer_load_dwordx4 v[144:147], v53, s[68:71], s42 offen sc1
    s_lshr_b32 s42, s61, 7
    s_lshl_b32 s43, s38, 1
    s_sub_u32 s42, s43, s42
    s_and_b32 s42, s42, 7
    s_mul_i32 s42, s42, 73728
    s_add_u32 s42, s42, s100
    buffer_load_dwordx4 v[148:151], v53, s[68:71], s42 offen sc1
    s_lshr_b32 s42, s62, 7
    s_lshl_b32 s43, s38, 1
    s_sub_u32 s42, s43, s42
    s_and_b32 s42, s42, 7
    s_mul_i32 s42, s42, 73728
    s_add_u32 s42, s42, s100
    buffer_load_dwordx4 v[152:155], v53, s[68:71], s42 offen sc1
    s_lshr_b32 s42, s63, 7
    s_lshl_b32 s43, s38, 1
    s_sub_u32 s42, s43, s42
    s_and_b32 s42, s42, 7
    s_mul_i32 s42, s42, 73728
    s_add_u32 s42, s42, s100
    buffer_load_dwordx4 v[156:159], v53, s[68:71], s42 offen sc1
    s_lshr_b32 s42, s64, 7
    s_lshl_b32 s43, s38, 1
    s_sub_u32 s42, s43, s42
    s_and_b32 s42, s42, 7
    s_mul_i32 s42, s42, 73728
    s_add_u32 s42, s42, s100
    buffer_load_dwordx4 v[160:163], v53, s[68:71], s42 offen sc1
    s_lshr_b32 s42, s65, 7
    s_lshl_b32 s43, s38, 1
    s_sub_u32 s42, s43, s42
    s_and_b32 s42, s42, 7
    s_mul_i32 s42, s42, 73728
    s_add_u32 s42, s42, s100
    buffer_load_dwordx4 v[164:167], v53, s[68:71], s42 offen sc1
LS_ns1:
    v_mfma_f32_16x16x32_bf16 v[36:39], v[16:19], v[192:195], v[36:39]
    ds_read_b64_tr_b16 v[30:31], v3 offset:38912
    s_waitcnt lgkmcnt(4)
    v_mfma_f32_16x16x32_bf16 v[32:35], v[20:23], v[196:199], v[32:35]
    ds_read_b64_tr_b16 v[16:17], v3 offset:40960
    v_mfma_f32_16x16x32_bf16 v[36:39], v[20:23], v[200:203], v[36:39]
    ds_read_b64_tr_b16 v[18:19], v3 offset:43008
    s_waitcnt lgkmcnt(4)
    v_mfma_f32_16x16x32_bf16 v[32:35], v[24:27], v[204:207], v[32:35]
    ds_read_b64_tr_b16 v[20:21], v3 offset:45056
    v_mfma_f32_16x16x32_bf16 v[36:39], v[24:27], v[208:211], v[36:39]
    ds_read_b64_tr_b16 v[22:23], v3 offset:47104
    s_waitcnt lgkmcnt(4)
    v_mfma_f32_16x16x32_bf16 v[32:35], v[28:31], v[212:215], v[32:35]
    ds_read_b64_tr_b16 v[24:25], v4 offset:24576
    v_mfma_f32_16x16x32_bf16 v[36:39], v[28:31], v[216:219], v[36:39]
    ds_read_b64_tr_b16 v[26:27], v5 offset:27136
    s_waitcnt lgkmcnt(4)
    v_mfma_f32_16x16x32_bf16 v[32:35], v[16:19], v[220:223], v[32:35]
    ds_read_b64_tr_b16 v[28:29], v5 offset:29184
    s_lshr_b32 s42, s65, 7
    s_lshl_b32 s43, s38, 1
    s_sub_u32 s42, s43, s42
    s_and_b32 s42, s42, 7
    s_mul_i32 s42, s42, 73728
    s_add_u32 s42, s42, s57
    buffer_load_dwordx4 v[132:135], v53, s[68:71], s42 offen sc1
    v_mfma_f32_16x16x32_bf16 v[36:39], v[16:19], v[224:227], v[36:39]
    ds_read_b64_tr_b16 v[30:31], v4 offset:31744
    s_waitcnt lgkmcnt(4)
    v_mfma_f32_16x16x32_bf16 v[32:35], v[20:23], v[228:231], v[32:35]
    ds_read_b64_tr_b16 v[16:17], v6 offset:24576
    v_mfma_f32_16x16x32_bf16 v[36:39], v[20:23], v[232:235], v[36:39]
    s_waitcnt lgkmcnt(3)
    v_mfma_f32_16x16x32_bf16 v[32:35], v[24:27], v[56:59], v[32:35]
    v_mfma_f32_16x16x32_bf16 v[36:39], v[24:27], v[60:63], v[36:39]
    s_waitcnt lgkmcnt(1)
    v_mfma_f32_16x16x32_bf16 v[32:35], v[28:31], v[64:67], v[32:35]
    v_mfma_f32_16x16x32_bf16 v[36:39], v[28:31], v[68:71], v[36:39]
    s_waitcnt lgkmcnt(0)
    v_mfma_f32_16x16x32_bf16 v[32:35], v[16:19], v[72:75], v[32:35]
    v_mfma_f32_16x16x32_bf16 v[36:39], v[16:19], v[76:79], v[36:39]
    s_waitcnt vmcnt(5)
    s_nop 0
    v_dot2_f32_bf16 v240, v12, s94, v240
    v_dot2_f32_bf16 v241, v12, s95, v241
    v_dot2_f32_bf16 v242, v13, s94, v242
    v_dot2_f32_bf16 v243, v13, s95, v243
    v_dot2_f32_bf16 v244, v14, s94, v244
    v_dot2_f32_bf16 v245, v14, s95, v245
    v_dot2_f32_bf16 v246, v15, s94, v246
    v_dot2_f32_bf16 v247, v15, s95, v247
    v_dot2_f32_bf16 v240, v100, s94, v240
    v_dot2_f32_bf16 v241, v100, s95, v241
    v_dot2_f32_bf16 v242, v101, s94, v242
    v_dot2_f32_bf16 v243, v101, s95, v243
    v_dot2_f32_bf16 v244, v102, s94, v244
    v_dot2_f32_bf16 v245, v102, s95, v245
    v_dot2_f32_bf16 v246, v103, s94, v246
    v_dot2_f32_bf16 v247, v103, s95, v247
    s_movk_i32 s86, 4000
LS_c1a:
    s_waitcnt vmcnt(0)
LS_c1c:
    v_max3_u32 v239, v120, v121, v122
    v_max3_u32 v239, v123, v124, v239
    v_max3_u32 v239, v125, v126, v239
    v_max3_u32 v239, v127, v128, v239
    v_max3_u32 v239, v129, v130, v239
    v_max3_u32 v239, v131, v132, v239
    v_max3_u32 v239, v133, v134, v239
    v_max_u32 v239, v135, v239
    v_cmp_eq_u32 vcc, -1, v239
    s_nop 4
    s_cbranch_vccz LS_c1b
    s_lshr_b32 s42, s62, 7
    s_lshl_b32 s43, s38, 1
    s_sub_u32 s42, s43, s42
    s_and_b32 s42, s42, 7
    s_mul_i32 s42, s42, 73728
    s_add_u32 s42, s42, s57
    buffer_load_dwordx4 v[120:123], v53, s[68:71], s42 offen sc1
    s_lshr_b32 s42, s63, 7
    s_lshl_b32 s43, s38, 1
    s_sub_u32 s42, s43, s42
    s_and_b32 s42, s42, 7
    s_mul_i32 s42, s42, 73728
    s_add_u32 s42, s42, s57
    buffer_load_dwordx4 v[124:127], v53, s[68:71], s42 offen sc1
    s_lshr_b32 s42, s64, 7
    s_lshl_b32 s43, s38, 1
    s_sub_u32 s42, s43, s42
    s_and_b32 s42, s42, 7
    s_mul_i32 s42, s42, 73728
    s_add_u32 s42, s42, s57
    buffer_load_dwordx4 v[128:131], v53, s[68:71], s42 offen sc1
    s_lshr_b32 s42, s65, 7
    s_lshl_b32 s43, s38, 1
    s_sub_u32 s42, s43, s42
    s_and_b32 s42, s42, 7
    s_mul_i32 s42, s42, 73728
    s_add_u32 s42, s42, s57
    buffer_load_dwordx4 v[132:135], v53, s[68:71], s42 offen sc1
    s_sub_u32 s86, s86, 1
    s_cbranch_scc0 LS_c1a
    s_waitcnt vmcnt(0)
LS_c1b:
    s_nop 0
    v_dot2_f32_bf16 v240, v120, s94, v240
    v_dot2_f32_bf16 v241, v120, s95, v241
    v_dot2_f32_bf16 v242, v121, s94, v242
    v_dot2_f32_bf16 v243, v121, s95, v243
    v_dot2_f32_bf16 v244, v122, s94, v244
    v_dot2_f32_bf16 v245, v122, s95, v245
    v_dot2_f32_bf16 v246, v123, s94, v246
    v_dot2_f32_bf16 v247, v123, s95, v247
    v_dot2_f32_bf16 v240, v124, s94, v240
    v_dot2_f32_bf16 v241, v124, s95, v241
    v_dot2_f32_bf16 v242, v125, s94, v242
    v_dot2_f32_bf16 v243, v125, s95, v243
    v_dot2_f32_bf16 v244, v126, s94, v244
    v_dot2_f32_bf16 v245, v126, s95, v245
    v_dot2_f32_bf16 v246, v127, s94, v246
    v_dot2_f32_bf16 v247, v127, s95, v247
    v_dot2_f32_bf16 v240, v128, s94, v240
    v_dot2_f32_bf16 v241, v128, s95, v241
    v_dot2_f32_bf16 v242, v129, s94, v242
    v_dot2_f32_bf16 v243, v129, s95, v243
    v_dot2_f32_bf16 v244, v130, s94, v244
    v_dot2_f32_bf16 v245, v130, s95, v245
    v_dot2_f32_bf16 v246, v131, s94, v246
    v_dot2_f32_bf16 v247, v131, s95, v247
    v_dot2_f32_bf16 v240, v132, s94, v240
    v_dot2_f32_bf16 v241, v132, s95, v241
    v_dot2_f32_bf16 v242, v133, s94, v242
    v_dot2_f32_bf16 v243, v133, s95, v243
    v_dot2_f32_bf16 v244, v134, s94, v244
    v_dot2_f32_bf16 v245, v134, s95, v245
    v_dot2_f32_bf16 v246, v135, s94, v246
    v_dot2_f32_bf16 v247, v135, s95, v247
    s_nop 2
    s_nop 0
    v_pk_add_f32 v[32:33], v[32:33], v[240:241]
    v_pk_add_f32 v[34:35], v[34:35], v[242:243]
    v_pk_add_f32 v[36:37], v[36:37], v[244:245]
    v_pk_add_f32 v[38:39], v[38:39], v[246:247]
    s_nop 2
    s_nop 0
    v_cvt_pk_bf16_f32 v32, v32, v33
    v_cvt_pk_bf16_f32 v33, v34, v35
    global_store_dwordx2 v105, v[32:33], s[32:33]
    v_cvt_pk_bf16_f32 v36, v36, v37
    v_cvt_pk_bf16_f32 v37, v38, v39
    global_store_dwordx2 v106, v[36:37], s[32:33]
    s_cmp_lg_u32 s40, s38
    s_cbranch_scc1 LS_end
    s_waitcnt vmcnt(2)
    s_nop 0
    v_dot2_f32_bf16 v80, v140, s94, v80
    v_dot2_f32_bf16 v81, v140, s95, v81
    v_dot2_f32_bf16 v82, v141, s94, v82
    v_dot2_f32_bf16 v83, v141, s95, v83
    v_dot2_f32_bf16 v84, v142, s94, v84
    v_dot2_f32_bf16 v85, v142, s95, v85
    v_dot2_f32_bf16 v86, v143, s94, v86
    v_dot2_f32_bf16 v87, v143, s95, v87
    v_dot2_f32_bf16 v80, v144, s94, v80
    v_dot2_f32_bf16 v81, v144, s95, v81
    v_dot2_f32_bf16 v82, v145, s94, v82
    v_dot2_f32_bf16 v83, v145, s95, v83
    v_dot2_f32_bf16 v84, v146, s94, v84
    v_dot2_f32_bf16 v85, v146, s95, v85
    v_dot2_f32_bf16 v86, v147, s94, v86
    v_dot2_f32_bf16 v87, v147, s95, v87
    v_dot2_f32_bf16 v80, v148, s94, v80
    v_dot2_f32_bf16 v81, v148, s95, v81
    v_dot2_f32_bf16 v82, v149, s94, v82
    v_dot2_f32_bf16 v83, v149, s95, v83
    v_dot2_f32_bf16 v84, v150, s94, v84
    v_dot2_f32_bf16 v85, v150, s95, v85
    v_dot2_f32_bf16 v86, v151, s94, v86
    v_dot2_f32_bf16 v87, v151, s95, v87
    v_dot2_f32_bf16 v80, v152, s94, v80
    v_dot2_f32_bf16 v81, v152, s95, v81
    v_dot2_f32_bf16 v82, v153, s94, v82
    v_dot2_f32_bf16 v83, v153, s95, v83
    v_dot2_f32_bf16 v84, v154, s94, v84
    v_dot2_f32_bf16 v85, v154, s95, v85
    v_dot2_f32_bf16 v86, v155, s94, v86
    v_dot2_f32_bf16 v87, v155, s95, v87
    v_dot2_f32_bf16 v80, v156, s94, v80
    v_dot2_f32_bf16 v81, v156, s95, v81
    v_dot2_f32_bf16 v82, v157, s94, v82
    v_dot2_f32_bf16 v83, v157, s95, v83
    v_dot2_f32_bf16 v84, v158, s94, v84
    v_dot2_f32_bf16 v85, v158, s95, v85
    v_dot2_f32_bf16 v86, v159, s94, v86
    v_dot2_f32_bf16 v87, v159, s95, v87
    v_dot2_f32_bf16 v80, v160, s94, v80
    v_dot2_f32_bf16 v81, v160, s95, v81
    v_dot2_f32_bf16 v82, v161, s94, v82
    v_dot2_f32_bf16 v83, v161, s95, v83
    v_dot2_f32_bf16 v84, v162, s94, v84
    v_dot2_f32_bf16 v85, v162, s95, v85
    v_dot2_f32_bf16 v86, v163, s94, v86
    v_dot2_f32_bf16 v87, v163, s95, v87
    v_dot2_f32_bf16 v80, v164, s94, v80
    v_dot2_f32_bf16 v81, v164, s95, v81
    v_dot2_f32_bf16 v82, v165, s94, v82
    v_dot2_f32_bf16 v83, v165, s95, v83
    v_dot2_f32_bf16 v84, v166, s94, v84
    v_dot2_f32_bf16 v85, v166, s95, v85
    v_dot2_f32_bf16 v86, v167, s94, v86
    v_dot2_f32_bf16 v87, v167, s95, v87
    v_dot2_f32_bf16 v80, v168, s94, v80
    v_dot2_f32_bf16 v81, v168, s95, v81
    v_dot2_f32_bf16 v82, v169, s94, v82
    v_dot2_f32_bf16 v83, v169, s95, v83
    v_dot2_f32_bf16 v84, v170, s94, v84
    v_dot2_f32_bf16 v85, v170, s95, v85
    v_dot2_f32_bf16 v86, v171, s94, v86
    v_dot2_f32_bf16 v87, v171, s95, v87
    s_nop 2
    s_nop 0
    v_cvt_pk_bf16_f32 v80, v80, v81
    v_cvt_pk_bf16_f32 v81, v82, v83
    global_store_dwordx2 v116, v[80:81], s[32:33]
    v_cvt_pk_bf16_f32 v84, v84, v85
    v_cvt_pk_bf16_f32 v85, v86, v87
    global_store_dwordx2 v117, v[84:85], s[32:33]
LS_end:
    s_endpgm
LS_sm:
    s_nop 0
    ds_read_b64 v[16:17], v12 offset:41472
    ds_read_b32 v18, v13 offset:41472
    ds_read_b64 v[20:21], v12 offset:41984
    ds_read_b32 v22, v13 offset:41600
    ds_read_b64 v[24:25], v12 offset:36864
    ds_read_b32 v26, v13 offset:36864
    ds_read_b64 v[28:29], v12 offset:37376
    ds_read_b32 v30, v13 offset:36992
    ds_read_b64 v[92:93], v12 offset:32256
    ds_read_b32 v94, v13 offset:32256
    ds_read_b64 v[96:97], v12 offset:32768
    ds_read_b32 v98, v13 offset:32384
    v_cvt_pk_bf16_f32 v88, v32, v33
    v_cvt_pk_bf16_f32 v89, v34, v35
    v_cvt_pk_bf16_f32 v90, v36, v37
    v_cvt_pk_bf16_f32 v91, v38, v39
    v_pk_max_i16 v88, v88, 0
    v_pk_max_i16 v89, v89, 0
    v_pk_max_i16 v90, v90, 0
    v_pk_max_i16 v91, v91, 0
    ds_read_b64 v[100:101], v12 offset:27648
    ds_read_b32 v102, v13 offset:27648
    s_waitcnt lgkmcnt(12)
    v_mfma_f32_16x16x32_bf16 v[220:223], v[16:19], v[48:51], v[40:43]
    v_mfma_f32_16x16x32_bf16 v[228:231], v[16:19], v[52:55], 0
    ds_read_b64 v[104:105], v12 offset:28160
    ds_read_b32 v106, v13 offset:27776
    s_waitcnt lgkmcnt(12)
    v_mfma_f32_16x16x32_bf16 v[232:235], v[20:23], v[52:55], v[40:43]
    s_cmp_ge_u32 s57, 1
    s_cselect_b32 s42, 0, s81
    v_mov_b32 v244, s42
    v_mov_b32 v245, s42
    v_mov_b32 v246, s42
    v_mov_b32_e64 v247, s42
    s_nop 1
    ds_read_b64 v[108:109], v12 offset:23040
    ds_read_b32 v110, v13 offset:23040
    s_waitcnt lgkmcnt(12)
    v_mfma_f32_16x16x32_bf16 v[204:207], v[24:27], v[48:51], v[244:247]
    v_mfma_f32_16x16x32_bf16 v[212:215], v[24:27], v[52:55], v[244:247]
    ds_read_b64 v[112:113], v12 offset:23552
    ds_read_b32 v114, v13 offset:23168
    s_waitcnt lgkmcnt(12)
    v_mfma_f32_16x16x32_bf16 v[208:211], v[28:31], v[48:51], v[244:247]
    v_mfma_f32_16x16x32_bf16 v[216:219], v[28:31], v[52:55], v[244:247]
    s_cmp_ge_u32 s57, 2
    s_cselect_b32 s42, 0, s81
    v_mov_b32 v240, s42
    v_mov_b32 v241, s42
    v_mov_b32 v242, s42
    v_mov_b32_e64 v243, s42
    s_nop 1
    ds_read_b64 v[116:117], v12 offset:18432
    ds_read_b32 v118, v13 offset:18432
    s_waitcnt lgkmcnt(12)
    v_mfma_f32_16x16x32_bf16 v[188:191], v[92:95], v[48:51], v[240:243]
    v_max_f32 v248, v220, v221
    v_max_f32_e64 v249, v222, v223
    v_mfma_f32_16x16x32_bf16 v[196:199], v[92:95], v[52:55], v[240:243]
    v_max_f32 v250, v228, v229
    v_max_f32 v251, v230, v231
    ds_read_b64 v[120:121], v12 offset:18944
    ds_read_b32 v122, v13 offset:18560
    s_waitcnt lgkmcnt(12)
    v_mfma_f32_16x16x32_bf16 v[192:195], v[96:99], v[48:51], v[240:243]
    v_max3_f32 v250, v232, v233, v250
    v_max3_f32 v251, v234, v235, v251
    v_mfma_f32_16x16x32_bf16 v[200:203], v[96:99], v[52:55], v[240:243]
    s_cmp_ge_u32 s57, 3
    s_cselect_b32 s42, 0, s81
    v_mov_b32 v244, s42
    v_mov_b32 v245, s42
    v_mov_b32 v246, s42
    v_mov_b32 v247, s42
    s_nop 1
    ds_read_b64 v[16:17], v12 offset:13824
    ds_read_b32 v18, v13 offset:13824
    s_waitcnt lgkmcnt(12)
    s_nop 0
    v_mfma_f32_16x16x32_bf16 v[172:175], v[100:103], v[48:51], v[244:247]
    v_max3_f32 v248, v204, v205, v248
    v_max3_f32 v249, v206, v207, v249
    v_mfma_f32_16x16x32_bf16 v[180:183], v[100:103], v[52:55], v[244:247]
    v_max3_f32 v250, v212, v213, v250
    v_max3_f32 v251, v214, v215, v251
    ds_read_b64 v[20:21], v12 offset:14336
    ds_read_b32 v22, v13 offset:13952
    s_waitcnt lgkmcnt(12)
    s_nop 0
    v_mfma_f32_16x16x32_bf16 v[176:179], v[104:107], v[48:51], v[244:247]
    v_max3_f32 v248, v208, v209, v248
    v_max3_f32 v249, v210, v211, v249
    v_mfma_f32_16x16x32_bf16 v[184:187], v[104:107], v[52:55], v[244:247]
    v_max3_f32 v250, v216, v217, v250
    v_max3_f32 v251, v218, v219, v251
    s_cmp_ge_u32 s57, 4
    s_cselect_b32 s42, 0, s81
    v_mov_b32 v240, s42
    v_mov_b32 v241, s42
    v_mov_b32 v242, s42
    v_mov_b32_e64 v243, s42
    s_nop 1
    ds_read_b64 v[24:25], v12 offset:9216
    ds_read_b32 v26, v13 offset:9216
    s_waitcnt lgkmcnt(12)
    s_nop 0
    v_mfma_f32_16x16x32_bf16 v[156:159], v[108:111], v[48:51], v[240:243]
    v_max3_f32 v248, v188, v189, v248
    v_max3_f32 v249, v190, v191, v249
    v_mfma_f32_16x16x32_bf16 v[164:167], v[108:111], v[52:55], v[240:243]
    v_max3_f32 v250, v196, v197, v250
    v_max3_f32 v251, v198, v199, v251
    ds_read_b64 v[28:29], v12 offset:9728
    ds_read_b32 v30, v13 offset:9344
    s_waitcnt lgkmcnt(12)
    s_nop 0
    v_mfma_f32_16x16x32_bf16 v[160:163], v[112:115], v[48:51], v[240:243]
    v_max3_f32 v248, v192, v193, v248
    v_max3_f32 v249, v194, v195, v249
    v_mfma_f32_16x16x32_bf16 v[168:171], v[112:115], v[52:55], v[240:243]
    v_max3_f32 v250, v200, v201, v250
    v_max3_f32 v251, v202, v203, v251
    s_cmp_ge_u32 s57, 5
    s_cselect_b32 s42, 0, s81
    v_mov_b32 v244, s42
    v_mov_b32 v245, s42
    v_mov_b32 v246, s42
    v_mov_b32 v247, s42
    s_nop 1
    s_waitcnt lgkmcnt(10)
    v_mfma_f32_16x16x32_bf16 v[140:143], v[116:119], v[48:51], v[244:247]
    v_max3_f32 v248, v172, v173, v248
    v_max3_f32 v249, v174, v175, v249
    v_mfma_f32_16x16x32_bf16 v[148:151], v[116:119], v[52:55], v[244:247]
    v_max3_f32 v250, v180, v181, v250
    v_max3_f32 v251, v182, v183, v251
    s_waitcnt lgkmcnt(8)
    s_nop 0
    v_mfma_f32_16x16x32_bf16 v[144:147], v[120:123], v[48:51], v[244:247]
    v_max3_f32 v248, v176, v177, v248
    v_max3_f32 v249, v178, v179, v249
    v_mfma_f32_16x16x32_bf16 v[152:155], v[120:123], v[52:55], v[244:247]
    v_max3_f32 v250, v184, v185, v250
    v_max3_f32 v251, v186, v187, v251
    s_cmp_ge_u32 s57, 6
    s_cselect_b32 s42, 0, s81
    v_mov_b32 v240, s42
    v_mov_b32 v241, s42
    v_mov_b32 v242, s42
    v_mov_b32 v243, s42
    s_nop 1
    s_waitcnt lgkmcnt(6)
    v_mfma_f32_16x16x32_bf16 v[124:127], v[16:19], v[48:51], v[240:243]
    v_max3_f32 v248, v156, v157, v248
    v_max3_f32 v249, v158, v159, v249
    v_mfma_f32_16x16x32_bf16 v[132:135], v[16:19], v[52:55], v[240:243]
    v_max3_f32 v250, v164, v165, v250
    v_max3_f32 v251, v166, v167, v251
    ds_read_b64 v[16:17], v12 offset:4608
    ds_read_b32 v18, v13 offset:4608
    s_waitcnt lgkmcnt(6)
    s_nop 0
    v_mfma_f32_16x16x32_bf16 v[128:131], v[20:23], v[48:51], v[240:243]
    v_max3_f32 v248, v160, v161, v248
    v_max3_f32 v249, v162, v163, v249
    v_mfma_f32_16x16x32_bf16 v[136:139], v[20:23], v[52:55], v[240:243]
    v_max3_f32 v250, v168, v169, v250
    v_max3_f32 v251, v170, v171, v251
    s_cmp_ge_u32 s57, 7
    s_cselect_b32 s42, 0, s81
    v_mov_b32 v244, s42
    v_mov_b32 v245, s42
    v_mov_b32 v246, s42
    v_mov_b32_e64 v247, s42
    s_nop 1
    ds_read_b64 v[20:21], v12 offset:5120
    ds_read_b32 v22, v13 offset:4736
    s_waitcnt lgkmcnt(6)
    s_nop 0
    v_mfma_f32_16x16x32_bf16 v[108:111], v[24:27], v[48:51], v[244:247]
    v_max3_f32 v248, v140, v141, v248
    v_max3_f32 v249, v142, v143, v249
    v_mfma_f32_16x16x32_bf16 v[116:119], v[24:27], v[52:55], v[244:247]
    v_max3_f32 v250, v148, v149, v250
    v_max3_f32 v251, v150, v151, v251
    s_waitcnt lgkmcnt(4)
    s_nop 0
    v_mfma_f32_16x16x32_bf16 v[112:115], v[28:31], v[48:51], v[244:247]
    v_max3_f32 v248, v144, v145, v248
    v_max3_f32 v249, v146, v147, v249
    v_mfma_f32_16x16x32_bf16 v[120:123], v[28:31], v[52:55], v[244:247]
    v_max3_f32 v250, v152, v153, v250
    v_max3_f32 v251, v154, v155, v251
    s_cmp_ge_u32 s57, 8
    s_cselect_b32 s42, 0, s81
    v_mov_b32 v240, s42
    v_mov_b32 v241, s42
    v_mov_b32 v242, s42
    v_mov_b32 v243, s42
    s_nop 1
    s_waitcnt lgkmcnt(2)
    v_mfma_f32_16x16x32_bf16 v[92:95], v[16:19], v[48:51], v[44:47]
    v_max3_f32 v248, v124, v125, v248
    v_max3_f32 v249, v126, v127, v249
    s_waitcnt lgkmcnt(0)
    s_nop 0
    v_mfma_f32_16x16x32_bf16 v[96:99], v[20:23], v[48:51], v[240:243]
    v_max3_f32 v250, v132, v133, v250
    v_max3_f32 v251, v134, v135, v251
    v_mfma_f32_16x16x32_bf16 v[104:107], v[20:23], v[52:55], v[44:47]
    v_max3_f32 v248, v128, v129, v248
    v_max3_f32 v249, v130, v131, v249
    v_max3_f32 v250, v136, v137, v250
    v_max3_f32 v251, v138, v139, v251
    v_max3_f32 v248, v108, v109, v248
    v_max3_f32 v249, v110, v111, v249
    v_max3_f32 v250, v116, v117, v250
    v_max3_f32 v251, v118, v119, v251
    v_max3_f32 v248, v112, v113, v248
    v_max3_f32 v249, v114, v115, v249
    v_max3_f32 v250, v120, v121, v250
    v_max3_f32 v251, v122, v123, v251
    v_mov_b32 v20, 0x3f803f80
    v_mov_b32 v28, 0x3f803f80
    v_mov_b32 v21, 0x3f803f80
    v_mov_b32 v29, 0x3f803f80
    v_mov_b32 v22, 0x3f803f80
    v_mov_b32 v30, 0x3f803f80
    v_mov_b32 v23, 0x3f803f80
    v_mov_b32 v31, 0x3f803f80
    v_max3_f32 v248, v92, v93, v248
    v_max3_f32 v249, v94, v95, v249
    v_max3_f32 v248, v96, v97, v248
    v_max3_f32 v249, v98, v99, v249
    v_max3_f32 v250, v104, v105, v250
    v_max3_f32 v251, v106, v107, v251
    s_branch LS_sj
L_exit:
    s_endpgm
.section .rodata,"a"
.p2align 6
.amdhsa_kernel parallel_sum__sliding_block__dense_activation_relu__prompt_kernel
  .amdhsa_next_free_vgpr 256
  .amdhsa_next_free_sgpr 102
  .amdhsa_accum_offset 256
  .amdhsa_group_segment_fixed_size 0
  .amdhsa_kernarg_size 72
  .amdhsa_user_sgpr_count 2
  .amdhsa_user_sgpr_kernarg_segment_ptr 1
  .amdhsa_system_sgpr_workgroup_id_x 1
  .amdhsa_float_denorm_mode_32 3
.end_amdhsa_kernel
```
